```python
import torch

def _softmax(x, axis=-1):
    return torch.softmax(x, dim=axis)
def _gelu(x):
    return torch.nn.functional.gelu(x, approximate="tanh")
def _silu(x):
    return torch.nn.functional.silu(x)
def _sigmoid(x):
    return torch.sigmoid(x)
def _layernorm(x, axis=-1, eps=1e-5):
    m = x.mean(dim=axis, keepdim=True)
    v = x.var(dim=axis, keepdim=True, unbiased=False)
    return (x - m) / torch.sqrt(v + eps)
def _scatter_add(tgt, idx, src, axis=0):
    return tgt.clone().index_add_(axis, idx, src)
def _segment_sum(src, seg, n):
    out = torch.zeros((n,) + src.shape[1:], dtype=src.dtype)
    return out.index_add_(0, seg, src)
def _pad(x, pw):
    flat = tuple(v for pair in reversed(pw) for v in pair)
    return torch.nn.functional.pad(x, flat)

kernel_name = 'interleave_layers__sliding_block__glu_gated_bilinear__prompt'

def setup_inputs():

    _w = (lambda a: (lambda t: t.to(torch.bfloat16) if t.is_floating_point() else t)(torch.as_tensor(a)))
    def _A_setup():
        B, S, D = 1, 2048, 512
        return {
            "x": _w((lambda *s: torch.randn(*s, dtype=torch.bfloat16) * 0.05)(B, S, D)),
            "wqkv": _w((lambda *s: torch.randn(*s, dtype=torch.bfloat16) * 0.05)(D, 3 * D)),
            "wo": _w((lambda *s: torch.randn(*s, dtype=torch.bfloat16) * 0.05)(D, D)),
        }
    _A_in = _A_setup()

    def _B_setup():
        B, S, D, F = 1, 2048, 512, 1376
        return {
            "x": _w((lambda *s: torch.randn(*s, dtype=torch.bfloat16) * 0.05)(B, S, D)),
            "w_gate": _w((lambda *s: torch.randn(*s, dtype=torch.bfloat16) * 0.8)(D, F) * (D ** -0.5)),
            "w_up": _w((lambda *s: torch.randn(*s, dtype=torch.bfloat16) * 0.8)(D, F) * (D ** -0.5)),
            "w_down": _w((lambda *s: torch.randn(*s, dtype=torch.bfloat16) * 0.8)(F, D) * (F ** -0.5)),
        }
    _B_in = _B_setup()

    return {
        "A_x": _A_in["x"],
        "A_wqkv": _A_in["wqkv"],
        "A_wo": _A_in["wo"],
        "B_x": _B_in["x"],
        "B_w_gate": _B_in["w_gate"],
        "B_w_up": _B_in["w_up"],
        "B_w_down": _B_in["w_down"],
    }

def reference(A_x, A_wqkv, A_wo, B_x, B_w_gate, B_w_up, B_w_down):
    def _A_ref(x, wqkv, wo):
        B, S, D = x.shape
        H = 32; Dh = D // H; W = 256
        qkv = (lambda x, *d: x.permute(*d))((x @ wqkv).reshape(B, S, 3, H, Dh), 2, 0, 3, 1, 4)
        q, k, v = qkv[0], qkv[1], qkv[2]
        scores = torch.einsum("bhqd,bhkd->bhqk", q, k) * (Dh ** -0.5)
        idx = torch.arange(S)
        mask = (idx[:, None] - idx[None, :] >= 0) & (idx[:, None] - idx[None, :] < W)
        scores = torch.where(mask[None, None], scores, -1e9)
        p = _softmax(scores, axis=-1)
        o = torch.einsum("bhqk,bhkd->bhqd", p, v)
        return (lambda x, *d: x.permute(*d))(o, 0, 2, 1, 3).reshape(B, S, D) @ wo

    def _B_ref(x, w_gate, w_up, w_down):
        g = torch.einsum("bsd,df->bsf", x, w_gate)
        u = torch.einsum("bsd,df->bsf", x, w_up)
        h = g * u
        return torch.einsum("bsf,fd->bsd", h, w_down)

    x = A_x
    x = x + _A_ref(_layernorm(x, axis=-1), A_wqkv, A_wo)
    x = x + _B_ref(_layernorm(x, axis=-1), B_w_gate, B_w_up, B_w_down)
    x = x + _A_ref(_layernorm(x, axis=-1), A_wqkv, A_wo)
    x = x + _B_ref(_layernorm(x, axis=-1), B_w_gate, B_w_up, B_w_down)
    return x
```

```asm
; @launch grid=(256,1,1) block=(256,1,1) lds=163840
.amdgcn_target "amdgcn-amd-amdhsa--gfx950"
.text
.p2align 12
.globl interleave_layers__sliding_block__glu_gated_bilinear__prompt_kernel
.p2align 8
.type interleave_layers__sliding_block__glu_gated_bilinear__prompt_kernel,@function
interleave_layers__sliding_block__glu_gated_bilinear__prompt_kernel:
    s_getpc_b64 s[26:27]
M_pc:
    s_load_dwordx8 s[48:55], s[0:1], 0
    s_load_dwordx8 s[56:63], s[0:1], 32
    s_load_dwordx4 s[64:67], s[0:1], 64
    s_cmp_ge_u32 s2, 256
    s_cbranch_scc1 M_exit
    s_lshr_b32 s13, s2, 3
    v_lshrrev_b32 v41, 6, v0
    v_and_b32 v13, 63, v0
    v_lshrrev_b32 v40, 3, v0
    v_readfirstlane_b32 s14, v41
    v_lshlrev_b32 v40, 12, v40
    s_lshl_b32 s71, s13, 7
    v_add_u32 v40, s71, v40
    v_min_u32 v40, M_last - M_pc - 4, v40
    s_and_b32 s76, s2, 0xdf
    s_cmp_eq_u32 s76, 24
    s_cbranch_scc1 M_nopf
    global_load_dword v254, v40, s[26:27]
M_nopf:
    s_and_b32 s12, s2, 7
    s_lshr_b32 s68, s13, 2
    s_and_b32 s69, s13, 3
    s_mov_b32 s88, s2
    v_lshlrev_b32 v16, 4, v13
    v_lshrrev_b32 v44, 3, v13
    v_and_b32 v45, 0x70, v16
    s_add_u32 s71, s69, 1
    s_cmp_ge_u32 s69, 2
    s_cselect_b32 s71, 0, s71
    s_lshl3_add_u32 s71, s71, s68
    s_lshl_b32 s71, s71, 7
    s_lshl2_add_u32 s73, s12, s14
    s_mov_b32 s43, 0x20000
    s_lshl_b32 s75, s14, 11
    s_add_u32 m0, s75, 147456
    s_cmp_eq_u32 s69, 3
    s_cselect_b32 s74, 1, 3
    s_waitcnt lgkmcnt(0)
    s_cselect_b64 s[40:41], s[52:53], s[50:51]
    s_cmp_eq_u32 s76, 24
    s_cbranch_scc1 J_lead
J_nolead:
    s_lshl_b32 s42, s74, 19
    s_lshl_b32 s72, s74, 13
    s_lshl_b32 s74, s74, 10
    s_mul_i32 s73, s73, s72
    v_mad_u32_u24 v164, v44, s74, v45
    s_lshl1_add_u32 s71, s73, s71
    s_add_u32 s72, s72, s71
    s_sub_u32 s72, s72, 1024
    buffer_load_dwordx4 v164, s[40:43], s71 offen nt lds
    buffer_load_dwordx4 v164, s[40:43], s72 offen offset:1024 nt lds
    s_lshl2_add_u32 s70, s12, s69
    s_mul_i32 s70, s70, 3
    s_add_u32 s70, s70, s14
    s_cmp_eq_u32 s14, 3
    s_cselect_b32 s70, 100, s70
    s_mov_b64 s[44:45], s[60:61]
    s_mov_b32 s46, 1409024
    s_mov_b32 s47, 0x20000
    s_lshl_b32 s71, s70, 14
    v_lshl_add_u32 v46, v44, 10, v45
    v_add_u32 v165, s71, v46
    s_lshl_b32 s71, s68, 7
    s_add_u32 s72, s71, 7168
    s_add_u32 m0, s75, 155648
    s_mov_b64 s[0:1], s[48:49]
    buffer_load_dwordx4 v165, s[44:47], s71 offen nt lds
    buffer_load_dwordx4 v165, s[44:47], s72 offen offset:1024 nt lds
    s_and_b32 s71, s13, 1
    s_lshl2_add_u32 s71, s71, s14
    s_lshl_b32 s71, s71, 2
    s_lshr_b32 s19, 0x54327610, s71
    s_and_b32 s19, s19, 7
    s_lshl3_add_u32 s34, s12, s19
    s_lshl_b32 s34, s34, 15
    s_bfe_u32 s87, s13, 0x30001
    s_mov_b32 s2, 2097152
    s_mov_b32 s3, 0x20000
    v_and_b32 v45, 0x30, v13
    v_xor_b32 v160, v46, v45
    v_xor_b32 v161, 64, v160
    v_add_u32 v161, 7168, v161
    v_add_u32 v162, 14336, v160
    v_add_u32 v163, 14336, v161
    s_mul_i32 s35, s14, 12288
    s_add_u32 s35, s35, 98304
    s_cmp_eq_u32 s76, 24
    s_cbranch_scc0 J_nomark
    s_waitcnt vmcnt(4)
    s_barrier
    s_and_b32 s75, s88, 32
    s_lshl_b32 s75, s75, 2
    v_and_b32 v46, 31, v13
    v_lshl_add_u32 v46, v46, 2, s75
    v_mov_b32 v47, 1
    s_cmp_eq_u32 s14, 3
    s_cbranch_scc0 J_pf
    global_store_dword v46, v47, s[64:65] sc1
J_pf:
    global_load_dword v254, v40, s[26:27]
    s_branch J_nomark
M_exit:
    s_endpgm
J_lead:
    v_mov_b32 v48, 0
    v_mov_b32 v49, 0
    v_mov_b32 v50, 0
    v_mov_b32 v51, 0
    s_lshr_b32 s75, s2, 5
    s_lshl2_add_u32 s75, s75, s14
    s_lshl_b32 s75, s75, 12
    s_add_u32 s75, s75, 24641536
    v_add_u32 v46, s75, v16
    global_store_dwordx4 v46, v[48:51], s[66:67] sc1
    global_store_dwordx4 v46, v[48:51], s[66:67] offset:1024 sc1
    global_store_dwordx4 v46, v[48:51], s[66:67] offset:2048 sc1
    global_store_dwordx4 v46, v[48:51], s[66:67] offset:3072 sc1
    s_lshl_b32 s75, s14, 11
    s_barrier
    s_branch J_nolead
J_nomark:
    s_cmp_ge_u32 s12, 4
    s_cselect_b64 s[92:93], s[58:59], s[56:57]
    s_cselect_b64 s[96:97], s[56:57], s[58:59]
    s_mov_b32 s94, 1409024
    s_mov_b32 s98, 1409024
    s_mov_b32 s95, 0x20000
    s_mov_b32 s99, 0x20000
    s_mul_i32 s31, s13, 3
    s_lshl1_add_u32 s30, s13, 22
    s_cmp_lt_u32 s13, 22
    s_cselect_b32 s31, s31, s30
    s_cselect_b32 s18, 3, 2
    s_mul_i32 s81, s14, 88064
    s_lshl_b32 s30, s31, 5
    s_add_u32 s81, s81, s30
    s_mul_i32 s89, s14, 6144
    s_cmp_eq_u32 s18, 3
    s_cselect_b32 s30, 43, 64
    s_cselect_b32 s31, 4, 0
    s_cselect_b32 s32, 0, 32
    s_lshl_b32 s33, s18, 1
    v_add_u32 v40, 0, v13
    v_mul_u32_u24 v41, s30, v40
    v_lshrrev_b32 v41, 8, v41
    v_mul_u32_u24 v43, s33, v41
    v_sub_u32 v43, v40, v43
    v_ashrrev_i32 v44, 31, v43
    v_add_u32 v41, v41, v44
    v_and_b32 v44, s33, v44
    v_add_lshl_u32 v43, v43, v44, 4
    v_mul_u32_u24 v44, 2752, v41
    v_add_u32 v234, v44, v43
    v_xor_b32 v41, s31, v41
    v_mul_u32_u24 v44, 2752, v41
    v_xor_b32 v43, s32, v43
    v_add_u32 v237, v44, v43
    v_add_u32 v40, 64, v13
    v_mul_u32_u24 v41, s30, v40
    v_lshrrev_b32 v41, 8, v41
    v_mul_u32_u24 v43, s33, v41
    v_sub_u32 v43, v40, v43
    v_ashrrev_i32 v44, 31, v43
    v_add_u32 v41, v41, v44
    v_and_b32 v44, s33, v44
    v_add_lshl_u32 v43, v43, v44, 4
    v_mul_u32_u24 v44, 2752, v41
    v_add_u32 v235, v44, v43
    v_xor_b32 v41, s31, v41
    v_mul_u32_u24 v44, 2752, v41
    v_xor_b32 v43, s32, v43
    v_add_u32 v238, v44, v43
    v_subrev_u32 v235, 1024, v235
    v_subrev_u32 v238, 1024, v238
    v_add_u32 v40, 128, v13
    v_mul_u32_u24 v41, s30, v40
    v_lshrrev_b32 v41, 8, v41
    v_mul_u32_u24 v43, s33, v41
    v_sub_u32 v43, v40, v43
    v_ashrrev_i32 v44, 31, v43
    v_add_u32 v41, v41, v44
    v_and_b32 v44, s33, v44
    v_add_lshl_u32 v43, v43, v44, 4
    v_mul_u32_u24 v44, 2752, v41
    v_add_u32 v236, v44, v43
    v_xor_b32 v41, s31, v41
    v_mul_u32_u24 v44, 2752, v41
    v_xor_b32 v43, s32, v43
    v_add_u32 v239, v44, v43
    v_subrev_u32 v236, 2048, v236
    v_subrev_u32 v239, 2048, v239
    s_lshl_b32 s32, s32, 25
    v_or_b32 v236, s32, v236
    v_or_b32 v239, s32, v239
    s_add_u32 m0, s89, 0
    s_lshr_b32 s42, s13, 5
    s_add_u32 s42, s42, s12
    s_add_u32 s42, s42, 0
    s_and_b32 s42, s42, 3
    s_mul_i32 s42, s42, 352256
    s_add_u32 s42, s42, s81
    buffer_load_dwordx4 v234, s[92:95], s42 offen offset:0  lds
    buffer_load_dwordx4 v235, s[92:95], s42 offen offset:1024  lds
    buffer_load_dwordx4 v236, s[92:95], s42 offen offset:2048  lds
    s_add_u32 m0, s89, 3072
    s_nop 0
    buffer_load_dwordx4 v237, s[96:99], s42 offen offset:0  lds
    buffer_load_dwordx4 v238, s[96:99], s42 offen offset:1024  lds
    buffer_load_dwordx4 v239, s[96:99], s42 offen offset:2048  lds
    s_mov_b64 s[4:5], s[66:67]
    s_mov_b64 s[8:9], s[62:63]
    s_mov_b64 s[90:91], s[64:65]
    s_mov_b32 s6, 268435456
    s_mov_b32 s7, 0x20000
    s_mov_b32 s10, 2097152
    s_mov_b32 s11, 0x20000
    s_mov_b32 s16, 400000
    s_lshr_b32 s62, s13, 1
    v_add_u32 v17, 4096, v16
    s_mul_i32 s40, s62, 98304
    s_lshl_b32 s30, s14, 13
    s_add_u32 s41, s30, 98304
    s_lshl_b32 s43, s14, 3
    s_lshl_b32 s66, s12, 13
    s_add_u32 s66, s66, 24248320
    s_and_b32 s61, s13, 1
    s_and_b32 s63, s13, 3
    s_lshr_b32 s64, s13, 2
    s_lshl_b32 s86, s12, 3
    s_lshl_b32 s30, s61, 4
    s_lshl_b32 s31, s14, 2
    s_add_u32 s30, s30, s31
    s_xor_b32 s30, s30, 16
    s_lshr_b32 s85, 0x54327610, s30
    s_and_b32 s85, s85, 7
    s_sub_u32 s30, 7, s19
    s_min_u32 s17, s30, s19
    s_mul_i32 s65, s13, 3
    s_lshl_b32 s30, s13, 1
    s_add_u32 s30, s30, 22
    s_cmp_lt_u32 s13, 22
    s_cselect_b32 s65, s65, s30
    s_mov_b32 s20, 0xffff
    s_mov_b32 s21, 0xffff
    s_mov_b32 s22, 0x00ff00ff
    s_mov_b32 s23, 0
    s_mov_b32 s36, 0x3f803f80
    s_mov_b32 s24, -1
    s_mov_b32 s25, 0
    v_lshrrev_b32 v3, 5, v13
    v_and_b32 v0, 31, v13
    v_lshlrev_b32 v9, 2, v0
    v_cmp_eq_u32 vcc, 0, v13
    v_mov_b32 v1, 0x7ff00000
    s_nop 0
    v_cndmask_b32 v10, v1, 0, vcc
    s_getreg_b32 s30, hwreg(HW_REG_XCC_ID, 0, 4)
    s_or_b32 s30, s30, 0x100
    v_mov_b32 v11, s30
    v_and_b32 v43, 7, v13
    s_lshl2_add_u32 s30, s12, s14
    s_lshl_b32 s30, s30, 3
    v_add_u32 v44, s30, v43
    s_lshl2_add_u32 s30, s64, s14
    v_lshl_add_u32 v45, v43, 5, s30
    v_and_b32 v43, 8, v13
    v_cmp_eq_u32 vcc, 0, v43
    s_nop 1
    v_cndmask_b32 v44, v45, v44, vcc
    v_lshlrev_b32 v251, 7, v44
    s_cmp_eq_u32 s14, 3
    s_cselect_b32 s30, 0, 0x7ff00000
    v_or_b32 v252, s30, v9
    v_add_u32 v18, 8192, v16
    v_add_u32 v19, 12288, v16
    v_add_u32 v20, 16384, v16
    v_add_u32 v21, 20480, v16
    v_add_u32 v22, 24576, v16
    v_add_u32 v23, 28672, v16
    v_add_u32 v30, 98304, v16
    v_bfe_u32 v1, v13, 4, 1
    v_lshlrev_b32 v1, 7, v1
    v_xor_b32 v5, v16, v1
    v_add_u32 v5, s41, v5
    v_and_b32 v0, 7, v13
    v_lshlrev_b32 v15, 2, v0
    s_lshl_b32 s30, s14, 3
    v_add_u32 v0, s30, v0
    v_bfe_u32 v1, v13, 3, 1
    v_lshrrev_b32 v2, 4, v13
    v_lshl_add_u32 v7, v1, 5, v0
    v_lshlrev_b32 v7, 4, v7
    v_lshlrev_b32 v6, 7, v1
    v_and_b32 v40, 0xf0, v7
    v_lshl_add_u32 v40, v1, 8, v40
    s_lshr_b32 s31, s14, 1
    s_lshl_b32 s31, s31, 10
    v_add_u32 v40, s31, v40
    v_xor_b32 v6, v40, v6
    v_lshl_add_u32 v6, v2, 11, v6
    v_add_u32 v6, 98304, v6
    v_lshl_add_u32 v7, v2, 9, v40
    v_lshl_add_u32 v7, v3, 10, v7
    v_lshlrev_b32 v8, 4, v0
    v_lshl_add_u32 v8, v2, 2, v8
    v_mov_b32 v1, 0x7ff00000
    v_cndmask_b32 v8, v1, v8, s[22:23]
    s_add_u32 s30, s86, s19
    s_lshl_b32 s37, s30, 15
    s_lshl_b32 s38, s30, 11
    s_add_u32 s38, s38, 24117248
    s_lshl_b32 s39, s19, 7
    s_add_u32 s39, s39, s66
    s_add_u32 s39, s39, 2048
    s_lshl_b32 s31, s62, 12
    s_mul_i32 s44, s30, 67584
    s_add_u32 s44, s44, s31
    s_add_u32 s44, s44, 9060352
    s_add_u32 s31, s31, 4194304
    s_mul_i32 s49, s30, 67584
    s_add_u32 s49, s49, s31
    s_add_u32 s30, s86, s85
    s_mul_i32 s45, s30, 67584
    s_add_u32 s45, s45, s31
    s_lshl_b32 s30, s62, 5
    s_add_u32 s30, s30, s66
    s_add_u32 s30, s30, 4096
    s_lshl_b32 s31, s19, 2
    s_add_u32 s46, s30, s31
    s_lshl_b32 s31, s85, 2
    s_add_u32 s48, s30, s31
    s_lshl_b32 s50, s85, 12
    s_add_u32 s50, s50, 131072
    s_lshl_b32 s30, s12, 14
    s_lshl_b32 s31, s62, 10
    s_add_u32 s30, s30, s31
    s_add_u32 s30, s30, 24379392
    s_lshl_b32 s31, s19, 7
    s_add_u32 s47, s30, s31
    s_lshl_b32 s31, s14, 7
    s_add_u32 s51, s30, s31
    s_sub_u32 s51, s51, 16384
    s_cmp_eq_u32 s12, 0
    s_cselect_b32 s51, s47, s51
    s_cselect_b32 s31, 0, 1
    v_and_b32 v4, s31, v13
    v_lshlrev_b32 v4, 9, v4
    s_add_u32 s30, s14, s86
    s_sub_u32 s30, s30, 8
    s_mul_i32 s30, s30, 67584
    s_lshl_b32 s31, s62, 12
    s_add_u32 s30, s30, s31
    s_add_u32 s52, s30, 9060352
    s_lshr_b32 s30, s14, 1
    s_lshl_b32 s31, s62, 1
    s_add_u32 s30, s30, s31
    s_add_u32 s31, s86, s17
    s_mul_i32 s53, s31, 67584
    s_lshl_b32 s32, s62, 12
    s_and_b32 s33, s30, 1
    s_lshl_b32 s33, s33, 9
    s_add_u32 s32, s32, s33
    s_add_u32 s53, s53, s32
    s_add_u32 s53, s53, 4194304
    s_xor_b32 s31, s31, 7
    s_mul_i32 s54, s31, 67584
    s_xor_b32 s32, s32, 512
    s_add_u32 s54, s54, s32
    s_add_u32 s54, s54, 4194304
    s_lshl_b32 s31, s17, 5
    s_add_u32 s30, s30, s31
    s_xor_b32 s31, s30, 0xe1
    s_lshl_b32 s30, s30, 2
    s_add_u32 s55, s30, s66
    s_lshl_b32 s31, s31, 2
    s_add_u32 s56, s31, s66
    s_lshl_b32 s82, s14, 12
    s_xor_b32 s30, s14, 7
    s_lshl_b32 s71, s30, 7
    s_add_u32 s71, s71, s66
    s_lshl_b32 s31, s13, 2
    s_add_u32 s75, s71, s31
    s_add_u32 s30, s30, s86
    s_lshl_b32 s67, s30, 15
    s_lshl_b32 s69, s30, 11
    s_add_u32 s69, s69, 24117248
    s_mul_i32 s73, s30, 67584
    s_lshl_b32 s31, s65, 10
    s_add_u32 s73, s73, s31
    s_add_u32 s73, s73, 4194304
    s_and_b32 s31, s65, 1
    s_lshl_b32 s31, s31, 9
    s_sub_u32 s73, s73, s31
    s_xor_b32 s30, s14, 0
    s_lshl_b32 s72, s30, 7
    s_add_u32 s72, s72, s66
    s_lshl_b32 s31, s13, 2
    s_add_u32 s76, s72, s31
    s_add_u32 s30, s30, s86
    s_lshl_b32 s68, s30, 15
    s_lshl_b32 s70, s30, 11
    s_add_u32 s70, s70, 24117248
    s_mul_i32 s74, s30, 67584
    s_lshl_b32 s31, s65, 10
    s_add_u32 s74, s74, s31
    s_add_u32 s74, s74, 4194304
    s_and_b32 s31, s65, 1
    s_lshl_b32 s31, s31, 9
    s_sub_u32 s74, s74, s31
    s_lshl_b32 s83, s64, 16
    s_lshl_b32 s30, s14, 14
    s_add_u32 s83, s83, s30
    s_add_u32 s83, s83, 1572864
    s_mul_i32 s33, s14, 22
    s_and_b32 s30, s14, 2
    s_sub_u32 s33, s33, s30
    s_lshl_b32 s33, s33, 10
    s_mul_i32 s84, s64, 176128
    s_lshl_b32 s30, s33, 1
    s_add_u32 s84, s84, s30
    s_add_u32 s84, s84, 2097152
    s_cmp_eq_u32 s14, 3
    s_cselect_b32 s30, 4259840, 0
    s_add_u32 s33, s33, s30
    s_mov_b32 s26, s63
    s_mov_b32 s27, s64
    s_mov_b32 s28, s66
    s_mov_b32 s29, s86
    s_xor_b32 s30, s26, 7
    s_lshl_b32 s79, s30, 7
    s_add_u32 s79, s79, s28
    s_lshl_b32 s31, s14, 5
    s_add_u32 s59, s79, s31
    s_lshl_b32 s31, s27, 2
    s_add_u32 s31, s31, s14
    s_lshl_b32 s31, s31, 2
    s_add_u32 s65, s79, s31
    s_add_u32 s30, s30, s29
    s_mul_i32 s77, s30, 67584
    s_add_u32 s77, s77, 4194304
    s_lshl_b32 s31, s14, 14
    s_add_u32 s57, s77, s31
    s_add_u32 s77, s77, s33
    s_lshl_b32 s85, s30, 15
    s_lshl_b32 s31, s27, 12
    s_add_u32 s61, s85, s31
    s_lshl_b32 s31, s27, 7
    s_add_u32 s85, s85, s31
    s_lshl_b32 s63, s30, 11
    s_lshr_b32 s31, s27, 1
    s_lshl_b32 s31, s31, 9
    s_add_u32 s63, s63, s31
    s_and_b32 s31, s27, 1
    s_lshl_b32 s31, s31, 3
    s_add_u32 s63, s63, s31
    s_add_u32 s63, s63, 24117248
    s_xor_b32 s30, s26, 0
    s_lshl_b32 s80, s30, 7
    s_add_u32 s80, s80, s28
    s_lshl_b32 s31, s14, 5
    s_add_u32 s60, s80, s31
    s_lshl_b32 s31, s27, 2
    s_add_u32 s31, s31, s14
    s_lshl_b32 s31, s31, 2
    s_add_u32 s66, s80, s31
    s_add_u32 s30, s30, s29
    s_mul_i32 s78, s30, 67584
    s_add_u32 s78, s78, 4194304
    s_lshl_b32 s31, s14, 14
    s_add_u32 s58, s78, s31
    s_add_u32 s78, s78, s33
    s_lshl_b32 s86, s30, 15
    s_lshl_b32 s31, s27, 12
    s_add_u32 s62, s86, s31
    s_lshl_b32 s31, s27, 7
    s_add_u32 s86, s86, s31
    s_lshl_b32 s64, s30, 11
    s_lshr_b32 s31, s27, 1
    s_lshl_b32 s31, s31, 9
    s_add_u32 s64, s64, s31
    s_and_b32 s31, s27, 1
    s_lshl_b32 s31, s31, 3
    s_add_u32 s64, s64, s31
    s_add_u32 s64, s64, 24117248
    v_mov_b32 v25, 0
    v_mov_b32 v27, 0
    v_mov_b32 v29, 0
    s_cmp_eq_u32 s18, 3
    s_cselect_b32 s30, 4, 0
    s_cselect_b32 s31, 0, 32
    s_lshl_b32 s32, s18, 5
    s_add_u32 s31, s31, 3072
    v_bfe_u32 v0, v13, 2, 2
    v_lshl_add_u32 v0, v3, 2, v0
    v_bfe_u32 v1, v13, 4, 1
    v_mul_u32_u24 v2, s30, v1
    v_xor_b32 v0, v0, v2
    v_mul_u32_u24 v0, s32, v0
    v_mad_u32_u24 v0, v1, s31, v0
    v_and_b32 v1, 3, v13
    v_lshl_add_u32 v224, v1, 3, v0
    s_add_u32 s15, s87, 0
    s_and_b32 s15, s15, 7
    s_lshl_b32 s15, s15, 7
    s_add_u32 m0, s35, 0
    s_add_u32 s15, s15, s34
    buffer_load_dwordx4 v160, s[0:3], s15 offen offset:0 nt lds
    buffer_load_dwordx4 v161, s[0:3], s15 offen offset:1024 nt lds
    buffer_load_dwordx4 v162, s[0:3], s15 offen offset:2048 nt lds
    buffer_load_dwordx4 v163, s[0:3], s15 offen offset:3072 nt lds
    s_lshl2_add_u32 s28, s12, s14
    s_andn2_b32 s28, s28, 1
    s_cmp_eq_u32 s26, 2
    s_cselect_b32 s29, 10, 11
    s_cselect_b32 s32, 32, s26
    s_lshl_b32 s28, s28, s29
    s_and_b32 s29, s14, 1
    s_lshl_b32 s29, s29, 9
    s_add_u32 s28, s28, s29
    s_lshl_b32 s32, s32, 11
    s_mul_i32 s30, s27, 196608
    s_add_u32 s30, s30, s32
    s_add_u32 s31, s30, 98304
    s_lshl_b32 s32, s27, 16
    s_add_u32 s32, s32, 1572864
    s_add_u32 s33, s32, 2048
    v_and_b32 v166, 0xf0, v16
    v_lshl_add_u32 v166, v3, 8, v166
    v_bfe_u32 v167, v13, 4, 1
    v_lshl_add_u32 v166, v167, 10, v166
    v_mov_b32 v167, v166
    s_cmp_eq_u32 s26, 3
    s_cselect_b32 s30, s32, s30
    s_cselect_b32 s31, s33, s31
    s_cselect_b32 s29, 2, s14
    s_add_u32 s30, s30, s28
    s_add_u32 s31, s31, s28
    s_cmp_ge_u32 s29, 2
    s_cselect_b32 s29, 0x7ff00000, 0
    v_or_b32 v170, s29, v9
    s_lshl1_add_u32 s32, s27, s14
    s_mul_i32 s32, s32, 3
    s_add_u32 s32, s32, s26
    s_lshl3_add_u32 s32, s32, s12
    s_lshl_b32 s32, s32, 7
    s_add_u32 s32, s32, 3538944
    s_lshl2_add_u32 s28, s12, s26
    s_mul_i32 s28, s28, 3
    s_add_u32 s28, s28, s14
    s_mul_i32 s33, s27, 86
    s_add_u32 s33, s33, s28
    s_lshl_b32 s33, s33, 11
    s_add_u32 s33, s33, 2097152
    s_and_b32 s29, s28, 1
    s_mul_i32 s29, s29, 1536
    s_sub_u32 s33, s33, s29
    s_cmp_eq_u32 s14, 3
    s_cselect_b32 s28, 100, s28
    s_cmp_ge_u32 s28, 86
    s_cselect_b32 s29, 0x7ff00000, 0
    v_or_b32 v171, s29, v166
    v_lshlrev_b32 v40, 2, v3
    v_bfe_u32 v41, v13, 2, 2
    v_add_u32 v40, v40, v41
    v_and_b32 v41, 3, v13
    v_lshlrev_b32 v41, 3, v41
    v_and_b32 v43, 16, v13
    v_lshl_add_u32 v44, v40, 7, v41
    v_lshl_add_u32 v44, v43, 1, v44
    s_lshl_b32 s28, s14, 11
    s_add_u32 s28, s28, 147456
    v_add_u32 v172, s28, v44
    s_and_b32 s28, s14, 1
    s_lshl_b32 s28, s28, 6
    s_add_u32 s28, s28, 147456
    v_add_u32 v173, s28, v44
    v_mov_b32 v52, s36
    v_mov_b32 v53, s36
    v_mov_b32 v54, s36
    v_mov_b32 v55, s36
    v_lshlrev_b32 v174, 7, v3
    v_mov_b32 v175, 0
    v_and_b32 v40, 15, v13
    v_bfe_u32 v41, v13, 1, 3
    v_lshlrev_b32 v43, 1, v3
    v_xor_b32 v41, v41, v43
    v_lshlrev_b32 v41, 4, v41
    v_lshl_add_u32 v40, v40, 7, v41
    v_bfe_u32 v41, v13, 4, 1
    v_lshl_add_u32 v40, v41, 3, v40
    v_add_u32 v176, s35, v40
    v_and_b32 v40, 7, v13
    s_lshl_b32 s28, s14, 3
    v_add_u32 v40, s28, v40
    v_bfe_u32 v41, v13, 3, 1
    v_lshrrev_b32 v43, 4, v13
    v_lshlrev_b32 v40, 10, v40
    v_lshl_add_u32 v40, v43, 5, v40
    v_lshl_add_u32 v184, v41, 3, v40
    v_xor_b32 v177, 16, v176
    v_xor_b32 v180, 64, v176
    v_xor_b32 v181, 80, v176
    s_waitcnt vmcnt(10)
    s_barrier
    ds_read_b64_tr_b16 v[192:193], v172 offset:0
    ds_read_b64_tr_b16 v[194:195], v172 offset:1024
    ds_read_b64_tr_b16 v[196:197], v172 offset:64
    ds_read_b64_tr_b16 v[198:199], v172 offset:1088
    ds_read_b64_tr_b16 v[200:201], v172 offset:8192
    ds_read_b64_tr_b16 v[202:203], v172 offset:9216
    ds_read_b64_tr_b16 v[204:205], v172 offset:8256
    ds_read_b64_tr_b16 v[206:207], v172 offset:9280
    ds_read_b64_tr_b16 v[208:209], v173 offset:0
    ds_read_b64_tr_b16 v[210:211], v173 offset:1024
    ds_read_b64_tr_b16 v[212:213], v173 offset:2048
    ds_read_b64_tr_b16 v[214:215], v173 offset:3072
    ds_read_b64_tr_b16 v[216:217], v173 offset:4096
    ds_read_b64_tr_b16 v[218:219], v173 offset:5120
    ds_read_b64_tr_b16 v[220:221], v173 offset:6144
    ds_read_b64_tr_b16 v[222:223], v173 offset:7168
    s_waitcnt lgkmcnt(12)
    buffer_store_dwordx4 v[192:195], v167, s[4:7], s30 offen sc1
    buffer_store_dwordx4 v[196:199], v167, s[4:7], s31 offen sc1
    s_waitcnt lgkmcnt(0)
    v_mfma_f32_32x32x16_bf16 v[128:143], v[52:55], v[208:211], 0
    v_mfma_f32_32x32x16_bf16 v[128:143], v[52:55], v[212:215], v[128:143]
    v_mfma_f32_32x32x16_bf16 v[128:143], v[52:55], v[216:219], v[128:143]
    v_mfma_f32_32x32x16_bf16 v[128:143], v[52:55], v[220:223], v[128:143]
    buffer_store_dwordx4 v[200:203], v171, s[4:7], s33 offen sc1
    buffer_store_dwordx4 v[204:207], v171, s[4:7], s33 offen offset:2048 sc1
    s_add_u32 s28, s47, 0x20000
    buffer_store_dword v175, v9, s[4:7], s47 offen sc1
    buffer_store_dword v175, v9, s[4:7], s28 offen sc1
    s_and_b32 s28, s46, 0xffffe000
    s_lshl_b32 s29, s13, 8
    s_add_u32 s28, s28, s29
    s_cmp_eq_u32 s14, 2
    s_cselect_b32 s29, 0, 0x7ff00000
    v_lshl_add_u32 v44, v13, 2, s29
    buffer_store_dword v175, v44, s[4:7], s28 offen sc1
    buffer_store_dword v128, v170, s[4:7], s32 offen sc1
    v_mov_b32 v232, 0
    v_mov_b32 v233, 0
    v_mov_b32 v244, 0
    v_mov_b32 v245, 0
    global_load_dword v185, v174, s[90:91] sc1
    s_lshl_b32 s31, s18, 8
    v_add_u32 v216, s89, v224
    v_add_u32 v217, s31, v216
    v_add_u32 v218, s31, v217
    v_add_u32 v219, s31, v218
    s_cmp_eq_u32 s18, 3
    s_cselect_b32 s31, 32, 0
    s_cselect_b32 s32, 0, 32
    v_xor_b32 v220, s32, v216
    v_add_u32 v220, s31, v220
    v_xor_b32 v221, s32, v217
    v_add_u32 v221, s31, v221
    v_xor_b32 v222, s32, v218
    v_add_u32 v222, s31, v222
    v_xor_b32 v223, s32, v219
    v_add_u32 v223, s31, v223
    s_add_u32 s15, s87, 1
    s_and_b32 s15, s15, 7
    s_lshl_b32 s15, s15, 7
    s_add_u32 m0, s35, 4096
    s_add_u32 s15, s15, s34
    buffer_load_dwordx4 v160, s[0:3], s15 offen offset:0  lds
    buffer_load_dwordx4 v161, s[0:3], s15 offen offset:1024  lds
    buffer_load_dwordx4 v162, s[0:3], s15 offen offset:2048  lds
    buffer_load_dwordx4 v163, s[0:3], s15 offen offset:3072  lds
    s_add_u32 s15, s87, 2
    s_and_b32 s15, s15, 7
    s_lshl_b32 s15, s15, 7
    s_add_u32 m0, s35, 8192
    s_add_u32 s15, s15, s34
    buffer_load_dwordx4 v160, s[0:3], s15 offen offset:0  lds
    buffer_load_dwordx4 v161, s[0:3], s15 offen offset:1024  lds
    buffer_load_dwordx4 v162, s[0:3], s15 offen offset:2048  lds
    buffer_load_dwordx4 v163, s[0:3], s15 offen offset:3072  lds
    s_waitcnt vmcnt(8)
JM_chk:
    v_cmp_eq_u32 vcc, 0, v185
    s_cbranch_vccnz JM_spin
    s_lshl_b32 s28, s12, 5
    s_add_u32 s28, s28, s13
    s_lshl_b32 s28, s28, 7
    s_add_u32 s28, s28, 24641536
    s_barrier
    buffer_store_dword v11, v252, s[4:7], s28 offen sc1
    ds_read_b64 v[32:33], v176 offset:0
    ds_read_b64 v[34:35], v177 offset:0
    ds_read_b64 v[36:37], v176 offset:2048
    ds_read_b64 v[38:39], v177 offset:2048
    ds_read_b64 v[40:41], v180 offset:0
    ds_read_b64 v[42:43], v181 offset:0
    ds_read_b64 v[44:45], v180 offset:2048
    ds_read_b64 v[46:47], v181 offset:2048
    s_waitcnt lgkmcnt(0)
    s_add_u32 s15, s87, 3
    s_and_b32 s15, s15, 7
    s_lshl_b32 s15, s15, 7
    s_add_u32 m0, s35, 0
    s_add_u32 s15, s15, s34
    buffer_load_dwordx4 v160, s[0:3], s15 offen offset:0  lds
    buffer_load_dwordx4 v161, s[0:3], s15 offen offset:1024  lds
    buffer_load_dwordx4 v162, s[0:3], s15 offen offset:2048  lds
    buffer_load_dwordx4 v163, s[0:3], s15 offen offset:3072  lds
    s_add_u32 m0, s89, 24576
    s_lshr_b32 s42, s13, 5
    s_add_u32 s42, s42, s12
    s_add_u32 s42, s42, 1
    s_and_b32 s42, s42, 3
    s_mul_i32 s42, s42, 352256
    s_add_u32 s42, s42, s81
    buffer_load_dwordx4 v234, s[92:95], s42 offen offset:0  lds
    buffer_load_dwordx4 v235, s[92:95], s42 offen offset:1024  lds
    buffer_load_dwordx4 v236, s[92:95], s42 offen offset:2048  lds
    s_waitcnt vmcnt(12)
    ds_read_b64 v[48:49], v176 offset:4096
    ds_read_b64 v[50:51], v177 offset:4096
    ds_read_b64 v[52:53], v176 offset:6144
    ds_read_b64 v[54:55], v177 offset:6144
    ds_read_b64 v[56:57], v180 offset:4096
    ds_read_b64 v[58:59], v181 offset:4096
    ds_read_b64 v[60:61], v180 offset:6144
    ds_read_b64 v[62:63], v181 offset:6144
    s_waitcnt lgkmcnt(0)
    s_add_u32 s15, s87, 4
    s_and_b32 s15, s15, 7
    s_lshl_b32 s15, s15, 7
    s_add_u32 m0, s35, 4096
    s_add_u32 s15, s15, s34
    buffer_load_dwordx4 v160, s[0:3], s15 offen offset:0  lds
    buffer_load_dwordx4 v161, s[0:3], s15 offen offset:1024  lds
    buffer_load_dwordx4 v162, s[0:3], s15 offen offset:2048  lds
    buffer_load_dwordx4 v163, s[0:3], s15 offen offset:3072  lds
    s_add_u32 m0, s89, 27648
    s_nop 0
    buffer_load_dwordx4 v237, s[96:99], s42 offen offset:0  lds
    buffer_load_dwordx4 v238, s[96:99], s42 offen offset:1024  lds
    buffer_load_dwordx4 v239, s[96:99], s42 offen offset:2048  lds
    v_dot2c_f32_bf16 v232, s36, v32
    v_dot2c_f32_bf16 v233, v32, v32
    v_dot2c_f32_bf16 v232, s36, v33
    v_dot2c_f32_bf16 v233, v33, v33
    v_dot2c_f32_bf16 v232, s36, v34
    v_dot2c_f32_bf16 v233, v34, v34
    v_dot2c_f32_bf16 v232, s36, v35
    v_dot2c_f32_bf16 v233, v35, v35
    v_dot2c_f32_bf16 v244, s36, v36
    v_dot2c_f32_bf16 v245, v36, v36
    v_dot2c_f32_bf16 v244, s36, v37
    v_dot2c_f32_bf16 v245, v37, v37
    v_dot2c_f32_bf16 v244, s36, v38
    v_dot2c_f32_bf16 v245, v38, v38
    v_dot2c_f32_bf16 v244, s36, v39
    v_dot2c_f32_bf16 v245, v39, v39
    v_dot2c_f32_bf16 v232, s36, v40
    v_dot2c_f32_bf16 v233, v40, v40
    v_dot2c_f32_bf16 v232, s36, v41
    v_dot2c_f32_bf16 v233, v41, v41
    v_dot2c_f32_bf16 v232, s36, v42
    v_dot2c_f32_bf16 v233, v42, v42
    v_dot2c_f32_bf16 v232, s36, v43
    v_dot2c_f32_bf16 v233, v43, v43
    v_dot2c_f32_bf16 v244, s36, v44
    v_dot2c_f32_bf16 v245, v44, v44
    v_dot2c_f32_bf16 v244, s36, v45
    v_dot2c_f32_bf16 v245, v45, v45
    v_dot2c_f32_bf16 v244, s36, v46
    v_dot2c_f32_bf16 v245, v46, v46
    v_dot2c_f32_bf16 v244, s36, v47
    v_dot2c_f32_bf16 v245, v47, v47
    s_waitcnt vmcnt(15)
    ds_read_b64 v[64:65], v176 offset:8192
    ds_read_b64 v[66:67], v177 offset:8192
    ds_read_b64 v[68:69], v176 offset:10240
    ds_read_b64 v[70:71], v177 offset:10240
    ds_read_b64 v[72:73], v180 offset:8192
    ds_read_b64 v[74:75], v181 offset:8192
    ds_read_b64 v[76:77], v180 offset:10240
    ds_read_b64 v[78:79], v181 offset:10240
    s_waitcnt lgkmcnt(0)
    s_add_u32 s15, s87, 5
    s_and_b32 s15, s15, 7
    s_lshl_b32 s15, s15, 7
    s_add_u32 m0, s35, 8192
    s_add_u32 s15, s15, s34
    buffer_load_dwordx4 v160, s[0:3], s15 offen offset:0  lds
    buffer_load_dwordx4 v161, s[0:3], s15 offen offset:1024  lds
    buffer_load_dwordx4 v162, s[0:3], s15 offen offset:2048  lds
    buffer_load_dwordx4 v163, s[0:3], s15 offen offset:3072  lds
    s_add_u32 m0, s89, 49152
    s_lshr_b32 s42, s13, 5
    s_add_u32 s42, s42, s12
    s_add_u32 s42, s42, 2
    s_and_b32 s42, s42, 3
    s_mul_i32 s42, s42, 352256
    s_add_u32 s42, s42, s81
    buffer_load_dwordx4 v234, s[92:95], s42 offen offset:0  lds
    buffer_load_dwordx4 v235, s[92:95], s42 offen offset:1024  lds
    buffer_load_dwordx4 v236, s[92:95], s42 offen offset:2048  lds
    v_dot2c_f32_bf16 v232, s36, v48
    v_dot2c_f32_bf16 v233, v48, v48
    v_dot2c_f32_bf16 v232, s36, v49
    v_dot2c_f32_bf16 v233, v49, v49
    v_dot2c_f32_bf16 v232, s36, v50
    v_dot2c_f32_bf16 v233, v50, v50
    v_dot2c_f32_bf16 v232, s36, v51
    v_dot2c_f32_bf16 v233, v51, v51
    v_dot2c_f32_bf16 v244, s36, v52
    v_dot2c_f32_bf16 v245, v52, v52
    v_dot2c_f32_bf16 v244, s36, v53
    v_dot2c_f32_bf16 v245, v53, v53
    v_dot2c_f32_bf16 v244, s36, v54
    v_dot2c_f32_bf16 v245, v54, v54
    v_dot2c_f32_bf16 v244, s36, v55
    v_dot2c_f32_bf16 v245, v55, v55
    v_dot2c_f32_bf16 v232, s36, v56
    v_dot2c_f32_bf16 v233, v56, v56
    v_dot2c_f32_bf16 v232, s36, v57
    v_dot2c_f32_bf16 v233, v57, v57
    v_dot2c_f32_bf16 v232, s36, v58
    v_dot2c_f32_bf16 v233, v58, v58
    v_dot2c_f32_bf16 v232, s36, v59
    v_dot2c_f32_bf16 v233, v59, v59
    v_dot2c_f32_bf16 v244, s36, v60
    v_dot2c_f32_bf16 v245, v60, v60
    v_dot2c_f32_bf16 v244, s36, v61
    v_dot2c_f32_bf16 v245, v61, v61
    v_dot2c_f32_bf16 v244, s36, v62
    v_dot2c_f32_bf16 v245, v62, v62
    v_dot2c_f32_bf16 v244, s36, v63
    v_dot2c_f32_bf16 v245, v63, v63
    s_waitcnt vmcnt(17)
    ds_read_b64 v[80:81], v176 offset:0
    ds_read_b64 v[82:83], v177 offset:0
    ds_read_b64 v[84:85], v176 offset:2048
    ds_read_b64 v[86:87], v177 offset:2048
    ds_read_b64 v[88:89], v180 offset:0
    ds_read_b64 v[90:91], v181 offset:0
    ds_read_b64 v[92:93], v180 offset:2048
    ds_read_b64 v[94:95], v181 offset:2048
    s_waitcnt lgkmcnt(0)
    s_add_u32 s15, s87, 6
    s_and_b32 s15, s15, 7
    s_lshl_b32 s15, s15, 7
    s_add_u32 m0, s35, 0
    s_add_u32 s15, s15, s34
    buffer_load_dwordx4 v160, s[0:3], s15 offen offset:0  lds
    buffer_load_dwordx4 v161, s[0:3], s15 offen offset:1024  lds
    buffer_load_dwordx4 v162, s[0:3], s15 offen offset:2048  lds
    buffer_load_dwordx4 v163, s[0:3], s15 offen offset:3072  lds
    s_add_u32 m0, s89, 52224
    s_nop 0
    buffer_load_dwordx4 v237, s[96:99], s42 offen offset:0  lds
    buffer_load_dwordx4 v238, s[96:99], s42 offen offset:1024  lds
    buffer_load_dwordx4 v239, s[96:99], s42 offen offset:2048  lds
    v_dot2c_f32_bf16 v232, s36, v64
    v_dot2c_f32_bf16 v233, v64, v64
    v_dot2c_f32_bf16 v232, s36, v65
    v_dot2c_f32_bf16 v233, v65, v65
    v_dot2c_f32_bf16 v232, s36, v66
    v_dot2c_f32_bf16 v233, v66, v66
    v_dot2c_f32_bf16 v232, s36, v67
    v_dot2c_f32_bf16 v233, v67, v67
    v_dot2c_f32_bf16 v244, s36, v68
    v_dot2c_f32_bf16 v245, v68, v68
    v_dot2c_f32_bf16 v244, s36, v69
    v_dot2c_f32_bf16 v245, v69, v69
    v_dot2c_f32_bf16 v244, s36, v70
    v_dot2c_f32_bf16 v245, v70, v70
    v_dot2c_f32_bf16 v244, s36, v71
    v_dot2c_f32_bf16 v245, v71, v71
    v_dot2c_f32_bf16 v232, s36, v72
    v_dot2c_f32_bf16 v233, v72, v72
    v_dot2c_f32_bf16 v232, s36, v73
    v_dot2c_f32_bf16 v233, v73, v73
    v_dot2c_f32_bf16 v232, s36, v74
    v_dot2c_f32_bf16 v233, v74, v74
    v_dot2c_f32_bf16 v232, s36, v75
    v_dot2c_f32_bf16 v233, v75, v75
    v_dot2c_f32_bf16 v244, s36, v76
    v_dot2c_f32_bf16 v245, v76, v76
    v_dot2c_f32_bf16 v244, s36, v77
    v_dot2c_f32_bf16 v245, v77, v77
    v_dot2c_f32_bf16 v244, s36, v78
    v_dot2c_f32_bf16 v245, v78, v78
    v_dot2c_f32_bf16 v244, s36, v79
    v_dot2c_f32_bf16 v245, v79, v79
    ds_read_b64_tr_b16 v[192:193], v216 offset:0
    ds_read_b64_tr_b16 v[194:195], v217 offset:0
    ds_read_b64_tr_b16 v[196:197], v220 offset:0
    ds_read_b64_tr_b16 v[198:199], v221 offset:0
    ds_read_b64_tr_b16 v[200:201], v216 offset:64
    ds_read_b64_tr_b16 v[202:203], v217 offset:64
    ds_read_b64_tr_b16 v[204:205], v218 offset:0
    ds_read_b64_tr_b16 v[206:207], v219 offset:0
    ds_read_b64_tr_b16 v[208:209], v222 offset:0
    ds_read_b64_tr_b16 v[210:211], v223 offset:0
    ds_read_b64_tr_b16 v[212:213], v218 offset:64
    ds_read_b64_tr_b16 v[214:215], v219 offset:64
    s_add_u32 s31, s89, 0
    v_add_u32 v224, s31, v16
    s_waitcnt lgkmcnt(8)
    ds_write_b128 v224, v[192:195] offset:0
    v_dot2_f32_bf16 v12, v192, s36, 0
    v_dot2_f32_bf16 v12, v193, s36, v12
    v_dot2_f32_bf16 v12, v194, s36, v12
    v_dot2_f32_bf16 v12, v195, s36, v12
    ds_write_b128 v224, v[196:199] offset:1024
    v_dot2_f32_bf16 v253, v196, s36, 0
    v_dot2_f32_bf16 v253, v197, s36, v253
    v_dot2_f32_bf16 v253, v198, s36, v253
    v_dot2_f32_bf16 v253, v199, s36, v253
    s_waitcnt lgkmcnt(6)
    ds_write_b128 v224, v[200:203] offset:2048
    v_dot2_f32_bf16 v31, v200, s36, 0
    v_dot2_f32_bf16 v31, v201, s36, v31
    v_dot2_f32_bf16 v31, v202, s36, v31
    v_dot2_f32_bf16 v31, v203, s36, v31
    ds_write_b128 v224, v[204:207] offset:3072
    v_dot2_f32_bf16 v12, v204, s36, v12
    v_dot2_f32_bf16 v12, v205, s36, v12
    v_dot2_f32_bf16 v12, v206, s36, v12
    v_dot2_f32_bf16 v12, v207, s36, v12
    s_waitcnt lgkmcnt(4)
    ds_write_b128 v224, v[208:211] offset:4096
    v_dot2_f32_bf16 v253, v208, s36, v253
    v_dot2_f32_bf16 v253, v209, s36, v253
    v_dot2_f32_bf16 v253, v210, s36, v253
    v_dot2_f32_bf16 v253, v211, s36, v253
    ds_write_b128 v224, v[212:215] offset:5120
    v_dot2_f32_bf16 v31, v212, s36, v31
    v_dot2_f32_bf16 v31, v213, s36, v31
    v_dot2_f32_bf16 v31, v214, s36, v31
    v_dot2_f32_bf16 v31, v215, s36, v31
    s_waitcnt vmcnt(17)
    ds_read_b64 v[96:97], v176 offset:4096
    ds_read_b64 v[98:99], v177 offset:4096
    ds_read_b64 v[100:101], v176 offset:6144
    ds_read_b64 v[102:103], v177 offset:6144
    ds_read_b64 v[104:105], v180 offset:4096
    ds_read_b64 v[106:107], v181 offset:4096
    ds_read_b64 v[108:109], v180 offset:6144
    ds_read_b64 v[110:111], v181 offset:6144
    s_waitcnt lgkmcnt(0)
    s_add_u32 s15, s87, 7
    s_and_b32 s15, s15, 7
    s_lshl_b32 s15, s15, 7
    s_add_u32 m0, s35, 4096
    s_add_u32 s15, s15, s34
    buffer_load_dwordx4 v160, s[0:3], s15 offen offset:0  lds
    buffer_load_dwordx4 v161, s[0:3], s15 offen offset:1024  lds
    buffer_load_dwordx4 v162, s[0:3], s15 offen offset:2048  lds
    buffer_load_dwordx4 v163, s[0:3], s15 offen offset:3072  lds
    buffer_load_dwordx2 v[186:187], v184, s[0:3], s85 offen
    buffer_load_dwordx2 v[188:189], v184, s[0:3], s85 offen offset:16
    buffer_load_dwordx2 v[160:161], v184, s[0:3], s86 offen
    buffer_load_dwordx2 v[162:163], v184, s[0:3], s86 offen offset:16
    s_mov_b32 s33, 24641536
    buffer_load_dword v14, v251, s[4:7], s33 offen sc1
    s_add_u32 m0, s89, 73728
    s_lshr_b32 s42, s13, 5
    s_add_u32 s42, s42, s12
    s_add_u32 s42, s42, 3
    s_and_b32 s42, s42, 3
    s_mul_i32 s42, s42, 352256
    s_add_u32 s42, s42, s81
    buffer_load_dwordx4 v234, s[92:95], s42 offen offset:0  lds
    buffer_load_dwordx4 v235, s[92:95], s42 offen offset:1024  lds
    buffer_load_dwordx4 v236, s[92:95], s42 offen offset:2048  lds
    v_dot2c_f32_bf16 v232, s36, v80
    v_dot2c_f32_bf16 v233, v80, v80
    v_dot2c_f32_bf16 v232, s36, v81
    v_dot2c_f32_bf16 v233, v81, v81
    v_dot2c_f32_bf16 v232, s36, v82
    v_dot2c_f32_bf16 v233, v82, v82
    v_dot2c_f32_bf16 v232, s36, v83
    v_dot2c_f32_bf16 v233, v83, v83
    v_dot2c_f32_bf16 v244, s36, v84
    v_dot2c_f32_bf16 v245, v84, v84
    v_dot2c_f32_bf16 v244, s36, v85
    v_dot2c_f32_bf16 v245, v85, v85
    v_dot2c_f32_bf16 v244, s36, v86
    v_dot2c_f32_bf16 v245, v86, v86
    v_dot2c_f32_bf16 v244, s36, v87
    v_dot2c_f32_bf16 v245, v87, v87
    v_dot2c_f32_bf16 v232, s36, v88
    v_dot2c_f32_bf16 v233, v88, v88
    v_dot2c_f32_bf16 v232, s36, v89
    v_dot2c_f32_bf16 v233, v89, v89
    v_dot2c_f32_bf16 v232, s36, v90
    v_dot2c_f32_bf16 v233, v90, v90
    v_dot2c_f32_bf16 v232, s36, v91
    v_dot2c_f32_bf16 v233, v91, v91
    v_dot2c_f32_bf16 v244, s36, v92
    v_dot2c_f32_bf16 v245, v92, v92
    v_dot2c_f32_bf16 v244, s36, v93
    v_dot2c_f32_bf16 v245, v93, v93
    v_dot2c_f32_bf16 v244, s36, v94
    v_dot2c_f32_bf16 v245, v94, v94
    v_dot2c_f32_bf16 v244, s36, v95
    v_dot2c_f32_bf16 v245, v95, v95
    s_waitcnt vmcnt(22)
    ds_read_b64 v[112:113], v176 offset:8192
    ds_read_b64 v[114:115], v177 offset:8192
    ds_read_b64 v[116:117], v176 offset:10240
    ds_read_b64 v[118:119], v177 offset:10240
    ds_read_b64 v[120:121], v180 offset:8192
    ds_read_b64 v[122:123], v181 offset:8192
    ds_read_b64 v[124:125], v180 offset:10240
    ds_read_b64 v[126:127], v181 offset:10240
    s_add_u32 m0, s89, 76800
    s_nop 0
    buffer_load_dwordx4 v237, s[96:99], s42 offen offset:0  lds
    buffer_load_dwordx4 v238, s[96:99], s42 offen offset:1024  lds
    buffer_load_dwordx4 v239, s[96:99], s42 offen offset:2048  lds
    v_dot2c_f32_bf16 v232, s36, v96
    v_dot2c_f32_bf16 v233, v96, v96
    v_dot2c_f32_bf16 v232, s36, v97
    v_dot2c_f32_bf16 v233, v97, v97
    v_dot2c_f32_bf16 v232, s36, v98
    v_dot2c_f32_bf16 v233, v98, v98
    v_dot2c_f32_bf16 v232, s36, v99
    v_dot2c_f32_bf16 v233, v99, v99
    v_dot2c_f32_bf16 v244, s36, v100
    v_dot2c_f32_bf16 v245, v100, v100
    v_dot2c_f32_bf16 v244, s36, v101
    v_dot2c_f32_bf16 v245, v101, v101
    v_dot2c_f32_bf16 v244, s36, v102
    v_dot2c_f32_bf16 v245, v102, v102
    v_dot2c_f32_bf16 v244, s36, v103
    v_dot2c_f32_bf16 v245, v103, v103
    v_dot2c_f32_bf16 v232, s36, v104
    v_dot2c_f32_bf16 v233, v104, v104
    v_dot2c_f32_bf16 v232, s36, v105
    v_dot2c_f32_bf16 v233, v105, v105
    v_dot2c_f32_bf16 v232, s36, v106
    v_dot2c_f32_bf16 v233, v106, v106
    v_dot2c_f32_bf16 v232, s36, v107
    v_dot2c_f32_bf16 v233, v107, v107
    v_dot2c_f32_bf16 v244, s36, v108
    v_dot2c_f32_bf16 v245, v108, v108
    v_dot2c_f32_bf16 v244, s36, v109
    v_dot2c_f32_bf16 v245, v109, v109
    v_dot2c_f32_bf16 v244, s36, v110
    v_dot2c_f32_bf16 v245, v110, v110
    v_dot2c_f32_bf16 v244, s36, v111
    v_dot2c_f32_bf16 v245, v111, v111
    ds_read_b64_tr_b16 v[192:193], v216 offset:24576
    ds_read_b64_tr_b16 v[194:195], v217 offset:24576
    ds_read_b64_tr_b16 v[196:197], v220 offset:24576
    ds_read_b64_tr_b16 v[198:199], v221 offset:24576
    ds_read_b64_tr_b16 v[200:201], v216 offset:24640
    ds_read_b64_tr_b16 v[202:203], v217 offset:24640
    ds_read_b64_tr_b16 v[204:205], v218 offset:24576
    ds_read_b64_tr_b16 v[206:207], v219 offset:24576
    ds_read_b64_tr_b16 v[208:209], v222 offset:24576
    ds_read_b64_tr_b16 v[210:211], v223 offset:24576
    ds_read_b64_tr_b16 v[212:213], v218 offset:24640
    ds_read_b64_tr_b16 v[214:215], v219 offset:24640
    s_add_u32 s31, s89, 24576
    v_add_u32 v224, s31, v16
    s_waitcnt lgkmcnt(8)
    ds_write_b128 v224, v[192:195] offset:0
    v_dot2_f32_bf16 v12, v192, s36, v12
    v_dot2_f32_bf16 v12, v193, s36, v12
    v_dot2_f32_bf16 v12, v194, s36, v12
    v_dot2_f32_bf16 v12, v195, s36, v12
    ds_write_b128 v224, v[196:199] offset:1024
    v_dot2_f32_bf16 v253, v196, s36, v253
    v_dot2_f32_bf16 v253, v197, s36, v253
    v_dot2_f32_bf16 v253, v198, s36, v253
    v_dot2_f32_bf16 v253, v199, s36, v253
    s_waitcnt lgkmcnt(6)
    ds_write_b128 v224, v[200:203] offset:2048
    v_dot2_f32_bf16 v31, v200, s36, v31
    v_dot2_f32_bf16 v31, v201, s36, v31
    v_dot2_f32_bf16 v31, v202, s36, v31
    v_dot2_f32_bf16 v31, v203, s36, v31
    ds_write_b128 v224, v[204:207] offset:3072
    v_dot2_f32_bf16 v12, v204, s36, v12
    v_dot2_f32_bf16 v12, v205, s36, v12
    v_dot2_f32_bf16 v12, v206, s36, v12
    v_dot2_f32_bf16 v12, v207, s36, v12
    s_waitcnt lgkmcnt(4)
    ds_write_b128 v224, v[208:211] offset:4096
    v_dot2_f32_bf16 v253, v208, s36, v253
    v_dot2_f32_bf16 v253, v209, s36, v253
    v_dot2_f32_bf16 v253, v210, s36, v253
    v_dot2_f32_bf16 v253, v211, s36, v253
    ds_write_b128 v224, v[212:215] offset:5120
    v_dot2_f32_bf16 v31, v212, s36, v31
    v_dot2_f32_bf16 v31, v213, s36, v31
    v_dot2_f32_bf16 v31, v214, s36, v31
    v_dot2_f32_bf16 v31, v215, s36, v31
    s_waitcnt vmcnt(18)
    ds_read_b64 v[128:129], v176 offset:0
    ds_read_b64 v[130:131], v177 offset:0
    ds_read_b64 v[132:133], v176 offset:2048
    ds_read_b64 v[134:135], v177 offset:2048
    ds_read_b64 v[136:137], v180 offset:0
    ds_read_b64 v[138:139], v181 offset:0
    ds_read_b64 v[140:141], v180 offset:2048
    ds_read_b64 v[142:143], v181 offset:2048
    v_dot2c_f32_bf16 v232, s36, v112
    v_dot2c_f32_bf16 v233, v112, v112
    v_dot2c_f32_bf16 v232, s36, v113
    v_dot2c_f32_bf16 v233, v113, v113
    v_dot2c_f32_bf16 v232, s36, v114
    v_dot2c_f32_bf16 v233, v114, v114
    v_dot2c_f32_bf16 v232, s36, v115
    v_dot2c_f32_bf16 v233, v115, v115
    v_dot2c_f32_bf16 v244, s36, v116
    v_dot2c_f32_bf16 v245, v116, v116
    v_dot2c_f32_bf16 v244, s36, v117
    v_dot2c_f32_bf16 v245, v117, v117
    v_dot2c_f32_bf16 v244, s36, v118
    v_dot2c_f32_bf16 v245, v118, v118
    v_dot2c_f32_bf16 v244, s36, v119
    v_dot2c_f32_bf16 v245, v119, v119
    v_dot2c_f32_bf16 v232, s36, v120
    v_dot2c_f32_bf16 v233, v120, v120
    v_dot2c_f32_bf16 v232, s36, v121
    v_dot2c_f32_bf16 v233, v121, v121
    v_dot2c_f32_bf16 v232, s36, v122
    v_dot2c_f32_bf16 v233, v122, v122
    v_dot2c_f32_bf16 v232, s36, v123
    v_dot2c_f32_bf16 v233, v123, v123
    v_dot2c_f32_bf16 v244, s36, v124
    v_dot2c_f32_bf16 v245, v124, v124
    v_dot2c_f32_bf16 v244, s36, v125
    v_dot2c_f32_bf16 v245, v125, v125
    v_dot2c_f32_bf16 v244, s36, v126
    v_dot2c_f32_bf16 v245, v126, v126
    v_dot2c_f32_bf16 v244, s36, v127
    v_dot2c_f32_bf16 v245, v127, v127
    s_waitcnt vmcnt(11)
    ds_read_b64 v[144:145], v176 offset:4096
    ds_read_b64 v[146:147], v177 offset:4096
    ds_read_b64 v[148:149], v176 offset:6144
    ds_read_b64 v[150:151], v177 offset:6144
    ds_read_b64 v[152:153], v180 offset:4096
    ds_read_b64 v[154:155], v181 offset:4096
    ds_read_b64 v[156:157], v180 offset:6144
    ds_read_b64 v[158:159], v181 offset:6144
    s_waitcnt lgkmcnt(12)
    v_dot2c_f32_bf16 v232, s36, v128
    v_dot2c_f32_bf16 v233, v128, v128
    v_dot2c_f32_bf16 v232, s36, v129
    v_dot2c_f32_bf16 v233, v129, v129
    v_dot2c_f32_bf16 v232, s36, v130
    v_dot2c_f32_bf16 v233, v130, v130
    v_dot2c_f32_bf16 v232, s36, v131
    v_dot2c_f32_bf16 v233, v131, v131
    v_dot2c_f32_bf16 v244, s36, v132
    v_dot2c_f32_bf16 v245, v132, v132
    v_dot2c_f32_bf16 v244, s36, v133
    v_dot2c_f32_bf16 v245, v133, v133
    v_dot2c_f32_bf16 v244, s36, v134
    v_dot2c_f32_bf16 v245, v134, v134
    v_dot2c_f32_bf16 v244, s36, v135
    v_dot2c_f32_bf16 v245, v135, v135
    s_waitcnt lgkmcnt(8)
    v_dot2c_f32_bf16 v232, s36, v136
    v_dot2c_f32_bf16 v233, v136, v136
    v_dot2c_f32_bf16 v232, s36, v137
    v_dot2c_f32_bf16 v233, v137, v137
    v_dot2c_f32_bf16 v232, s36, v138
    v_dot2c_f32_bf16 v233, v138, v138
    v_dot2c_f32_bf16 v232, s36, v139
    v_dot2c_f32_bf16 v233, v139, v139
    v_dot2c_f32_bf16 v244, s36, v140
    v_dot2c_f32_bf16 v245, v140, v140
    v_dot2c_f32_bf16 v244, s36, v141
    v_dot2c_f32_bf16 v245, v141, v141
    v_dot2c_f32_bf16 v244, s36, v142
    v_dot2c_f32_bf16 v245, v142, v142
    v_dot2c_f32_bf16 v244, s36, v143
    v_dot2c_f32_bf16 v245, v143, v143
    s_waitcnt lgkmcnt(4)
    v_dot2c_f32_bf16 v232, s36, v144
    v_dot2c_f32_bf16 v233, v144, v144
    v_dot2c_f32_bf16 v232, s36, v145
    v_dot2c_f32_bf16 v233, v145, v145
    v_dot2c_f32_bf16 v232, s36, v146
    v_dot2c_f32_bf16 v233, v146, v146
    v_dot2c_f32_bf16 v232, s36, v147
    v_dot2c_f32_bf16 v233, v147, v147
    v_dot2c_f32_bf16 v244, s36, v148
    v_dot2c_f32_bf16 v245, v148, v148
    v_dot2c_f32_bf16 v244, s36, v149
    v_dot2c_f32_bf16 v245, v149, v149
    v_dot2c_f32_bf16 v244, s36, v150
    v_dot2c_f32_bf16 v245, v150, v150
    v_dot2c_f32_bf16 v244, s36, v151
    v_dot2c_f32_bf16 v245, v151, v151
    s_waitcnt lgkmcnt(0)
    v_dot2c_f32_bf16 v232, s36, v152
    v_dot2c_f32_bf16 v233, v152, v152
    v_dot2c_f32_bf16 v232, s36, v153
    v_dot2c_f32_bf16 v233, v153, v153
    v_dot2c_f32_bf16 v232, s36, v154
    v_dot2c_f32_bf16 v233, v154, v154
    v_dot2c_f32_bf16 v232, s36, v155
    v_dot2c_f32_bf16 v233, v155, v155
    v_dot2c_f32_bf16 v244, s36, v156
    v_dot2c_f32_bf16 v245, v156, v156
    v_dot2c_f32_bf16 v244, s36, v157
    v_dot2c_f32_bf16 v245, v157, v157
    v_dot2c_f32_bf16 v244, s36, v158
    v_dot2c_f32_bf16 v245, v158, v158
    v_dot2c_f32_bf16 v244, s36, v159
    v_dot2c_f32_bf16 v245, v159, v159
    s_waitcnt vmcnt(6)
S2_back:
    v_cmp_eq_u32 vcc, 0, v14
    s_cbranch_vccnz S2_spin
    v_cmp_ne_u32 vcc, v14, v11
    s_lshl2_add_u32 s30, s14, 147456
    v_mov_b32 v250, s30
    s_and_b32 s30, vcc_lo, 0xff
    v_mov_b32 v14, s30
    ds_write_b32 v250, v14
    s_waitcnt lgkmcnt(0)
    s_barrier
    s_lshr_b32 s31, 0x2010010, s43
    s_and_b32 s31, s31, 31
    s_cmp_ge_u32 s31, 16
    s_cselect_b32 s32, 7, 15
    s_cselect_b32 s33, 0, s87
    s_add_u32 s33, s33, s87
    s_add_u32 s33, s33, s31
    s_and_b32 s33, s33, s32
    s_and_b32 s31, s31, 16
    s_or_b32 s31, s31, s33
    s_lshl_b32 s31, s31, 12
    s_add_u32 m0, s82, 98304
    s_add_u32 s31, s31, s40
    buffer_load_dwordx4 v16, s[4:7], s31 offen offset:0 sc1 lds
    buffer_load_dwordx4 v16, s[4:7], s31 offen offset:1024 sc1 lds
    buffer_load_dwordx4 v16, s[4:7], s31 offen offset:2048 sc1 lds
    buffer_load_dwordx4 v16, s[4:7], s31 offen offset:3072 sc1 lds
    s_lshr_b32 s31, 0x5040311, s43
    s_and_b32 s31, s31, 31
    s_cmp_ge_u32 s31, 16
    s_cselect_b32 s32, 7, 15
    s_cselect_b32 s33, 0, s87
    s_add_u32 s33, s33, s87
    s_add_u32 s33, s33, s31
    s_and_b32 s33, s33, s32
    s_and_b32 s31, s31, 16
    s_or_b32 s31, s31, s33
    s_lshl_b32 s31, s31, 12
    s_add_u32 m0, s82, 114688
    s_add_u32 s31, s31, s40
    buffer_load_dwordx4 v16, s[4:7], s31 offen offset:0 sc1 lds
    buffer_load_dwordx4 v16, s[4:7], s31 offen offset:1024 sc1 lds
    buffer_load_dwordx4 v16, s[4:7], s31 offen offset:2048 sc1 lds
    buffer_load_dwordx4 v16, s[4:7], s31 offen offset:3072 sc1 lds
    s_lshr_b32 s31, 0x9080706, s43
    s_and_b32 s31, s31, 31
    s_cmp_ge_u32 s31, 16
    s_cselect_b32 s32, 7, 15
    s_cselect_b32 s33, 0, s87
    s_add_u32 s33, s33, s87
    s_add_u32 s33, s33, s31
    s_and_b32 s33, s33, s32
    s_and_b32 s31, s31, 16
    s_or_b32 s31, s31, s33
    s_lshl_b32 s31, s31, 12
    s_add_u32 m0, s82, 131072
    s_add_u32 s31, s31, s40
    buffer_load_dwordx4 v16, s[4:7], s31 offen offset:0 sc1 lds
    buffer_load_dwordx4 v16, s[4:7], s31 offen offset:1024 sc1 lds
    buffer_load_dwordx4 v16, s[4:7], s31 offen offset:2048 sc1 lds
    buffer_load_dwordx4 v16, s[4:7], s31 offen offset:3072 sc1 lds
    s_lshr_b32 s30, s13, 1
    s_mul_i32 s30, s30, 3072
    s_add_u32 s30, s30, 3538944
    v_lshl_add_u32 v246, v3, 9, v9
    v_and_b32 v250, 12, v15
    v_add_u32 v250, 147456, v250
    ds_read_b32 v14, v250
    v_lshlrev_b32 v0, 16, v186
    v_and_b32 v1, 0xffff0000, v186
    v_accvgpr_write_b32 a240, v0
    v_accvgpr_write_b32 a241, v1
    v_lshlrev_b32 v0, 16, v187
    v_and_b32 v1, 0xffff0000, v187
    v_accvgpr_write_b32 a242, v0
    v_accvgpr_write_b32 a243, v1
    v_lshlrev_b32 v0, 16, v188
    v_and_b32 v1, 0xffff0000, v188
    v_accvgpr_write_b32 a244, v0
    v_accvgpr_write_b32 a245, v1
    v_lshlrev_b32 v0, 16, v189
    v_and_b32 v1, 0xffff0000, v189
    v_accvgpr_write_b32 a246, v0
    v_accvgpr_write_b32 a247, v1
    v_lshlrev_b32 v0, 16, v160
    v_and_b32 v1, 0xffff0000, v160
    v_accvgpr_write_b32 a248, v0
    v_accvgpr_write_b32 a249, v1
    v_lshlrev_b32 v0, 16, v161
    v_and_b32 v1, 0xffff0000, v161
    v_accvgpr_write_b32 a250, v0
    v_accvgpr_write_b32 a251, v1
    v_lshlrev_b32 v0, 16, v162
    v_and_b32 v1, 0xffff0000, v162
    v_accvgpr_write_b32 a252, v0
    v_accvgpr_write_b32 a253, v1
    v_lshlrev_b32 v0, 16, v163
    v_and_b32 v1, 0xffff0000, v163
    v_accvgpr_write_b32 a254, v0
    v_accvgpr_write_b32 a255, v1
    s_waitcnt lgkmcnt(0)
    v_cmp_ne_u32 vcc, 0, v14
    v_mov_b32 v11, 1
    s_cmp_lg_u64 vcc, 0
    s_cselect_b32 s15, -1, 0
    s_cselect_b32 s34, -1, 1
    s_cselect_b32 s35, -1, 2
    s_waitcnt vmcnt(8)
    s_barrier
    ds_read_b128 v[208:211], v30 offset:4096
    ds_read_b128 v[212:215], v30 offset:6144
    ds_read_b128 v[216:219], v30 offset:0
    ds_read_b128 v[220:223], v30 offset:5120
    ds_read_b128 v[224:227], v30 offset:7168
    ds_read_b128 v[228:231], v30 offset:1024
    s_waitcnt lgkmcnt(5)
    v_mfma_f32_16x16x32_bf16 v[160:163], v[208:211], v[32:35], 0
    v_mfma_f32_16x16x32_bf16 v[164:167], v[208:211], v[36:39], 0
    s_waitcnt lgkmcnt(4)
    ds_read_b128 v[208:211], v30 offset:8192
    v_mfma_f32_16x16x32_bf16 v[176:179], v[32:35], v[212:215], 0
    s_lshr_b32 s31, 0xd0c0b0a, s43
    s_and_b32 s31, s31, 31
    s_cmp_ge_u32 s31, 16
    s_cselect_b32 s32, 7, 15
    s_cselect_b32 s33, 0, s87
    v_mfma_f32_16x16x32_bf16 v[184:187], v[36:39], v[212:215], 0
    s_waitcnt lgkmcnt(4)
    ds_read_b128 v[212:215], v30 offset:10240
    v_mfma_f32_16x16x32_bf16 v[192:195], v[216:219], v[32:35], 0
    s_add_u32 s33, s33, s87
    s_add_u32 s33, s33, s31
    s_and_b32 s33, s33, s32
    s_and_b32 s31, s31, 16
    s_or_b32 s31, s31, s33
    v_mfma_f32_16x16x32_bf16 v[196:199], v[216:219], v[36:39], 0
    s_waitcnt lgkmcnt(4)
    ds_read_b128 v[216:219], v30 offset:2048
    v_mfma_f32_16x16x32_bf16 v[168:171], v[220:223], v[32:35], 0
    s_lshl_b32 s31, s31, 12
    s_add_u32 m0, s82, 147456
    s_add_u32 s31, s31, s40
    v_mfma_f32_16x16x32_bf16 v[172:175], v[220:223], v[36:39], 0
    s_waitcnt lgkmcnt(4)
    ds_read_b128 v[220:223], v30 offset:9216
    buffer_load_dwordx4 v16, s[4:7], s31 offen offset:0 sc1 lds
    v_mfma_f32_16x16x32_bf16 v[180:183], v[32:35], v[224:227], 0
    buffer_load_dwordx4 v16, s[4:7], s31 offen offset:1024 sc1 lds
    v_mfma_f32_16x16x32_bf16 v[188:191], v[36:39], v[224:227], 0
    s_waitcnt lgkmcnt(4)
    ds_read_b128 v[224:227], v30 offset:11264
    buffer_load_dwordx4 v16, s[4:7], s31 offen offset:2048 sc1 lds
    v_mfma_f32_16x16x32_bf16 v[200:203], v[228:231], v[32:35], 0
    buffer_load_dwordx4 v16, s[4:7], s31 offen offset:3072 sc1 lds
    v_mfma_f32_16x16x32_bf16 v[204:207], v[228:231], v[36:39], 0
    s_waitcnt lgkmcnt(4)
    ds_read_b128 v[228:231], v30 offset:3072
    v_mfma_f32_16x16x32_bf16 v[160:163], v[208:211], v[40:43], v[160:163]
    s_add_u32 s1, s84, 32768
    s_lshr_b32 s2, s13, 1
    s_lshl_b32 s2, s2, 7
    s_add_u32 s2, s2, s38
    v_mfma_f32_16x16x32_bf16 v[164:167], v[208:211], v[44:47], v[164:167]
    s_waitcnt lgkmcnt(4)
    ds_read_b128 v[208:211], v30 offset:12288
    v_mfma_f32_16x16x32_bf16 v[176:179], v[40:43], v[212:215], v[176:179]
    s_lshr_b32 s0, s13, 1
    s_lshl_b32 s0, s0, 11
    s_sub_u32 s0, s49, s0
    s_add_u32 s0, s0, 4325376
    v_mfma_f32_16x16x32_bf16 v[184:187], v[44:47], v[212:215], v[184:187]
    s_waitcnt lgkmcnt(4)
    ds_read_b128 v[212:215], v30 offset:14336
    v_mfma_f32_16x16x32_bf16 v[192:195], v[216:219], v[40:43], v[192:195]
    s_lshl_b32 s3, s12, 5
    s_add_u32 s3, s3, s13
    v_mfma_f32_16x16x32_bf16 v[196:199], v[216:219], v[44:47], v[196:199]
    s_waitcnt vmcnt(8) lgkmcnt(4)
    s_barrier
    ds_read_b128 v[216:219], v30 offset:16384
    v_mfma_f32_16x16x32_bf16 v[168:171], v[220:223], v[40:43], v[168:171]
    s_cmp_ge_u32 s3, 22
    s_cselect_b32 s26, 0, 65535
    s_mov_b32 s27, 0
    v_mfma_f32_16x16x32_bf16 v[172:175], v[220:223], v[44:47], v[172:175]
    s_waitcnt lgkmcnt(4)
    ds_read_b128 v[220:223], v30 offset:13312
    v_permlane16_swap_b32 v232, v244
    v_mfma_f32_16x16x32_bf16 v[180:183], v[40:43], v[224:227], v[180:183]
    v_permlane16_swap_b32 v233, v245
    v_add_f32 v232, v232, v244
    v_mfma_f32_16x16x32_bf16 v[188:191], v[44:47], v[224:227], v[188:191]
    s_waitcnt lgkmcnt(4)
    ds_read_b128 v[224:227], v30 offset:15360
    v_add_f32 v233, v233, v245
    v_mfma_f32_16x16x32_bf16 v[200:203], v[228:231], v[40:43], v[200:203]
    s_nop 0
    v_permlane32_swap_b32 v232, v233
    v_add_f32 v232, v232, v233
    v_mfma_f32_16x16x32_bf16 v[204:207], v[228:231], v[44:47], v[204:207]
    s_waitcnt lgkmcnt(4)
    ds_read_b128 v[228:231], v30 offset:17408
    buffer_load_dword v32, v246, s[4:7], s30 offen offset:0 sc1
    v_mfma_f32_16x16x32_bf16 v[160:163], v[208:211], v[48:51], v[160:163]
    v_mul_f32 v232, 0x3b000000, v232
    v_mov_b32 v233, v232
    v_mfma_f32_16x16x32_bf16 v[164:167], v[208:211], v[52:55], v[164:167]
    s_waitcnt lgkmcnt(4)
    ds_read_b128 v[208:211], v30 offset:20480
    buffer_load_dword v33, v246, s[4:7], s30 offen offset:128 sc1
    v_mfma_f32_16x16x32_bf16 v[176:179], v[48:51], v[212:215], v[176:179]
    v_permlane32_swap_b32 v232, v233
    v_fma_f32 v233, -v232, v232, v233
    v_mfma_f32_16x16x32_bf16 v[184:187], v[52:55], v[212:215], v[184:187]
    s_waitcnt lgkmcnt(4)
    ds_read_b128 v[212:215], v30 offset:22528
    buffer_load_dword v34, v246, s[4:7], s30 offen offset:256 sc1
    v_mfma_f32_16x16x32_bf16 v[192:195], v[216:219], v[48:51], v[192:195]
    v_max_f32 v233, 0, v233
    v_add_f32 v233, 0x3727c5ac, v233
    v_mfma_f32_16x16x32_bf16 v[196:199], v[216:219], v[52:55], v[196:199]
    s_waitcnt lgkmcnt(4)
    ds_read_b128 v[216:219], v30 offset:18432
    buffer_load_dword v35, v246, s[4:7], s30 offen offset:384 sc1
    v_mfma_f32_16x16x32_bf16 v[168:171], v[220:223], v[48:51], v[168:171]
    v_rsq_f32 v240, v233
    v_mfma_f32_16x16x32_bf16 v[172:175], v[220:223], v[52:55], v[172:175]
    s_waitcnt lgkmcnt(4)
    ds_read_b128 v[220:223], v30 offset:21504
    buffer_load_dword v36, v246, s[4:7], s30 offen offset:1024 sc1
    v_mfma_f32_16x16x32_bf16 v[180:183], v[48:51], v[224:227], v[180:183]
    v_cvt_pk_bf16_f32 v244, -v232, -v232
    v_and_b32 v245, 0xffff0000, v244
    v_mfma_f32_16x16x32_bf16 v[188:191], v[52:55], v[224:227], v[188:191]
    s_waitcnt lgkmcnt(4)
    ds_read_b128 v[224:227], v30 offset:23552
    buffer_load_dword v37, v246, s[4:7], s30 offen offset:1152 sc1
    v_mfma_f32_16x16x32_bf16 v[200:203], v[228:231], v[48:51], v[200:203]
    v_sub_f32 v245, -v232, v245
    v_cvt_pk_bf16_f32 v245, v245, v245
    v_mfma_f32_16x16x32_bf16 v[204:207], v[228:231], v[52:55], v[204:207]
    s_waitcnt lgkmcnt(4)
    ds_read_b128 v[228:231], v30 offset:19456
    buffer_load_dword v38, v246, s[4:7], s30 offen offset:1280 sc1
    v_mfma_f32_16x16x32_bf16 v[160:163], v[208:211], v[56:59], v[160:163]
    v_cndmask_b32 v236, v245, v244, s[24:25]
    v_cvt_pk_bf16_f32 v232, v240, v240
    v_mfma_f32_16x16x32_bf16 v[164:167], v[208:211], v[60:63], v[164:167]
    s_waitcnt lgkmcnt(4)
    ds_read_b128 v[208:211], v30 offset:24576
    buffer_load_dword v39, v246, s[4:7], s30 offen offset:1408 sc1
    v_mfma_f32_16x16x32_bf16 v[176:179], v[56:59], v[212:215], v[176:179]
    v_and_b32 v232, 0xffff0000, v232
    v_sub_f32 v233, v240, v232
    v_mfma_f32_16x16x32_bf16 v[184:187], v[60:63], v[212:215], v[184:187]
    s_waitcnt lgkmcnt(4)
    ds_read_b128 v[212:215], v30 offset:26624
    buffer_load_dword v40, v246, s[4:7], s30 offen offset:2048 sc1
    v_mfma_f32_16x16x32_bf16 v[192:195], v[216:219], v[56:59], v[192:195]
    v_cvt_pk_bf16_f32 v232, v232, v233
    v_mov_b32 v241, v240
    v_mfma_f32_16x16x32_bf16 v[196:199], v[216:219], v[60:63], v[196:199]
    s_waitcnt lgkmcnt(4)
    ds_read_b128 v[216:219], v30 offset:25600
    buffer_load_dword v41, v246, s[4:7], s30 offen offset:2176 sc1
    v_mfma_f32_16x16x32_bf16 v[168:171], v[220:223], v[56:59], v[168:171]
    v_cndmask_b32 v242, 0, v232, s[24:25]
    v_mov_b32 v244, 0
    v_mfma_f32_16x16x32_bf16 v[172:175], v[220:223], v[60:63], v[172:175]
    s_waitcnt lgkmcnt(4)
    ds_read_b128 v[220:223], v30 offset:27648
    buffer_load_dword v42, v246, s[4:7], s30 offen offset:2304 sc1
    v_mfma_f32_16x16x32_bf16 v[180:183], v[56:59], v[224:227], v[180:183]
    v_permlane16_swap_b32 v240, v241
    v_mov_b32 v243, 0
    v_mfma_f32_16x16x32_bf16 v[188:191], v[60:63], v[224:227], v[188:191]
    s_waitcnt lgkmcnt(4)
    ds_read_b128 v[224:227], v30 offset:28672
    buffer_load_dword v43, v246, s[4:7], s30 offen offset:2432 sc1
    v_mfma_f32_16x16x32_bf16 v[200:203], v[228:231], v[56:59], v[200:203]
    s_lshr_b32 s31, 0x13120f0e, s43
    s_and_b32 s31, s31, 31
    s_cmp_ge_u32 s31, 16
    s_cselect_b32 s32, 7, 15
    s_cselect_b32 s33, 0, s87
    v_mfma_f32_16x16x32_bf16 v[204:207], v[228:231], v[60:63], v[204:207]
    s_waitcnt lgkmcnt(4)
    ds_read_b128 v[228:231], v30 offset:30720
    v_permlane16_swap_b32 v242, v244
    v_mfma_f32_16x16x32_bf16 v[160:163], v[208:211], v[64:67], v[160:163]
    s_add_u32 s33, s33, s87
    s_add_u32 s33, s33, s31
    s_and_b32 s33, s33, s32
    s_and_b32 s31, s31, 16
    s_or_b32 s31, s31, s33
    v_mfma_f32_16x16x32_bf16 v[164:167], v[208:211], v[68:71], v[164:167]
    s_waitcnt lgkmcnt(4)
    ds_read_b128 v[208:211], v30 offset:29696
    v_mov_b32 v245, 0
    v_mfma_f32_16x16x32_bf16 v[176:179], v[64:67], v[212:215], v[176:179]
    s_lshl_b32 s31, s31, 12
    s_add_u32 m0, s82, 98304
    s_add_u32 s31, s31, s40
    v_mfma_f32_16x16x32_bf16 v[184:187], v[68:71], v[212:215], v[184:187]
    s_waitcnt lgkmcnt(4)
    ds_read_b128 v[212:215], v30 offset:31744
    v_mul_f32 v238, 0x3eb8aa3b, v240
    v_mfma_f32_16x16x32_bf16 v[168:171], v[216:219], v[64:67], v[168:171]
    v_mul_f32 v239, 0x3eb8aa3b, v241
    v_mfma_f32_16x16x32_bf16 v[172:175], v[216:219], v[68:71], v[172:175]
    s_waitcnt vmcnt(16) lgkmcnt(4)
    s_barrier
    ds_read_b128 v[216:219], v30 offset:32768
    v_mfma_f32_16x16x32_bf16 v[180:183], v[64:67], v[220:223], v[180:183]
    s_cmp_eq_u32 s14, 2
    s_cselect_b32 s28, 0x7ff00000, 0
    v_or_b32 v233, s28, v16
    v_mfma_f32_16x16x32_bf16 v[188:191], v[68:71], v[220:223], v[188:191]
    s_waitcnt lgkmcnt(4)
    ds_read_b128 v[220:223], v30 offset:34816
    buffer_load_dwordx4 v16, s[4:7], s31 offen offset:0 sc1 lds
    v_mfma_f32_16x16x32_bf16 v[160:163], v[224:227], v[72:75], v[160:163]
    buffer_load_dwordx4 v16, s[4:7], s31 offen offset:1024 sc1 lds
    v_lshl_add_u32 v248, v9, 5, s0
    v_mfma_f32_16x16x32_bf16 v[164:167], v[224:227], v[76:79], v[164:167]
    s_waitcnt lgkmcnt(4)
    ds_read_b128 v[224:227], v30 offset:33792
    buffer_load_dwordx4 v16, s[4:7], s31 offen offset:2048 sc1 lds
    v_mfma_f32_16x16x32_bf16 v[176:179], v[72:75], v[228:231], v[176:179]
    buffer_load_dwordx4 v16, s[4:7], s31 offen offset:3072 sc1 lds
    v_mov_b32 v249, s2
    v_mfma_f32_16x16x32_bf16 v[184:187], v[76:79], v[228:231], v[184:187]
    s_waitcnt lgkmcnt(4)
    ds_read_b128 v[228:231], v30 offset:35840
    v_cndmask_b32 v232, v249, v248, s[26:27]
    v_mfma_f32_16x16x32_bf16 v[168:171], v[208:211], v[72:75], v[168:171]
    v_mfma_f32_16x16x32_bf16 v[172:175], v[208:211], v[76:79], v[172:175]
    s_waitcnt lgkmcnt(4)
    ds_read_b128 v[208:211], v30 offset:36864
    buffer_store_dwordx4 v[16:19], v16, s[4:7], s45 offen offset:0 sc1
    v_mfma_f32_16x16x32_bf16 v[180:183], v[72:75], v[212:215], v[180:183]
    v_mfma_f32_16x16x32_bf16 v[188:191], v[76:79], v[212:215], v[188:191]
    s_waitcnt lgkmcnt(4)
    ds_read_b128 v[212:215], v30 offset:38912
    buffer_store_dwordx4 v[16:19], v16, s[4:7], s45 offen offset:1024 sc1
    v_mfma_f32_16x16x32_bf16 v[160:163], v[216:219], v[80:83], v[160:163]
    v_mfma_f32_16x16x32_bf16 v[164:167], v[216:219], v[84:87], v[164:167]
    s_waitcnt lgkmcnt(4)
    ds_read_b128 v[216:219], v30 offset:37888
    v_mfma_f32_16x16x32_bf16 v[176:179], v[80:83], v[220:223], v[176:179]
    v_mfma_f32_16x16x32_bf16 v[184:187], v[84:87], v[220:223], v[184:187]
    s_waitcnt lgkmcnt(4)
    ds_read_b128 v[220:223], v30 offset:39936
    buffer_store_dwordx4 v[16:19], v16, s[4:7], s45 offen offset:2048 sc1
    v_mfma_f32_16x16x32_bf16 v[168:171], v[224:227], v[80:83], v[168:171]
    v_mfma_f32_16x16x32_bf16 v[172:175], v[224:227], v[84:87], v[172:175]
    s_waitcnt vmcnt(7) lgkmcnt(4)
    ds_read_b128 v[224:227], v30 offset:40960
    buffer_store_dwordx4 v[16:19], v16, s[4:7], s45 offen offset:3072 sc1
    v_mfma_f32_16x16x32_bf16 v[180:183], v[80:83], v[228:231], v[180:183]
    v_add_f32 v32, v32, v33
    v_add_f32 v34, v34, v35
    v_mfma_f32_16x16x32_bf16 v[188:191], v[84:87], v[228:231], v[188:191]
    s_waitcnt lgkmcnt(4)
    ds_read_b128 v[228:231], v30 offset:43008
    v_add_f32 v32, v32, v34
    v_mfma_f32_16x16x32_bf16 v[160:163], v[208:211], v[88:91], v[160:163]
    v_mov_b32 v33, v32
    v_add_f32 v36, v36, v37
    v_mfma_f32_16x16x32_bf16 v[164:167], v[208:211], v[92:95], v[164:167]
    s_waitcnt lgkmcnt(4)
    ds_read_b128 v[208:211], v30 offset:41984
    v_add_f32 v38, v38, v39
    v_mfma_f32_16x16x32_bf16 v[176:179], v[88:91], v[212:215], v[176:179]
    s_cmp_ge_u32 s3, 22
    s_cbranch_scc1 NOZ_1
    buffer_store_dwordx4 v[16:19], v16, s[4:7], s0 offen sc1
    buffer_store_dwordx4 v[16:19], v16, s[4:7], s0 offen offset:1024 sc1
NOZ_1:
    v_mfma_f32_16x16x32_bf16 v[184:187], v[92:95], v[212:215], v[184:187]
    s_waitcnt lgkmcnt(4)
    ds_read_b128 v[212:215], v30 offset:44032
    buffer_store_dwordx4 v[16:19], v7, s[8:11], s61 offen sc1
    v_mfma_f32_16x16x32_bf16 v[168:171], v[216:219], v[88:91], v[168:171]
    v_add_f32 v36, v36, v38
    v_mov_b32 v37, v36
    v_mfma_f32_16x16x32_bf16 v[172:175], v[216:219], v[92:95], v[172:175]
    s_waitcnt lgkmcnt(4)
    ds_read_b128 v[216:219], v30 offset:45056
    v_add_f32 v40, v40, v41
    v_mfma_f32_16x16x32_bf16 v[180:183], v[88:91], v[220:223], v[180:183]
    v_add_f32 v42, v42, v43
    v_add_f32 v40, v40, v42
    v_mfma_f32_16x16x32_bf16 v[188:191], v[92:95], v[220:223], v[188:191]
    s_waitcnt lgkmcnt(4)
    ds_read_b128 v[220:223], v30 offset:47104
    buffer_store_dwordx4 v[16:19], v7, s[8:11], s62 offen sc1
    v_mfma_f32_16x16x32_bf16 v[160:163], v[224:227], v[96:99], v[160:163]
    v_mov_b32 v41, v40
    v_permlane32_swap_b32 v32, v33
    v_mfma_f32_16x16x32_bf16 v[164:167], v[224:227], v[100:103], v[164:167]
    s_waitcnt lgkmcnt(4)
    ds_read_b128 v[224:227], v30 offset:46080
    buffer_store_dword v13, v9, s[4:7], s2 offen sc1
    v_mfma_f32_16x16x32_bf16 v[176:179], v[96:99], v[228:231], v[176:179]
    s_lshr_b32 s31, 0x17161514, s43
    s_and_b32 s31, s31, 31
    s_cmp_ge_u32 s31, 16
    s_cselect_b32 s32, 7, 15
    s_cselect_b32 s33, 0, s87
    v_mfma_f32_16x16x32_bf16 v[184:187], v[100:103], v[228:231], v[184:187]
    s_waitcnt lgkmcnt(4)
    ds_read_b128 v[228:231], v30 offset:48128
    v_add_f32 v32, v32, v33
    v_mfma_f32_16x16x32_bf16 v[168:171], v[208:211], v[96:99], v[168:171]
    s_add_u32 s33, s33, s87
    s_add_u32 s33, s33, s31
    s_and_b32 s33, s33, s32
    s_and_b32 s31, s31, 16
    s_or_b32 s31, s31, s33
    v_mfma_f32_16x16x32_bf16 v[172:175], v[208:211], v[100:103], v[172:175]
    s_waitcnt lgkmcnt(4)
    s_barrier
    ds_read_b128 v[208:211], v30 offset:49152
    v_mfma_f32_16x16x32_bf16 v[180:183], v[96:99], v[212:215], v[180:183]
    s_lshl_b32 s31, s31, 12
    s_add_u32 m0, s82, 114688
    s_add_u32 s31, s31, s40
    v_mfma_f32_16x16x32_bf16 v[188:191], v[100:103], v[212:215], v[188:191]
    s_waitcnt lgkmcnt(4)
    ds_read_b128 v[212:215], v30 offset:51200
    buffer_load_dwordx4 v16, s[4:7], s31 offen offset:0 sc1 lds
    v_mfma_f32_16x16x32_bf16 v[160:163], v[216:219], v[104:107], v[160:163]
    buffer_load_dwordx4 v16, s[4:7], s31 offen offset:1024 sc1 lds
    v_cvt_pk_bf16_f32 v33, v32, v32
    v_mfma_f32_16x16x32_bf16 v[164:167], v[216:219], v[108:111], v[164:167]
    s_waitcnt lgkmcnt(4)
    ds_read_b128 v[216:219], v30 offset:50176
    buffer_load_dwordx4 v16, s[4:7], s31 offen offset:2048 sc1 lds
    v_mfma_f32_16x16x32_bf16 v[176:179], v[104:107], v[220:223], v[176:179]
    buffer_load_dwordx4 v16, s[4:7], s31 offen offset:3072 sc1 lds
    v_and_b32 v33, 0xffff0000, v33
    v_mfma_f32_16x16x32_bf16 v[184:187], v[108:111], v[220:223], v[184:187]
    s_waitcnt lgkmcnt(4)
    ds_read_b128 v[220:223], v30 offset:52224
    v_sub_f32 v32, v32, v33
    v_mfma_f32_16x16x32_bf16 v[168:171], v[224:227], v[104:107], v[168:171]
    v_cvt_pk_bf16_f32 v24, v33, v32
    v_permlane32_swap_b32 v36, v37
    v_mfma_f32_16x16x32_bf16 v[172:175], v[224:227], v[108:111], v[172:175]
    s_waitcnt lgkmcnt(4)
    ds_read_b128 v[224:227], v30 offset:53248
    v_add_f32 v36, v36, v37
    v_mfma_f32_16x16x32_bf16 v[180:183], v[104:107], v[228:231], v[180:183]
    v_cvt_pk_bf16_f32 v37, v36, v36
    v_and_b32 v37, 0xffff0000, v37
    v_mfma_f32_16x16x32_bf16 v[188:191], v[108:111], v[228:231], v[188:191]
    s_waitcnt lgkmcnt(4)
    ds_read_b128 v[228:231], v30 offset:55296
    v_sub_f32 v36, v36, v37
    v_mfma_f32_16x16x32_bf16 v[160:163], v[208:211], v[112:115], v[160:163]
    v_cvt_pk_bf16_f32 v26, v37, v36
    v_permlane32_swap_b32 v40, v41
    v_mfma_f32_16x16x32_bf16 v[164:167], v[208:211], v[116:119], v[164:167]
    s_waitcnt lgkmcnt(4)
    ds_read_b128 v[208:211], v30 offset:54272
    v_add_f32 v40, v40, v41
    v_mfma_f32_16x16x32_bf16 v[176:179], v[112:115], v[212:215], v[176:179]
    v_cvt_pk_bf16_f32 v41, v40, v40
    v_and_b32 v41, 0xffff0000, v41
    v_mfma_f32_16x16x32_bf16 v[184:187], v[116:119], v[212:215], v[184:187]
    s_waitcnt lgkmcnt(4)
    ds_read_b128 v[212:215], v30 offset:56320
    v_sub_f32 v40, v40, v41
    v_mfma_f32_16x16x32_bf16 v[168:171], v[216:219], v[112:115], v[168:171]
    v_cvt_pk_bf16_f32 v28, v41, v40
    v_mfma_f32_16x16x32_bf16 v[172:175], v[216:219], v[116:119], v[172:175]
    s_waitcnt lgkmcnt(4)
    ds_read_b128 v[216:219], v30 offset:57344
    v_mfma_f32_16x16x32_bf16 v[180:183], v[112:115], v[220:223], v[180:183]
    s_add_u32 s96, s52, 270336
    s_cmp_eq_u32 s12, 0
    s_cselect_b32 s96, s49, s96
    s_cselect_b32 s97, s49, s52
    v_mfma_f32_16x16x32_bf16 v[188:191], v[116:119], v[220:223], v[188:191]
    s_waitcnt lgkmcnt(4)
    ds_read_b128 v[220:223], v30 offset:59392
    v_and_b32 v237, 0xf0, v16
    v_mfma_f32_16x16x32_bf16 v[160:163], v[224:227], v[120:123], v[160:163]
    v_lshl_add_u32 v237, v3, 8, v237
    v_bfe_u32 v1, v13, 4, 1
    v_mfma_f32_16x16x32_bf16 v[164:167], v[224:227], v[124:127], v[164:167]
    s_waitcnt lgkmcnt(4)
    ds_read_b128 v[224:227], v30 offset:58368
    v_lshl_add_u32 v237, v1, 9, v237
    v_mfma_f32_16x16x32_bf16 v[176:179], v[120:123], v[228:231], v[176:179]
    s_lshl_b32 s28, s19, 12
    s_add_u32 s28, s28, 131072
    v_add_u32 v2, s28, v237
    v_mfma_f32_16x16x32_bf16 v[184:187], v[124:127], v[228:231], v[184:187]
    s_waitcnt lgkmcnt(4)
    ds_read_b128 v[228:231], v30 offset:60416
    v_and_b32 v0, 31, v13
    v_mfma_f32_16x16x32_bf16 v[168:171], v[208:211], v[120:123], v[168:171]
    v_lshlrev_b32 v1, 2, v3
    v_sub_u32 v0, v0, v1
    v_mfma_f32_16x16x32_bf16 v[172:175], v[208:211], v[124:127], v[172:175]
    s_waitcnt lgkmcnt(4)
    ds_read_b128 v[208:211], v30 offset:61440
    v_mov_b32 v1, 0xff800000
    v_mfma_f32_16x16x32_bf16 v[180:183], v[120:123], v[212:215], v[180:183]
    s_lshr_b32 s28, s14, 1
    s_lshl_b32 s29, s28, 10
    v_add_u32 v248, s29, v30
    v_mfma_f32_16x16x32_bf16 v[188:191], v[124:127], v[212:215], v[188:191]
    s_waitcnt lgkmcnt(4)
    ds_read_b128 v[212:215], v30 offset:63488
    v_xor_b32 v249, 1024, v248
    v_mfma_f32_16x16x32_bf16 v[160:163], v[216:219], v[128:131], v[160:163]
    s_lshl_b32 s29, s28, 8
    s_add_u32 s29, s29, 2048
    v_add_u32 v250, s29, v30
    v_mfma_f32_16x16x32_bf16 v[164:167], v[216:219], v[132:135], v[164:167]
    s_waitcnt lgkmcnt(4)
    ds_read_b128 v[216:219], v30 offset:62464
    v_xor_b32 v251, 256, v250
    v_mfma_f32_16x16x32_bf16 v[176:179], v[128:131], v[220:223], v[176:179]
    v_add_u32 v252, s50, v237
    s_xor_b32 s29, s50, 28672
    v_mfma_f32_16x16x32_bf16 v[184:187], v[132:135], v[220:223], v[184:187]
    s_waitcnt lgkmcnt(4)
    ds_read_b128 v[220:223], v30 offset:64512
    v_add_u32 v254, s29, v237
    v_mfma_f32_16x16x32_bf16 v[168:171], v[224:227], v[128:131], v[168:171]
    s_lshl_b32 s29, s28, 10
    s_add_u32 s29, s29, s50
    v_add_u32 v247, s29, v16
    v_mfma_f32_16x16x32_bf16 v[172:175], v[224:227], v[132:135], v[172:175]
    s_waitcnt vmcnt(11) lgkmcnt(4)
    s_barrier
    ds_read_b128 v[224:227], v30 offset:0
    v_mfma_f32_16x16x32_bf16 v[180:183], v[128:131], v[228:231], v[180:183]
    v_mov_b32 v56, v236
    v_mov_b32 v58, 0
    v_mfma_f32_16x16x32_bf16 v[188:191], v[132:135], v[228:231], v[188:191]
    s_waitcnt lgkmcnt(4)
    ds_read_b128 v[228:231], v30 offset:2048
    v_mov_b32 v60, 0
    v_mfma_f32_16x16x32_bf16 v[160:163], v[208:211], v[136:139], v[160:163]
    v_mov_b32 v62, v236
    v_mov_b32 v57, 0
    v_mfma_f32_16x16x32_bf16 v[164:167], v[208:211], v[140:143], v[164:167]
    s_waitcnt lgkmcnt(4)
    ds_read_b128 v[208:211], v30 offset:1024
    v_permlane16_swap_b32 v56, v58
    v_mfma_f32_16x16x32_bf16 v[176:179], v[136:139], v[212:215], v[176:179]
    v_mov_b32 v59, 0
    v_permlane16_swap_b32 v60, v62
    v_mfma_f32_16x16x32_bf16 v[184:187], v[140:143], v[212:215], v[184:187]
    s_waitcnt lgkmcnt(4)
    ds_read_b128 v[212:215], v30 offset:3072
    v_mov_b32 v61, 0
    v_mfma_f32_16x16x32_bf16 v[168:171], v[216:219], v[136:139], v[168:171]
    v_mov_b32 v63, 0
    v_cmp_le_i32 s[26:27], 0, v0
    v_mfma_f32_16x16x32_bf16 v[172:175], v[216:219], v[140:143], v[172:175]
    s_waitcnt lgkmcnt(4)
    ds_read_b128 v[216:219], v30 offset:4096
    v_cmp_le_i32 s[28:29], 1, v0
    v_mfma_f32_16x16x32_bf16 v[180:183], v[136:139], v[220:223], v[180:183]
    v_mov_b32 v246, 0x3f803f80
    v_cndmask_b32 v32, v1, 0, s[26:27]
    v_mfma_f32_16x16x32_bf16 v[188:191], v[140:143], v[220:223], v[188:191]
    ds_read_b128 v[220:223], v30 offset:6144
    v_cndmask_b32 v33, v1, 0, s[28:29]
    v_cmp_le_i32 s[26:27], 2, v0
    v_cmp_le_i32 s[28:29], 3, v0
    v_mov_b32 v246, 0x3f803f80
    v_cndmask_b32 v34, v1, 0, s[26:27]
    v_cndmask_b32 v35, v1, 0, s[28:29]
    v_cmp_le_i32 s[26:27], 8, v0
    v_cmp_le_i32 s[28:29], 9, v0
    v_mov_b32 v246, 0x3f803f80
    v_cndmask_b32 v36, v1, 0, s[26:27]
    v_cndmask_b32 v37, v1, 0, s[28:29]
    v_cmp_le_i32 s[26:27], 10, v0
    v_cmp_le_i32 s[28:29], 11, v0
    v_mov_b32 v246, 0x3f803f80
    v_cndmask_b32 v38, v1, 0, s[26:27]
    v_cndmask_b32 v39, v1, 0, s[28:29]
    v_cmp_le_i32 s[26:27], 16, v0
    v_cmp_le_i32 s[28:29], 17, v0
    v_mov_b32 v246, 0x3f803f80
    v_cndmask_b32 v40, v1, 0, s[26:27]
    v_cndmask_b32 v41, v1, 0, s[28:29]
    v_cmp_le_i32 s[26:27], 18, v0
    v_cmp_le_i32 s[28:29], 19, v0
    v_mov_b32 v246, 0x3f803f80
    v_cndmask_b32 v42, v1, 0, s[26:27]
    v_cndmask_b32 v43, v1, 0, s[28:29]
    v_cmp_le_i32 s[26:27], 24, v0
    v_cmp_le_i32 s[28:29], 25, v0
    v_mov_b32 v246, 0x3f803f80
    v_cndmask_b32 v44, v1, 0, s[26:27]
    v_cndmask_b32 v45, v1, 0, s[28:29]
    v_cmp_le_i32 s[26:27], 26, v0
    v_cmp_le_i32 s[28:29], 27, v0
    v_mov_b32 v246, 0x3f803f80
    v_cndmask_b32 v46, v1, 0, s[26:27]
    v_cndmask_b32 v47, v1, 0, s[28:29]
    v_and_b32 v0, 0xf0, v16
    v_lshl_add_u32 v0, v3, 8, v0
    v_bfe_u32 v1, v13, 4, 1
    v_lshl_add_u32 v0, v1, 10, v0
    v_mov_b32 v1, 0
    s_nop 0
    v_mfma_f32_16x16x16_bf16 v[160:163], v[24:25], v[56:57], v[160:163]
    v_mfma_f32_16x16x16_bf16 v[164:167], v[24:25], v[58:59], v[164:167]
    v_mfma_f32_16x16x16_bf16 v[168:171], v[24:25], v[60:61], v[168:171]
    v_mfma_f32_16x16x16_bf16 v[172:175], v[24:25], v[62:63], v[172:175]
    v_mfma_f32_16x16x16_bf16 v[176:179], v[56:57], v[26:27], v[176:179]
    v_mfma_f32_16x16x16_bf16 v[184:187], v[58:59], v[26:27], v[184:187]
    v_mfma_f32_16x16x16_bf16 v[180:183], v[60:61], v[26:27], v[180:183]
    v_mfma_f32_16x16x16_bf16 v[188:191], v[62:63], v[26:27], v[188:191]
    v_mfma_f32_16x16x16_bf16 v[192:195], v[28:29], v[56:57], v[192:195]
    v_mfma_f32_16x16x16_bf16 v[196:199], v[28:29], v[58:59], v[196:199]
    v_mfma_f32_16x16x16_bf16 v[200:203], v[28:29], v[60:61], v[200:203]
    v_mfma_f32_16x16x16_bf16 v[204:207], v[28:29], v[62:63], v[204:207]
    v_mfma_f32_16x16x16_bf16 v[48:51], v[242:243], v[246:247], 0
    v_mfma_f32_16x16x16_bf16 v[52:55], v[244:245], v[246:247], 0
    s_waitcnt lgkmcnt(5)
    v_mfma_f32_16x16x32_bf16 v[160:163], v[224:227], v[144:147], v[160:163]
    v_mfma_f32_16x16x32_bf16 v[164:167], v[224:227], v[148:151], v[164:167]
    s_waitcnt lgkmcnt(4)
    ds_read_b128 v[224:227], v30 offset:5120
    v_mfma_f32_16x16x32_bf16 v[176:179], v[144:147], v[228:231], v[176:179]
    v_mfma_f32_16x16x32_bf16 v[184:187], v[148:151], v[228:231], v[184:187]
    s_waitcnt lgkmcnt(4)
    ds_read_b128 v[228:231], v30 offset:7168
    v_mfma_f32_16x16x32_bf16 v[168:171], v[208:211], v[144:147], v[168:171]
    v_mfma_f32_16x16x32_bf16 v[172:175], v[208:211], v[148:151], v[172:175]
    s_waitcnt lgkmcnt(4)
    ds_read_b128 v[208:211], v30 offset:8192
    v_mfma_f32_16x16x32_bf16 v[180:183], v[144:147], v[212:215], v[180:183]
    v_mfma_f32_16x16x32_bf16 v[188:191], v[148:151], v[212:215], v[188:191]
    s_waitcnt lgkmcnt(4)
    ds_read_b128 v[212:215], v30 offset:9216
    v_mfma_f32_16x16x32_bf16 v[160:163], v[216:219], v[152:155], v[160:163]
    v_mfma_f32_16x16x32_bf16 v[164:167], v[216:219], v[156:159], v[164:167]
    s_waitcnt lgkmcnt(4)
    ds_read_b128 v[216:219], v30 offset:10240
    v_mfma_f32_16x16x32_bf16 v[176:179], v[152:155], v[220:223], v[176:179]
    v_mfma_f32_16x16x32_bf16 v[184:187], v[156:159], v[220:223], v[184:187]
    s_waitcnt lgkmcnt(4)
    ds_read_b128 v[220:223], v30 offset:11264
    v_mfma_f32_16x16x32_bf16 v[168:171], v[224:227], v[152:155], v[168:171]
    v_mfma_f32_16x16x32_bf16 v[172:175], v[224:227], v[156:159], v[172:175]
    s_waitcnt lgkmcnt(4)
    ds_read_b128 v[224:227], v30 offset:12288
    v_mfma_f32_16x16x32_bf16 v[180:183], v[152:155], v[228:231], v[180:183]
    v_mfma_f32_16x16x32_bf16 v[188:191], v[156:159], v[228:231], v[188:191]
    s_waitcnt lgkmcnt(4)
    ds_read_b128 v[228:231], v30 offset:13312
    v_pk_mul_f32 v[160:161], v[160:161], v[240:241] op_sel_hi:[1,0]
    v_cvt_pk_bf16_f32 v160, v160, v161
    v_pk_mul_f32 v[162:163], v[162:163], v[240:241] op_sel_hi:[1,0]
    v_cvt_pk_bf16_f32 v161, v162, v163
    v_pk_mul_f32 v[164:165], v[164:165], v[240:241] op_sel:[0,1] op_sel_hi:[1,1]
    v_cvt_pk_bf16_f32 v162, v164, v165
    v_pk_mul_f32 v[166:167], v[166:167], v[240:241] op_sel:[0,1] op_sel_hi:[1,1]
    v_cvt_pk_bf16_f32 v163, v166, v167
    v_pk_mul_f32 v[168:169], v[168:169], v[240:241] op_sel_hi:[1,0]
    v_cvt_pk_bf16_f32 v164, v168, v169
    v_permlane32_swap_b32 v160, v162
    v_permlane32_swap_b32 v161, v163
    buffer_store_dwordx4 v[160:163], v237, s[4:7], s44 offen offset:0 sc1
    v_pk_mul_f32 v[170:171], v[170:171], v[240:241] op_sel_hi:[1,0]
    v_cvt_pk_bf16_f32 v165, v170, v171
    v_pk_mul_f32 v[172:173], v[172:173], v[240:241] op_sel:[0,1] op_sel_hi:[1,1]
    v_cvt_pk_bf16_f32 v166, v172, v173
    v_pk_mul_f32 v[174:175], v[174:175], v[240:241] op_sel:[0,1] op_sel_hi:[1,1]
    v_cvt_pk_bf16_f32 v167, v174, v175
    v_pk_mul_f32 v[176:177], v[176:177], v[48:49]
    v_cvt_pk_bf16_f32 v176, v176, v177
    v_permlane32_swap_b32 v164, v166
    v_permlane32_swap_b32 v165, v167
    buffer_store_dwordx4 v[164:167], v237, s[4:7], s44 offen offset:1024 sc1
    v_pk_mul_f32 v[178:179], v[178:179], v[50:51]
    v_cvt_pk_bf16_f32 v177, v178, v179
    v_pk_mul_f32 v[180:181], v[180:181], v[48:49]
    v_cvt_pk_bf16_f32 v178, v180, v181
    v_pk_mul_f32 v[182:183], v[182:183], v[50:51]
    v_cvt_pk_bf16_f32 v179, v182, v183
    v_pk_mul_f32 v[184:185], v[184:185], v[52:53]
    v_cvt_pk_bf16_f32 v180, v184, v185
    v_permlane32_swap_b32 v176, v178
    v_permlane32_swap_b32 v177, v179
    buffer_store_dwordx4 v[176:179], v237, s[4:7], s44 offen offset:2048 sc1
    v_pk_mul_f32 v[186:187], v[186:187], v[54:55]
    v_cvt_pk_bf16_f32 v181, v186, v187
    v_pk_mul_f32 v[188:189], v[188:189], v[52:53]
    v_cvt_pk_bf16_f32 v182, v188, v189
    v_pk_mul_f32 v[190:191], v[190:191], v[54:55]
    v_cvt_pk_bf16_f32 v183, v190, v191
    v_permlane32_swap_b32 v180, v182
    s_nop 0
    v_permlane32_swap_b32 v181, v183
    buffer_store_dwordx4 v[180:183], v237, s[4:7], s44 offen offset:3072 sc1
    v_mfma_f32_16x16x32_bf16 v[192:195], v[208:211], v[64:67], v[192:195]
    s_waitcnt vmcnt(11)
    v_mfma_f32_16x16x32_bf16 v[196:199], v[208:211], v[68:71], v[196:199]
    s_waitcnt lgkmcnt(4)
    ds_read_b128 v[208:211], v30 offset:14336
    v_mfma_f32_16x16x32_bf16 v[200:203], v[212:215], v[64:67], v[200:203]
    v_mfma_f32_16x16x32_bf16 v[204:207], v[212:215], v[68:71], v[204:207]
    s_waitcnt lgkmcnt(4)
    ds_read_b128 v[212:215], v30 offset:15360
    v_mfma_f32_16x16x32_bf16 v[192:195], v[216:219], v[72:75], v[192:195]
    v_mfma_f32_16x16x32_bf16 v[196:199], v[216:219], v[76:79], v[196:199]
    s_waitcnt vmcnt(4) lgkmcnt(4)
    s_barrier
    ds_read_b128 v[216:219], v30 offset:16384
    v_mfma_f32_16x16x32_bf16 v[200:203], v[220:223], v[72:75], v[200:203]
    v_mfma_f32_16x16x32_bf16 v[204:207], v[220:223], v[76:79], v[204:207]
    s_waitcnt lgkmcnt(4)
    ds_read_b128 v[220:223], v30 offset:17408
    ds_write_b128 v2, v[160:163] offset:0
    v_mfma_f32_16x16x32_bf16 v[192:195], v[224:227], v[80:83], v[192:195]
    v_xor_b32 v48, 0xff800000, v32
    v_xor_b32 v49, 0xff800000, v33
    v_mfma_f32_16x16x32_bf16 v[196:199], v[224:227], v[84:87], v[196:199]
    s_waitcnt lgkmcnt(5)
    ds_read_b128 v[224:227], v30 offset:18432
    v_xor_b32 v50, 0xff800000, v34
    v_mfma_f32_16x16x32_bf16 v[200:203], v[228:231], v[80:83], v[200:203]
    v_xor_b32 v51, 0xff800000, v35
    v_mfma_f32_16x16x32_bf16 v[204:207], v[228:231], v[84:87], v[204:207]
    s_waitcnt lgkmcnt(5)
    ds_read_b128 v[228:231], v30 offset:19456
    buffer_store_dwordx4 v[160:163], v237, s[4:7], s45 offen offset:0
    v_mfma_f32_16x16x32_bf16 v[192:195], v[208:211], v[88:91], v[192:195]
    v_mov_b32 v64, 0x3f803f80
    v_mov_b32 v65, 0x3f803f80
    v_mfma_f32_16x16x32_bf16 v[196:199], v[208:211], v[92:95], v[196:199]
    s_waitcnt lgkmcnt(5)
    ds_read_b128 v[208:211], v30 offset:20480
    v_mov_b32 v66, 0x3f803f80
    v_mfma_f32_16x16x32_bf16 v[200:203], v[212:215], v[88:91], v[200:203]
    v_mov_b32 v67, 0x3f803f80
    v_mfma_f32_16x16x32_bf16 v[204:207], v[212:215], v[92:95], v[204:207]
    s_waitcnt lgkmcnt(5)
    ds_read_b128 v[212:215], v30 offset:21504
    ds_write_b128 v2, v[164:167] offset:1024
    v_mfma_f32_16x16x32_bf16 v[192:195], v[216:219], v[96:99], v[192:195]
    v_xor_b32 v52, 0xff800000, v36
    v_xor_b32 v53, 0xff800000, v37
    v_mfma_f32_16x16x32_bf16 v[196:199], v[216:219], v[100:103], v[196:199]
    s_waitcnt lgkmcnt(6)
    ds_read_b128 v[216:219], v30 offset:22528
    v_xor_b32 v54, 0xff800000, v38
    v_mfma_f32_16x16x32_bf16 v[200:203], v[220:223], v[96:99], v[200:203]
    v_xor_b32 v55, 0xff800000, v39
    v_mfma_f32_16x16x32_bf16 v[204:207], v[220:223], v[100:103], v[204:207]
    s_waitcnt lgkmcnt(5)
    ds_read_b128 v[220:223], v30 offset:23552
    buffer_store_dwordx4 v[164:167], v237, s[4:7], s45 offen offset:1024
    v_mfma_f32_16x16x32_bf16 v[192:195], v[224:227], v[104:107], v[192:195]
    v_mov_b32 v68, 0x3f803f80
    v_mov_b32 v69, 0x3f803f80
    v_mfma_f32_16x16x32_bf16 v[196:199], v[224:227], v[108:111], v[196:199]
    s_waitcnt lgkmcnt(5)
    ds_read_b128 v[224:227], v30 offset:24576
    v_mov_b32 v70, 0x3f803f80
    v_mfma_f32_16x16x32_bf16 v[200:203], v[228:231], v[104:107], v[200:203]
    v_mov_b32 v71, 0x3f803f80
    v_mfma_f32_16x16x32_bf16 v[204:207], v[228:231], v[108:111], v[204:207]
    s_waitcnt lgkmcnt(5)
    ds_read_b128 v[228:231], v30 offset:25600
    ds_write_b128 v2, v[176:179] offset:2048
    v_mfma_f32_16x16x32_bf16 v[192:195], v[208:211], v[112:115], v[192:195]
    v_xor_b32 v56, 0xff800000, v40
    v_xor_b32 v57, 0xff800000, v41
    v_mfma_f32_16x16x32_bf16 v[196:199], v[208:211], v[116:119], v[196:199]
    s_waitcnt lgkmcnt(6)
    ds_read_b128 v[208:211], v30 offset:26624
    v_xor_b32 v58, 0xff800000, v42
    v_mfma_f32_16x16x32_bf16 v[200:203], v[212:215], v[112:115], v[200:203]
    v_xor_b32 v59, 0xff800000, v43
    v_mfma_f32_16x16x32_bf16 v[204:207], v[212:215], v[116:119], v[204:207]
    s_waitcnt lgkmcnt(5)
    ds_read_b128 v[212:215], v30 offset:27648
    buffer_load_dwordx4 a[0:3], v233, s[4:7], s84 offen offset:0 sc1
    v_mfma_f32_16x16x32_bf16 v[192:195], v[216:219], v[120:123], v[192:195]
    buffer_store_dwordx4 v[176:179], v237, s[4:7], s45 offen offset:2048
    v_mov_b32 v72, 0x3f803f80
    v_mfma_f32_16x16x32_bf16 v[196:199], v[216:219], v[124:127], v[196:199]
    s_waitcnt lgkmcnt(5)
    ds_read_b128 v[216:219], v30 offset:28672
    buffer_load_dwordx4 a[4:7], v233, s[4:7], s84 offen offset:1024 sc1
    v_mfma_f32_16x16x32_bf16 v[200:203], v[220:223], v[120:123], v[200:203]
    v_mov_b32 v73, 0x3f803f80
    v_mov_b32 v74, 0x3f803f80
    v_mfma_f32_16x16x32_bf16 v[204:207], v[220:223], v[124:127], v[204:207]
    s_waitcnt lgkmcnt(5)
    ds_read_b128 v[220:223], v30 offset:29696
    buffer_load_dwordx4 a[8:11], v233, s[4:7], s84 offen offset:2048 sc1
    v_mfma_f32_16x16x32_bf16 v[192:195], v[224:227], v[128:131], v[192:195]
    v_mov_b32 v75, 0x3f803f80
    v_mfma_f32_16x16x32_bf16 v[196:199], v[224:227], v[132:135], v[196:199]
    s_waitcnt lgkmcnt(5)
    ds_read_b128 v[224:227], v30 offset:30720
    buffer_load_dwordx4 a[12:15], v233, s[4:7], s84 offen offset:3072 sc1
    v_mfma_f32_16x16x32_bf16 v[200:203], v[228:231], v[128:131], v[200:203]
    ds_write_b128 v2, v[180:183] offset:3072
    v_xor_b32 v60, 0xff800000, v44
    v_mfma_f32_16x16x32_bf16 v[204:207], v[228:231], v[132:135], v[204:207]
    s_waitcnt lgkmcnt(5)
    ds_read_b128 v[228:231], v30 offset:31744
    buffer_load_dwordx4 a[16:19], v17, s[4:7], s84 offen offset:0 sc1
    v_mfma_f32_16x16x32_bf16 v[192:195], v[208:211], v[136:139], v[192:195]
    v_xor_b32 v61, 0xff800000, v45
    v_xor_b32 v62, 0xff800000, v46
    v_mfma_f32_16x16x32_bf16 v[196:199], v[208:211], v[140:143], v[196:199]
    s_waitcnt lgkmcnt(5)
    buffer_load_dwordx4 a[20:23], v17, s[4:7], s84 offen offset:1024 sc1
    v_xor_b32 v63, 0xff800000, v47
    v_mfma_f32_16x16x32_bf16 v[200:203], v[212:215], v[136:139], v[200:203]
    buffer_store_dwordx4 v[180:183], v237, s[4:7], s45 offen offset:3072
    v_mov_b32 v76, 0x3f803f80
    v_mfma_f32_16x16x32_bf16 v[204:207], v[212:215], v[140:143], v[204:207]
    s_waitcnt lgkmcnt(4)
    buffer_load_dwordx4 a[24:27], v17, s[4:7], s84 offen offset:2048 sc1
    v_mov_b32 v77, 0x3f803f80
    v_mfma_f32_16x16x32_bf16 v[192:195], v[216:219], v[144:147], v[192:195]
    v_mov_b32 v78, 0x3f803f80
    v_mov_b32 v79, 0x3f803f80
    v_mfma_f32_16x16x32_bf16 v[196:199], v[216:219], v[148:151], v[196:199]
    s_waitcnt lgkmcnt(3)
    buffer_load_dword v232, v232, s[4:7], 0 offen sc1
    v_mfma_f32_16x16x32_bf16 v[200:203], v[220:223], v[144:147], v[200:203]
    v_mfma_f32_16x16x32_bf16 v[204:207], v[220:223], v[148:151], v[204:207]
    s_waitcnt lgkmcnt(2)
    buffer_load_dword v232, v7, s[8:11], s61 offen sc1
    v_mfma_f32_16x16x32_bf16 v[192:195], v[224:227], v[152:155], v[192:195]
    v_mfma_f32_16x16x32_bf16 v[196:199], v[224:227], v[156:159], v[196:199]
    s_waitcnt lgkmcnt(0)
    buffer_load_dword v232, v7, s[8:11], s62 offen sc1
    v_mfma_f32_16x16x32_bf16 v[200:203], v[228:231], v[152:155], v[200:203]
    v_mfma_f32_16x16x32_bf16 v[204:207], v[228:231], v[156:159], v[204:207]
    s_nop 2
    v_pk_mul_f32 v[192:193], v[192:193], v[238:239] op_sel_hi:[1,0]
    v_cvt_pk_bf16_f32 v192, v192, v193
    v_pk_mul_f32 v[194:195], v[194:195], v[238:239] op_sel_hi:[1,0]
    v_cvt_pk_bf16_f32 v193, v194, v195
    v_pk_mul_f32 v[196:197], v[196:197], v[238:239] op_sel:[0,1] op_sel_hi:[1,1]
    v_cvt_pk_bf16_f32 v194, v196, v197
    v_pk_mul_f32 v[198:199], v[198:199], v[238:239] op_sel:[0,1] op_sel_hi:[1,1]
    v_cvt_pk_bf16_f32 v195, v198, v199
    v_pk_mul_f32 v[200:201], v[200:201], v[238:239] op_sel_hi:[1,0]
    v_cvt_pk_bf16_f32 v196, v200, v201
    v_permlane32_swap_b32 v192, v194
    v_permlane32_swap_b32 v193, v195
    ds_write_b128 v252, v[192:195]
    v_pk_mul_f32 v[202:203], v[202:203], v[238:239] op_sel_hi:[1,0]
    v_cvt_pk_bf16_f32 v197, v202, v203
    v_pk_mul_f32 v[204:205], v[204:205], v[238:239] op_sel:[0,1] op_sel_hi:[1,1]
    v_cvt_pk_bf16_f32 v198, v204, v205
    v_pk_mul_f32 v[206:207], v[206:207], v[238:239] op_sel:[0,1] op_sel_hi:[1,1]
    v_cvt_pk_bf16_f32 v199, v206, v207
    v_permlane32_swap_b32 v196, v198
    s_nop 0
    v_permlane32_swap_b32 v197, v199
    ds_write_b128 v254, v[196:199] offset:1024
    s_cmp_eq_u32 s18, 3
    s_cselect_b32 s30, 4, 0
    s_cselect_b32 s31, 0, 32
    s_lshl_b32 s32, s18, 5
    s_add_u32 s31, s31, 3072
    v_bfe_u32 v89, v13, 2, 2
    v_lshl_add_u32 v89, v3, 2, v89
    v_bfe_u32 v90, v13, 4, 1
    v_mul_u32_u24 v91, s30, v90
    v_xor_b32 v89, v89, v91
    v_mul_u32_u24 v89, s32, v89
    v_mad_u32_u24 v89, v90, s31, v89
    v_and_b32 v90, 3, v13
    v_lshl_add_u32 v88, v90, 3, v89
    v_add_u32 v88, 49152, v88
    s_lshl_b32 s31, s18, 8
    v_add_u32 v80, s89, v88
    v_add_u32 v81, s31, v80
    v_add_u32 v82, s31, v81
    v_add_u32 v83, s31, v82
    s_cmp_eq_u32 s18, 3
    s_cselect_b32 s31, 32, 0
    s_cselect_b32 s32, 0, 32
    v_xor_b32 v84, s32, v80
    v_add_u32 v84, s31, v84
    v_xor_b32 v85, s32, v81
    v_add_u32 v85, s31, v85
    v_xor_b32 v86, s32, v82
    v_add_u32 v86, s31, v86
    v_xor_b32 v87, s32, v83
    v_add_u32 v87, s31, v87
    s_waitcnt vmcnt(14)
    buffer_store_dword v11, v9, s[4:7], s47 offen offset:0 sc1
    ds_read_b64_tr_b16 v[96:97], v80 offset:0
    ds_read_b64_tr_b16 v[98:99], v81 offset:0
    ds_read_b64_tr_b16 v[100:101], v84 offset:0
    ds_read_b64_tr_b16 v[102:103], v85 offset:0
    ds_read_b64_tr_b16 v[104:105], v80 offset:64
    ds_read_b64_tr_b16 v[106:107], v81 offset:64
    ds_read_b64_tr_b16 v[108:109], v82 offset:0
    ds_read_b64_tr_b16 v[110:111], v83 offset:0
    ds_read_b64_tr_b16 v[112:113], v86 offset:0
    ds_read_b64_tr_b16 v[114:115], v87 offset:0
    ds_read_b64_tr_b16 v[116:117], v82 offset:64
    ds_read_b64_tr_b16 v[118:119], v83 offset:64
    s_add_u32 s31, s89, 49152
    v_add_u32 v88, s31, v16
    s_waitcnt lgkmcnt(8)
    ds_write_b128 v88, v[96:99] offset:0
    buffer_load_dwordx4 a[28:31], v17, s[4:7], s84 offen offset:3072 sc1
    v_dot2_f32_bf16 v12, v96, s36, v12
    v_dot2_f32_bf16 v12, v97, s36, v12
    v_dot2_f32_bf16 v12, v98, s36, v12
    v_dot2_f32_bf16 v12, v99, s36, v12
    ds_write_b128 v88, v[100:103] offset:1024
    buffer_load_dwordx4 a[32:35], v18, s[4:7], s84 offen offset:0 sc1
    v_dot2_f32_bf16 v253, v100, s36, v253
    v_dot2_f32_bf16 v253, v101, s36, v253
    v_dot2_f32_bf16 v253, v102, s36, v253
    v_dot2_f32_bf16 v253, v103, s36, v253
    s_waitcnt lgkmcnt(6)
    ds_write_b128 v88, v[104:107] offset:2048
    buffer_load_dwordx4 a[36:39], v18, s[4:7], s84 offen offset:1024 sc1
    v_dot2_f32_bf16 v31, v104, s36, v31
    v_dot2_f32_bf16 v31, v105, s36, v31
    v_dot2_f32_bf16 v31, v106, s36, v31
    v_dot2_f32_bf16 v31, v107, s36, v31
    ds_write_b128 v88, v[108:111] offset:3072
    buffer_load_dwordx4 a[40:43], v18, s[4:7], s84 offen offset:2048 sc1
    v_dot2_f32_bf16 v12, v108, s36, v12
    v_dot2_f32_bf16 v12, v109, s36, v12
    v_dot2_f32_bf16 v12, v110, s36, v12
    v_dot2_f32_bf16 v12, v111, s36, v12
    s_waitcnt lgkmcnt(4)
    ds_write_b128 v88, v[112:115] offset:4096
    buffer_load_dwordx4 a[44:47], v18, s[4:7], s84 offen offset:3072 sc1
    v_dot2_f32_bf16 v253, v112, s36, v253
    v_dot2_f32_bf16 v253, v113, s36, v253
    v_dot2_f32_bf16 v253, v114, s36, v253
    v_dot2_f32_bf16 v253, v115, s36, v253
    ds_write_b128 v88, v[116:119] offset:5120
    buffer_load_dwordx4 a[48:51], v19, s[4:7], s84 offen offset:0 sc1
    buffer_load_dwordx4 a[52:55], v19, s[4:7], s84 offen offset:1024 sc1
    v_dot2_f32_bf16 v31, v116, s36, v31
    v_dot2_f32_bf16 v31, v117, s36, v31
    v_dot2_f32_bf16 v31, v118, s36, v31
    v_dot2_f32_bf16 v31, v119, s36, v31
    s_waitcnt vmcnt(12)
    s_cbranch_vccnz SAFE_2
    buffer_store_dword v11, v10, s[4:7], s46 offen offset:0
BACK_3:
    ds_read_b64_tr_b16 v[96:97], v80 offset:24576
    ds_read_b64_tr_b16 v[98:99], v81 offset:24576
    ds_read_b64_tr_b16 v[100:101], v84 offset:24576
    ds_read_b64_tr_b16 v[102:103], v85 offset:24576
    ds_read_b64_tr_b16 v[104:105], v80 offset:24640
    ds_read_b64_tr_b16 v[106:107], v81 offset:24640
    ds_read_b64_tr_b16 v[108:109], v82 offset:24576
    ds_read_b64_tr_b16 v[110:111], v83 offset:24576
    ds_read_b64_tr_b16 v[112:113], v86 offset:24576
    ds_read_b64_tr_b16 v[114:115], v87 offset:24576
    ds_read_b64_tr_b16 v[116:117], v82 offset:24640
    ds_read_b64_tr_b16 v[118:119], v83 offset:24640
    s_add_u32 s31, s89, 73728
    v_add_u32 v88, s31, v16
    s_waitcnt lgkmcnt(8)
    ds_write_b128 v88, v[96:99] offset:0
    s_getpc_b64 s[90:91]
CPF_4:
    s_lshl2_add_u32 s92, s13, s14
    s_lshl_b32 s92, s92, 7
    s_sub_u32 s90, s90, CPF_4 - M_pc
    s_subb_u32 s91, s91, 0
    s_add_u32 s92, s92, ATT0_done - M_pc
    v_lshl_add_u32 v246, v15, 12, s92
    v_min_u32 v246, M_last - M_pc - 4, v246
    v_dot2_f32_bf16 v12, v96, s36, v12
    v_dot2_f32_bf16 v12, v97, s36, v12
    v_dot2_f32_bf16 v12, v98, s36, v12
    v_dot2_f32_bf16 v12, v99, s36, v12
    ds_write_b128 v88, v[100:103] offset:1024
    buffer_load_dwordx4 a[56:59], v19, s[4:7], s84 offen offset:2048 sc1
    v_dot2_f32_bf16 v253, v100, s36, v253
    v_dot2_f32_bf16 v253, v101, s36, v253
    v_dot2_f32_bf16 v253, v102, s36, v253
    v_dot2_f32_bf16 v253, v103, s36, v253
    s_waitcnt lgkmcnt(6)
    ds_write_b128 v88, v[104:107] offset:2048
    buffer_load_dwordx4 a[60:63], v19, s[4:7], s84 offen offset:3072 sc1
    buffer_load_dwordx4 a[64:67], v20, s[4:7], s84 offen offset:0 sc1
    v_dot2_f32_bf16 v31, v104, s36, v31
    v_dot2_f32_bf16 v31, v105, s36, v31
    v_dot2_f32_bf16 v31, v106, s36, v31
    v_dot2_f32_bf16 v31, v107, s36, v31
    ds_write_b128 v88, v[108:111] offset:3072
    buffer_load_dwordx4 a[68:71], v20, s[4:7], s84 offen offset:1024 sc1
    v_dot2_f32_bf16 v12, v108, s36, v12
    v_dot2_f32_bf16 v12, v109, s36, v12
    v_dot2_f32_bf16 v12, v110, s36, v12
    v_dot2_f32_bf16 v12, v111, s36, v12
    s_waitcnt lgkmcnt(4)
    ds_write_b128 v88, v[112:115] offset:4096
    buffer_load_dwordx4 a[72:75], v20, s[4:7], s84 offen offset:2048 sc1
    v_dot2_f32_bf16 v253, v112, s36, v253
    v_dot2_f32_bf16 v253, v113, s36, v253
    v_dot2_f32_bf16 v253, v114, s36, v253
    v_dot2_f32_bf16 v253, v115, s36, v253
    ds_write_b128 v88, v[116:119] offset:5120
    buffer_load_dwordx4 a[76:79], v20, s[4:7], s84 offen offset:3072 sc1
    buffer_load_dwordx4 a[80:83], v21, s[4:7], s84 offen offset:0 sc1
    v_dot2_f32_bf16 v31, v116, s36, v31
    v_dot2_f32_bf16 v31, v117, s36, v31
    v_dot2_f32_bf16 v31, v118, s36, v31
    v_dot2_f32_bf16 v31, v119, s36, v31
    v_xor_b32 v252, 1024, v247
    s_mov_b32 s87, 671088640
    s_cmp_eq_u32 s17, 1
    s_cbranch_scc1 ATT0_1
    s_cmp_eq_u32 s17, 2
    s_cbranch_scc1 ATT0_2
    s_cmp_eq_u32 s17, 3
    s_cbranch_scc1 ATT0_3
    s_branch ATT0_0
.p2align 12
ATT0_0:
    s_waitcnt lgkmcnt(0)
    s_barrier
    ds_read_b128 v[144:147], v247
    ds_read_b128 v[148:151], v252
    ds_read_b128 v[136:139], v249 offset:32768
    ds_read_b128 v[140:143], v249 offset:36864
    s_mov_b64 exec, s[20:21]
    ds_read_b128 v[64:67], v251 offset:32768
    ds_read_b128 v[68:71], v251 offset:33792
    s_mov_b64 exec, -1
    s_waitcnt lgkmcnt(3)
    v_mfma_f32_32x32x16_bf16 v[96:111], v[136:139], v[148:151], 0
    ds_read_b128 v[136:139], v249 offset:57344
    s_waitcnt lgkmcnt(3)
    v_mfma_f32_32x32x16_bf16 v[112:127], v[140:143], v[148:151], 0
    s_waitcnt lgkmcnt(1)
    ds_read_b128 v[140:143], v249 offset:61440
    buffer_load_dword v14, v1, s[4:7], s48 offen offset:0 sc1
    buffer_load_dwordx4 a[84:87], v21, s[4:7], s84 offen offset:1024 sc1
    s_nop 4
    v_exp_f32 v96, v96
    v_exp_f32 v97, v97
    v_exp_f32 v98, v98
    v_exp_f32 v99, v99
    s_mov_b64 exec, s[20:21]
    ds_read_b128 v[72:75], v251 offset:36864
    ds_read_b128 v[76:79], v251 offset:37888
    s_mov_b64 exec, -1
    v_cvt_pk_bf16_f32 v128, v96, v97
    v_exp_f32 v100, v100
    v_exp_f32 v101, v101
    v_cvt_pk_bf16_f32 v129, v98, v99
    v_exp_f32 v102, v102
    v_exp_f32 v103, v103
    v_exp_f32 v104, v104
    v_cvt_pk_bf16_f32 v130, v100, v101
    v_cvt_pk_bf16_f32 v131, v102, v103
    v_exp_f32 v105, v105
    v_exp_f32 v106, v106
    v_mfma_f32_32x32x16_bf16 v[208:223], v[64:67], v[128:131], 0
    buffer_load_dwordx4 a[88:91], v21, s[4:7], s84 offen offset:2048 sc1
    v_exp_f32 v107, v107
    v_cvt_pk_bf16_f32 v132, v104, v105
    v_exp_f32 v108, v108
    v_exp_f32 v109, v109
    v_cvt_pk_bf16_f32 v133, v106, v107
    v_exp_f32 v110, v110
    v_exp_f32 v111, v111
    v_cvt_pk_bf16_f32 v134, v108, v109
    v_cvt_pk_bf16_f32 v135, v110, v111
    s_waitcnt lgkmcnt(3)
    v_mfma_f32_32x32x16_bf16 v[96:111], v[136:139], v[148:151], 0
    s_waitcnt lgkmcnt(0)
    ds_read_b128 v[136:139], v248 offset:32768
    s_waitcnt vmcnt(2)
    v_cmp_gt_u32 vcc, s34, v14
    s_cbranch_vccnz SPIN_5
BACK_6:
    s_mov_b32 m0, s50
    s_nop 0
    buffer_load_dwordx4 v16, s[4:7], s49 offen offset:0 sc1 lds
    buffer_load_dwordx4 v16, s[4:7], s49 offen offset:1024 sc1 lds
    buffer_load_dwordx4 v16, s[4:7], s49 offen offset:2048 sc1 lds
    buffer_load_dwordx4 v16, s[4:7], s49 offen offset:3072 sc1 lds
    buffer_load_dwordx4 a[92:95], v21, s[4:7], s84 offen offset:3072 sc1
    v_exp_f32 v112, v112
    v_exp_f32 v113, v113
    v_exp_f32 v114, v114
    v_exp_f32 v115, v115
    v_mfma_f32_32x32x16_bf16 v[208:223], v[68:71], v[132:135], v[208:223]
    s_mov_b64 exec, s[20:21]
    ds_read_b128 v[64:67], v251 offset:57344
    ds_read_b128 v[68:71], v251 offset:58368
    s_mov_b64 exec, -1
    v_cvt_pk_bf16_f32 v128, v112, v113
    v_exp_f32 v116, v116
    v_exp_f32 v117, v117
    v_cvt_pk_bf16_f32 v129, v114, v115
    v_exp_f32 v118, v118
    v_exp_f32 v119, v119
    v_exp_f32 v120, v120
    v_cvt_pk_bf16_f32 v130, v116, v117
    v_cvt_pk_bf16_f32 v131, v118, v119
    v_exp_f32 v121, v121
    v_exp_f32 v122, v122
    v_mfma_f32_32x32x16_bf16 v[208:223], v[72:75], v[128:131], v[208:223]
    buffer_load_dword v2, v4, s[4:7], s51 offen offset:0 sc1
    buffer_load_dwordx4 a[96:99], v22, s[4:7], s84 offen offset:0 sc1
    buffer_load_dwordx4 a[100:103], v22, s[4:7], s84 offen offset:1024 sc1
    v_exp_f32 v123, v123
    v_cvt_pk_bf16_f32 v132, v120, v121
    v_exp_f32 v124, v124
    v_exp_f32 v125, v125
    v_cvt_pk_bf16_f32 v133, v122, v123
    v_exp_f32 v126, v126
    v_exp_f32 v127, v127
    v_cvt_pk_bf16_f32 v134, v124, v125
    v_cvt_pk_bf16_f32 v135, v126, v127
    v_mfma_f32_32x32x16_bf16 v[112:127], v[140:143], v[148:151], v[32:47]
    s_waitcnt lgkmcnt(0)
    buffer_load_dwordx4 a[104:107], v22, s[4:7], s84 offen offset:2048 sc1
    v_exp_f32 v96, v96
    v_exp_f32 v97, v97
    v_exp_f32 v98, v98
    v_exp_f32 v99, v99
    v_mfma_f32_32x32x16_bf16 v[208:223], v[76:79], v[132:135], v[208:223]
    s_mov_b64 exec, s[20:21]
    ds_read_b128 v[72:75], v251 offset:61440
    ds_read_b128 v[76:79], v251 offset:62464
    s_mov_b64 exec, -1
    v_cvt_pk_bf16_f32 v128, v96, v97
    v_exp_f32 v100, v100
    v_exp_f32 v101, v101
    v_cvt_pk_bf16_f32 v129, v98, v99
    v_exp_f32 v102, v102
    v_exp_f32 v103, v103
    v_exp_f32 v104, v104
    v_cvt_pk_bf16_f32 v130, v100, v101
    v_cvt_pk_bf16_f32 v131, v102, v103
    v_exp_f32 v105, v105
    v_exp_f32 v106, v106
    v_mfma_f32_32x32x16_bf16 v[208:223], v[64:67], v[128:131], v[208:223]
    buffer_load_dwordx4 a[108:111], v22, s[4:7], s84 offen offset:3072 sc1
    v_exp_f32 v107, v107
    v_cvt_pk_bf16_f32 v132, v104, v105
    v_exp_f32 v108, v108
    v_exp_f32 v109, v109
    v_cvt_pk_bf16_f32 v133, v106, v107
    v_exp_f32 v110, v110
    v_exp_f32 v111, v111
    v_cvt_pk_bf16_f32 v134, v108, v109
    v_cvt_pk_bf16_f32 v135, v110, v111
    v_mfma_f32_32x32x16_bf16 v[96:111], v[136:139], v[144:147], v[32:47]
    s_waitcnt lgkmcnt(0)
    buffer_load_dwordx4 a[112:115], v23, s[4:7], s84 offen offset:0 sc1
    v_exp_f32 v112, v112
    v_exp_f32 v113, v113
    v_exp_f32 v114, v114
    v_exp_f32 v115, v115
    v_mfma_f32_32x32x16_bf16 v[208:223], v[68:71], v[132:135], v[208:223]
    s_mov_b64 exec, s[20:21]
    ds_read_b128 v[64:67], v250 offset:32768
    ds_read_b128 v[68:71], v250 offset:33792
    s_mov_b64 exec, -1
    v_cvt_pk_bf16_f32 v128, v112, v113
    v_exp_f32 v116, v116
    v_exp_f32 v117, v117
    v_cvt_pk_bf16_f32 v129, v114, v115
    v_exp_f32 v118, v118
    v_exp_f32 v119, v119
    v_exp_f32 v120, v120
    v_cvt_pk_bf16_f32 v130, v116, v117
    v_cvt_pk_bf16_f32 v131, v118, v119
    v_exp_f32 v121, v121
    v_exp_f32 v122, v122
    v_mfma_f32_32x32x16_bf16 v[208:223], v[72:75], v[128:131], v[208:223]
    s_waitcnt vmcnt(7)
    s_barrier
    s_waitcnt vmcnt(5)
    v_cmp_gt_u32 vcc, s34, v2
    s_cbranch_vccnz SPIN_8
BACK_9:
    s_add_u32 m0, s82, 114688
    s_nop 0
    buffer_load_dwordx4 v16, s[4:7], s96 offen offset:0 sc1 lds
    buffer_load_dwordx4 v16, s[4:7], s96 offen offset:1024 sc1 lds
    buffer_load_dwordx4 v16, s[4:7], s96 offen offset:2048 sc1 lds
    buffer_load_dwordx4 v16, s[4:7], s96 offen offset:3072 sc1 lds
    buffer_load_dwordx4 a[116:119], v23, s[4:7], s84 offen offset:1024 sc1
    ds_read_b128 v[140:143], v249 offset:40960
    ds_read_b128 v[136:139], v249 offset:45056
    v_exp_f32 v123, v123
    v_cvt_pk_bf16_f32 v132, v120, v121
    v_exp_f32 v124, v124
    v_exp_f32 v125, v125
    v_cvt_pk_bf16_f32 v133, v122, v123
    v_exp_f32 v126, v126
    v_exp_f32 v127, v127
    v_cvt_pk_bf16_f32 v134, v124, v125
    v_cvt_pk_bf16_f32 v135, v126, v127
    s_waitcnt lgkmcnt(1)
    v_mfma_f32_32x32x16_bf16 v[112:127], v[140:143], v[148:151], 0
    ds_read_b128 v[140:143], v249 offset:49152
    buffer_load_dwordx4 a[120:123], v23, s[4:7], s84 offen offset:2048 sc1
    buffer_load_dwordx4 a[124:127], v23, s[4:7], s84 offen offset:3072 sc1
    v_exp_f32 v96, v96
    v_exp_f32 v97, v97
    v_exp_f32 v98, v98
    v_exp_f32 v99, v99
    v_mfma_f32_32x32x16_bf16 v[208:223], v[76:79], v[132:135], v[208:223]
    s_mov_b64 exec, s[20:21]
    ds_read_b128 v[72:75], v251 offset:40960
    ds_read_b128 v[76:79], v251 offset:41984
    s_mov_b64 exec, -1
    v_cvt_pk_bf16_f32 v128, v96, v97
    v_exp_f32 v100, v100
    v_exp_f32 v101, v101
    v_cvt_pk_bf16_f32 v129, v98, v99
    v_exp_f32 v102, v102
    v_exp_f32 v103, v103
    v_exp_f32 v104, v104
    v_cvt_pk_bf16_f32 v130, v100, v101
    v_cvt_pk_bf16_f32 v131, v102, v103
    v_exp_f32 v105, v105
    v_exp_f32 v106, v106
    v_mfma_f32_32x32x16_bf16 v[192:207], v[64:67], v[128:131], 0
    buffer_load_dwordx4 a[128:131], v16, s[4:7], s1 offen offset:0 sc1
    v_exp_f32 v107, v107
    v_cvt_pk_bf16_f32 v132, v104, v105
    v_exp_f32 v108, v108
    v_exp_f32 v109, v109
    v_cvt_pk_bf16_f32 v133, v106, v107
    v_exp_f32 v110, v110
    v_exp_f32 v111, v111
    v_cvt_pk_bf16_f32 v134, v108, v109
    v_cvt_pk_bf16_f32 v135, v110, v111
    s_waitcnt lgkmcnt(3)
    v_mfma_f32_32x32x16_bf16 v[96:111], v[136:139], v[148:151], 0
    s_waitcnt lgkmcnt(0)
    ds_read_b128 v[136:139], v249 offset:53248
    s_add_u32 m0, s82, 98304
    s_nop 0
    buffer_load_dwordx4 v16, s[4:7], s97 offen offset:0 sc1 lds
    buffer_load_dwordx4 v16, s[4:7], s97 offen offset:1024 sc1 lds
    buffer_load_dwordx4 v16, s[4:7], s97 offen offset:2048 sc1 lds
    buffer_load_dwordx4 v16, s[4:7], s97 offen offset:3072 sc1 lds
    buffer_load_dwordx4 a[132:135], v16, s[4:7], s1 offen offset:1024 sc1
    v_exp_f32 v112, v112
    v_exp_f32 v113, v113
    v_exp_f32 v114, v114
    v_exp_f32 v115, v115
    v_mfma_f32_32x32x16_bf16 v[192:207], v[68:71], v[132:135], v[192:207]
    s_mov_b64 exec, s[20:21]
    ds_read_b128 v[64:67], v251 offset:45056
    ds_read_b128 v[68:71], v251 offset:46080
    s_mov_b64 exec, -1
    v_cvt_pk_bf16_f32 v128, v112, v113
    v_exp_f32 v116, v116
    v_exp_f32 v117, v117
    v_cvt_pk_bf16_f32 v129, v114, v115
    v_exp_f32 v118, v118
    v_exp_f32 v119, v119
    v_exp_f32 v120, v120
    v_cvt_pk_bf16_f32 v130, v116, v117
    v_cvt_pk_bf16_f32 v131, v118, v119
    v_exp_f32 v121, v121
    v_exp_f32 v122, v122
    v_mfma_f32_32x32x16_bf16 v[208:223], v[72:75], v[128:131], v[208:223]
    buffer_load_dwordx4 a[136:139], v16, s[4:7], s1 offen offset:2048 sc1
    v_exp_f32 v123, v123
    v_cvt_pk_bf16_f32 v132, v120, v121
    v_exp_f32 v124, v124
    v_exp_f32 v125, v125
    v_cvt_pk_bf16_f32 v133, v122, v123
    v_exp_f32 v126, v126
    v_exp_f32 v127, v127
    v_cvt_pk_bf16_f32 v134, v124, v125
    v_cvt_pk_bf16_f32 v135, v126, v127
    v_mfma_f32_32x32x16_bf16 v[112:127], v[140:143], v[148:151], 0
    s_waitcnt lgkmcnt(0)
    buffer_load_dwordx4 a[140:143], v16, s[4:7], s1 offen offset:3072 sc1
    v_exp_f32 v96, v96
    v_exp_f32 v97, v97
    v_exp_f32 v98, v98
    v_exp_f32 v99, v99
    v_mfma_f32_32x32x16_bf16 v[208:223], v[76:79], v[132:135], v[208:223]
    s_mov_b64 exec, s[20:21]
    ds_read_b128 v[72:75], v251 offset:49152
    ds_read_b128 v[76:79], v251 offset:50176
    s_mov_b64 exec, -1
    v_cvt_pk_bf16_f32 v128, v96, v97
    v_exp_f32 v100, v100
    v_exp_f32 v101, v101
    v_cvt_pk_bf16_f32 v129, v98, v99
    v_exp_f32 v102, v102
    v_exp_f32 v103, v103
    v_exp_f32 v104, v104
    v_cvt_pk_bf16_f32 v130, v100, v101
    v_cvt_pk_bf16_f32 v131, v102, v103
    v_exp_f32 v105, v105
    v_exp_f32 v106, v106
    v_mfma_f32_32x32x16_bf16 v[208:223], v[64:67], v[128:131], v[208:223]
    buffer_load_dwordx4 a[144:147], v17, s[4:7], s1 offen offset:0 sc1
    buffer_load_dwordx4 a[148:151], v17, s[4:7], s1 offen offset:1024 sc1
    v_exp_f32 v107, v107
    v_cvt_pk_bf16_f32 v132, v104, v105
    v_exp_f32 v108, v108
    v_exp_f32 v109, v109
    v_cvt_pk_bf16_f32 v133, v106, v107
    v_exp_f32 v110, v110
    v_exp_f32 v111, v111
    v_cvt_pk_bf16_f32 v134, v108, v109
    v_cvt_pk_bf16_f32 v135, v110, v111
    s_cmp_eq_u32 s12, 0
    s_cbranch_scc1 ATTG00_0
    v_mfma_f32_32x32x16_bf16 v[96:111], v[136:139], v[148:151], 0
    s_waitcnt lgkmcnt(0)
    buffer_load_dwordx4 a[152:155], v17, s[4:7], s1 offen offset:2048 sc1
    v_exp_f32 v112, v112
    v_exp_f32 v113, v113
    v_exp_f32 v114, v114
    v_exp_f32 v115, v115
    v_mfma_f32_32x32x16_bf16 v[208:223], v[68:71], v[132:135], v[208:223]
    s_mov_b64 exec, s[20:21]
    ds_read_b128 v[64:67], v251 offset:53248
    ds_read_b128 v[68:71], v251 offset:54272
    s_mov_b64 exec, -1
    v_cvt_pk_bf16_f32 v128, v112, v113
    v_exp_f32 v116, v116
    v_exp_f32 v117, v117
    v_cvt_pk_bf16_f32 v129, v114, v115
    v_exp_f32 v118, v118
    v_exp_f32 v119, v119
    v_exp_f32 v120, v120
    v_cvt_pk_bf16_f32 v130, v116, v117
    v_cvt_pk_bf16_f32 v131, v118, v119
    v_exp_f32 v121, v121
    v_exp_f32 v122, v122
    v_mfma_f32_32x32x16_bf16 v[208:223], v[72:75], v[128:131], v[208:223]
    s_waitcnt vmcnt(14)
    s_barrier
    buffer_load_dwordx4 a[156:159], v17, s[4:7], s1 offen offset:3072 sc1
    ds_read_b128 v[140:143], v249 offset:28672
    ds_read_b128 v[136:139], v248 offset:28672
    v_exp_f32 v123, v123
    v_cvt_pk_bf16_f32 v132, v120, v121
    v_exp_f32 v124, v124
    v_exp_f32 v125, v125
    v_cvt_pk_bf16_f32 v133, v122, v123
    v_exp_f32 v126, v126
    v_exp_f32 v127, v127
    v_cvt_pk_bf16_f32 v134, v124, v125
    v_cvt_pk_bf16_f32 v135, v126, v127
    s_waitcnt lgkmcnt(1)
    v_mfma_f32_32x32x16_bf16 v[112:127], v[140:143], v[148:151], v[48:63]
    ds_read_b128 v[140:143], v248 offset:24576
    buffer_load_dwordx4 a[160:163], v18, s[4:7], s1 offen offset:0 sc1
    v_exp_f32 v96, v96
    v_exp_f32 v97, v97
    v_exp_f32 v98, v98
    v_exp_f32 v99, v99
    v_mfma_f32_32x32x16_bf16 v[208:223], v[76:79], v[132:135], v[208:223]
    s_mov_b64 exec, s[20:21]
    ds_read_b128 v[72:75], v251 offset:28672
    ds_read_b128 v[76:79], v251 offset:29696
    s_mov_b64 exec, -1
    v_cvt_pk_bf16_f32 v128, v96, v97
    v_exp_f32 v100, v100
    v_exp_f32 v101, v101
    v_cvt_pk_bf16_f32 v129, v98, v99
    v_exp_f32 v102, v102
    v_exp_f32 v103, v103
    v_exp_f32 v104, v104
    v_cvt_pk_bf16_f32 v130, v100, v101
    v_cvt_pk_bf16_f32 v131, v102, v103
    v_exp_f32 v105, v105
    v_exp_f32 v106, v106
    v_mfma_f32_32x32x16_bf16 v[208:223], v[64:67], v[128:131], v[208:223]
    buffer_load_dwordx4 a[164:167], v18, s[4:7], s1 offen offset:1024 sc1
    v_exp_f32 v107, v107
    v_cvt_pk_bf16_f32 v132, v104, v105
    v_exp_f32 v108, v108
    v_exp_f32 v109, v109
    v_cvt_pk_bf16_f32 v133, v106, v107
    v_exp_f32 v110, v110
    v_exp_f32 v111, v111
    v_cvt_pk_bf16_f32 v134, v108, v109
    v_cvt_pk_bf16_f32 v135, v110, v111
    s_waitcnt lgkmcnt(3)
    v_mfma_f32_32x32x16_bf16 v[96:111], v[136:139], v[144:147], 0
    s_waitcnt lgkmcnt(0)
    ds_read_b128 v[136:139], v248 offset:20480
    buffer_load_dwordx4 a[168:171], v18, s[4:7], s1 offen offset:2048 sc1
    v_exp_f32 v112, v112
    v_exp_f32 v113, v113
    v_exp_f32 v114, v114
    v_exp_f32 v115, v115
    v_mfma_f32_32x32x16_bf16 v[208:223], v[68:71], v[132:135], v[208:223]
    s_mov_b64 exec, s[20:21]
    ds_read_b128 v[64:67], v250 offset:28672
    ds_read_b128 v[68:71], v250 offset:29696
    s_mov_b64 exec, -1
    v_cvt_pk_bf16_f32 v128, v112, v113
    v_exp_f32 v116, v116
    v_exp_f32 v117, v117
    v_cvt_pk_bf16_f32 v129, v114, v115
    v_exp_f32 v118, v118
    v_exp_f32 v119, v119
    v_exp_f32 v120, v120
    v_cvt_pk_bf16_f32 v130, v116, v117
    v_cvt_pk_bf16_f32 v131, v118, v119
    v_exp_f32 v121, v121
    v_exp_f32 v122, v122
    v_mfma_f32_32x32x16_bf16 v[208:223], v[72:75], v[128:131], v[208:223]
    buffer_load_dwordx4 a[172:175], v18, s[4:7], s1 offen offset:3072 sc1
    buffer_load_dwordx4 a[176:179], v16, s[4:7], s83 offen offset:0 sc1
    v_exp_f32 v123, v123
    v_cvt_pk_bf16_f32 v132, v120, v121
    v_exp_f32 v124, v124
    v_exp_f32 v125, v125
    v_cvt_pk_bf16_f32 v133, v122, v123
    v_exp_f32 v126, v126
    v_exp_f32 v127, v127
    v_cvt_pk_bf16_f32 v134, v124, v125
    v_cvt_pk_bf16_f32 v135, v126, v127
    v_mfma_f32_32x32x16_bf16 v[112:127], v[140:143], v[144:147], 0
    s_waitcnt lgkmcnt(0)
    ds_read_b128 v[140:143], v248 offset:16384
    buffer_load_dwordx4 a[180:183], v16, s[4:7], s83 offen offset:1024 sc1
    v_exp_f32 v96, v96
    v_exp_f32 v97, v97
    v_exp_f32 v98, v98
    v_exp_f32 v99, v99
    v_mfma_f32_32x32x16_bf16 v[208:223], v[76:79], v[132:135], v[208:223]
    s_mov_b64 exec, s[20:21]
    ds_read_b128 v[72:75], v250 offset:24576
    ds_read_b128 v[76:79], v250 offset:25600
    s_mov_b64 exec, -1
    v_cvt_pk_bf16_f32 v128, v96, v97
    v_exp_f32 v100, v100
    v_exp_f32 v101, v101
    v_cvt_pk_bf16_f32 v129, v98, v99
    v_exp_f32 v102, v102
    v_exp_f32 v103, v103
    v_exp_f32 v104, v104
    v_cvt_pk_bf16_f32 v130, v100, v101
    v_cvt_pk_bf16_f32 v131, v102, v103
    v_exp_f32 v105, v105
    v_exp_f32 v106, v106
    v_mfma_f32_32x32x16_bf16 v[192:207], v[64:67], v[128:131], v[192:207]
    s_waitcnt vmcnt(13)
    s_barrier
    v_subrev_u32 v217, 0x2b800000, v216
    v_cmp_lt_u32 s[26:27], s87, v217
    s_nop 0
    s_cmp_lg_u64 s[26:27], 0
    s_cbranch_scc1 SLOW_11
BACK_12:
    v_rcp_f32 v217, v216
    s_nop 0
    v_mul_f32 v208, v208, v217
    v_mul_f32 v209, v209, v217
    v_cvt_pk_bf16_f32 v220, v208, v209
    v_mul_f32 v210, v210, v217
    v_mul_f32 v211, v211, v217
    v_cvt_pk_bf16_f32 v221, v210, v211
    v_mul_f32 v212, v212, v217
    v_mul_f32 v213, v213, v217
    v_cvt_pk_bf16_f32 v222, v212, v213
    v_mul_f32 v214, v214, v217
    v_mul_f32 v215, v215, v217
    v_cvt_pk_bf16_f32 v223, v214, v215
    buffer_load_dwordx4 a[184:187], v16, s[4:7], s83 offen offset:2048 sc1
    v_exp_f32 v107, v107
    v_cvt_pk_bf16_f32 v132, v104, v105
    v_exp_f32 v108, v108
    v_exp_f32 v109, v109
    v_cvt_pk_bf16_f32 v133, v106, v107
    v_exp_f32 v110, v110
    v_exp_f32 v111, v111
    v_cvt_pk_bf16_f32 v134, v108, v109
    v_cvt_pk_bf16_f32 v135, v110, v111
    v_mfma_f32_32x32x16_bf16 v[96:111], v[136:139], v[144:147], 0
    s_waitcnt lgkmcnt(0)
    ds_read_b128 v[136:139], v248 offset:12288
    buffer_store_dwordx4 v[220:223], v0, s[4:7], s54 offen
    buffer_load_dwordx4 a[188:191], v16, s[4:7], s83 offen offset:3072 sc1
    v_exp_f32 v112, v112
    v_exp_f32 v113, v113
    v_exp_f32 v114, v114
    v_exp_f32 v115, v115
    v_mfma_f32_32x32x16_bf16 v[192:207], v[68:71], v[132:135], v[192:207]
    s_mov_b64 exec, s[20:21]
    ds_read_b128 v[64:67], v250 offset:20480
    ds_read_b128 v[68:71], v250 offset:21504
    s_mov_b64 exec, -1
    v_cvt_pk_bf16_f32 v128, v112, v113
    v_exp_f32 v116, v116
    v_exp_f32 v117, v117
    v_cvt_pk_bf16_f32 v129, v114, v115
    v_exp_f32 v118, v118
    v_exp_f32 v119, v119
    v_exp_f32 v120, v120
    v_cvt_pk_bf16_f32 v130, v116, v117
    v_cvt_pk_bf16_f32 v131, v118, v119
    v_exp_f32 v121, v121
    v_exp_f32 v122, v122
    v_mfma_f32_32x32x16_bf16 v[192:207], v[72:75], v[128:131], v[192:207]
    buffer_load_dwordx4 a[192:195], v17, s[4:7], s83 offen offset:0 sc1
    v_exp_f32 v123, v123
    v_cvt_pk_bf16_f32 v132, v120, v121
    v_exp_f32 v124, v124
    v_exp_f32 v125, v125
    v_cvt_pk_bf16_f32 v133, v122, v123
    v_exp_f32 v126, v126
    v_exp_f32 v127, v127
    v_cvt_pk_bf16_f32 v134, v124, v125
    v_cvt_pk_bf16_f32 v135, v126, v127
    v_mfma_f32_32x32x16_bf16 v[112:127], v[140:143], v[144:147], 0
    s_waitcnt lgkmcnt(0)
    ds_read_b128 v[140:143], v248 offset:8192
    buffer_load_dwordx4 a[196:199], v17, s[4:7], s83 offen offset:1024 sc1
    buffer_load_dwordx4 a[200:203], v17, s[4:7], s83 offen offset:2048 sc1
    v_exp_f32 v96, v96
    v_exp_f32 v97, v97
    v_exp_f32 v98, v98
    v_exp_f32 v99, v99
    v_mfma_f32_32x32x16_bf16 v[192:207], v[76:79], v[132:135], v[192:207]
    s_mov_b64 exec, s[20:21]
    ds_read_b128 v[72:75], v250 offset:16384
    ds_read_b128 v[76:79], v250 offset:17408
    s_mov_b64 exec, -1
    v_cvt_pk_bf16_f32 v128, v96, v97
    v_exp_f32 v100, v100
    v_exp_f32 v101, v101
    v_cvt_pk_bf16_f32 v129, v98, v99
    v_exp_f32 v102, v102
    v_exp_f32 v103, v103
    v_exp_f32 v104, v104
    v_cvt_pk_bf16_f32 v130, v100, v101
    v_cvt_pk_bf16_f32 v131, v102, v103
    v_exp_f32 v105, v105
    v_exp_f32 v106, v106
    v_mfma_f32_32x32x16_bf16 v[192:207], v[64:67], v[128:131], v[192:207]
    s_waitcnt vmcnt(4)
    s_cbranch_vccnz SAFE_13
    buffer_store_dword v11, v10, s[4:7], s56 offen offset:0
BACK_14:
    buffer_load_dwordx4 a[204:207], v17, s[4:7], s83 offen offset:3072 sc1
    v_exp_f32 v107, v107
    v_cvt_pk_bf16_f32 v132, v104, v105
    v_exp_f32 v108, v108
    v_exp_f32 v109, v109
    v_cvt_pk_bf16_f32 v133, v106, v107
    v_exp_f32 v110, v110
    v_exp_f32 v111, v111
    v_cvt_pk_bf16_f32 v134, v108, v109
    v_cvt_pk_bf16_f32 v135, v110, v111
    v_mfma_f32_32x32x16_bf16 v[96:111], v[136:139], v[144:147], 0
    s_waitcnt lgkmcnt(0)
    ds_read_b128 v[136:139], v248 offset:4096
    buffer_load_dwordx4 a[208:211], v18, s[4:7], s83 offen offset:0 sc1
    v_exp_f32 v112, v112
    v_exp_f32 v113, v113
    v_exp_f32 v114, v114
    v_exp_f32 v115, v115
    v_mfma_f32_32x32x16_bf16 v[192:207], v[68:71], v[132:135], v[192:207]
    s_mov_b64 exec, s[20:21]
    ds_read_b128 v[64:67], v250 offset:12288
    ds_read_b128 v[68:71], v250 offset:13312
    s_mov_b64 exec, -1
    v_cvt_pk_bf16_f32 v128, v112, v113
    v_exp_f32 v116, v116
    v_exp_f32 v117, v117
    v_cvt_pk_bf16_f32 v129, v114, v115
    v_exp_f32 v118, v118
    v_exp_f32 v119, v119
    v_exp_f32 v120, v120
    v_cvt_pk_bf16_f32 v130, v116, v117
    v_cvt_pk_bf16_f32 v131, v118, v119
    v_exp_f32 v121, v121
    v_exp_f32 v122, v122
    v_mfma_f32_32x32x16_bf16 v[192:207], v[72:75], v[128:131], v[192:207]
    buffer_load_dwordx4 a[212:215], v18, s[4:7], s83 offen offset:1024 sc1
    v_exp_f32 v123, v123
    v_cvt_pk_bf16_f32 v132, v120, v121
    v_exp_f32 v124, v124
    v_exp_f32 v125, v125
    v_cvt_pk_bf16_f32 v133, v122, v123
    v_exp_f32 v126, v126
    v_exp_f32 v127, v127
    v_cvt_pk_bf16_f32 v134, v124, v125
    v_cvt_pk_bf16_f32 v135, v126, v127
    v_mfma_f32_32x32x16_bf16 v[112:127], v[140:143], v[144:147], 0
    s_waitcnt lgkmcnt(0)
    ds_read_b128 v[140:143], v248 offset:0
    buffer_load_dwordx4 a[216:219], v18, s[4:7], s83 offen offset:2048 sc1
    v_exp_f32 v96, v96
    v_exp_f32 v97, v97
    v_exp_f32 v98, v98
    v_exp_f32 v99, v99
    v_mfma_f32_32x32x16_bf16 v[192:207], v[76:79], v[132:135], v[192:207]
    s_mov_b64 exec, s[20:21]
    ds_read_b128 v[72:75], v250 offset:8192
    ds_read_b128 v[76:79], v250 offset:9216
    s_mov_b64 exec, -1
    v_cvt_pk_bf16_f32 v128, v96, v97
    v_exp_f32 v100, v100
    v_exp_f32 v101, v101
    v_cvt_pk_bf16_f32 v129, v98, v99
    v_exp_f32 v102, v102
    v_exp_f32 v103, v103
    v_exp_f32 v104, v104
    v_cvt_pk_bf16_f32 v130, v100, v101
    v_cvt_pk_bf16_f32 v131, v102, v103
    v_exp_f32 v105, v105
    v_exp_f32 v106, v106
    v_mfma_f32_32x32x16_bf16 v[192:207], v[64:67], v[128:131], v[192:207]
    buffer_load_dwordx4 a[220:223], v18, s[4:7], s83 offen offset:3072 sc1
    buffer_load_dwordx4 a[224:227], v19, s[4:7], s83 offen offset:0 sc1
    v_exp_f32 v107, v107
    v_cvt_pk_bf16_f32 v132, v104, v105
    v_exp_f32 v108, v108
    v_exp_f32 v109, v109
    v_cvt_pk_bf16_f32 v133, v106, v107
    v_exp_f32 v110, v110
    v_exp_f32 v111, v111
    v_cvt_pk_bf16_f32 v134, v108, v109
    v_cvt_pk_bf16_f32 v135, v110, v111
    v_mfma_f32_32x32x16_bf16 v[96:111], v[136:139], v[144:147], 0
    s_waitcnt lgkmcnt(0)
    buffer_load_dwordx4 a[228:231], v19, s[4:7], s83 offen offset:1024 sc1
    global_load_dword v246, v246, s[90:91]
    v_exp_f32 v112, v112
    v_exp_f32 v113, v113
    v_exp_f32 v114, v114
    v_exp_f32 v115, v115
    v_mfma_f32_32x32x16_bf16 v[192:207], v[68:71], v[132:135], v[192:207]
    s_mov_b64 exec, s[20:21]
    ds_read_b128 v[64:67], v250 offset:4096
    ds_read_b128 v[68:71], v250 offset:5120
    s_mov_b64 exec, -1
    v_cvt_pk_bf16_f32 v128, v112, v113
    v_exp_f32 v116, v116
    v_exp_f32 v117, v117
    v_cvt_pk_bf16_f32 v129, v114, v115
    v_exp_f32 v118, v118
    v_exp_f32 v119, v119
    v_exp_f32 v120, v120
    v_cvt_pk_bf16_f32 v130, v116, v117
    v_cvt_pk_bf16_f32 v131, v118, v119
    v_exp_f32 v121, v121
    v_exp_f32 v122, v122
    v_mfma_f32_32x32x16_bf16 v[192:207], v[72:75], v[128:131], v[192:207]
    buffer_load_dwordx4 a[232:235], v19, s[4:7], s83 offen offset:2048 sc1
    v_exp_f32 v123, v123
    v_cvt_pk_bf16_f32 v132, v120, v121
    v_exp_f32 v124, v124
    v_exp_f32 v125, v125
    v_cvt_pk_bf16_f32 v133, v122, v123
    v_exp_f32 v126, v126
    v_exp_f32 v127, v127
    v_cvt_pk_bf16_f32 v134, v124, v125
    v_cvt_pk_bf16_f32 v135, v126, v127
    v_mfma_f32_32x32x16_bf16 v[112:127], v[140:143], v[144:147], v[48:63]
    s_waitcnt lgkmcnt(0)
    buffer_load_dwordx4 a[236:239], v19, s[4:7], s83 offen offset:3072 sc1
    v_exp_f32 v96, v96
    v_exp_f32 v97, v97
    v_exp_f32 v98, v98
    v_exp_f32 v99, v99
    v_mfma_f32_32x32x16_bf16 v[192:207], v[76:79], v[132:135], v[192:207]
    s_mov_b64 exec, s[20:21]
    ds_read_b128 v[72:75], v250 offset:0
    ds_read_b128 v[76:79], v250 offset:1024
    s_mov_b64 exec, -1
    v_cvt_pk_bf16_f32 v128, v96, v97
    v_exp_f32 v100, v100
    v_exp_f32 v101, v101
    v_cvt_pk_bf16_f32 v129, v98, v99
    v_exp_f32 v102, v102
    v_exp_f32 v103, v103
    v_exp_f32 v104, v104
    v_cvt_pk_bf16_f32 v130, v100, v101
    v_cvt_pk_bf16_f32 v131, v102, v103
    v_exp_f32 v105, v105
    v_exp_f32 v106, v106
    v_mfma_f32_32x32x16_bf16 v[192:207], v[64:67], v[128:131], v[192:207]
    v_exp_f32 v107, v107
    v_cvt_pk_bf16_f32 v132, v104, v105
    v_exp_f32 v108, v108
    v_exp_f32 v109, v109
    v_cvt_pk_bf16_f32 v133, v106, v107
    v_exp_f32 v110, v110
    v_exp_f32 v111, v111
    v_cvt_pk_bf16_f32 v134, v108, v109
    v_cvt_pk_bf16_f32 v135, v110, v111
    buffer_load_dword v14, v15, s[4:7], s59 offen offset:0 sc1
    v_exp_f32 v112, v112
    v_exp_f32 v113, v113
    v_exp_f32 v114, v114
    v_exp_f32 v115, v115
    v_mfma_f32_32x32x16_bf16 v[192:207], v[68:71], v[132:135], v[192:207]
    v_cvt_pk_bf16_f32 v128, v112, v113
    v_exp_f32 v116, v116
    v_exp_f32 v117, v117
    v_cvt_pk_bf16_f32 v129, v114, v115
    v_exp_f32 v118, v118
    v_exp_f32 v119, v119
    v_exp_f32 v120, v120
    v_cvt_pk_bf16_f32 v130, v116, v117
    v_cvt_pk_bf16_f32 v131, v118, v119
    v_exp_f32 v121, v121
    v_exp_f32 v122, v122
    s_waitcnt lgkmcnt(0)
    v_mfma_f32_32x32x16_bf16 v[192:207], v[72:75], v[128:131], v[192:207]
    v_exp_f32 v123, v123
    v_cvt_pk_bf16_f32 v132, v120, v121
    v_exp_f32 v124, v124
    v_exp_f32 v125, v125
    v_cvt_pk_bf16_f32 v133, v122, v123
    v_exp_f32 v126, v126
    v_exp_f32 v127, v127
    v_cvt_pk_bf16_f32 v134, v124, v125
    v_cvt_pk_bf16_f32 v135, v126, v127
    s_nop 1
    v_mfma_f32_32x32x16_bf16 v[192:207], v[76:79], v[132:135], v[192:207]
    s_branch ATT0_done
.p2align 12
ATT0_1:
    s_waitcnt lgkmcnt(0)
    s_barrier
    ds_read_b128 v[144:147], v247
    ds_read_b128 v[148:151], v252
    ds_read_b128 v[136:139], v249 offset:32768
    ds_read_b128 v[140:143], v249 offset:36864
    s_mov_b64 exec, s[20:21]
    ds_read_b128 v[64:67], v251 offset:32768
    ds_read_b128 v[68:71], v251 offset:33792
    s_mov_b64 exec, -1
    s_waitcnt lgkmcnt(3)
    v_mfma_f32_32x32x16_bf16 v[96:111], v[136:139], v[148:151], 0
    ds_read_b128 v[136:139], v249 offset:57344
    s_waitcnt lgkmcnt(3)
    v_mfma_f32_32x32x16_bf16 v[112:127], v[140:143], v[148:151], 0
    s_waitcnt lgkmcnt(1)
    ds_read_b128 v[140:143], v248 offset:32768
    buffer_load_dword v14, v1, s[4:7], s48 offen offset:0 sc1
    buffer_load_dwordx4 a[84:87], v21, s[4:7], s84 offen offset:1024 sc1
    s_nop 4
    v_exp_f32 v96, v96
    v_exp_f32 v97, v97
    v_exp_f32 v98, v98
    v_exp_f32 v99, v99
    s_mov_b64 exec, s[20:21]
    ds_read_b128 v[72:75], v251 offset:36864
    ds_read_b128 v[76:79], v251 offset:37888
    s_mov_b64 exec, -1
    v_cvt_pk_bf16_f32 v128, v96, v97
    v_exp_f32 v100, v100
    v_exp_f32 v101, v101
    v_cvt_pk_bf16_f32 v129, v98, v99
    v_exp_f32 v102, v102
    v_exp_f32 v103, v103
    v_exp_f32 v104, v104
    v_cvt_pk_bf16_f32 v130, v100, v101
    v_cvt_pk_bf16_f32 v131, v102, v103
    v_exp_f32 v105, v105
    v_exp_f32 v106, v106
    v_mfma_f32_32x32x16_bf16 v[208:223], v[64:67], v[128:131], 0
    buffer_load_dwordx4 a[88:91], v21, s[4:7], s84 offen offset:2048 sc1
    v_exp_f32 v107, v107
    v_cvt_pk_bf16_f32 v132, v104, v105
    v_exp_f32 v108, v108
    v_exp_f32 v109, v109
    v_cvt_pk_bf16_f32 v133, v106, v107
    v_exp_f32 v110, v110
    v_exp_f32 v111, v111
    v_cvt_pk_bf16_f32 v134, v108, v109
    v_cvt_pk_bf16_f32 v135, v110, v111
    s_waitcnt lgkmcnt(3)
    v_mfma_f32_32x32x16_bf16 v[96:111], v[136:139], v[148:151], v[32:47]
    s_waitcnt lgkmcnt(0)
    ds_read_b128 v[136:139], v248 offset:36864
    s_waitcnt vmcnt(2)
    v_cmp_gt_u32 vcc, s34, v14
    s_cbranch_vccnz SPIN_27
BACK_28:
    s_mov_b32 m0, s50
    s_nop 0
    buffer_load_dwordx4 v16, s[4:7], s49 offen offset:0 sc1 lds
    buffer_load_dwordx4 v16, s[4:7], s49 offen offset:1024 sc1 lds
    buffer_load_dwordx4 v16, s[4:7], s49 offen offset:2048 sc1 lds
    buffer_load_dwordx4 v16, s[4:7], s49 offen offset:3072 sc1 lds
    buffer_load_dwordx4 a[92:95], v21, s[4:7], s84 offen offset:3072 sc1
    v_exp_f32 v112, v112
    v_exp_f32 v113, v113
    v_exp_f32 v114, v114
    v_exp_f32 v115, v115
    v_mfma_f32_32x32x16_bf16 v[208:223], v[68:71], v[132:135], v[208:223]
    s_mov_b64 exec, s[20:21]
    ds_read_b128 v[64:67], v251 offset:57344
    ds_read_b128 v[68:71], v251 offset:58368
    s_mov_b64 exec, -1
    v_cvt_pk_bf16_f32 v128, v112, v113
    v_exp_f32 v116, v116
    v_exp_f32 v117, v117
    v_cvt_pk_bf16_f32 v129, v114, v115
    v_exp_f32 v118, v118
    v_exp_f32 v119, v119
    v_exp_f32 v120, v120
    v_cvt_pk_bf16_f32 v130, v116, v117
    v_cvt_pk_bf16_f32 v131, v118, v119
    v_exp_f32 v121, v121
    v_exp_f32 v122, v122
    v_mfma_f32_32x32x16_bf16 v[208:223], v[72:75], v[128:131], v[208:223]
    buffer_load_dword v2, v4, s[4:7], s51 offen offset:0 sc1
    buffer_load_dwordx4 a[96:99], v22, s[4:7], s84 offen offset:0 sc1
    buffer_load_dwordx4 a[100:103], v22, s[4:7], s84 offen offset:1024 sc1
    v_exp_f32 v123, v123
    v_cvt_pk_bf16_f32 v132, v120, v121
    v_exp_f32 v124, v124
    v_exp_f32 v125, v125
    v_cvt_pk_bf16_f32 v133, v122, v123
    v_exp_f32 v126, v126
    v_exp_f32 v127, v127
    v_cvt_pk_bf16_f32 v134, v124, v125
    v_cvt_pk_bf16_f32 v135, v126, v127
    v_mfma_f32_32x32x16_bf16 v[112:127], v[140:143], v[144:147], 0
    s_waitcnt lgkmcnt(0)
    buffer_load_dwordx4 a[104:107], v22, s[4:7], s84 offen offset:2048 sc1
    v_exp_f32 v96, v96
    v_exp_f32 v97, v97
    v_exp_f32 v98, v98
    v_exp_f32 v99, v99
    v_mfma_f32_32x32x16_bf16 v[208:223], v[76:79], v[132:135], v[208:223]
    s_mov_b64 exec, s[20:21]
    ds_read_b128 v[72:75], v250 offset:32768
    ds_read_b128 v[76:79], v250 offset:33792
    s_mov_b64 exec, -1
    v_cvt_pk_bf16_f32 v128, v96, v97
    v_exp_f32 v100, v100
    v_exp_f32 v101, v101
    v_cvt_pk_bf16_f32 v129, v98, v99
    v_exp_f32 v102, v102
    v_exp_f32 v103, v103
    v_exp_f32 v104, v104
    v_cvt_pk_bf16_f32 v130, v100, v101
    v_cvt_pk_bf16_f32 v131, v102, v103
    v_exp_f32 v105, v105
    v_exp_f32 v106, v106
    v_mfma_f32_32x32x16_bf16 v[208:223], v[64:67], v[128:131], v[208:223]
    buffer_load_dwordx4 a[108:111], v22, s[4:7], s84 offen offset:3072 sc1
    v_exp_f32 v107, v107
    v_cvt_pk_bf16_f32 v132, v104, v105
    v_exp_f32 v108, v108
    v_exp_f32 v109, v109
    v_cvt_pk_bf16_f32 v133, v106, v107
    v_exp_f32 v110, v110
    v_exp_f32 v111, v111
    v_cvt_pk_bf16_f32 v134, v108, v109
    v_cvt_pk_bf16_f32 v135, v110, v111
    v_mfma_f32_32x32x16_bf16 v[96:111], v[136:139], v[144:147], v[32:47]
    s_waitcnt lgkmcnt(0)
    buffer_load_dwordx4 a[112:115], v23, s[4:7], s84 offen offset:0 sc1
    v_exp_f32 v112, v112
    v_exp_f32 v113, v113
    v_exp_f32 v114, v114
    v_exp_f32 v115, v115
    v_mfma_f32_32x32x16_bf16 v[208:223], v[68:71], v[132:135], v[208:223]
    s_mov_b64 exec, s[20:21]
    ds_read_b128 v[64:67], v250 offset:36864
    ds_read_b128 v[68:71], v250 offset:37888
    s_mov_b64 exec, -1
    v_cvt_pk_bf16_f32 v128, v112, v113
    v_exp_f32 v116, v116
    v_exp_f32 v117, v117
    v_cvt_pk_bf16_f32 v129, v114, v115
    v_exp_f32 v118, v118
    v_exp_f32 v119, v119
    v_exp_f32 v120, v120
    v_cvt_pk_bf16_f32 v130, v116, v117
    v_cvt_pk_bf16_f32 v131, v118, v119
    v_exp_f32 v121, v121
    v_exp_f32 v122, v122
    v_mfma_f32_32x32x16_bf16 v[192:207], v[72:75], v[128:131], 0
    s_waitcnt vmcnt(7)
    s_barrier
    s_waitcnt vmcnt(5)
    v_cmp_gt_u32 vcc, s34, v2
    s_cbranch_vccnz SPIN_30
BACK_31:
    s_add_u32 m0, s82, 114688
    s_nop 0
    buffer_load_dwordx4 v16, s[4:7], s96 offen offset:0 sc1 lds
    buffer_load_dwordx4 v16, s[4:7], s96 offen offset:1024 sc1 lds
    buffer_load_dwordx4 v16, s[4:7], s96 offen offset:2048 sc1 lds
    buffer_load_dwordx4 v16, s[4:7], s96 offen offset:3072 sc1 lds
    buffer_load_dwordx4 a[116:119], v23, s[4:7], s84 offen offset:1024 sc1
    ds_read_b128 v[140:143], v249 offset:40960
    ds_read_b128 v[136:139], v249 offset:45056
    v_exp_f32 v123, v123
    v_cvt_pk_bf16_f32 v132, v120, v121
    v_exp_f32 v124, v124
    v_exp_f32 v125, v125
    v_cvt_pk_bf16_f32 v133, v122, v123
    v_exp_f32 v126, v126
    v_exp_f32 v127, v127
    v_cvt_pk_bf16_f32 v134, v124, v125
    v_cvt_pk_bf16_f32 v135, v126, v127
    s_waitcnt lgkmcnt(1)
    v_mfma_f32_32x32x16_bf16 v[112:127], v[140:143], v[148:151], 0
    ds_read_b128 v[140:143], v249 offset:49152
    buffer_load_dwordx4 a[120:123], v23, s[4:7], s84 offen offset:2048 sc1
    buffer_load_dwordx4 a[124:127], v23, s[4:7], s84 offen offset:3072 sc1
    v_exp_f32 v96, v96
    v_exp_f32 v97, v97
    v_exp_f32 v98, v98
    v_exp_f32 v99, v99
    v_mfma_f32_32x32x16_bf16 v[192:207], v[76:79], v[132:135], v[192:207]
    s_mov_b64 exec, s[20:21]
    ds_read_b128 v[72:75], v251 offset:40960
    ds_read_b128 v[76:79], v251 offset:41984
    s_mov_b64 exec, -1
    v_cvt_pk_bf16_f32 v128, v96, v97
    v_exp_f32 v100, v100
    v_exp_f32 v101, v101
    v_cvt_pk_bf16_f32 v129, v98, v99
    v_exp_f32 v102, v102
    v_exp_f32 v103, v103
    v_exp_f32 v104, v104
    v_cvt_pk_bf16_f32 v130, v100, v101
    v_cvt_pk_bf16_f32 v131, v102, v103
    v_exp_f32 v105, v105
    v_exp_f32 v106, v106
    v_mfma_f32_32x32x16_bf16 v[192:207], v[64:67], v[128:131], v[192:207]
    buffer_load_dwordx4 a[128:131], v16, s[4:7], s1 offen offset:0 sc1
    v_exp_f32 v107, v107
    v_cvt_pk_bf16_f32 v132, v104, v105
    v_exp_f32 v108, v108
    v_exp_f32 v109, v109
    v_cvt_pk_bf16_f32 v133, v106, v107
    v_exp_f32 v110, v110
    v_exp_f32 v111, v111
    v_cvt_pk_bf16_f32 v134, v108, v109
    v_cvt_pk_bf16_f32 v135, v110, v111
    s_waitcnt lgkmcnt(3)
    v_mfma_f32_32x32x16_bf16 v[96:111], v[136:139], v[148:151], 0
    s_waitcnt lgkmcnt(0)
    ds_read_b128 v[136:139], v249 offset:53248
    s_add_u32 m0, s82, 98304
    s_nop 0
    buffer_load_dwordx4 v16, s[4:7], s97 offen offset:0 sc1 lds
    buffer_load_dwordx4 v16, s[4:7], s97 offen offset:1024 sc1 lds
    buffer_load_dwordx4 v16, s[4:7], s97 offen offset:2048 sc1 lds
    buffer_load_dwordx4 v16, s[4:7], s97 offen offset:3072 sc1 lds
    buffer_load_dwordx4 a[132:135], v16, s[4:7], s1 offen offset:1024 sc1
    v_exp_f32 v112, v112
    v_exp_f32 v113, v113
    v_exp_f32 v114, v114
    v_exp_f32 v115, v115
    v_mfma_f32_32x32x16_bf16 v[192:207], v[68:71], v[132:135], v[192:207]
    s_mov_b64 exec, s[20:21]
    ds_read_b128 v[64:67], v251 offset:45056
    ds_read_b128 v[68:71], v251 offset:46080
    s_mov_b64 exec, -1
    v_cvt_pk_bf16_f32 v128, v112, v113
    v_exp_f32 v116, v116
    v_exp_f32 v117, v117
    v_cvt_pk_bf16_f32 v129, v114, v115
    v_exp_f32 v118, v118
    v_exp_f32 v119, v119
    v_exp_f32 v120, v120
    v_cvt_pk_bf16_f32 v130, v116, v117
    v_cvt_pk_bf16_f32 v131, v118, v119
    v_exp_f32 v121, v121
    v_exp_f32 v122, v122
    v_mfma_f32_32x32x16_bf16 v[208:223], v[72:75], v[128:131], v[208:223]
    buffer_load_dwordx4 a[136:139], v16, s[4:7], s1 offen offset:2048 sc1
    v_exp_f32 v123, v123
    v_cvt_pk_bf16_f32 v132, v120, v121
    v_exp_f32 v124, v124
    v_exp_f32 v125, v125
    v_cvt_pk_bf16_f32 v133, v122, v123
    v_exp_f32 v126, v126
    v_exp_f32 v127, v127
    v_cvt_pk_bf16_f32 v134, v124, v125
    v_cvt_pk_bf16_f32 v135, v126, v127
    v_mfma_f32_32x32x16_bf16 v[112:127], v[140:143], v[148:151], 0
    s_waitcnt lgkmcnt(0)
    buffer_load_dwordx4 a[140:143], v16, s[4:7], s1 offen offset:3072 sc1
    v_exp_f32 v96, v96
    v_exp_f32 v97, v97
    v_exp_f32 v98, v98
    v_exp_f32 v99, v99
    v_mfma_f32_32x32x16_bf16 v[208:223], v[76:79], v[132:135], v[208:223]
    s_mov_b64 exec, s[20:21]
    ds_read_b128 v[72:75], v251 offset:49152
    ds_read_b128 v[76:79], v251 offset:50176
    s_mov_b64 exec, -1
    v_cvt_pk_bf16_f32 v128, v96, v97
    v_exp_f32 v100, v100
    v_exp_f32 v101, v101
    v_cvt_pk_bf16_f32 v129, v98, v99
    v_exp_f32 v102, v102
    v_exp_f32 v103, v103
    v_exp_f32 v104, v104
    v_cvt_pk_bf16_f32 v130, v100, v101
    v_cvt_pk_bf16_f32 v131, v102, v103
    v_exp_f32 v105, v105
    v_exp_f32 v106, v106
    v_mfma_f32_32x32x16_bf16 v[208:223], v[64:67], v[128:131], v[208:223]
    buffer_load_dwordx4 a[144:147], v17, s[4:7], s1 offen offset:0 sc1
    buffer_load_dwordx4 a[148:151], v17, s[4:7], s1 offen offset:1024 sc1
    v_exp_f32 v107, v107
    v_cvt_pk_bf16_f32 v132, v104, v105
    v_exp_f32 v108, v108
    v_exp_f32 v109, v109
    v_cvt_pk_bf16_f32 v133, v106, v107
    v_exp_f32 v110, v110
    v_exp_f32 v111, v111
    v_cvt_pk_bf16_f32 v134, v108, v109
    v_cvt_pk_bf16_f32 v135, v110, v111
    s_cmp_eq_u32 s12, 0
    s_cbranch_scc1 ATTG00_1
    v_mfma_f32_32x32x16_bf16 v[96:111], v[136:139], v[148:151], 0
    s_waitcnt lgkmcnt(0)
    buffer_load_dwordx4 a[152:155], v17, s[4:7], s1 offen offset:2048 sc1
    v_exp_f32 v112, v112
    v_exp_f32 v113, v113
    v_exp_f32 v114, v114
    v_exp_f32 v115, v115
    v_mfma_f32_32x32x16_bf16 v[208:223], v[68:71], v[132:135], v[208:223]
    s_mov_b64 exec, s[20:21]
    ds_read_b128 v[64:67], v251 offset:53248
    ds_read_b128 v[68:71], v251 offset:54272
    s_mov_b64 exec, -1
    v_cvt_pk_bf16_f32 v128, v112, v113
    v_exp_f32 v116, v116
    v_exp_f32 v117, v117
    v_cvt_pk_bf16_f32 v129, v114, v115
    v_exp_f32 v118, v118
    v_exp_f32 v119, v119
    v_exp_f32 v120, v120
    v_cvt_pk_bf16_f32 v130, v116, v117
    v_cvt_pk_bf16_f32 v131, v118, v119
    v_exp_f32 v121, v121
    v_exp_f32 v122, v122
    v_mfma_f32_32x32x16_bf16 v[208:223], v[72:75], v[128:131], v[208:223]
    s_waitcnt vmcnt(14)
    s_barrier
    buffer_load_dwordx4 a[156:159], v17, s[4:7], s1 offen offset:3072 sc1
    ds_read_b128 v[140:143], v249 offset:24576
    ds_read_b128 v[136:139], v249 offset:28672
    v_exp_f32 v123, v123
    v_cvt_pk_bf16_f32 v132, v120, v121
    v_exp_f32 v124, v124
    v_exp_f32 v125, v125
    v_cvt_pk_bf16_f32 v133, v122, v123
    v_exp_f32 v126, v126
    v_exp_f32 v127, v127
    v_cvt_pk_bf16_f32 v134, v124, v125
    v_cvt_pk_bf16_f32 v135, v126, v127
    s_waitcnt lgkmcnt(1)
    v_mfma_f32_32x32x16_bf16 v[112:127], v[140:143], v[148:151], v[48:63]
    ds_read_b128 v[140:143], v248 offset:28672
    buffer_load_dwordx4 a[160:163], v18, s[4:7], s1 offen offset:0 sc1
    v_exp_f32 v96, v96
    v_exp_f32 v97, v97
    v_exp_f32 v98, v98
    v_exp_f32 v99, v99
    v_mfma_f32_32x32x16_bf16 v[208:223], v[76:79], v[132:135], v[208:223]
    s_mov_b64 exec, s[20:21]
    ds_read_b128 v[72:75], v251 offset:24576
    ds_read_b128 v[76:79], v251 offset:25600
    s_mov_b64 exec, -1
    v_cvt_pk_bf16_f32 v128, v96, v97
    v_exp_f32 v100, v100
    v_exp_f32 v101, v101
    v_cvt_pk_bf16_f32 v129, v98, v99
    v_exp_f32 v102, v102
    v_exp_f32 v103, v103
    v_exp_f32 v104, v104
    v_cvt_pk_bf16_f32 v130, v100, v101
    v_cvt_pk_bf16_f32 v131, v102, v103
    v_exp_f32 v105, v105
    v_exp_f32 v106, v106
    v_mfma_f32_32x32x16_bf16 v[208:223], v[64:67], v[128:131], v[208:223]
    buffer_load_dwordx4 a[164:167], v18, s[4:7], s1 offen offset:1024 sc1
    v_exp_f32 v107, v107
    v_cvt_pk_bf16_f32 v132, v104, v105
    v_exp_f32 v108, v108
    v_exp_f32 v109, v109
    v_cvt_pk_bf16_f32 v133, v106, v107
    v_exp_f32 v110, v110
    v_exp_f32 v111, v111
    v_cvt_pk_bf16_f32 v134, v108, v109
    v_cvt_pk_bf16_f32 v135, v110, v111
    s_waitcnt lgkmcnt(3)
    v_mfma_f32_32x32x16_bf16 v[96:111], v[136:139], v[148:151], 0
    s_waitcnt lgkmcnt(0)
    ds_read_b128 v[136:139], v248 offset:24576
    buffer_load_dwordx4 a[168:171], v18, s[4:7], s1 offen offset:2048 sc1
    v_exp_f32 v112, v112
    v_exp_f32 v113, v113
    v_exp_f32 v114, v114
    v_exp_f32 v115, v115
    v_mfma_f32_32x32x16_bf16 v[208:223], v[68:71], v[132:135], v[208:223]
    s_mov_b64 exec, s[20:21]
    ds_read_b128 v[64:67], v251 offset:28672
    ds_read_b128 v[68:71], v251 offset:29696
    s_mov_b64 exec, -1
    v_cvt_pk_bf16_f32 v128, v112, v113
    v_exp_f32 v116, v116
    v_exp_f32 v117, v117
    v_cvt_pk_bf16_f32 v129, v114, v115
    v_exp_f32 v118, v118
    v_exp_f32 v119, v119
    v_exp_f32 v120, v120
    v_cvt_pk_bf16_f32 v130, v116, v117
    v_cvt_pk_bf16_f32 v131, v118, v119
    v_exp_f32 v121, v121
    v_exp_f32 v122, v122
    v_mfma_f32_32x32x16_bf16 v[208:223], v[72:75], v[128:131], v[208:223]
    buffer_load_dwordx4 a[172:175], v18, s[4:7], s1 offen offset:3072 sc1
    buffer_load_dwordx4 a[176:179], v16, s[4:7], s83 offen offset:0 sc1
    v_exp_f32 v123, v123
    v_cvt_pk_bf16_f32 v132, v120, v121
    v_exp_f32 v124, v124
    v_exp_f32 v125, v125
    v_cvt_pk_bf16_f32 v133, v122, v123
    v_exp_f32 v126, v126
    v_exp_f32 v127, v127
    v_cvt_pk_bf16_f32 v134, v124, v125
    v_cvt_pk_bf16_f32 v135, v126, v127
    v_mfma_f32_32x32x16_bf16 v[112:127], v[140:143], v[144:147], 0
    s_waitcnt lgkmcnt(0)
    ds_read_b128 v[140:143], v248 offset:20480
    buffer_load_dwordx4 a[180:183], v16, s[4:7], s83 offen offset:1024 sc1
    v_exp_f32 v96, v96
    v_exp_f32 v97, v97
    v_exp_f32 v98, v98
    v_exp_f32 v99, v99
    v_mfma_f32_32x32x16_bf16 v[208:223], v[76:79], v[132:135], v[208:223]
    s_mov_b64 exec, s[20:21]
    ds_read_b128 v[72:75], v250 offset:28672
    ds_read_b128 v[76:79], v250 offset:29696
    s_mov_b64 exec, -1
    v_cvt_pk_bf16_f32 v128, v96, v97
    v_exp_f32 v100, v100
    v_exp_f32 v101, v101
    v_cvt_pk_bf16_f32 v129, v98, v99
    v_exp_f32 v102, v102
    v_exp_f32 v103, v103
    v_exp_f32 v104, v104
    v_cvt_pk_bf16_f32 v130, v100, v101
    v_cvt_pk_bf16_f32 v131, v102, v103
    v_exp_f32 v105, v105
    v_exp_f32 v106, v106
    v_mfma_f32_32x32x16_bf16 v[208:223], v[64:67], v[128:131], v[208:223]
    s_waitcnt vmcnt(13)
    s_barrier
    buffer_load_dwordx4 a[184:187], v16, s[4:7], s83 offen offset:2048 sc1
    v_exp_f32 v107, v107
    v_cvt_pk_bf16_f32 v132, v104, v105
    v_exp_f32 v108, v108
    v_exp_f32 v109, v109
    v_cvt_pk_bf16_f32 v133, v106, v107
    v_exp_f32 v110, v110
    v_exp_f32 v111, v111
    v_cvt_pk_bf16_f32 v134, v108, v109
    v_cvt_pk_bf16_f32 v135, v110, v111
    v_mfma_f32_32x32x16_bf16 v[96:111], v[136:139], v[144:147], 0
    s_waitcnt lgkmcnt(0)
    ds_read_b128 v[136:139], v248 offset:16384
    buffer_load_dwordx4 a[188:191], v16, s[4:7], s83 offen offset:3072 sc1
    v_exp_f32 v112, v112
    v_exp_f32 v113, v113
    v_exp_f32 v114, v114
    v_exp_f32 v115, v115
    v_mfma_f32_32x32x16_bf16 v[208:223], v[68:71], v[132:135], v[208:223]
    s_mov_b64 exec, s[20:21]
    ds_read_b128 v[64:67], v250 offset:24576
    ds_read_b128 v[68:71], v250 offset:25600
    s_mov_b64 exec, -1
    v_cvt_pk_bf16_f32 v128, v112, v113
    v_exp_f32 v116, v116
    v_exp_f32 v117, v117
    v_cvt_pk_bf16_f32 v129, v114, v115
    v_exp_f32 v118, v118
    v_exp_f32 v119, v119
    v_exp_f32 v120, v120
    v_cvt_pk_bf16_f32 v130, v116, v117
    v_cvt_pk_bf16_f32 v131, v118, v119
    v_exp_f32 v121, v121
    v_exp_f32 v122, v122
    v_mfma_f32_32x32x16_bf16 v[192:207], v[72:75], v[128:131], v[192:207]
    v_subrev_u32 v217, 0x2b800000, v216
    v_cmp_lt_u32 s[26:27], s87, v217
    s_nop 0
    s_cmp_lg_u64 s[26:27], 0
    s_cbranch_scc1 SLOW_33
BACK_34:
    v_rcp_f32 v217, v216
    s_nop 0
    v_mul_f32 v208, v208, v217
    v_mul_f32 v209, v209, v217
    v_cvt_pk_bf16_f32 v220, v208, v209
    v_mul_f32 v210, v210, v217
    v_mul_f32 v211, v211, v217
    v_cvt_pk_bf16_f32 v221, v210, v211
    v_mul_f32 v212, v212, v217
    v_mul_f32 v213, v213, v217
    v_cvt_pk_bf16_f32 v222, v212, v213
    v_mul_f32 v214, v214, v217
    v_mul_f32 v215, v215, v217
    v_cvt_pk_bf16_f32 v223, v214, v215
    buffer_load_dwordx4 a[192:195], v17, s[4:7], s83 offen offset:0 sc1
    v_exp_f32 v123, v123
    v_cvt_pk_bf16_f32 v132, v120, v121
    v_exp_f32 v124, v124
    v_exp_f32 v125, v125
    v_cvt_pk_bf16_f32 v133, v122, v123
    v_exp_f32 v126, v126
    v_exp_f32 v127, v127
    v_cvt_pk_bf16_f32 v134, v124, v125
    v_cvt_pk_bf16_f32 v135, v126, v127
    v_mfma_f32_32x32x16_bf16 v[112:127], v[140:143], v[144:147], 0
    s_waitcnt lgkmcnt(0)
    ds_read_b128 v[140:143], v248 offset:12288
    buffer_store_dwordx4 v[220:223], v0, s[4:7], s54 offen
    buffer_load_dwordx4 a[196:199], v17, s[4:7], s83 offen offset:1024 sc1
    buffer_load_dwordx4 a[200:203], v17, s[4:7], s83 offen offset:2048 sc1
    v_exp_f32 v96, v96
    v_exp_f32 v97, v97
    v_exp_f32 v98, v98
    v_exp_f32 v99, v99
    v_mfma_f32_32x32x16_bf16 v[192:207], v[76:79], v[132:135], v[192:207]
    s_mov_b64 exec, s[20:21]
    ds_read_b128 v[72:75], v250 offset:20480
    ds_read_b128 v[76:79], v250 offset:21504
    s_mov_b64 exec, -1
    v_cvt_pk_bf16_f32 v128, v96, v97
    v_exp_f32 v100, v100
    v_exp_f32 v101, v101
    v_cvt_pk_bf16_f32 v129, v98, v99
    v_exp_f32 v102, v102
    v_exp_f32 v103, v103
    v_exp_f32 v104, v104
    v_cvt_pk_bf16_f32 v130, v100, v101
    v_cvt_pk_bf16_f32 v131, v102, v103
    v_exp_f32 v105, v105
    v_exp_f32 v106, v106
    v_mfma_f32_32x32x16_bf16 v[192:207], v[64:67], v[128:131], v[192:207]
    buffer_load_dwordx4 a[204:207], v17, s[4:7], s83 offen offset:3072 sc1
    v_exp_f32 v107, v107
    v_cvt_pk_bf16_f32 v132, v104, v105
    v_exp_f32 v108, v108
    v_exp_f32 v109, v109
    v_cvt_pk_bf16_f32 v133, v106, v107
    v_exp_f32 v110, v110
    v_exp_f32 v111, v111
    v_cvt_pk_bf16_f32 v134, v108, v109
    v_cvt_pk_bf16_f32 v135, v110, v111
    v_mfma_f32_32x32x16_bf16 v[96:111], v[136:139], v[144:147], 0
    s_waitcnt lgkmcnt(0)
    ds_read_b128 v[136:139], v248 offset:8192
    buffer_load_dwordx4 a[208:211], v18, s[4:7], s83 offen offset:0 sc1
    v_exp_f32 v112, v112
    v_exp_f32 v113, v113
    v_exp_f32 v114, v114
    v_exp_f32 v115, v115
    v_mfma_f32_32x32x16_bf16 v[192:207], v[68:71], v[132:135], v[192:207]
    s_mov_b64 exec, s[20:21]
    ds_read_b128 v[64:67], v250 offset:16384
    ds_read_b128 v[68:71], v250 offset:17408
    s_mov_b64 exec, -1
    v_cvt_pk_bf16_f32 v128, v112, v113
    v_exp_f32 v116, v116
    v_exp_f32 v117, v117
    v_cvt_pk_bf16_f32 v129, v114, v115
    v_exp_f32 v118, v118
    v_exp_f32 v119, v119
    v_exp_f32 v120, v120
    v_cvt_pk_bf16_f32 v130, v116, v117
    v_cvt_pk_bf16_f32 v131, v118, v119
    v_exp_f32 v121, v121
    v_exp_f32 v122, v122
    v_mfma_f32_32x32x16_bf16 v[192:207], v[72:75], v[128:131], v[192:207]
    s_waitcnt vmcnt(4)
    s_cbranch_vccnz SAFE_35
    buffer_store_dword v11, v10, s[4:7], s56 offen offset:0
BACK_36:
    buffer_load_dwordx4 a[212:215], v18, s[4:7], s83 offen offset:1024 sc1
    v_exp_f32 v123, v123
    v_cvt_pk_bf16_f32 v132, v120, v121
    v_exp_f32 v124, v124
    v_exp_f32 v125, v125
    v_cvt_pk_bf16_f32 v133, v122, v123
    v_exp_f32 v126, v126
    v_exp_f32 v127, v127
    v_cvt_pk_bf16_f32 v134, v124, v125
    v_cvt_pk_bf16_f32 v135, v126, v127
    v_mfma_f32_32x32x16_bf16 v[112:127], v[140:143], v[144:147], 0
    s_waitcnt lgkmcnt(0)
    ds_read_b128 v[140:143], v248 offset:4096
    buffer_load_dwordx4 a[216:219], v18, s[4:7], s83 offen offset:2048 sc1
    v_exp_f32 v96, v96
    v_exp_f32 v97, v97
    v_exp_f32 v98, v98
    v_exp_f32 v99, v99
    v_mfma_f32_32x32x16_bf16 v[192:207], v[76:79], v[132:135], v[192:207]
    s_mov_b64 exec, s[20:21]
    ds_read_b128 v[72:75], v250 offset:12288
    ds_read_b128 v[76:79], v250 offset:13312
    s_mov_b64 exec, -1
    v_cvt_pk_bf16_f32 v128, v96, v97
    v_exp_f32 v100, v100
    v_exp_f32 v101, v101
    v_cvt_pk_bf16_f32 v129, v98, v99
    v_exp_f32 v102, v102
    v_exp_f32 v103, v103
    v_exp_f32 v104, v104
    v_cvt_pk_bf16_f32 v130, v100, v101
    v_cvt_pk_bf16_f32 v131, v102, v103
    v_exp_f32 v105, v105
    v_exp_f32 v106, v106
    v_mfma_f32_32x32x16_bf16 v[192:207], v[64:67], v[128:131], v[192:207]
    buffer_load_dwordx4 a[220:223], v18, s[4:7], s83 offen offset:3072 sc1
    buffer_load_dwordx4 a[224:227], v19, s[4:7], s83 offen offset:0 sc1
    v_exp_f32 v107, v107
    v_cvt_pk_bf16_f32 v132, v104, v105
    v_exp_f32 v108, v108
    v_exp_f32 v109, v109
    v_cvt_pk_bf16_f32 v133, v106, v107
    v_exp_f32 v110, v110
    v_exp_f32 v111, v111
    v_cvt_pk_bf16_f32 v134, v108, v109
    v_cvt_pk_bf16_f32 v135, v110, v111
    v_mfma_f32_32x32x16_bf16 v[96:111], v[136:139], v[144:147], 0
    s_waitcnt lgkmcnt(0)
    buffer_load_dwordx4 a[228:231], v19, s[4:7], s83 offen offset:1024 sc1
    global_load_dword v246, v246, s[90:91]
    v_exp_f32 v112, v112
    v_exp_f32 v113, v113
    v_exp_f32 v114, v114
    v_exp_f32 v115, v115
    v_mfma_f32_32x32x16_bf16 v[192:207], v[68:71], v[132:135], v[192:207]
    s_mov_b64 exec, s[20:21]
    ds_read_b128 v[64:67], v250 offset:8192
    ds_read_b128 v[68:71], v250 offset:9216
    s_mov_b64 exec, -1
    v_cvt_pk_bf16_f32 v128, v112, v113
    v_exp_f32 v116, v116
    v_exp_f32 v117, v117
    v_cvt_pk_bf16_f32 v129, v114, v115
    v_exp_f32 v118, v118
    v_exp_f32 v119, v119
    v_exp_f32 v120, v120
    v_cvt_pk_bf16_f32 v130, v116, v117
    v_cvt_pk_bf16_f32 v131, v118, v119
    v_exp_f32 v121, v121
    v_exp_f32 v122, v122
    v_mfma_f32_32x32x16_bf16 v[192:207], v[72:75], v[128:131], v[192:207]
    buffer_load_dwordx4 a[232:235], v19, s[4:7], s83 offen offset:2048 sc1
    v_exp_f32 v123, v123
    v_cvt_pk_bf16_f32 v132, v120, v121
    v_exp_f32 v124, v124
    v_exp_f32 v125, v125
    v_cvt_pk_bf16_f32 v133, v122, v123
    v_exp_f32 v126, v126
    v_exp_f32 v127, v127
    v_cvt_pk_bf16_f32 v134, v124, v125
    v_cvt_pk_bf16_f32 v135, v126, v127
    v_mfma_f32_32x32x16_bf16 v[112:127], v[140:143], v[144:147], v[48:63]
    s_waitcnt lgkmcnt(0)
    buffer_load_dwordx4 a[236:239], v19, s[4:7], s83 offen offset:3072 sc1
    v_exp_f32 v96, v96
    v_exp_f32 v97, v97
    v_exp_f32 v98, v98
    v_exp_f32 v99, v99
    v_mfma_f32_32x32x16_bf16 v[192:207], v[76:79], v[132:135], v[192:207]
    s_mov_b64 exec, s[20:21]
    ds_read_b128 v[72:75], v250 offset:4096
    ds_read_b128 v[76:79], v250 offset:5120
    s_mov_b64 exec, -1
    v_cvt_pk_bf16_f32 v128, v96, v97
    v_exp_f32 v100, v100
    v_exp_f32 v101, v101
    v_cvt_pk_bf16_f32 v129, v98, v99
    v_exp_f32 v102, v102
    v_exp_f32 v103, v103
    v_exp_f32 v104, v104
    v_cvt_pk_bf16_f32 v130, v100, v101
    v_cvt_pk_bf16_f32 v131, v102, v103
    v_exp_f32 v105, v105
    v_exp_f32 v106, v106
    v_mfma_f32_32x32x16_bf16 v[192:207], v[64:67], v[128:131], v[192:207]
    v_exp_f32 v107, v107
    v_cvt_pk_bf16_f32 v132, v104, v105
    v_exp_f32 v108, v108
    v_exp_f32 v109, v109
    v_cvt_pk_bf16_f32 v133, v106, v107
    v_exp_f32 v110, v110
    v_exp_f32 v111, v111
    v_cvt_pk_bf16_f32 v134, v108, v109
    v_cvt_pk_bf16_f32 v135, v110, v111
    buffer_load_dword v14, v15, s[4:7], s59 offen offset:0 sc1
    v_exp_f32 v112, v112
    v_exp_f32 v113, v113
    v_exp_f32 v114, v114
    v_exp_f32 v115, v115
    v_mfma_f32_32x32x16_bf16 v[192:207], v[68:71], v[132:135], v[192:207]
    v_cvt_pk_bf16_f32 v128, v112, v113
    v_exp_f32 v116, v116
    v_exp_f32 v117, v117
    v_cvt_pk_bf16_f32 v129, v114, v115
    v_exp_f32 v118, v118
    v_exp_f32 v119, v119
    v_exp_f32 v120, v120
    v_cvt_pk_bf16_f32 v130, v116, v117
    v_cvt_pk_bf16_f32 v131, v118, v119
    v_exp_f32 v121, v121
    v_exp_f32 v122, v122
    s_waitcnt lgkmcnt(0)
    v_mfma_f32_32x32x16_bf16 v[192:207], v[72:75], v[128:131], v[192:207]
    v_exp_f32 v123, v123
    v_cvt_pk_bf16_f32 v132, v120, v121
    v_exp_f32 v124, v124
    v_exp_f32 v125, v125
    v_cvt_pk_bf16_f32 v133, v122, v123
    v_exp_f32 v126, v126
    v_exp_f32 v127, v127
    v_cvt_pk_bf16_f32 v134, v124, v125
    v_cvt_pk_bf16_f32 v135, v126, v127
    s_nop 1
    v_mfma_f32_32x32x16_bf16 v[192:207], v[76:79], v[132:135], v[192:207]
    s_branch ATT0_done
.p2align 12
ATT0_2:
    s_waitcnt lgkmcnt(0)
    s_barrier
    ds_read_b128 v[144:147], v247
    ds_read_b128 v[148:151], v252
    ds_read_b128 v[136:139], v249 offset:40960
    ds_read_b128 v[140:143], v249 offset:45056
    s_mov_b64 exec, s[20:21]
    ds_read_b128 v[64:67], v251 offset:40960
    ds_read_b128 v[68:71], v251 offset:41984
    s_mov_b64 exec, -1
    s_waitcnt lgkmcnt(3)
    v_mfma_f32_32x32x16_bf16 v[96:111], v[136:139], v[148:151], 0
    ds_read_b128 v[136:139], v249 offset:49152
    s_waitcnt lgkmcnt(3)
    v_mfma_f32_32x32x16_bf16 v[112:127], v[140:143], v[148:151], 0
    s_waitcnt lgkmcnt(1)
    ds_read_b128 v[140:143], v249 offset:53248
    buffer_load_dword v14, v1, s[4:7], s48 offen offset:0 sc1
    buffer_load_dwordx4 a[84:87], v21, s[4:7], s84 offen offset:1024 sc1
    s_nop 4
    v_exp_f32 v96, v96
    v_exp_f32 v97, v97
    v_exp_f32 v98, v98
    v_exp_f32 v99, v99
    s_mov_b64 exec, s[20:21]
    ds_read_b128 v[72:75], v251 offset:45056
    ds_read_b128 v[76:79], v251 offset:46080
    s_mov_b64 exec, -1
    v_cvt_pk_bf16_f32 v128, v96, v97
    v_exp_f32 v100, v100
    v_exp_f32 v101, v101
    v_cvt_pk_bf16_f32 v129, v98, v99
    v_exp_f32 v102, v102
    v_exp_f32 v103, v103
    v_exp_f32 v104, v104
    v_cvt_pk_bf16_f32 v130, v100, v101
    v_cvt_pk_bf16_f32 v131, v102, v103
    v_exp_f32 v105, v105
    v_exp_f32 v106, v106
    v_mfma_f32_32x32x16_bf16 v[208:223], v[64:67], v[128:131], 0
    buffer_load_dwordx4 a[88:91], v21, s[4:7], s84 offen offset:2048 sc1
    v_exp_f32 v107, v107
    v_cvt_pk_bf16_f32 v132, v104, v105
    v_exp_f32 v108, v108
    v_exp_f32 v109, v109
    v_cvt_pk_bf16_f32 v133, v106, v107
    v_exp_f32 v110, v110
    v_exp_f32 v111, v111
    v_cvt_pk_bf16_f32 v134, v108, v109
    v_cvt_pk_bf16_f32 v135, v110, v111
    s_waitcnt lgkmcnt(3)
    v_mfma_f32_32x32x16_bf16 v[96:111], v[136:139], v[148:151], 0
    s_waitcnt lgkmcnt(0)
    ds_read_b128 v[136:139], v248 offset:40960
    s_waitcnt vmcnt(2)
    v_cmp_gt_u32 vcc, s34, v14
    s_cbranch_vccnz SPIN_49
BACK_50:
    s_mov_b32 m0, s50
    s_nop 0
    buffer_load_dwordx4 v16, s[4:7], s49 offen offset:0 sc1 lds
    buffer_load_dwordx4 v16, s[4:7], s49 offen offset:1024 sc1 lds
    buffer_load_dwordx4 v16, s[4:7], s49 offen offset:2048 sc1 lds
    buffer_load_dwordx4 v16, s[4:7], s49 offen offset:3072 sc1 lds
    buffer_load_dwordx4 a[92:95], v21, s[4:7], s84 offen offset:3072 sc1
    v_exp_f32 v112, v112
    v_exp_f32 v113, v113
    v_exp_f32 v114, v114
    v_exp_f32 v115, v115
    v_mfma_f32_32x32x16_bf16 v[208:223], v[68:71], v[132:135], v[208:223]
    s_mov_b64 exec, s[20:21]
    ds_read_b128 v[64:67], v251 offset:49152
    ds_read_b128 v[68:71], v251 offset:50176
    s_mov_b64 exec, -1
    v_cvt_pk_bf16_f32 v128, v112, v113
    v_exp_f32 v116, v116
    v_exp_f32 v117, v117
    v_cvt_pk_bf16_f32 v129, v114, v115
    v_exp_f32 v118, v118
    v_exp_f32 v119, v119
    v_exp_f32 v120, v120
    v_cvt_pk_bf16_f32 v130, v116, v117
    v_cvt_pk_bf16_f32 v131, v118, v119
    v_exp_f32 v121, v121
    v_exp_f32 v122, v122
    v_mfma_f32_32x32x16_bf16 v[208:223], v[72:75], v[128:131], v[208:223]
    buffer_load_dword v2, v4, s[4:7], s51 offen offset:0 sc1
    buffer_load_dwordx4 a[96:99], v22, s[4:7], s84 offen offset:0 sc1
    buffer_load_dwordx4 a[100:103], v22, s[4:7], s84 offen offset:1024 sc1
    v_exp_f32 v123, v123
    v_cvt_pk_bf16_f32 v132, v120, v121
    v_exp_f32 v124, v124
    v_exp_f32 v125, v125
    v_cvt_pk_bf16_f32 v133, v122, v123
    v_exp_f32 v126, v126
    v_exp_f32 v127, v127
    v_cvt_pk_bf16_f32 v134, v124, v125
    v_cvt_pk_bf16_f32 v135, v126, v127
    v_mfma_f32_32x32x16_bf16 v[112:127], v[140:143], v[148:151], v[32:47]
    s_waitcnt lgkmcnt(0)
    buffer_load_dwordx4 a[104:107], v22, s[4:7], s84 offen offset:2048 sc1
    v_exp_f32 v96, v96
    v_exp_f32 v97, v97
    v_exp_f32 v98, v98
    v_exp_f32 v99, v99
    v_mfma_f32_32x32x16_bf16 v[208:223], v[76:79], v[132:135], v[208:223]
    s_mov_b64 exec, s[20:21]
    ds_read_b128 v[72:75], v251 offset:53248
    ds_read_b128 v[76:79], v251 offset:54272
    s_mov_b64 exec, -1
    v_cvt_pk_bf16_f32 v128, v96, v97
    v_exp_f32 v100, v100
    v_exp_f32 v101, v101
    v_cvt_pk_bf16_f32 v129, v98, v99
    v_exp_f32 v102, v102
    v_exp_f32 v103, v103
    v_exp_f32 v104, v104
    v_cvt_pk_bf16_f32 v130, v100, v101
    v_cvt_pk_bf16_f32 v131, v102, v103
    v_exp_f32 v105, v105
    v_exp_f32 v106, v106
    v_mfma_f32_32x32x16_bf16 v[208:223], v[64:67], v[128:131], v[208:223]
    buffer_load_dwordx4 a[108:111], v22, s[4:7], s84 offen offset:3072 sc1
    v_exp_f32 v107, v107
    v_cvt_pk_bf16_f32 v132, v104, v105
    v_exp_f32 v108, v108
    v_exp_f32 v109, v109
    v_cvt_pk_bf16_f32 v133, v106, v107
    v_exp_f32 v110, v110
    v_exp_f32 v111, v111
    v_cvt_pk_bf16_f32 v134, v108, v109
    v_cvt_pk_bf16_f32 v135, v110, v111
    v_mfma_f32_32x32x16_bf16 v[96:111], v[136:139], v[144:147], v[32:47]
    s_waitcnt lgkmcnt(0)
    buffer_load_dwordx4 a[112:115], v23, s[4:7], s84 offen offset:0 sc1
    v_exp_f32 v112, v112
    v_exp_f32 v113, v113
    v_exp_f32 v114, v114
    v_exp_f32 v115, v115
    v_mfma_f32_32x32x16_bf16 v[208:223], v[68:71], v[132:135], v[208:223]
    s_mov_b64 exec, s[20:21]
    ds_read_b128 v[64:67], v250 offset:40960
    ds_read_b128 v[68:71], v250 offset:41984
    s_mov_b64 exec, -1
    v_cvt_pk_bf16_f32 v128, v112, v113
    v_exp_f32 v116, v116
    v_exp_f32 v117, v117
    v_cvt_pk_bf16_f32 v129, v114, v115
    v_exp_f32 v118, v118
    v_exp_f32 v119, v119
    v_exp_f32 v120, v120
    v_cvt_pk_bf16_f32 v130, v116, v117
    v_cvt_pk_bf16_f32 v131, v118, v119
    v_exp_f32 v121, v121
    v_exp_f32 v122, v122
    v_mfma_f32_32x32x16_bf16 v[208:223], v[72:75], v[128:131], v[208:223]
    s_waitcnt vmcnt(7)
    s_barrier
    s_waitcnt vmcnt(5)
    v_cmp_gt_u32 vcc, s34, v2
    s_cbranch_vccnz SPIN_52
BACK_53:
    s_add_u32 m0, s82, 114688
    s_nop 0
    buffer_load_dwordx4 v16, s[4:7], s96 offen offset:0 sc1 lds
    buffer_load_dwordx4 v16, s[4:7], s96 offen offset:1024 sc1 lds
    buffer_load_dwordx4 v16, s[4:7], s96 offen offset:2048 sc1 lds
    buffer_load_dwordx4 v16, s[4:7], s96 offen offset:3072 sc1 lds
    buffer_load_dwordx4 a[116:119], v23, s[4:7], s84 offen offset:1024 sc1
    ds_read_b128 v[140:143], v249 offset:32768
    ds_read_b128 v[136:139], v249 offset:36864
    v_exp_f32 v123, v123
    v_cvt_pk_bf16_f32 v132, v120, v121
    v_exp_f32 v124, v124
    v_exp_f32 v125, v125
    v_cvt_pk_bf16_f32 v133, v122, v123
    v_exp_f32 v126, v126
    v_exp_f32 v127, v127
    v_cvt_pk_bf16_f32 v134, v124, v125
    v_cvt_pk_bf16_f32 v135, v126, v127
    s_waitcnt lgkmcnt(1)
    v_mfma_f32_32x32x16_bf16 v[112:127], v[140:143], v[148:151], 0
    ds_read_b128 v[140:143], v248 offset:32768
    buffer_load_dwordx4 a[120:123], v23, s[4:7], s84 offen offset:2048 sc1
    buffer_load_dwordx4 a[124:127], v23, s[4:7], s84 offen offset:3072 sc1
    v_exp_f32 v96, v96
    v_exp_f32 v97, v97
    v_exp_f32 v98, v98
    v_exp_f32 v99, v99
    v_mfma_f32_32x32x16_bf16 v[208:223], v[76:79], v[132:135], v[208:223]
    s_mov_b64 exec, s[20:21]
    ds_read_b128 v[72:75], v251 offset:32768
    ds_read_b128 v[76:79], v251 offset:33792
    s_mov_b64 exec, -1
    v_cvt_pk_bf16_f32 v128, v96, v97
    v_exp_f32 v100, v100
    v_exp_f32 v101, v101
    v_cvt_pk_bf16_f32 v129, v98, v99
    v_exp_f32 v102, v102
    v_exp_f32 v103, v103
    v_exp_f32 v104, v104
    v_cvt_pk_bf16_f32 v130, v100, v101
    v_cvt_pk_bf16_f32 v131, v102, v103
    v_exp_f32 v105, v105
    v_exp_f32 v106, v106
    v_mfma_f32_32x32x16_bf16 v[192:207], v[64:67], v[128:131], 0
    buffer_load_dwordx4 a[128:131], v16, s[4:7], s1 offen offset:0 sc1
    v_exp_f32 v107, v107
    v_cvt_pk_bf16_f32 v132, v104, v105
    v_exp_f32 v108, v108
    v_exp_f32 v109, v109
    v_cvt_pk_bf16_f32 v133, v106, v107
    v_exp_f32 v110, v110
    v_exp_f32 v111, v111
    v_cvt_pk_bf16_f32 v134, v108, v109
    v_cvt_pk_bf16_f32 v135, v110, v111
    s_waitcnt lgkmcnt(3)
    v_mfma_f32_32x32x16_bf16 v[96:111], v[136:139], v[148:151], 0
    s_waitcnt lgkmcnt(0)
    ds_read_b128 v[136:139], v248 offset:36864
    s_add_u32 m0, s82, 98304
    s_nop 0
    buffer_load_dwordx4 v16, s[4:7], s97 offen offset:0 sc1 lds
    buffer_load_dwordx4 v16, s[4:7], s97 offen offset:1024 sc1 lds
    buffer_load_dwordx4 v16, s[4:7], s97 offen offset:2048 sc1 lds
    buffer_load_dwordx4 v16, s[4:7], s97 offen offset:3072 sc1 lds
    buffer_load_dwordx4 a[132:135], v16, s[4:7], s1 offen offset:1024 sc1
    v_exp_f32 v112, v112
    v_exp_f32 v113, v113
    v_exp_f32 v114, v114
    v_exp_f32 v115, v115
    v_mfma_f32_32x32x16_bf16 v[192:207], v[68:71], v[132:135], v[192:207]
    s_mov_b64 exec, s[20:21]
    ds_read_b128 v[64:67], v251 offset:36864
    ds_read_b128 v[68:71], v251 offset:37888
    s_mov_b64 exec, -1
    v_cvt_pk_bf16_f32 v128, v112, v113
    v_exp_f32 v116, v116
    v_exp_f32 v117, v117
    v_cvt_pk_bf16_f32 v129, v114, v115
    v_exp_f32 v118, v118
    v_exp_f32 v119, v119
    v_exp_f32 v120, v120
    v_cvt_pk_bf16_f32 v130, v116, v117
    v_cvt_pk_bf16_f32 v131, v118, v119
    v_exp_f32 v121, v121
    v_exp_f32 v122, v122
    v_mfma_f32_32x32x16_bf16 v[208:223], v[72:75], v[128:131], v[208:223]
    buffer_load_dwordx4 a[136:139], v16, s[4:7], s1 offen offset:2048 sc1
    v_exp_f32 v123, v123
    v_cvt_pk_bf16_f32 v132, v120, v121
    v_exp_f32 v124, v124
    v_exp_f32 v125, v125
    v_cvt_pk_bf16_f32 v133, v122, v123
    v_exp_f32 v126, v126
    v_exp_f32 v127, v127
    v_cvt_pk_bf16_f32 v134, v124, v125
    v_cvt_pk_bf16_f32 v135, v126, v127
    v_mfma_f32_32x32x16_bf16 v[112:127], v[140:143], v[144:147], 0
    s_waitcnt lgkmcnt(0)
    buffer_load_dwordx4 a[140:143], v16, s[4:7], s1 offen offset:3072 sc1
    v_exp_f32 v96, v96
    v_exp_f32 v97, v97
    v_exp_f32 v98, v98
    v_exp_f32 v99, v99
    v_mfma_f32_32x32x16_bf16 v[208:223], v[76:79], v[132:135], v[208:223]
    s_mov_b64 exec, s[20:21]
    ds_read_b128 v[72:75], v250 offset:32768
    ds_read_b128 v[76:79], v250 offset:33792
    s_mov_b64 exec, -1
    v_cvt_pk_bf16_f32 v128, v96, v97
    v_exp_f32 v100, v100
    v_exp_f32 v101, v101
    v_cvt_pk_bf16_f32 v129, v98, v99
    v_exp_f32 v102, v102
    v_exp_f32 v103, v103
    v_exp_f32 v104, v104
    v_cvt_pk_bf16_f32 v130, v100, v101
    v_cvt_pk_bf16_f32 v131, v102, v103
    v_exp_f32 v105, v105
    v_exp_f32 v106, v106
    v_mfma_f32_32x32x16_bf16 v[208:223], v[64:67], v[128:131], v[208:223]
    buffer_load_dwordx4 a[144:147], v17, s[4:7], s1 offen offset:0 sc1
    buffer_load_dwordx4 a[148:151], v17, s[4:7], s1 offen offset:1024 sc1
    v_exp_f32 v107, v107
    v_cvt_pk_bf16_f32 v132, v104, v105
    v_exp_f32 v108, v108
    v_exp_f32 v109, v109
    v_cvt_pk_bf16_f32 v133, v106, v107
    v_exp_f32 v110, v110
    v_exp_f32 v111, v111
    v_cvt_pk_bf16_f32 v134, v108, v109
    v_cvt_pk_bf16_f32 v135, v110, v111
    s_cmp_eq_u32 s12, 0
    s_cbranch_scc1 ATTG00_2
    v_mfma_f32_32x32x16_bf16 v[96:111], v[136:139], v[144:147], 0
    s_waitcnt lgkmcnt(0)
    buffer_load_dwordx4 a[152:155], v17, s[4:7], s1 offen offset:2048 sc1
    v_exp_f32 v112, v112
    v_exp_f32 v113, v113
    v_exp_f32 v114, v114
    v_exp_f32 v115, v115
    v_mfma_f32_32x32x16_bf16 v[208:223], v[68:71], v[132:135], v[208:223]
    s_mov_b64 exec, s[20:21]
    ds_read_b128 v[64:67], v250 offset:36864
    ds_read_b128 v[68:71], v250 offset:37888
    s_mov_b64 exec, -1
    v_cvt_pk_bf16_f32 v128, v112, v113
    v_exp_f32 v116, v116
    v_exp_f32 v117, v117
    v_cvt_pk_bf16_f32 v129, v114, v115
    v_exp_f32 v118, v118
    v_exp_f32 v119, v119
    v_exp_f32 v120, v120
    v_cvt_pk_bf16_f32 v130, v116, v117
    v_cvt_pk_bf16_f32 v131, v118, v119
    v_exp_f32 v121, v121
    v_exp_f32 v122, v122
    v_mfma_f32_32x32x16_bf16 v[192:207], v[72:75], v[128:131], v[192:207]
    s_waitcnt vmcnt(14)
    s_barrier
    buffer_load_dwordx4 a[156:159], v17, s[4:7], s1 offen offset:3072 sc1
    ds_read_b128 v[140:143], v249 offset:20480
    ds_read_b128 v[136:139], v249 offset:24576
    v_exp_f32 v123, v123
    v_cvt_pk_bf16_f32 v132, v120, v121
    v_exp_f32 v124, v124
    v_exp_f32 v125, v125
    v_cvt_pk_bf16_f32 v133, v122, v123
    v_exp_f32 v126, v126
    v_exp_f32 v127, v127
    v_cvt_pk_bf16_f32 v134, v124, v125
    v_cvt_pk_bf16_f32 v135, v126, v127
    s_waitcnt lgkmcnt(1)
    v_mfma_f32_32x32x16_bf16 v[112:127], v[140:143], v[148:151], v[48:63]
    ds_read_b128 v[140:143], v249 offset:28672
    buffer_load_dwordx4 a[160:163], v18, s[4:7], s1 offen offset:0 sc1
    v_exp_f32 v96, v96
    v_exp_f32 v97, v97
    v_exp_f32 v98, v98
    v_exp_f32 v99, v99
    v_mfma_f32_32x32x16_bf16 v[192:207], v[76:79], v[132:135], v[192:207]
    s_mov_b64 exec, s[20:21]
    ds_read_b128 v[72:75], v251 offset:20480
    ds_read_b128 v[76:79], v251 offset:21504
    s_mov_b64 exec, -1
    v_cvt_pk_bf16_f32 v128, v96, v97
    v_exp_f32 v100, v100
    v_exp_f32 v101, v101
    v_cvt_pk_bf16_f32 v129, v98, v99
    v_exp_f32 v102, v102
    v_exp_f32 v103, v103
    v_exp_f32 v104, v104
    v_cvt_pk_bf16_f32 v130, v100, v101
    v_cvt_pk_bf16_f32 v131, v102, v103
    v_exp_f32 v105, v105
    v_exp_f32 v106, v106
    v_mfma_f32_32x32x16_bf16 v[192:207], v[64:67], v[128:131], v[192:207]
    buffer_load_dwordx4 a[164:167], v18, s[4:7], s1 offen offset:1024 sc1
    v_exp_f32 v107, v107
    v_cvt_pk_bf16_f32 v132, v104, v105
    v_exp_f32 v108, v108
    v_exp_f32 v109, v109
    v_cvt_pk_bf16_f32 v133, v106, v107
    v_exp_f32 v110, v110
    v_exp_f32 v111, v111
    v_cvt_pk_bf16_f32 v134, v108, v109
    v_cvt_pk_bf16_f32 v135, v110, v111
    s_waitcnt lgkmcnt(3)
    v_mfma_f32_32x32x16_bf16 v[96:111], v[136:139], v[148:151], 0
    s_waitcnt lgkmcnt(0)
    ds_read_b128 v[136:139], v248 offset:28672
    buffer_load_dwordx4 a[168:171], v18, s[4:7], s1 offen offset:2048 sc1
    v_exp_f32 v112, v112
    v_exp_f32 v113, v113
    v_exp_f32 v114, v114
    v_exp_f32 v115, v115
    v_mfma_f32_32x32x16_bf16 v[192:207], v[68:71], v[132:135], v[192:207]
    s_mov_b64 exec, s[20:21]
    ds_read_b128 v[64:67], v251 offset:24576
    ds_read_b128 v[68:71], v251 offset:25600
    s_mov_b64 exec, -1
    v_cvt_pk_bf16_f32 v128, v112, v113
    v_exp_f32 v116, v116
    v_exp_f32 v117, v117
    v_cvt_pk_bf16_f32 v129, v114, v115
    v_exp_f32 v118, v118
    v_exp_f32 v119, v119
    v_exp_f32 v120, v120
    v_cvt_pk_bf16_f32 v130, v116, v117
    v_cvt_pk_bf16_f32 v131, v118, v119
    v_exp_f32 v121, v121
    v_exp_f32 v122, v122
    v_mfma_f32_32x32x16_bf16 v[208:223], v[72:75], v[128:131], v[208:223]
    buffer_load_dwordx4 a[172:175], v18, s[4:7], s1 offen offset:3072 sc1
    buffer_load_dwordx4 a[176:179], v16, s[4:7], s83 offen offset:0 sc1
    v_exp_f32 v123, v123
    v_cvt_pk_bf16_f32 v132, v120, v121
    v_exp_f32 v124, v124
    v_exp_f32 v125, v125
    v_cvt_pk_bf16_f32 v133, v122, v123
    v_exp_f32 v126, v126
    v_exp_f32 v127, v127
    v_cvt_pk_bf16_f32 v134, v124, v125
    v_cvt_pk_bf16_f32 v135, v126, v127
    v_mfma_f32_32x32x16_bf16 v[112:127], v[140:143], v[148:151], 0
    s_waitcnt lgkmcnt(0)
    ds_read_b128 v[140:143], v248 offset:24576
    buffer_load_dwordx4 a[180:183], v16, s[4:7], s83 offen offset:1024 sc1
    v_exp_f32 v96, v96
    v_exp_f32 v97, v97
    v_exp_f32 v98, v98
    v_exp_f32 v99, v99
    v_mfma_f32_32x32x16_bf16 v[208:223], v[76:79], v[132:135], v[208:223]
    s_mov_b64 exec, s[20:21]
    ds_read_b128 v[72:75], v251 offset:28672
    ds_read_b128 v[76:79], v251 offset:29696
    s_mov_b64 exec, -1
    v_cvt_pk_bf16_f32 v128, v96, v97
    v_exp_f32 v100, v100
    v_exp_f32 v101, v101
    v_cvt_pk_bf16_f32 v129, v98, v99
    v_exp_f32 v102, v102
    v_exp_f32 v103, v103
    v_exp_f32 v104, v104
    v_cvt_pk_bf16_f32 v130, v100, v101
    v_cvt_pk_bf16_f32 v131, v102, v103
    v_exp_f32 v105, v105
    v_exp_f32 v106, v106
    v_mfma_f32_32x32x16_bf16 v[208:223], v[64:67], v[128:131], v[208:223]
    s_waitcnt vmcnt(13)
    s_barrier
    buffer_load_dwordx4 a[184:187], v16, s[4:7], s83 offen offset:2048 sc1
    v_exp_f32 v107, v107
    v_cvt_pk_bf16_f32 v132, v104, v105
    v_exp_f32 v108, v108
    v_exp_f32 v109, v109
    v_cvt_pk_bf16_f32 v133, v106, v107
    v_exp_f32 v110, v110
    v_exp_f32 v111, v111
    v_cvt_pk_bf16_f32 v134, v108, v109
    v_cvt_pk_bf16_f32 v135, v110, v111
    v_mfma_f32_32x32x16_bf16 v[96:111], v[136:139], v[144:147], 0
    s_waitcnt lgkmcnt(0)
    ds_read_b128 v[136:139], v248 offset:20480
    buffer_load_dwordx4 a[188:191], v16, s[4:7], s83 offen offset:3072 sc1
    v_exp_f32 v112, v112
    v_exp_f32 v113, v113
    v_exp_f32 v114, v114
    v_exp_f32 v115, v115
    v_mfma_f32_32x32x16_bf16 v[208:223], v[68:71], v[132:135], v[208:223]
    s_mov_b64 exec, s[20:21]
    ds_read_b128 v[64:67], v250 offset:28672
    ds_read_b128 v[68:71], v250 offset:29696
    s_mov_b64 exec, -1
    v_cvt_pk_bf16_f32 v128, v112, v113
    v_exp_f32 v116, v116
    v_exp_f32 v117, v117
    v_cvt_pk_bf16_f32 v129, v114, v115
    v_exp_f32 v118, v118
    v_exp_f32 v119, v119
    v_exp_f32 v120, v120
    v_cvt_pk_bf16_f32 v130, v116, v117
    v_cvt_pk_bf16_f32 v131, v118, v119
    v_exp_f32 v121, v121
    v_exp_f32 v122, v122
    v_mfma_f32_32x32x16_bf16 v[208:223], v[72:75], v[128:131], v[208:223]
    buffer_load_dwordx4 a[192:195], v17, s[4:7], s83 offen offset:0 sc1
    v_exp_f32 v123, v123
    v_cvt_pk_bf16_f32 v132, v120, v121
    v_exp_f32 v124, v124
    v_exp_f32 v125, v125
    v_cvt_pk_bf16_f32 v133, v122, v123
    v_exp_f32 v126, v126
    v_exp_f32 v127, v127
    v_cvt_pk_bf16_f32 v134, v124, v125
    v_cvt_pk_bf16_f32 v135, v126, v127
    v_mfma_f32_32x32x16_bf16 v[112:127], v[140:143], v[144:147], 0
    s_waitcnt lgkmcnt(0)
    ds_read_b128 v[140:143], v248 offset:16384
    buffer_load_dwordx4 a[196:199], v17, s[4:7], s83 offen offset:1024 sc1
    buffer_load_dwordx4 a[200:203], v17, s[4:7], s83 offen offset:2048 sc1
    v_exp_f32 v96, v96
    v_exp_f32 v97, v97
    v_exp_f32 v98, v98
    v_exp_f32 v99, v99
    v_mfma_f32_32x32x16_bf16 v[208:223], v[76:79], v[132:135], v[208:223]
    s_mov_b64 exec, s[20:21]
    ds_read_b128 v[72:75], v250 offset:24576
    ds_read_b128 v[76:79], v250 offset:25600
    s_mov_b64 exec, -1
    v_cvt_pk_bf16_f32 v128, v96, v97
    v_exp_f32 v100, v100
    v_exp_f32 v101, v101
    v_cvt_pk_bf16_f32 v129, v98, v99
    v_exp_f32 v102, v102
    v_exp_f32 v103, v103
    v_exp_f32 v104, v104
    v_cvt_pk_bf16_f32 v130, v100, v101
    v_cvt_pk_bf16_f32 v131, v102, v103
    v_exp_f32 v105, v105
    v_exp_f32 v106, v106
    v_mfma_f32_32x32x16_bf16 v[192:207], v[64:67], v[128:131], v[192:207]
    v_subrev_u32 v217, 0x2b800000, v216
    v_cmp_lt_u32 s[26:27], s87, v217
    s_nop 0
    s_cmp_lg_u64 s[26:27], 0
    s_cbranch_scc1 SLOW_55
BACK_56:
    v_rcp_f32 v217, v216
    s_nop 0
    v_mul_f32 v208, v208, v217
    v_mul_f32 v209, v209, v217
    v_cvt_pk_bf16_f32 v220, v208, v209
    v_mul_f32 v210, v210, v217
    v_mul_f32 v211, v211, v217
    v_cvt_pk_bf16_f32 v221, v210, v211
    v_mul_f32 v212, v212, v217
    v_mul_f32 v213, v213, v217
    v_cvt_pk_bf16_f32 v222, v212, v213
    v_mul_f32 v214, v214, v217
    v_mul_f32 v215, v215, v217
    v_cvt_pk_bf16_f32 v223, v214, v215
    buffer_load_dwordx4 a[204:207], v17, s[4:7], s83 offen offset:3072 sc1
    v_exp_f32 v107, v107
    v_cvt_pk_bf16_f32 v132, v104, v105
    v_exp_f32 v108, v108
    v_exp_f32 v109, v109
    v_cvt_pk_bf16_f32 v133, v106, v107
    v_exp_f32 v110, v110
    v_exp_f32 v111, v111
    v_cvt_pk_bf16_f32 v134, v108, v109
    v_cvt_pk_bf16_f32 v135, v110, v111
    v_mfma_f32_32x32x16_bf16 v[96:111], v[136:139], v[144:147], 0
    s_waitcnt lgkmcnt(0)
    ds_read_b128 v[136:139], v248 offset:12288
    buffer_store_dwordx4 v[220:223], v0, s[4:7], s54 offen
    buffer_load_dwordx4 a[208:211], v18, s[4:7], s83 offen offset:0 sc1
    v_exp_f32 v112, v112
    v_exp_f32 v113, v113
    v_exp_f32 v114, v114
    v_exp_f32 v115, v115
    v_mfma_f32_32x32x16_bf16 v[192:207], v[68:71], v[132:135], v[192:207]
    s_mov_b64 exec, s[20:21]
    ds_read_b128 v[64:67], v250 offset:20480
    ds_read_b128 v[68:71], v250 offset:21504
    s_mov_b64 exec, -1
    v_cvt_pk_bf16_f32 v128, v112, v113
    v_exp_f32 v116, v116
    v_exp_f32 v117, v117
    v_cvt_pk_bf16_f32 v129, v114, v115
    v_exp_f32 v118, v118
    v_exp_f32 v119, v119
    v_exp_f32 v120, v120
    v_cvt_pk_bf16_f32 v130, v116, v117
    v_cvt_pk_bf16_f32 v131, v118, v119
    v_exp_f32 v121, v121
    v_exp_f32 v122, v122
    v_mfma_f32_32x32x16_bf16 v[192:207], v[72:75], v[128:131], v[192:207]
    buffer_load_dwordx4 a[212:215], v18, s[4:7], s83 offen offset:1024 sc1
    v_exp_f32 v123, v123
    v_cvt_pk_bf16_f32 v132, v120, v121
    v_exp_f32 v124, v124
    v_exp_f32 v125, v125
    v_cvt_pk_bf16_f32 v133, v122, v123
    v_exp_f32 v126, v126
    v_exp_f32 v127, v127
    v_cvt_pk_bf16_f32 v134, v124, v125
    v_cvt_pk_bf16_f32 v135, v126, v127
    v_mfma_f32_32x32x16_bf16 v[112:127], v[140:143], v[144:147], 0
    s_waitcnt lgkmcnt(0)
    ds_read_b128 v[140:143], v248 offset:8192
    buffer_load_dwordx4 a[216:219], v18, s[4:7], s83 offen offset:2048 sc1
    v_exp_f32 v96, v96
    v_exp_f32 v97, v97
    v_exp_f32 v98, v98
    v_exp_f32 v99, v99
    v_mfma_f32_32x32x16_bf16 v[192:207], v[76:79], v[132:135], v[192:207]
    s_mov_b64 exec, s[20:21]
    ds_read_b128 v[72:75], v250 offset:16384
    ds_read_b128 v[76:79], v250 offset:17408
    s_mov_b64 exec, -1
    v_cvt_pk_bf16_f32 v128, v96, v97
    v_exp_f32 v100, v100
    v_exp_f32 v101, v101
    v_cvt_pk_bf16_f32 v129, v98, v99
    v_exp_f32 v102, v102
    v_exp_f32 v103, v103
    v_exp_f32 v104, v104
    v_cvt_pk_bf16_f32 v130, v100, v101
    v_cvt_pk_bf16_f32 v131, v102, v103
    v_exp_f32 v105, v105
    v_exp_f32 v106, v106
    v_mfma_f32_32x32x16_bf16 v[192:207], v[64:67], v[128:131], v[192:207]
    s_waitcnt vmcnt(3)
    s_cbranch_vccnz SAFE_57
    buffer_store_dword v11, v10, s[4:7], s56 offen offset:0
BACK_58:
    buffer_load_dwordx4 a[220:223], v18, s[4:7], s83 offen offset:3072 sc1
    buffer_load_dwordx4 a[224:227], v19, s[4:7], s83 offen offset:0 sc1
    v_exp_f32 v107, v107
    v_cvt_pk_bf16_f32 v132, v104, v105
    v_exp_f32 v108, v108
    v_exp_f32 v109, v109
    v_cvt_pk_bf16_f32 v133, v106, v107
    v_exp_f32 v110, v110
    v_exp_f32 v111, v111
    v_cvt_pk_bf16_f32 v134, v108, v109
    v_cvt_pk_bf16_f32 v135, v110, v111
    v_mfma_f32_32x32x16_bf16 v[96:111], v[136:139], v[144:147], 0
    s_waitcnt lgkmcnt(0)
    buffer_load_dwordx4 a[228:231], v19, s[4:7], s83 offen offset:1024 sc1
    global_load_dword v246, v246, s[90:91]
    v_exp_f32 v112, v112
    v_exp_f32 v113, v113
    v_exp_f32 v114, v114
    v_exp_f32 v115, v115
    v_mfma_f32_32x32x16_bf16 v[192:207], v[68:71], v[132:135], v[192:207]
    s_mov_b64 exec, s[20:21]
    ds_read_b128 v[64:67], v250 offset:12288
    ds_read_b128 v[68:71], v250 offset:13312
    s_mov_b64 exec, -1
    v_cvt_pk_bf16_f32 v128, v112, v113
    v_exp_f32 v116, v116
    v_exp_f32 v117, v117
    v_cvt_pk_bf16_f32 v129, v114, v115
    v_exp_f32 v118, v118
    v_exp_f32 v119, v119
    v_exp_f32 v120, v120
    v_cvt_pk_bf16_f32 v130, v116, v117
    v_cvt_pk_bf16_f32 v131, v118, v119
    v_exp_f32 v121, v121
    v_exp_f32 v122, v122
    v_mfma_f32_32x32x16_bf16 v[192:207], v[72:75], v[128:131], v[192:207]
    buffer_load_dwordx4 a[232:235], v19, s[4:7], s83 offen offset:2048 sc1
    v_exp_f32 v123, v123
    v_cvt_pk_bf16_f32 v132, v120, v121
    v_exp_f32 v124, v124
    v_exp_f32 v125, v125
    v_cvt_pk_bf16_f32 v133, v122, v123
    v_exp_f32 v126, v126
    v_exp_f32 v127, v127
    v_cvt_pk_bf16_f32 v134, v124, v125
    v_cvt_pk_bf16_f32 v135, v126, v127
    v_mfma_f32_32x32x16_bf16 v[112:127], v[140:143], v[144:147], v[48:63]
    s_waitcnt lgkmcnt(0)
    buffer_load_dwordx4 a[236:239], v19, s[4:7], s83 offen offset:3072 sc1
    v_exp_f32 v96, v96
    v_exp_f32 v97, v97
    v_exp_f32 v98, v98
    v_exp_f32 v99, v99
    v_mfma_f32_32x32x16_bf16 v[192:207], v[76:79], v[132:135], v[192:207]
    s_mov_b64 exec, s[20:21]
    ds_read_b128 v[72:75], v250 offset:8192
    ds_read_b128 v[76:79], v250 offset:9216
    s_mov_b64 exec, -1
    v_cvt_pk_bf16_f32 v128, v96, v97
    v_exp_f32 v100, v100
    v_exp_f32 v101, v101
    v_cvt_pk_bf16_f32 v129, v98, v99
    v_exp_f32 v102, v102
    v_exp_f32 v103, v103
    v_exp_f32 v104, v104
    v_cvt_pk_bf16_f32 v130, v100, v101
    v_cvt_pk_bf16_f32 v131, v102, v103
    v_exp_f32 v105, v105
    v_exp_f32 v106, v106
    v_mfma_f32_32x32x16_bf16 v[192:207], v[64:67], v[128:131], v[192:207]
    v_exp_f32 v107, v107
    v_cvt_pk_bf16_f32 v132, v104, v105
    v_exp_f32 v108, v108
    v_exp_f32 v109, v109
    v_cvt_pk_bf16_f32 v133, v106, v107
    v_exp_f32 v110, v110
    v_exp_f32 v111, v111
    v_cvt_pk_bf16_f32 v134, v108, v109
    v_cvt_pk_bf16_f32 v135, v110, v111
    buffer_load_dword v14, v15, s[4:7], s59 offen offset:0 sc1
    v_exp_f32 v112, v112
    v_exp_f32 v113, v113
    v_exp_f32 v114, v114
    v_exp_f32 v115, v115
    v_mfma_f32_32x32x16_bf16 v[192:207], v[68:71], v[132:135], v[192:207]
    v_cvt_pk_bf16_f32 v128, v112, v113
    v_exp_f32 v116, v116
    v_exp_f32 v117, v117
    v_cvt_pk_bf16_f32 v129, v114, v115
    v_exp_f32 v118, v118
    v_exp_f32 v119, v119
    v_exp_f32 v120, v120
    v_cvt_pk_bf16_f32 v130, v116, v117
    v_cvt_pk_bf16_f32 v131, v118, v119
    v_exp_f32 v121, v121
    v_exp_f32 v122, v122
    s_waitcnt lgkmcnt(0)
    v_mfma_f32_32x32x16_bf16 v[192:207], v[72:75], v[128:131], v[192:207]
    v_exp_f32 v123, v123
    v_cvt_pk_bf16_f32 v132, v120, v121
    v_exp_f32 v124, v124
    v_exp_f32 v125, v125
    v_cvt_pk_bf16_f32 v133, v122, v123
    v_exp_f32 v126, v126
    v_exp_f32 v127, v127
    v_cvt_pk_bf16_f32 v134, v124, v125
    v_cvt_pk_bf16_f32 v135, v126, v127
    s_nop 1
    v_mfma_f32_32x32x16_bf16 v[192:207], v[76:79], v[132:135], v[192:207]
    s_branch ATT0_done
.p2align 12
ATT0_3:
    s_waitcnt lgkmcnt(0)
    s_barrier
    ds_read_b128 v[144:147], v247
    ds_read_b128 v[148:151], v252
    ds_read_b128 v[136:139], v249 offset:40960
    ds_read_b128 v[140:143], v249 offset:45056
    s_mov_b64 exec, s[20:21]
    ds_read_b128 v[64:67], v251 offset:40960
    ds_read_b128 v[68:71], v251 offset:41984
    s_mov_b64 exec, -1
    s_waitcnt lgkmcnt(3)
    v_mfma_f32_32x32x16_bf16 v[96:111], v[136:139], v[148:151], 0
    ds_read_b128 v[136:139], v249 offset:49152
    s_waitcnt lgkmcnt(3)
    v_mfma_f32_32x32x16_bf16 v[112:127], v[140:143], v[148:151], 0
    s_waitcnt lgkmcnt(1)
    ds_read_b128 v[140:143], v248 offset:40960
    buffer_load_dword v14, v1, s[4:7], s48 offen offset:0 sc1
    buffer_load_dwordx4 a[84:87], v21, s[4:7], s84 offen offset:1024 sc1
    s_nop 4
    v_exp_f32 v96, v96
    v_exp_f32 v97, v97
    v_exp_f32 v98, v98
    v_exp_f32 v99, v99
    s_mov_b64 exec, s[20:21]
    ds_read_b128 v[72:75], v251 offset:45056
    ds_read_b128 v[76:79], v251 offset:46080
    s_mov_b64 exec, -1
    v_cvt_pk_bf16_f32 v128, v96, v97
    v_exp_f32 v100, v100
    v_exp_f32 v101, v101
    v_cvt_pk_bf16_f32 v129, v98, v99
    v_exp_f32 v102, v102
    v_exp_f32 v103, v103
    v_exp_f32 v104, v104
    v_cvt_pk_bf16_f32 v130, v100, v101
    v_cvt_pk_bf16_f32 v131, v102, v103
    v_exp_f32 v105, v105
    v_exp_f32 v106, v106
    v_mfma_f32_32x32x16_bf16 v[208:223], v[64:67], v[128:131], 0
    buffer_load_dwordx4 a[88:91], v21, s[4:7], s84 offen offset:2048 sc1
    v_exp_f32 v107, v107
    v_cvt_pk_bf16_f32 v132, v104, v105
    v_exp_f32 v108, v108
    v_exp_f32 v109, v109
    v_cvt_pk_bf16_f32 v133, v106, v107
    v_exp_f32 v110, v110
    v_exp_f32 v111, v111
    v_cvt_pk_bf16_f32 v134, v108, v109
    v_cvt_pk_bf16_f32 v135, v110, v111
    s_waitcnt lgkmcnt(3)
    v_mfma_f32_32x32x16_bf16 v[96:111], v[136:139], v[148:151], v[32:47]
    s_waitcnt lgkmcnt(0)
    ds_read_b128 v[136:139], v248 offset:45056
    s_waitcnt vmcnt(2)
    v_cmp_gt_u32 vcc, s34, v14
    s_cbranch_vccnz SPIN_71
BACK_72:
    s_mov_b32 m0, s50
    s_nop 0
    buffer_load_dwordx4 v16, s[4:7], s49 offen offset:0 sc1 lds
    buffer_load_dwordx4 v16, s[4:7], s49 offen offset:1024 sc1 lds
    buffer_load_dwordx4 v16, s[4:7], s49 offen offset:2048 sc1 lds
    buffer_load_dwordx4 v16, s[4:7], s49 offen offset:3072 sc1 lds
    buffer_load_dwordx4 a[92:95], v21, s[4:7], s84 offen offset:3072 sc1
    v_exp_f32 v112, v112
    v_exp_f32 v113, v113
    v_exp_f32 v114, v114
    v_exp_f32 v115, v115
    v_mfma_f32_32x32x16_bf16 v[208:223], v[68:71], v[132:135], v[208:223]
    s_mov_b64 exec, s[20:21]
    ds_read_b128 v[64:67], v251 offset:49152
    ds_read_b128 v[68:71], v251 offset:50176
    s_mov_b64 exec, -1
    v_cvt_pk_bf16_f32 v128, v112, v113
    v_exp_f32 v116, v116
    v_exp_f32 v117, v117
    v_cvt_pk_bf16_f32 v129, v114, v115
    v_exp_f32 v118, v118
    v_exp_f32 v119, v119
    v_exp_f32 v120, v120
    v_cvt_pk_bf16_f32 v130, v116, v117
    v_cvt_pk_bf16_f32 v131, v118, v119
    v_exp_f32 v121, v121
    v_exp_f32 v122, v122
    v_mfma_f32_32x32x16_bf16 v[208:223], v[72:75], v[128:131], v[208:223]
    buffer_load_dword v2, v4, s[4:7], s51 offen offset:0 sc1
    buffer_load_dwordx4 a[96:99], v22, s[4:7], s84 offen offset:0 sc1
    buffer_load_dwordx4 a[100:103], v22, s[4:7], s84 offen offset:1024 sc1
    v_exp_f32 v123, v123
    v_cvt_pk_bf16_f32 v132, v120, v121
    v_exp_f32 v124, v124
    v_exp_f32 v125, v125
    v_cvt_pk_bf16_f32 v133, v122, v123
    v_exp_f32 v126, v126
    v_exp_f32 v127, v127
    v_cvt_pk_bf16_f32 v134, v124, v125
    v_cvt_pk_bf16_f32 v135, v126, v127
    v_mfma_f32_32x32x16_bf16 v[112:127], v[140:143], v[144:147], 0
    s_waitcnt lgkmcnt(0)
    buffer_load_dwordx4 a[104:107], v22, s[4:7], s84 offen offset:2048 sc1
    v_exp_f32 v96, v96
    v_exp_f32 v97, v97
    v_exp_f32 v98, v98
    v_exp_f32 v99, v99
    v_mfma_f32_32x32x16_bf16 v[208:223], v[76:79], v[132:135], v[208:223]
    s_mov_b64 exec, s[20:21]
    ds_read_b128 v[72:75], v250 offset:40960
    ds_read_b128 v[76:79], v250 offset:41984
    s_mov_b64 exec, -1
    v_cvt_pk_bf16_f32 v128, v96, v97
    v_exp_f32 v100, v100
    v_exp_f32 v101, v101
    v_cvt_pk_bf16_f32 v129, v98, v99
    v_exp_f32 v102, v102
    v_exp_f32 v103, v103
    v_exp_f32 v104, v104
    v_cvt_pk_bf16_f32 v130, v100, v101
    v_cvt_pk_bf16_f32 v131, v102, v103
    v_exp_f32 v105, v105
    v_exp_f32 v106, v106
    v_mfma_f32_32x32x16_bf16 v[208:223], v[64:67], v[128:131], v[208:223]
    buffer_load_dwordx4 a[108:111], v22, s[4:7], s84 offen offset:3072 sc1
    v_exp_f32 v107, v107
    v_cvt_pk_bf16_f32 v132, v104, v105
    v_exp_f32 v108, v108
    v_exp_f32 v109, v109
    v_cvt_pk_bf16_f32 v133, v106, v107
    v_exp_f32 v110, v110
    v_exp_f32 v111, v111
    v_cvt_pk_bf16_f32 v134, v108, v109
    v_cvt_pk_bf16_f32 v135, v110, v111
    v_mfma_f32_32x32x16_bf16 v[96:111], v[136:139], v[144:147], v[32:47]
    s_waitcnt lgkmcnt(0)
    buffer_load_dwordx4 a[112:115], v23, s[4:7], s84 offen offset:0 sc1
    v_exp_f32 v112, v112
    v_exp_f32 v113, v113
    v_exp_f32 v114, v114
    v_exp_f32 v115, v115
    v_mfma_f32_32x32x16_bf16 v[208:223], v[68:71], v[132:135], v[208:223]
    s_mov_b64 exec, s[20:21]
    ds_read_b128 v[64:67], v250 offset:45056
    ds_read_b128 v[68:71], v250 offset:46080
    s_mov_b64 exec, -1
    v_cvt_pk_bf16_f32 v128, v112, v113
    v_exp_f32 v116, v116
    v_exp_f32 v117, v117
    v_cvt_pk_bf16_f32 v129, v114, v115
    v_exp_f32 v118, v118
    v_exp_f32 v119, v119
    v_exp_f32 v120, v120
    v_cvt_pk_bf16_f32 v130, v116, v117
    v_cvt_pk_bf16_f32 v131, v118, v119
    v_exp_f32 v121, v121
    v_exp_f32 v122, v122
    v_mfma_f32_32x32x16_bf16 v[192:207], v[72:75], v[128:131], 0
    s_waitcnt vmcnt(7)
    s_barrier
    s_waitcnt vmcnt(5)
    v_cmp_gt_u32 vcc, s34, v2
    s_cbranch_vccnz SPIN_74
BACK_75:
    s_add_u32 m0, s82, 114688
    s_nop 0
    buffer_load_dwordx4 v16, s[4:7], s96 offen offset:0 sc1 lds
    buffer_load_dwordx4 v16, s[4:7], s96 offen offset:1024 sc1 lds
    buffer_load_dwordx4 v16, s[4:7], s96 offen offset:2048 sc1 lds
    buffer_load_dwordx4 v16, s[4:7], s96 offen offset:3072 sc1 lds
    buffer_load_dwordx4 a[116:119], v23, s[4:7], s84 offen offset:1024 sc1
    ds_read_b128 v[140:143], v249 offset:32768
    ds_read_b128 v[136:139], v249 offset:36864
    v_exp_f32 v123, v123
    v_cvt_pk_bf16_f32 v132, v120, v121
    v_exp_f32 v124, v124
    v_exp_f32 v125, v125
    v_cvt_pk_bf16_f32 v133, v122, v123
    v_exp_f32 v126, v126
    v_exp_f32 v127, v127
    v_cvt_pk_bf16_f32 v134, v124, v125
    v_cvt_pk_bf16_f32 v135, v126, v127
    s_waitcnt lgkmcnt(1)
    v_mfma_f32_32x32x16_bf16 v[112:127], v[140:143], v[148:151], 0
    ds_read_b128 v[140:143], v248 offset:32768
    buffer_load_dwordx4 a[120:123], v23, s[4:7], s84 offen offset:2048 sc1
    buffer_load_dwordx4 a[124:127], v23, s[4:7], s84 offen offset:3072 sc1
    v_exp_f32 v96, v96
    v_exp_f32 v97, v97
    v_exp_f32 v98, v98
    v_exp_f32 v99, v99
    v_mfma_f32_32x32x16_bf16 v[192:207], v[76:79], v[132:135], v[192:207]
    s_mov_b64 exec, s[20:21]
    ds_read_b128 v[72:75], v251 offset:32768
    ds_read_b128 v[76:79], v251 offset:33792
    s_mov_b64 exec, -1
    v_cvt_pk_bf16_f32 v128, v96, v97
    v_exp_f32 v100, v100
    v_exp_f32 v101, v101
    v_cvt_pk_bf16_f32 v129, v98, v99
    v_exp_f32 v102, v102
    v_exp_f32 v103, v103
    v_exp_f32 v104, v104
    v_cvt_pk_bf16_f32 v130, v100, v101
    v_cvt_pk_bf16_f32 v131, v102, v103
    v_exp_f32 v105, v105
    v_exp_f32 v106, v106
    v_mfma_f32_32x32x16_bf16 v[192:207], v[64:67], v[128:131], v[192:207]
    buffer_load_dwordx4 a[128:131], v16, s[4:7], s1 offen offset:0 sc1
    v_exp_f32 v107, v107
    v_cvt_pk_bf16_f32 v132, v104, v105
    v_exp_f32 v108, v108
    v_exp_f32 v109, v109
    v_cvt_pk_bf16_f32 v133, v106, v107
    v_exp_f32 v110, v110
    v_exp_f32 v111, v111
    v_cvt_pk_bf16_f32 v134, v108, v109
    v_cvt_pk_bf16_f32 v135, v110, v111
    s_waitcnt lgkmcnt(3)
    v_mfma_f32_32x32x16_bf16 v[96:111], v[136:139], v[148:151], 0
    s_waitcnt lgkmcnt(0)
    ds_read_b128 v[136:139], v248 offset:36864
    s_add_u32 m0, s82, 98304
    s_nop 0
    buffer_load_dwordx4 v16, s[4:7], s97 offen offset:0 sc1 lds
    buffer_load_dwordx4 v16, s[4:7], s97 offen offset:1024 sc1 lds
    buffer_load_dwordx4 v16, s[4:7], s97 offen offset:2048 sc1 lds
    buffer_load_dwordx4 v16, s[4:7], s97 offen offset:3072 sc1 lds
    buffer_load_dwordx4 a[132:135], v16, s[4:7], s1 offen offset:1024 sc1
    v_exp_f32 v112, v112
    v_exp_f32 v113, v113
    v_exp_f32 v114, v114
    v_exp_f32 v115, v115
    v_mfma_f32_32x32x16_bf16 v[192:207], v[68:71], v[132:135], v[192:207]
    s_mov_b64 exec, s[20:21]
    ds_read_b128 v[64:67], v251 offset:36864
    ds_read_b128 v[68:71], v251 offset:37888
    s_mov_b64 exec, -1
    v_cvt_pk_bf16_f32 v128, v112, v113
    v_exp_f32 v116, v116
    v_exp_f32 v117, v117
    v_cvt_pk_bf16_f32 v129, v114, v115
    v_exp_f32 v118, v118
    v_exp_f32 v119, v119
    v_exp_f32 v120, v120
    v_cvt_pk_bf16_f32 v130, v116, v117
    v_cvt_pk_bf16_f32 v131, v118, v119
    v_exp_f32 v121, v121
    v_exp_f32 v122, v122
    v_mfma_f32_32x32x16_bf16 v[208:223], v[72:75], v[128:131], v[208:223]
    buffer_load_dwordx4 a[136:139], v16, s[4:7], s1 offen offset:2048 sc1
    v_exp_f32 v123, v123
    v_cvt_pk_bf16_f32 v132, v120, v121
    v_exp_f32 v124, v124
    v_exp_f32 v125, v125
    v_cvt_pk_bf16_f32 v133, v122, v123
    v_exp_f32 v126, v126
    v_exp_f32 v127, v127
    v_cvt_pk_bf16_f32 v134, v124, v125
    v_cvt_pk_bf16_f32 v135, v126, v127
    v_mfma_f32_32x32x16_bf16 v[112:127], v[140:143], v[144:147], 0
    s_waitcnt lgkmcnt(0)
    buffer_load_dwordx4 a[140:143], v16, s[4:7], s1 offen offset:3072 sc1
    v_exp_f32 v96, v96
    v_exp_f32 v97, v97
    v_exp_f32 v98, v98
    v_exp_f32 v99, v99
    v_mfma_f32_32x32x16_bf16 v[208:223], v[76:79], v[132:135], v[208:223]
    s_mov_b64 exec, s[20:21]
    ds_read_b128 v[72:75], v250 offset:32768
    ds_read_b128 v[76:79], v250 offset:33792
    s_mov_b64 exec, -1
    v_cvt_pk_bf16_f32 v128, v96, v97
    v_exp_f32 v100, v100
    v_exp_f32 v101, v101
    v_cvt_pk_bf16_f32 v129, v98, v99
    v_exp_f32 v102, v102
    v_exp_f32 v103, v103
    v_exp_f32 v104, v104
    v_cvt_pk_bf16_f32 v130, v100, v101
    v_cvt_pk_bf16_f32 v131, v102, v103
    v_exp_f32 v105, v105
    v_exp_f32 v106, v106
    v_mfma_f32_32x32x16_bf16 v[208:223], v[64:67], v[128:131], v[208:223]
    buffer_load_dwordx4 a[144:147], v17, s[4:7], s1 offen offset:0 sc1
    buffer_load_dwordx4 a[148:151], v17, s[4:7], s1 offen offset:1024 sc1
    v_exp_f32 v107, v107
    v_cvt_pk_bf16_f32 v132, v104, v105
    v_exp_f32 v108, v108
    v_exp_f32 v109, v109
    v_cvt_pk_bf16_f32 v133, v106, v107
    v_exp_f32 v110, v110
    v_exp_f32 v111, v111
    v_cvt_pk_bf16_f32 v134, v108, v109
    v_cvt_pk_bf16_f32 v135, v110, v111
    s_cmp_eq_u32 s12, 0
    s_cbranch_scc1 ATTG00_3
    v_mfma_f32_32x32x16_bf16 v[96:111], v[136:139], v[144:147], 0
    s_waitcnt lgkmcnt(0)
    buffer_load_dwordx4 a[152:155], v17, s[4:7], s1 offen offset:2048 sc1
    v_exp_f32 v112, v112
    v_exp_f32 v113, v113
    v_exp_f32 v114, v114
    v_exp_f32 v115, v115
    v_mfma_f32_32x32x16_bf16 v[208:223], v[68:71], v[132:135], v[208:223]
    s_mov_b64 exec, s[20:21]
    ds_read_b128 v[64:67], v250 offset:36864
    ds_read_b128 v[68:71], v250 offset:37888
    s_mov_b64 exec, -1
    v_cvt_pk_bf16_f32 v128, v112, v113
    v_exp_f32 v116, v116
    v_exp_f32 v117, v117
    v_cvt_pk_bf16_f32 v129, v114, v115
    v_exp_f32 v118, v118
    v_exp_f32 v119, v119
    v_exp_f32 v120, v120
    v_cvt_pk_bf16_f32 v130, v116, v117
    v_cvt_pk_bf16_f32 v131, v118, v119
    v_exp_f32 v121, v121
    v_exp_f32 v122, v122
    v_mfma_f32_32x32x16_bf16 v[192:207], v[72:75], v[128:131], v[192:207]
    s_waitcnt vmcnt(14)
    s_barrier
    buffer_load_dwordx4 a[156:159], v17, s[4:7], s1 offen offset:3072 sc1
    ds_read_b128 v[140:143], v249 offset:16384
    ds_read_b128 v[136:139], v249 offset:20480
    v_exp_f32 v123, v123
    v_cvt_pk_bf16_f32 v132, v120, v121
    v_exp_f32 v124, v124
    v_exp_f32 v125, v125
    v_cvt_pk_bf16_f32 v133, v122, v123
    v_exp_f32 v126, v126
    v_exp_f32 v127, v127
    v_cvt_pk_bf16_f32 v134, v124, v125
    v_cvt_pk_bf16_f32 v135, v126, v127
    s_waitcnt lgkmcnt(1)
    v_mfma_f32_32x32x16_bf16 v[112:127], v[140:143], v[148:151], v[48:63]
    ds_read_b128 v[140:143], v249 offset:24576
    buffer_load_dwordx4 a[160:163], v18, s[4:7], s1 offen offset:0 sc1
    v_exp_f32 v96, v96
    v_exp_f32 v97, v97
    v_exp_f32 v98, v98
    v_exp_f32 v99, v99
    v_mfma_f32_32x32x16_bf16 v[192:207], v[76:79], v[132:135], v[192:207]
    s_mov_b64 exec, s[20:21]
    ds_read_b128 v[72:75], v251 offset:16384
    ds_read_b128 v[76:79], v251 offset:17408
    s_mov_b64 exec, -1
    v_cvt_pk_bf16_f32 v128, v96, v97
    v_exp_f32 v100, v100
    v_exp_f32 v101, v101
    v_cvt_pk_bf16_f32 v129, v98, v99
    v_exp_f32 v102, v102
    v_exp_f32 v103, v103
    v_exp_f32 v104, v104
    v_cvt_pk_bf16_f32 v130, v100, v101
    v_cvt_pk_bf16_f32 v131, v102, v103
    v_exp_f32 v105, v105
    v_exp_f32 v106, v106
    v_mfma_f32_32x32x16_bf16 v[192:207], v[64:67], v[128:131], v[192:207]
    buffer_load_dwordx4 a[164:167], v18, s[4:7], s1 offen offset:1024 sc1
    v_exp_f32 v107, v107
    v_cvt_pk_bf16_f32 v132, v104, v105
    v_exp_f32 v108, v108
    v_exp_f32 v109, v109
    v_cvt_pk_bf16_f32 v133, v106, v107
    v_exp_f32 v110, v110
    v_exp_f32 v111, v111
    v_cvt_pk_bf16_f32 v134, v108, v109
    v_cvt_pk_bf16_f32 v135, v110, v111
    s_waitcnt lgkmcnt(3)
    v_mfma_f32_32x32x16_bf16 v[96:111], v[136:139], v[148:151], 0
    s_waitcnt lgkmcnt(0)
    ds_read_b128 v[136:139], v249 offset:28672
    buffer_load_dwordx4 a[168:171], v18, s[4:7], s1 offen offset:2048 sc1
    v_exp_f32 v112, v112
    v_exp_f32 v113, v113
    v_exp_f32 v114, v114
    v_exp_f32 v115, v115
    v_mfma_f32_32x32x16_bf16 v[192:207], v[68:71], v[132:135], v[192:207]
    s_mov_b64 exec, s[20:21]
    ds_read_b128 v[64:67], v251 offset:20480
    ds_read_b128 v[68:71], v251 offset:21504
    s_mov_b64 exec, -1
    v_cvt_pk_bf16_f32 v128, v112, v113
    v_exp_f32 v116, v116
    v_exp_f32 v117, v117
    v_cvt_pk_bf16_f32 v129, v114, v115
    v_exp_f32 v118, v118
    v_exp_f32 v119, v119
    v_exp_f32 v120, v120
    v_cvt_pk_bf16_f32 v130, v116, v117
    v_cvt_pk_bf16_f32 v131, v118, v119
    v_exp_f32 v121, v121
    v_exp_f32 v122, v122
    v_mfma_f32_32x32x16_bf16 v[208:223], v[72:75], v[128:131], v[208:223]
    buffer_load_dwordx4 a[172:175], v18, s[4:7], s1 offen offset:3072 sc1
    buffer_load_dwordx4 a[176:179], v16, s[4:7], s83 offen offset:0 sc1
    v_exp_f32 v123, v123
    v_cvt_pk_bf16_f32 v132, v120, v121
    v_exp_f32 v124, v124
    v_exp_f32 v125, v125
    v_cvt_pk_bf16_f32 v133, v122, v123
    v_exp_f32 v126, v126
    v_exp_f32 v127, v127
    v_cvt_pk_bf16_f32 v134, v124, v125
    v_cvt_pk_bf16_f32 v135, v126, v127
    v_mfma_f32_32x32x16_bf16 v[112:127], v[140:143], v[148:151], 0
    s_waitcnt lgkmcnt(0)
    ds_read_b128 v[140:143], v248 offset:28672
    buffer_load_dwordx4 a[180:183], v16, s[4:7], s83 offen offset:1024 sc1
    v_exp_f32 v96, v96
    v_exp_f32 v97, v97
    v_exp_f32 v98, v98
    v_exp_f32 v99, v99
    v_mfma_f32_32x32x16_bf16 v[208:223], v[76:79], v[132:135], v[208:223]
    s_mov_b64 exec, s[20:21]
    ds_read_b128 v[72:75], v251 offset:24576
    ds_read_b128 v[76:79], v251 offset:25600
    s_mov_b64 exec, -1
    v_cvt_pk_bf16_f32 v128, v96, v97
    v_exp_f32 v100, v100
    v_exp_f32 v101, v101
    v_cvt_pk_bf16_f32 v129, v98, v99
    v_exp_f32 v102, v102
    v_exp_f32 v103, v103
    v_exp_f32 v104, v104
    v_cvt_pk_bf16_f32 v130, v100, v101
    v_cvt_pk_bf16_f32 v131, v102, v103
    v_exp_f32 v105, v105
    v_exp_f32 v106, v106
    v_mfma_f32_32x32x16_bf16 v[208:223], v[64:67], v[128:131], v[208:223]
    s_waitcnt vmcnt(13)
    s_barrier
    buffer_load_dwordx4 a[184:187], v16, s[4:7], s83 offen offset:2048 sc1
    v_exp_f32 v107, v107
    v_cvt_pk_bf16_f32 v132, v104, v105
    v_exp_f32 v108, v108
    v_exp_f32 v109, v109
    v_cvt_pk_bf16_f32 v133, v106, v107
    v_exp_f32 v110, v110
    v_exp_f32 v111, v111
    v_cvt_pk_bf16_f32 v134, v108, v109
    v_cvt_pk_bf16_f32 v135, v110, v111
    v_mfma_f32_32x32x16_bf16 v[96:111], v[136:139], v[148:151], 0
    s_waitcnt lgkmcnt(0)
    ds_read_b128 v[136:139], v248 offset:24576
    buffer_load_dwordx4 a[188:191], v16, s[4:7], s83 offen offset:3072 sc1
    v_exp_f32 v112, v112
    v_exp_f32 v113, v113
    v_exp_f32 v114, v114
    v_exp_f32 v115, v115
    v_mfma_f32_32x32x16_bf16 v[208:223], v[68:71], v[132:135], v[208:223]
    s_mov_b64 exec, s[20:21]
    ds_read_b128 v[64:67], v251 offset:28672
    ds_read_b128 v[68:71], v251 offset:29696
    s_mov_b64 exec, -1
    v_cvt_pk_bf16_f32 v128, v112, v113
    v_exp_f32 v116, v116
    v_exp_f32 v117, v117
    v_cvt_pk_bf16_f32 v129, v114, v115
    v_exp_f32 v118, v118
    v_exp_f32 v119, v119
    v_exp_f32 v120, v120
    v_cvt_pk_bf16_f32 v130, v116, v117
    v_cvt_pk_bf16_f32 v131, v118, v119
    v_exp_f32 v121, v121
    v_exp_f32 v122, v122
    v_mfma_f32_32x32x16_bf16 v[208:223], v[72:75], v[128:131], v[208:223]
    buffer_load_dwordx4 a[192:195], v17, s[4:7], s83 offen offset:0 sc1
    v_exp_f32 v123, v123
    v_cvt_pk_bf16_f32 v132, v120, v121
    v_exp_f32 v124, v124
    v_exp_f32 v125, v125
    v_cvt_pk_bf16_f32 v133, v122, v123
    v_exp_f32 v126, v126
    v_exp_f32 v127, v127
    v_cvt_pk_bf16_f32 v134, v124, v125
    v_cvt_pk_bf16_f32 v135, v126, v127
    v_mfma_f32_32x32x16_bf16 v[112:127], v[140:143], v[144:147], 0
    s_waitcnt lgkmcnt(0)
    ds_read_b128 v[140:143], v248 offset:20480
    buffer_load_dwordx4 a[196:199], v17, s[4:7], s83 offen offset:1024 sc1
    buffer_load_dwordx4 a[200:203], v17, s[4:7], s83 offen offset:2048 sc1
    v_exp_f32 v96, v96
    v_exp_f32 v97, v97
    v_exp_f32 v98, v98
    v_exp_f32 v99, v99
    v_mfma_f32_32x32x16_bf16 v[208:223], v[76:79], v[132:135], v[208:223]
    s_mov_b64 exec, s[20:21]
    ds_read_b128 v[72:75], v250 offset:28672
    ds_read_b128 v[76:79], v250 offset:29696
    s_mov_b64 exec, -1
    v_cvt_pk_bf16_f32 v128, v96, v97
    v_exp_f32 v100, v100
    v_exp_f32 v101, v101
    v_cvt_pk_bf16_f32 v129, v98, v99
    v_exp_f32 v102, v102
    v_exp_f32 v103, v103
    v_exp_f32 v104, v104
    v_cvt_pk_bf16_f32 v130, v100, v101
    v_cvt_pk_bf16_f32 v131, v102, v103
    v_exp_f32 v105, v105
    v_exp_f32 v106, v106
    v_mfma_f32_32x32x16_bf16 v[208:223], v[64:67], v[128:131], v[208:223]
    buffer_load_dwordx4 a[204:207], v17, s[4:7], s83 offen offset:3072 sc1
    v_exp_f32 v107, v107
    v_cvt_pk_bf16_f32 v132, v104, v105
    v_exp_f32 v108, v108
    v_exp_f32 v109, v109
    v_cvt_pk_bf16_f32 v133, v106, v107
    v_exp_f32 v110, v110
    v_exp_f32 v111, v111
    v_cvt_pk_bf16_f32 v134, v108, v109
    v_cvt_pk_bf16_f32 v135, v110, v111
    v_mfma_f32_32x32x16_bf16 v[96:111], v[136:139], v[144:147], 0
    s_waitcnt lgkmcnt(0)
    ds_read_b128 v[136:139], v248 offset:16384
    buffer_load_dwordx4 a[208:211], v18, s[4:7], s83 offen offset:0 sc1
    v_exp_f32 v112, v112
    v_exp_f32 v113, v113
    v_exp_f32 v114, v114
    v_exp_f32 v115, v115
    v_mfma_f32_32x32x16_bf16 v[208:223], v[68:71], v[132:135], v[208:223]
    s_mov_b64 exec, s[20:21]
    ds_read_b128 v[64:67], v250 offset:24576
    ds_read_b128 v[68:71], v250 offset:25600
    s_mov_b64 exec, -1
    v_cvt_pk_bf16_f32 v128, v112, v113
    v_exp_f32 v116, v116
    v_exp_f32 v117, v117
    v_cvt_pk_bf16_f32 v129, v114, v115
    v_exp_f32 v118, v118
    v_exp_f32 v119, v119
    v_exp_f32 v120, v120
    v_cvt_pk_bf16_f32 v130, v116, v117
    v_cvt_pk_bf16_f32 v131, v118, v119
    v_exp_f32 v121, v121
    v_exp_f32 v122, v122
    v_mfma_f32_32x32x16_bf16 v[192:207], v[72:75], v[128:131], v[192:207]
    v_subrev_u32 v217, 0x2b800000, v216
    v_cmp_lt_u32 s[26:27], s87, v217
    s_nop 0
    s_cmp_lg_u64 s[26:27], 0
    s_cbranch_scc1 SLOW_77
BACK_78:
    v_rcp_f32 v217, v216
    s_nop 0
    v_mul_f32 v208, v208, v217
    v_mul_f32 v209, v209, v217
    v_cvt_pk_bf16_f32 v220, v208, v209
    v_mul_f32 v210, v210, v217
    v_mul_f32 v211, v211, v217
    v_cvt_pk_bf16_f32 v221, v210, v211
    v_mul_f32 v212, v212, v217
    v_mul_f32 v213, v213, v217
    v_cvt_pk_bf16_f32 v222, v212, v213
    v_mul_f32 v214, v214, v217
    v_mul_f32 v215, v215, v217
    v_cvt_pk_bf16_f32 v223, v214, v215
    buffer_load_dwordx4 a[212:215], v18, s[4:7], s83 offen offset:1024 sc1
    v_exp_f32 v123, v123
    v_cvt_pk_bf16_f32 v132, v120, v121
    v_exp_f32 v124, v124
    v_exp_f32 v125, v125
    v_cvt_pk_bf16_f32 v133, v122, v123
    v_exp_f32 v126, v126
    v_exp_f32 v127, v127
    v_cvt_pk_bf16_f32 v134, v124, v125
    v_cvt_pk_bf16_f32 v135, v126, v127
    v_mfma_f32_32x32x16_bf16 v[112:127], v[140:143], v[144:147], 0
    s_waitcnt lgkmcnt(0)
    ds_read_b128 v[140:143], v248 offset:12288
    buffer_store_dwordx4 v[220:223], v0, s[4:7], s54 offen
    buffer_load_dwordx4 a[216:219], v18, s[4:7], s83 offen offset:2048 sc1
    v_exp_f32 v96, v96
    v_exp_f32 v97, v97
    v_exp_f32 v98, v98
    v_exp_f32 v99, v99
    v_mfma_f32_32x32x16_bf16 v[192:207], v[76:79], v[132:135], v[192:207]
    s_mov_b64 exec, s[20:21]
    ds_read_b128 v[72:75], v250 offset:20480
    ds_read_b128 v[76:79], v250 offset:21504
    s_mov_b64 exec, -1
    v_cvt_pk_bf16_f32 v128, v96, v97
    v_exp_f32 v100, v100
    v_exp_f32 v101, v101
    v_cvt_pk_bf16_f32 v129, v98, v99
    v_exp_f32 v102, v102
    v_exp_f32 v103, v103
    v_exp_f32 v104, v104
    v_cvt_pk_bf16_f32 v130, v100, v101
    v_cvt_pk_bf16_f32 v131, v102, v103
    v_exp_f32 v105, v105
    v_exp_f32 v106, v106
    v_mfma_f32_32x32x16_bf16 v[192:207], v[64:67], v[128:131], v[192:207]
    buffer_load_dwordx4 a[220:223], v18, s[4:7], s83 offen offset:3072 sc1
    buffer_load_dwordx4 a[224:227], v19, s[4:7], s83 offen offset:0 sc1
    v_exp_f32 v107, v107
    v_cvt_pk_bf16_f32 v132, v104, v105
    v_exp_f32 v108, v108
    v_exp_f32 v109, v109
    v_cvt_pk_bf16_f32 v133, v106, v107
    v_exp_f32 v110, v110
    v_exp_f32 v111, v111
    v_cvt_pk_bf16_f32 v134, v108, v109
    v_cvt_pk_bf16_f32 v135, v110, v111
    v_mfma_f32_32x32x16_bf16 v[96:111], v[136:139], v[144:147], 0
    s_waitcnt lgkmcnt(0)
    buffer_load_dwordx4 a[228:231], v19, s[4:7], s83 offen offset:1024 sc1
    global_load_dword v246, v246, s[90:91]
    v_exp_f32 v112, v112
    v_exp_f32 v113, v113
    v_exp_f32 v114, v114
    v_exp_f32 v115, v115
    v_mfma_f32_32x32x16_bf16 v[192:207], v[68:71], v[132:135], v[192:207]
    s_mov_b64 exec, s[20:21]
    ds_read_b128 v[64:67], v250 offset:16384
    ds_read_b128 v[68:71], v250 offset:17408
    s_mov_b64 exec, -1
    v_cvt_pk_bf16_f32 v128, v112, v113
    v_exp_f32 v116, v116
    v_exp_f32 v117, v117
    v_cvt_pk_bf16_f32 v129, v114, v115
    v_exp_f32 v118, v118
    v_exp_f32 v119, v119
    v_exp_f32 v120, v120
    v_cvt_pk_bf16_f32 v130, v116, v117
    v_cvt_pk_bf16_f32 v131, v118, v119
    v_exp_f32 v121, v121
    v_exp_f32 v122, v122
    v_mfma_f32_32x32x16_bf16 v[192:207], v[72:75], v[128:131], v[192:207]
    s_waitcnt vmcnt(5)
    s_cbranch_vccnz SAFE_79
    buffer_store_dword v11, v10, s[4:7], s56 offen offset:0
BACK_80:
    buffer_load_dwordx4 a[232:235], v19, s[4:7], s83 offen offset:2048 sc1
    v_exp_f32 v123, v123
    v_cvt_pk_bf16_f32 v132, v120, v121
    v_exp_f32 v124, v124
    v_exp_f32 v125, v125
    v_cvt_pk_bf16_f32 v133, v122, v123
    v_exp_f32 v126, v126
    v_exp_f32 v127, v127
    v_cvt_pk_bf16_f32 v134, v124, v125
    v_cvt_pk_bf16_f32 v135, v126, v127
    v_mfma_f32_32x32x16_bf16 v[112:127], v[140:143], v[144:147], v[48:63]
    s_waitcnt lgkmcnt(0)
    buffer_load_dwordx4 a[236:239], v19, s[4:7], s83 offen offset:3072 sc1
    v_exp_f32 v96, v96
    v_exp_f32 v97, v97
    v_exp_f32 v98, v98
    v_exp_f32 v99, v99
    v_mfma_f32_32x32x16_bf16 v[192:207], v[76:79], v[132:135], v[192:207]
    s_mov_b64 exec, s[20:21]
    ds_read_b128 v[72:75], v250 offset:12288
    ds_read_b128 v[76:79], v250 offset:13312
    s_mov_b64 exec, -1
    v_cvt_pk_bf16_f32 v128, v96, v97
    v_exp_f32 v100, v100
    v_exp_f32 v101, v101
    v_cvt_pk_bf16_f32 v129, v98, v99
    v_exp_f32 v102, v102
    v_exp_f32 v103, v103
    v_exp_f32 v104, v104
    v_cvt_pk_bf16_f32 v130, v100, v101
    v_cvt_pk_bf16_f32 v131, v102, v103
    v_exp_f32 v105, v105
    v_exp_f32 v106, v106
    v_mfma_f32_32x32x16_bf16 v[192:207], v[64:67], v[128:131], v[192:207]
    v_exp_f32 v107, v107
    v_cvt_pk_bf16_f32 v132, v104, v105
    v_exp_f32 v108, v108
    v_exp_f32 v109, v109
    v_cvt_pk_bf16_f32 v133, v106, v107
    v_exp_f32 v110, v110
    v_exp_f32 v111, v111
    v_cvt_pk_bf16_f32 v134, v108, v109
    v_cvt_pk_bf16_f32 v135, v110, v111
    buffer_load_dword v14, v15, s[4:7], s59 offen offset:0 sc1
    v_exp_f32 v112, v112
    v_exp_f32 v113, v113
    v_exp_f32 v114, v114
    v_exp_f32 v115, v115
    v_mfma_f32_32x32x16_bf16 v[192:207], v[68:71], v[132:135], v[192:207]
    v_cvt_pk_bf16_f32 v128, v112, v113
    v_exp_f32 v116, v116
    v_exp_f32 v117, v117
    v_cvt_pk_bf16_f32 v129, v114, v115
    v_exp_f32 v118, v118
    v_exp_f32 v119, v119
    v_exp_f32 v120, v120
    v_cvt_pk_bf16_f32 v130, v116, v117
    v_cvt_pk_bf16_f32 v131, v118, v119
    v_exp_f32 v121, v121
    v_exp_f32 v122, v122
    s_waitcnt lgkmcnt(0)
    v_mfma_f32_32x32x16_bf16 v[192:207], v[72:75], v[128:131], v[192:207]
    v_exp_f32 v123, v123
    v_cvt_pk_bf16_f32 v132, v120, v121
    v_exp_f32 v124, v124
    v_exp_f32 v125, v125
    v_cvt_pk_bf16_f32 v133, v122, v123
    v_exp_f32 v126, v126
    v_exp_f32 v127, v127
    v_cvt_pk_bf16_f32 v134, v124, v125
    v_cvt_pk_bf16_f32 v135, v126, v127
    s_nop 1
    v_mfma_f32_32x32x16_bf16 v[192:207], v[76:79], v[132:135], v[192:207]
    s_branch ATT0_done
.p2align 12
ATT0_done:
    s_waitcnt vmcnt(0)
    v_cmp_gt_u32 vcc, s34, v14
    s_cbranch_vccz BACK_83
SPIN_82:
    buffer_load_dword v14, v15, s[4:7], s59 offen offset:0 sc1
    s_sub_u32 s16, s16, 1
    s_cbranch_scc1 M_end
    s_waitcnt vmcnt(0)
    v_cmp_gt_u32 vcc, 1, v14
    s_cbranch_vccnz SPIN_82
    s_cmp_lg_u32 s15, 0
    s_cbranch_scc1 SPIN2_84
BACK_83:
    buffer_load_dwordx4 v[160:163], v16, s[4:7], s57 offen offset:0 sc1
    buffer_load_dwordx4 v[164:167], v17, s[4:7], s57 offen offset:0 sc1
    buffer_load_dwordx4 v[168:171], v18, s[4:7], s57 offen offset:0 sc1
    buffer_load_dwordx4 v[172:175], v19, s[4:7], s57 offen offset:0 sc1
    s_nop 3
    v_subrev_u32 v201, 0x2b800000, v200
    v_cmp_lt_u32 s[26:27], s87, v201
    s_nop 0
    s_cmp_lg_u64 s[26:27], 0
    s_cbranch_scc1 SLOW_93
BACK_94:
    v_rcp_f32 v201, v200
    s_nop 0
    v_mul_f32 v192, v192, v201
    v_mul_f32 v193, v193, v201
    v_cvt_pk_bf16_f32 v204, v192, v193
    v_mul_f32 v194, v194, v201
    v_mul_f32 v195, v195, v201
    v_cvt_pk_bf16_f32 v205, v194, v195
    v_mul_f32 v196, v196, v201
    v_mul_f32 v197, v197, v201
    v_cvt_pk_bf16_f32 v206, v196, v197
    v_mul_f32 v198, v198, v201
    v_mul_f32 v199, v199, v201
    v_cvt_pk_bf16_f32 v207, v198, v199
    buffer_store_dwordx4 v[204:207], v0, s[4:7], s53 offen
    buffer_load_dwordx4 v[176:179], v16, s[4:7], s57 offen offset:1024 sc1
    buffer_load_dwordx4 v[180:183], v17, s[4:7], s57 offen offset:1024 sc1
    s_waitcnt vmcnt(6)
    v_mfma_f32_16x16x32_bf16 v[96:99], a[176:179], v[160:163], 0
    v_mfma_f32_16x16x32_bf16 v[104:107], a[180:183], v[160:163], 0
    buffer_load_dwordx4 v[184:187], v18, s[4:7], s57 offen offset:1024 sc1
    v_accvgpr_read_b32 v224, a240
    v_mfma_f32_16x16x32_bf16 v[112:115], a[184:187], v[160:163], 0
    v_accvgpr_read_b32 v225, a241
    v_accvgpr_read_b32 v226, a242
    v_mfma_f32_16x16x32_bf16 v[120:123], a[188:191], v[160:163], 0
    s_waitcnt vmcnt(6)
    buffer_load_dwordx4 v[188:191], v19, s[4:7], s57 offen offset:1024 sc1
    v_accvgpr_read_b32 v227, a243
    v_mfma_f32_16x16x32_bf16 v[96:99], a[192:195], v[164:167], v[96:99]
    v_accvgpr_read_b32 v228, a244
    v_accvgpr_read_b32 v229, a245
    v_mfma_f32_16x16x32_bf16 v[104:107], a[196:199], v[164:167], v[104:107]
    s_barrier
    v_accvgpr_read_b32 v230, a246
    v_accvgpr_read_b32 v231, a247
    v_mfma_f32_16x16x32_bf16 v[112:115], a[200:203], v[164:167], v[112:115]
    v_mfma_f32_16x16x32_bf16 v[120:123], a[204:207], v[164:167], v[120:123]
    s_waitcnt vmcnt(6)
    v_mfma_f32_16x16x32_bf16 v[96:99], a[208:211], v[168:171], v[96:99]
    v_mfma_f32_16x16x32_bf16 v[104:107], a[212:215], v[168:171], v[104:107]
    v_mfma_f32_16x16x32_bf16 v[112:115], a[216:219], v[168:171], v[112:115]
    v_mfma_f32_16x16x32_bf16 v[120:123], a[220:223], v[168:171], v[120:123]
    s_waitcnt vmcnt(5)
    v_mfma_f32_16x16x32_bf16 v[96:99], a[224:227], v[172:175], v[96:99]
    v_mfma_f32_16x16x32_bf16 v[104:107], a[228:231], v[172:175], v[104:107]
    v_mfma_f32_16x16x32_bf16 v[112:115], a[232:235], v[172:175], v[112:115]
    v_mfma_f32_16x16x32_bf16 v[120:123], a[236:239], v[172:175], v[120:123]
    s_waitcnt vmcnt(3)
    s_cbranch_vccnz SAFE_100
    buffer_store_dword v11, v10, s[4:7], s55 offen offset:0
BACK_101:
    v_mfma_f32_16x16x32_bf16 v[100:103], a[176:179], v[176:179], 0
    v_mfma_f32_16x16x32_bf16 v[108:111], a[180:183], v[176:179], 0
    v_mfma_f32_16x16x32_bf16 v[116:119], a[184:187], v[176:179], 0
    v_mfma_f32_16x16x32_bf16 v[124:127], a[188:191], v[176:179], 0
    s_waitcnt vmcnt(3)
    ds_write_b128 v5, v[96:99] offset:0
    v_mfma_f32_16x16x32_bf16 v[100:103], a[192:195], v[180:183], v[100:103]
    v_mfma_f32_16x16x32_bf16 v[108:111], a[196:199], v[180:183], v[108:111]
    v_mfma_f32_16x16x32_bf16 v[116:119], a[200:203], v[180:183], v[116:119]
    v_mfma_f32_16x16x32_bf16 v[124:127], a[204:207], v[180:183], v[124:127]
    s_waitcnt vmcnt(2)
    ds_write_b128 v5, v[104:107] offset:2048
    v_mfma_f32_16x16x32_bf16 v[100:103], a[208:211], v[184:187], v[100:103]
    v_mfma_f32_16x16x32_bf16 v[108:111], a[212:215], v[184:187], v[108:111]
    v_mfma_f32_16x16x32_bf16 v[116:119], a[216:219], v[184:187], v[116:119]
    v_mfma_f32_16x16x32_bf16 v[124:127], a[220:223], v[184:187], v[124:127]
    s_waitcnt vmcnt(1)
    ds_write_b128 v5, v[112:115] offset:4096
    v_mfma_f32_16x16x32_bf16 v[100:103], a[224:227], v[188:191], v[100:103]
    v_mfma_f32_16x16x32_bf16 v[108:111], a[228:231], v[188:191], v[108:111]
    v_mfma_f32_16x16x32_bf16 v[116:119], a[232:235], v[188:191], v[116:119]
    v_mfma_f32_16x16x32_bf16 v[124:127], a[236:239], v[188:191], v[124:127]
    buffer_load_dword v14, v15, s[4:7], s60 offen offset:0 sc1
    ds_write_b128 v5, v[120:123] offset:6144
    s_nop 2
    ds_write_b128 v5, v[100:103] offset:1024
    ds_write_b128 v5, v[108:111] offset:3072
    ds_write_b128 v5, v[116:119] offset:5120
    ds_write_b128 v5, v[124:127] offset:7168
    s_waitcnt vmcnt(0)
    v_cmp_gt_u32 vcc, s34, v14
    s_cbranch_vccz BACK_98
SPIN_97:
    buffer_load_dword v14, v15, s[4:7], s60 offen offset:0 sc1
    s_sub_u32 s16, s16, 1
    s_cbranch_scc1 M_end
    s_waitcnt vmcnt(0)
    v_cmp_gt_u32 vcc, 1, v14
    s_cbranch_vccnz SPIN_97
    s_cmp_lg_u32 s15, 0
    s_cbranch_scc1 SPIN2_99
BACK_98:
    buffer_load_dwordx4 v[32:35], v16, s[4:7], s58 offen offset:0 sc1
    buffer_load_dwordx4 v[36:39], v17, s[4:7], s58 offen offset:0 sc1
    buffer_load_dwordx4 v[40:43], v18, s[4:7], s58 offen offset:0 sc1
    buffer_load_dwordx4 v[44:47], v19, s[4:7], s58 offen offset:0 sc1
    s_waitcnt lgkmcnt(0)
    s_barrier
    ds_read_b128 v[192:195], v6 offset:0
    ds_read_b128 v[196:199], v6 offset:512
    ds_read_b128 v[200:203], v6 offset:8192
    ds_read_b128 v[204:207], v6 offset:8704
    ds_read_b128 v[208:211], v6 offset:16384
    ds_read_b128 v[212:215], v6 offset:16896
    ds_read_b128 v[216:219], v6 offset:24576
    ds_read_b128 v[220:223], v6 offset:25088
    buffer_load_dwordx4 v[48:51], v16, s[4:7], s58 offen offset:1024 sc1
    buffer_load_dwordx4 v[52:55], v17, s[4:7], s58 offen offset:1024 sc1
    s_waitcnt lgkmcnt(6)
    v_pk_add_f32 v[224:225], v[224:225], v[192:193]
    v_pk_add_f32 v[226:227], v[226:227], v[194:195]
    v_pk_add_f32 v[228:229], v[228:229], v[196:197]
    v_pk_add_f32 v[230:231], v[230:231], v[198:199]
    s_waitcnt lgkmcnt(4)
    v_pk_add_f32 v[224:225], v[224:225], v[200:201]
    v_pk_add_f32 v[226:227], v[226:227], v[202:203]
    v_pk_add_f32 v[228:229], v[228:229], v[204:205]
    v_pk_add_f32 v[230:231], v[230:231], v[206:207]
    s_waitcnt lgkmcnt(2)
    v_pk_add_f32 v[224:225], v[224:225], v[208:209]
    v_pk_add_f32 v[226:227], v[226:227], v[210:211]
    v_pk_add_f32 v[228:229], v[228:229], v[212:213]
    v_pk_add_f32 v[230:231], v[230:231], v[214:215]
    s_waitcnt lgkmcnt(0)
    v_pk_add_f32 v[224:225], v[224:225], v[216:217]
    v_pk_add_f32 v[226:227], v[226:227], v[218:219]
    v_pk_add_f32 v[228:229], v[228:229], v[220:221]
    v_pk_add_f32 v[230:231], v[230:231], v[222:223]
    v_cvt_pk_bf16_f32 v192, v224, v225
    v_cvt_pk_bf16_f32 v193, v226, v227
    v_cvt_pk_bf16_f32 v194, v228, v229
    v_cvt_pk_bf16_f32 v195, v230, v231
    buffer_store_dwordx4 v[192:195], v7, s[8:11], s61 offen
    buffer_load_dwordx4 v[56:59], v18, s[4:7], s58 offen offset:1024 sc1
    buffer_load_dwordx4 v[60:63], v19, s[4:7], s58 offen offset:1024 sc1
    s_waitcnt vmcnt(8)
    v_mfma_f32_16x16x32_bf16 v[128:131], a[176:179], v[32:35], 0
    v_mfma_f32_16x16x32_bf16 v[136:139], a[180:183], v[32:35], 0
    v_dot2_f32_bf16 v196, v192, s36, 0
    v_dot2_f32_bf16 v197, v192, v192, 0
    v_dot2_f32_bf16 v196, v193, s36, v196
    v_dot2_f32_bf16 v197, v193, v193, v197
    v_dot2_f32_bf16 v196, v194, s36, v196
    v_dot2_f32_bf16 v197, v194, v194, v197
    v_dot2_f32_bf16 v196, v195, s36, v196
    v_dot2_f32_bf16 v197, v195, v195, v197
    v_mfma_f32_16x16x32_bf16 v[144:147], a[184:187], v[32:35], 0
    v_accvgpr_write_b32 a240, v224
    v_accvgpr_write_b32 a241, v225
    v_mfma_f32_16x16x32_bf16 v[152:155], a[188:191], v[32:35], 0
    s_waitcnt vmcnt(7)
    v_accvgpr_write_b32 a242, v226
    v_permlane16_swap_b32 v196, v197
    v_mfma_f32_16x16x32_bf16 v[128:131], a[192:195], v[36:39], v[128:131]
    v_add_f32 v196, v196, v197
    v_mov_b32 v197, v196
    v_mfma_f32_16x16x32_bf16 v[136:139], a[196:199], v[36:39], v[136:139]
    v_accvgpr_write_b32 a243, v227
    v_accvgpr_write_b32 a244, v228
    v_mfma_f32_16x16x32_bf16 v[144:147], a[200:203], v[36:39], v[144:147]
    v_permlane32_swap_b32 v196, v197
    v_add_f32 v196, v196, v197
    v_mfma_f32_16x16x32_bf16 v[152:155], a[204:207], v[36:39], v[152:155]
    s_waitcnt vmcnt(6)
    v_accvgpr_write_b32 a245, v229
    v_accvgpr_write_b32 a246, v230
    v_mfma_f32_16x16x32_bf16 v[128:131], a[208:211], v[40:43], v[128:131]
    v_add_f32_dpp v196, v196, v196 row_ror:8 row_mask:0xf bank_mask:0xf
    v_mfma_f32_16x16x32_bf16 v[136:139], a[212:215], v[40:43], v[136:139]
    s_cbranch_vccnz SAFE_95
    buffer_store_dword v196, v8, s[4:7], s63 offen
BACK_96:
    v_mfma_f32_16x16x32_bf16 v[144:147], a[216:219], v[40:43], v[144:147]
    v_accvgpr_write_b32 a247, v231
    v_mfma_f32_16x16x32_bf16 v[152:155], a[220:223], v[40:43], v[152:155]
    s_waitcnt vmcnt(6)
    s_lshr_b32 s30, s13, 5
    s_add_u32 s30, s30, s12
    v_mfma_f32_16x16x32_bf16 v[128:131], a[224:227], v[44:47], v[128:131]
    s_lshl_b32 s30, s30, 13
    v_and_b32 v0, 0xf0, v16
    v_bfe_u32 v1, v13, 4, 1
    v_mfma_f32_16x16x32_bf16 v[136:139], a[228:231], v[44:47], v[136:139]
    v_lshl_add_u32 v0, v1, 9, v0
    v_mul_u32_u24 v1, 3072, v3
    v_mfma_f32_16x16x32_bf16 v[144:147], a[232:235], v[44:47], v[144:147]
    v_add_u32 v248, v1, v0
    v_add_u32 v249, 61440, v248
    v_mfma_f32_16x16x32_bf16 v[152:155], a[236:239], v[44:47], v[152:155]
    s_waitcnt vmcnt(5)
    v_add_u32 v240, s30, v16
    v_and_b32 v240, 0x7fff, v240
    v_mfma_f32_16x16x32_bf16 v[132:135], a[176:179], v[48:51], 0
    v_add_u32 v241, s30, v17
    v_and_b32 v241, 0x7fff, v241
    v_mfma_f32_16x16x32_bf16 v[140:143], a[180:183], v[48:51], 0
    s_waitcnt vmcnt(3)
    s_cbranch_vccnz SAFE_102
    buffer_store_dword v11, v10, s[4:7], s65 offen offset:1024
BACK_103:
    v_mfma_f32_16x16x32_bf16 v[148:151], a[184:187], v[48:51], 0
    v_add_u32 v242, s30, v18
    v_and_b32 v242, 0x7fff, v242
    v_mfma_f32_16x16x32_bf16 v[156:159], a[188:191], v[48:51], 0
    ds_write_b128 v5, v[128:131] offset:32768
    v_add_u32 v243, s30, v19
    v_mfma_f32_16x16x32_bf16 v[132:135], a[192:195], v[52:55], v[132:135]
    v_and_b32 v243, 0x7fff, v243
    v_add_u32 v244, s30, v20
    v_mfma_f32_16x16x32_bf16 v[140:143], a[196:199], v[52:55], v[140:143]
    v_and_b32 v244, 0x7fff, v244
    v_add_u32 v245, s30, v21
    v_mfma_f32_16x16x32_bf16 v[148:151], a[200:203], v[52:55], v[148:151]
    v_and_b32 v245, 0x7fff, v245
    v_add_u32 v246, s30, v22
    v_mfma_f32_16x16x32_bf16 v[156:159], a[204:207], v[52:55], v[156:159]
    s_waitcnt vmcnt(3)
    ds_write_b128 v5, v[136:139] offset:34816
    v_and_b32 v246, 0x7fff, v246
    v_mfma_f32_16x16x32_bf16 v[132:135], a[208:211], v[56:59], v[132:135]
    v_add_u32 v247, s30, v23
    v_and_b32 v247, 0x7fff, v247
    v_mfma_f32_16x16x32_bf16 v[140:143], a[212:215], v[56:59], v[140:143]
    v_lshl_add_u32 v250, v3, 9, v16
    v_mfma_f32_16x16x32_bf16 v[148:151], a[216:219], v[56:59], v[148:151]
    s_cmp_ge_u32 s13, 21
    s_cselect_b32 s30, 4259840, 0
    v_add_u32 v125, s30, v250
    v_mfma_f32_16x16x32_bf16 v[156:159], a[220:223], v[56:59], v[156:159]
    s_waitcnt vmcnt(2)
    s_cmp_ge_u32 s13, 22
    s_cselect_b32 s30, 4259840, 0
    v_mfma_f32_16x16x32_bf16 v[132:135], a[224:227], v[60:63], v[132:135]
    ds_write_b128 v5, v[144:147] offset:36864
    v_add_u32 v250, s30, v250
    v_mfma_f32_16x16x32_bf16 v[140:143], a[228:231], v[60:63], v[140:143]
    s_and_b32 s30, s73, 512
    s_lshl_b32 s30, s30, 1
    v_add_u32 v251, s30, v125
    v_mfma_f32_16x16x32_bf16 v[148:151], a[232:235], v[60:63], v[148:151]
    v_mfma_f32_16x16x32_bf16 v[156:159], a[236:239], v[60:63], v[156:159]
    ds_write_b128 v5, v[152:155] offset:38912
    buffer_load_dword v14, v9, s[4:7], s71 offen offset:1024 sc1
    s_cmp_eq_u32 s18, 2
    s_cbranch_scc1 C0_2
    v_accvgpr_read_b32 v224, a248
    v_accvgpr_read_b32 v225, a249
    v_accvgpr_read_b32 v226, a250
    v_accvgpr_read_b32 v227, a251
    v_accvgpr_read_b32 v228, a252
    v_accvgpr_read_b32 v229, a253
    v_accvgpr_read_b32 v230, a254
    v_accvgpr_read_b32 v231, a255
    ds_write_b128 v5, v[132:135] offset:33792
    ds_write_b128 v5, v[140:143] offset:35840
    ds_write_b128 v5, v[148:151] offset:37888
    ds_write_b128 v5, v[156:159] offset:39936
    s_waitcnt vmcnt(0)
    v_cmp_gt_u32 vcc, s34, v14
    s_cbranch_vccz BACK_105
SPIN_104:
    buffer_load_dword v14, v9, s[4:7], s71 offen offset:1024 sc1
    s_sub_u32 s16, s16, 1
    s_cbranch_scc1 M_end
    s_waitcnt vmcnt(0)
    v_cmp_gt_u32 vcc, 1, v14
    s_cbranch_vccnz SPIN_104
    s_cmp_lg_u32 s15, 0
    s_cbranch_scc1 SPIN2_106
BACK_105:
    buffer_load_dwordx4 v[32:35], v240, s[8:11], s67 offen offset:0 sc1
    buffer_load_dwordx4 v[36:39], v240, s[8:11], s67 offen offset:1024 sc1
    buffer_load_dwordx4 v[40:43], v240, s[8:11], s67 offen offset:2048 sc1
    buffer_load_dwordx4 v[44:47], v240, s[8:11], s67 offen offset:3072 sc1
    ds_read_b128 v[80:83], v248 offset:0
    ds_read_b128 v[84:87], v248 offset:1024
    ds_read_b128 v[88:91], v248 offset:2048
    ds_read_b128 v[92:95], v248 offset:256
    ds_read_b128 v[96:99], v248 offset:1280
    ds_read_b128 v[100:103], v248 offset:2304
    s_waitcnt lgkmcnt(6)
    s_barrier
    s_waitcnt vmcnt(2) lgkmcnt(5)
    v_mfma_f32_16x16x32_bf16 v[144:147], v[80:83], v[32:35], 0
    v_mfma_f32_16x16x32_bf16 v[148:151], v[80:83], v[36:39], 0
    s_waitcnt lgkmcnt(4)
    ds_read_b128 v[80:83], v248 offset:6144
    buffer_load_dwordx4 v[48:51], v241, s[8:11], s67 offen offset:0 sc1
    v_mfma_f32_16x16x32_bf16 v[160:163], v[84:87], v[32:35], 0
    ds_read_b128 v[192:195], v6 offset:32768
    ds_read_b128 v[196:199], v6 offset:33280
    v_mfma_f32_16x16x32_bf16 v[164:167], v[84:87], v[36:39], 0
    s_waitcnt lgkmcnt(6)
    ds_read_b128 v[84:87], v248 offset:7168
    ds_read_b128 v[200:203], v6 offset:40960
    v_mfma_f32_16x16x32_bf16 v[176:179], v[88:91], v[32:35], 0
    ds_read_b128 v[204:207], v6 offset:41472
    v_mfma_f32_16x16x32_bf16 v[180:183], v[88:91], v[36:39], 0
    s_waitcnt lgkmcnt(8)
    ds_read_b128 v[88:91], v248 offset:8192
    buffer_load_dwordx4 v[52:55], v241, s[8:11], s67 offen offset:1024 sc1
    v_mfma_f32_16x16x32_bf16 v[152:155], v[92:95], v[32:35], 0
    ds_read_b128 v[208:211], v6 offset:49152
    ds_read_b128 v[212:215], v6 offset:49664
    v_mfma_f32_16x16x32_bf16 v[156:159], v[92:95], v[36:39], 0
    s_waitcnt lgkmcnt(10)
    ds_read_b128 v[92:95], v248 offset:6400
    ds_read_b128 v[216:219], v6 offset:57344
    v_mfma_f32_16x16x32_bf16 v[168:171], v[96:99], v[32:35], 0
    ds_read_b128 v[220:223], v6 offset:57856
    v_mfma_f32_16x16x32_bf16 v[172:175], v[96:99], v[36:39], 0
    s_waitcnt lgkmcnt(12)
    ds_read_b128 v[96:99], v248 offset:7424
    buffer_load_dwordx4 v[56:59], v241, s[8:11], s67 offen offset:2048 sc1
    v_mfma_f32_16x16x32_bf16 v[184:187], v[100:103], v[32:35], 0
    v_mfma_f32_16x16x32_bf16 v[188:191], v[100:103], v[36:39], 0
    s_waitcnt vmcnt(3) lgkmcnt(7)
    ds_read_b128 v[100:103], v248 offset:8448
    v_add_f32 v224, v224, v192
    v_mfma_f32_16x16x32_bf16 v[144:147], v[80:83], v[40:43], v[144:147]
    v_add_f32 v225, v225, v193
    v_add_f32 v226, v226, v194
    v_mfma_f32_16x16x32_bf16 v[148:151], v[80:83], v[44:47], v[148:151]
    ds_read_b128 v[80:83], v248 offset:12288
    v_add_f32 v227, v227, v195
    v_mfma_f32_16x16x32_bf16 v[160:163], v[84:87], v[40:43], v[160:163]
    v_add_f32 v228, v228, v196
    v_add_f32 v229, v229, v197
    v_mfma_f32_16x16x32_bf16 v[164:167], v[84:87], v[44:47], v[164:167]
    s_waitcnt lgkmcnt(8)
    ds_read_b128 v[84:87], v248 offset:13312
    buffer_load_dwordx4 v[60:63], v241, s[8:11], s67 offen offset:3072 sc1
    v_mfma_f32_16x16x32_bf16 v[176:179], v[88:91], v[40:43], v[176:179]
    v_add_f32 v230, v230, v198
    v_add_f32 v231, v231, v199
    v_mfma_f32_16x16x32_bf16 v[180:183], v[88:91], v[44:47], v[180:183]
    s_waitcnt lgkmcnt(6)
    ds_read_b128 v[88:91], v248 offset:14336
    v_add_f32 v224, v224, v200
    v_mfma_f32_16x16x32_bf16 v[152:155], v[92:95], v[40:43], v[152:155]
    v_add_f32 v225, v225, v201
    v_add_f32 v226, v226, v202
    v_mfma_f32_16x16x32_bf16 v[156:159], v[92:95], v[44:47], v[156:159]
    s_waitcnt lgkmcnt(4)
    ds_read_b128 v[92:95], v248 offset:12544
    buffer_load_dwordx4 v[64:67], v242, s[8:11], s67 offen offset:0 sc1
    v_mfma_f32_16x16x32_bf16 v[168:171], v[96:99], v[40:43], v[168:171]
    v_add_f32 v227, v227, v203
    v_add_f32 v228, v228, v204
    v_mfma_f32_16x16x32_bf16 v[172:175], v[96:99], v[44:47], v[172:175]
    s_waitcnt lgkmcnt(4)
    ds_read_b128 v[96:99], v248 offset:13568
    v_add_f32 v229, v229, v205
    v_mfma_f32_16x16x32_bf16 v[184:187], v[100:103], v[40:43], v[184:187]
    v_add_f32 v230, v230, v206
    v_add_f32 v231, v231, v207
    v_mfma_f32_16x16x32_bf16 v[188:191], v[100:103], v[44:47], v[188:191]
    s_waitcnt vmcnt(3) lgkmcnt(4)
    ds_read_b128 v[100:103], v248 offset:14592
    v_add_f32 v224, v224, v208
    v_mfma_f32_16x16x32_bf16 v[144:147], v[80:83], v[48:51], v[144:147]
    v_add_f32 v225, v225, v209
    v_add_f32 v226, v226, v210
    v_mfma_f32_16x16x32_bf16 v[148:151], v[80:83], v[52:55], v[148:151]
    s_waitcnt lgkmcnt(4)
    ds_read_b128 v[80:83], v248 offset:18432
    buffer_load_dwordx4 v[68:71], v242, s[8:11], s67 offen offset:1024 sc1
    v_mfma_f32_16x16x32_bf16 v[160:163], v[84:87], v[48:51], v[160:163]
    v_add_f32 v227, v227, v211
    v_add_f32 v228, v228, v212
    v_mfma_f32_16x16x32_bf16 v[164:167], v[84:87], v[52:55], v[164:167]
    s_waitcnt lgkmcnt(4)
    ds_read_b128 v[84:87], v248 offset:19456
    v_add_f32 v229, v229, v213
    v_mfma_f32_16x16x32_bf16 v[176:179], v[88:91], v[48:51], v[176:179]
    v_add_f32 v230, v230, v214
    v_add_f32 v231, v231, v215
    v_mfma_f32_16x16x32_bf16 v[180:183], v[88:91], v[52:55], v[180:183]
    s_waitcnt lgkmcnt(4)
    ds_read_b128 v[88:91], v248 offset:20480
    buffer_load_dwordx4 v[72:75], v242, s[8:11], s67 offen offset:2048 sc1
    v_mfma_f32_16x16x32_bf16 v[152:155], v[92:95], v[48:51], v[152:155]
    v_add_f32 v224, v224, v216
    v_add_f32 v225, v225, v217
    v_mfma_f32_16x16x32_bf16 v[156:159], v[92:95], v[52:55], v[156:159]
    s_waitcnt lgkmcnt(4)
    ds_read_b128 v[92:95], v248 offset:18688
    v_add_f32 v226, v226, v218
    v_mfma_f32_16x16x32_bf16 v[168:171], v[96:99], v[48:51], v[168:171]
    v_add_f32 v227, v227, v219
    v_add_f32 v228, v228, v220
    v_mfma_f32_16x16x32_bf16 v[172:175], v[96:99], v[52:55], v[172:175]
    s_waitcnt lgkmcnt(4)
    ds_read_b128 v[96:99], v248 offset:19712
    buffer_load_dwordx4 v[76:79], v242, s[8:11], s67 offen offset:3072 sc1
    v_mfma_f32_16x16x32_bf16 v[184:187], v[100:103], v[48:51], v[184:187]
    v_add_f32 v229, v229, v221
    v_add_f32 v230, v230, v222
    v_mfma_f32_16x16x32_bf16 v[188:191], v[100:103], v[52:55], v[188:191]
    s_waitcnt vmcnt(4) lgkmcnt(4)
    ds_read_b128 v[100:103], v248 offset:20736
    v_add_f32 v231, v231, v223
    v_mfma_f32_16x16x32_bf16 v[144:147], v[80:83], v[56:59], v[144:147]
    v_cvt_pk_bf16_f32 v192, v224, v225
    v_cvt_pk_bf16_f32 v193, v226, v227
    v_mfma_f32_16x16x32_bf16 v[148:151], v[80:83], v[60:63], v[148:151]
    s_waitcnt lgkmcnt(4)
    ds_read_b128 v[80:83], v248 offset:24576
    v_cvt_pk_bf16_f32 v194, v228, v229
    v_mfma_f32_16x16x32_bf16 v[160:163], v[84:87], v[56:59], v[160:163]
    v_cvt_pk_bf16_f32 v195, v230, v231
    v_mfma_f32_16x16x32_bf16 v[164:167], v[84:87], v[60:63], v[164:167]
    s_waitcnt lgkmcnt(4)
    ds_read_b128 v[84:87], v248 offset:25600
    buffer_load_dwordx4 v[32:35], v243, s[8:11], s67 offen offset:0 sc1
    v_mfma_f32_16x16x32_bf16 v[176:179], v[88:91], v[56:59], v[176:179]
    buffer_store_dwordx4 v[192:195], v7, s[8:11], s62 offen
    v_dot2_f32_bf16 v196, v192, s36, 0
    v_dot2_f32_bf16 v197, v192, v192, 0
    v_dot2_f32_bf16 v196, v193, s36, v196
    v_dot2_f32_bf16 v197, v193, v193, v197
    v_dot2_f32_bf16 v196, v194, s36, v196
    v_dot2_f32_bf16 v197, v194, v194, v197
    v_dot2_f32_bf16 v196, v195, s36, v196
    v_dot2_f32_bf16 v197, v195, v195, v197
    v_mfma_f32_16x16x32_bf16 v[180:183], v[88:91], v[60:63], v[180:183]
    s_waitcnt lgkmcnt(4)
    ds_read_b128 v[88:91], v248 offset:26624
    v_accvgpr_write_b32 a248, v224
    v_mfma_f32_16x16x32_bf16 v[152:155], v[92:95], v[56:59], v[152:155]
    v_accvgpr_write_b32 a249, v225
    v_accvgpr_write_b32 a250, v226
    v_mfma_f32_16x16x32_bf16 v[156:159], v[92:95], v[60:63], v[156:159]
    s_waitcnt lgkmcnt(4)
    ds_read_b128 v[92:95], v248 offset:24832
    buffer_load_dwordx4 v[36:39], v243, s[8:11], s67 offen offset:1024 sc1
    v_mfma_f32_16x16x32_bf16 v[168:171], v[96:99], v[56:59], v[168:171]
    v_permlane16_swap_b32 v196, v197
    v_add_f32 v196, v196, v197
    v_mfma_f32_16x16x32_bf16 v[172:175], v[96:99], v[60:63], v[172:175]
    s_waitcnt lgkmcnt(4)
    ds_read_b128 v[96:99], v248 offset:25856
    v_mov_b32 v197, v196
    v_mfma_f32_16x16x32_bf16 v[184:187], v[100:103], v[56:59], v[184:187]
    v_accvgpr_write_b32 a251, v227
    v_accvgpr_write_b32 a252, v228
    v_mfma_f32_16x16x32_bf16 v[188:191], v[100:103], v[60:63], v[188:191]
    s_waitcnt vmcnt(5) lgkmcnt(4)
    ds_read_b128 v[100:103], v248 offset:26880
    buffer_load_dwordx4 v[40:43], v243, s[8:11], s67 offen offset:2048 sc1
    v_mfma_f32_16x16x32_bf16 v[144:147], v[80:83], v[64:67], v[144:147]
    v_permlane32_swap_b32 v196, v197
    v_add_f32 v196, v196, v197
    v_mfma_f32_16x16x32_bf16 v[148:151], v[80:83], v[68:71], v[148:151]
    s_waitcnt lgkmcnt(4)
    ds_read_b128 v[80:83], v248 offset:30720
    v_accvgpr_write_b32 a253, v229
    v_mfma_f32_16x16x32_bf16 v[160:163], v[84:87], v[64:67], v[160:163]
    v_accvgpr_write_b32 a254, v230
    v_add_f32_dpp v196, v196, v196 row_ror:8 row_mask:0xf bank_mask:0xf
    v_mfma_f32_16x16x32_bf16 v[164:167], v[84:87], v[68:71], v[164:167]
    s_waitcnt lgkmcnt(4)
    ds_read_b128 v[84:87], v248 offset:31744
    v_mfma_f32_16x16x32_bf16 v[176:179], v[88:91], v[64:67], v[176:179]
    s_cbranch_vccnz SAFE_107
    buffer_store_dword v196, v8, s[4:7], s64 offen
BACK_108:
    v_mfma_f32_16x16x32_bf16 v[180:183], v[88:91], v[68:71], v[180:183]
    s_waitcnt lgkmcnt(4)
    ds_read_b128 v[88:91], v248 offset:32768
    buffer_load_dwordx4 v[44:47], v243, s[8:11], s67 offen offset:3072 sc1
    v_mfma_f32_16x16x32_bf16 v[152:155], v[92:95], v[64:67], v[152:155]
    v_accvgpr_write_b32 a255, v231
    v_mfma_f32_16x16x32_bf16 v[156:159], v[92:95], v[68:71], v[156:159]
    s_waitcnt lgkmcnt(4)
    ds_read_b128 v[92:95], v248 offset:30976
    v_mfma_f32_16x16x32_bf16 v[168:171], v[96:99], v[64:67], v[168:171]
    s_lshl_b32 s3, s14, 8
    s_add_u32 s3, s3, 98304
    v_lshl_add_u32 v252, v13, 2, s3
    v_mfma_f32_16x16x32_bf16 v[172:175], v[96:99], v[68:71], v[172:175]
    s_waitcnt lgkmcnt(4)
    ds_read_b128 v[96:99], v248 offset:32000
    buffer_load_dwordx4 v[48:51], v244, s[8:11], s67 offen offset:0 sc1
    v_mfma_f32_16x16x32_bf16 v[184:187], v[100:103], v[64:67], v[184:187]
    v_lshl_add_u32 v254, v3, 9, v9
    v_add_u32 v254, 98304, v254
    v_mfma_f32_16x16x32_bf16 v[188:191], v[100:103], v[68:71], v[188:191]
    s_waitcnt vmcnt(7) lgkmcnt(4)
    ds_read_b128 v[100:103], v248 offset:33024
    ds_write_b32 v252, v12 offset:0
    v_mfma_f32_16x16x32_bf16 v[144:147], v[80:83], v[72:75], v[144:147]
    ds_write_b32 v252, v253 offset:1024
    ds_write_b32 v252, v31 offset:2048
    v_mfma_f32_16x16x32_bf16 v[148:151], v[80:83], v[76:79], v[148:151]
    s_waitcnt lgkmcnt(7)
    ds_read_b128 v[80:83], v248 offset:36864
    v_mfma_f32_16x16x32_bf16 v[160:163], v[84:87], v[72:75], v[160:163]
    v_mfma_f32_16x16x32_bf16 v[164:167], v[84:87], v[76:79], v[164:167]
    s_waitcnt lgkmcnt(7)
    ds_read_b128 v[84:87], v248 offset:37888
    buffer_load_dwordx4 v[52:55], v244, s[8:11], s67 offen offset:1024 sc1
    v_mfma_f32_16x16x32_bf16 v[176:179], v[88:91], v[72:75], v[176:179]
    v_mfma_f32_16x16x32_bf16 v[180:183], v[88:91], v[76:79], v[180:183]
    s_waitcnt lgkmcnt(7)
    ds_read_b128 v[88:91], v248 offset:38912
    v_mfma_f32_16x16x32_bf16 v[152:155], v[92:95], v[72:75], v[152:155]
    v_mfma_f32_16x16x32_bf16 v[156:159], v[92:95], v[76:79], v[156:159]
    s_waitcnt lgkmcnt(7)
    ds_read_b128 v[92:95], v248 offset:37120
    buffer_load_dwordx4 v[56:59], v244, s[8:11], s67 offen offset:2048 sc1
    v_mfma_f32_16x16x32_bf16 v[168:171], v[96:99], v[72:75], v[168:171]
    v_mfma_f32_16x16x32_bf16 v[172:175], v[96:99], v[76:79], v[172:175]
    s_waitcnt lgkmcnt(4)
    ds_read_b128 v[96:99], v248 offset:38144
    s_barrier
    v_mfma_f32_16x16x32_bf16 v[184:187], v[100:103], v[72:75], v[184:187]
    s_waitcnt vmcnt(4)
    s_cbranch_vccnz SAFE_112
    buffer_store_dword v11, v10, s[4:7], s66 offen offset:1024
BACK_113:
    v_mfma_f32_16x16x32_bf16 v[188:191], v[100:103], v[76:79], v[188:191]
    s_waitcnt lgkmcnt(4)
    ds_read_b128 v[100:103], v248 offset:39168
    buffer_load_dwordx4 v[60:63], v244, s[8:11], s67 offen offset:3072 sc1
    v_mfma_f32_16x16x32_bf16 v[144:147], v[80:83], v[32:35], v[144:147]
    ds_read_b32 v200, v254 offset:0
    v_mfma_f32_16x16x32_bf16 v[148:151], v[80:83], v[36:39], v[148:151]
    s_waitcnt lgkmcnt(5)
    ds_read_b128 v[80:83], v248 offset:43008
    v_mfma_f32_16x16x32_bf16 v[160:163], v[84:87], v[32:35], v[160:163]
    ds_read_b32 v201, v254 offset:128
    v_mfma_f32_16x16x32_bf16 v[164:167], v[84:87], v[36:39], v[164:167]
    s_waitcnt lgkmcnt(6)
    ds_read_b128 v[84:87], v248 offset:44032
    v_mfma_f32_16x16x32_bf16 v[176:179], v[88:91], v[32:35], v[176:179]
    ds_read_b32 v202, v254 offset:256
    v_mfma_f32_16x16x32_bf16 v[180:183], v[88:91], v[36:39], v[180:183]
    s_waitcnt lgkmcnt(7)
    ds_read_b128 v[88:91], v248 offset:45056
    buffer_load_dwordx4 v[64:67], v245, s[8:11], s67 offen offset:0 sc1
    v_mfma_f32_16x16x32_bf16 v[152:155], v[92:95], v[32:35], v[152:155]
    ds_read_b32 v203, v254 offset:384
    v_mfma_f32_16x16x32_bf16 v[156:159], v[92:95], v[36:39], v[156:159]
    s_waitcnt lgkmcnt(8)
    ds_read_b128 v[92:95], v248 offset:43264
    v_mfma_f32_16x16x32_bf16 v[168:171], v[96:99], v[32:35], v[168:171]
    ds_read_b32 v204, v254 offset:1024
    v_mfma_f32_16x16x32_bf16 v[172:175], v[96:99], v[36:39], v[172:175]
    s_waitcnt lgkmcnt(9)
    ds_read_b128 v[96:99], v248 offset:44288
    buffer_load_dwordx4 v[68:71], v245, s[8:11], s67 offen offset:1024 sc1
    v_mfma_f32_16x16x32_bf16 v[184:187], v[100:103], v[32:35], v[184:187]
    ds_read_b32 v205, v254 offset:1152
    v_mfma_f32_16x16x32_bf16 v[188:191], v[100:103], v[36:39], v[188:191]
    s_waitcnt vmcnt(7) lgkmcnt(9)
    ds_read_b128 v[100:103], v248 offset:45312
    v_mfma_f32_16x16x32_bf16 v[144:147], v[80:83], v[40:43], v[144:147]
    ds_read_b32 v206, v254 offset:1280
    v_mfma_f32_16x16x32_bf16 v[148:151], v[80:83], v[44:47], v[148:151]
    s_waitcnt lgkmcnt(9)
    ds_read_b128 v[80:83], v248 offset:49152
    v_mfma_f32_16x16x32_bf16 v[160:163], v[84:87], v[40:43], v[160:163]
    ds_read_b32 v207, v254 offset:1408
    v_mfma_f32_16x16x32_bf16 v[164:167], v[84:87], v[44:47], v[164:167]
    s_waitcnt lgkmcnt(9)
    ds_read_b128 v[84:87], v248 offset:50176
    buffer_load_dwordx4 v[72:75], v245, s[8:11], s67 offen offset:2048 sc1
    v_mfma_f32_16x16x32_bf16 v[176:179], v[88:91], v[40:43], v[176:179]
    ds_read_b32 v208, v254 offset:2048
    v_mfma_f32_16x16x32_bf16 v[180:183], v[88:91], v[44:47], v[180:183]
    s_waitcnt lgkmcnt(9)
    ds_read_b128 v[88:91], v248 offset:51200
    v_mfma_f32_16x16x32_bf16 v[152:155], v[92:95], v[40:43], v[152:155]
    ds_read_b32 v209, v254 offset:2176
    v_mfma_f32_16x16x32_bf16 v[156:159], v[92:95], v[44:47], v[156:159]
    s_waitcnt lgkmcnt(9)
    ds_read_b128 v[92:95], v248 offset:49408
    buffer_load_dwordx4 v[76:79], v245, s[8:11], s67 offen offset:3072 sc1
    v_mfma_f32_16x16x32_bf16 v[168:171], v[96:99], v[40:43], v[168:171]
    ds_read_b32 v210, v254 offset:2304
    v_mfma_f32_16x16x32_bf16 v[172:175], v[96:99], v[44:47], v[172:175]
    s_waitcnt lgkmcnt(9)
    ds_read_b128 v[96:99], v248 offset:50432
    v_mfma_f32_16x16x32_bf16 v[184:187], v[100:103], v[40:43], v[184:187]
    ds_read_b32 v211, v254 offset:2432
    v_mfma_f32_16x16x32_bf16 v[188:191], v[100:103], v[44:47], v[188:191]
    s_waitcnt vmcnt(7) lgkmcnt(0)
    ds_read_b128 v[100:103], v248 offset:51456
    buffer_load_dwordx4 v[32:35], v246, s[8:11], s67 offen offset:0 sc1
    v_mfma_f32_16x16x32_bf16 v[144:147], v[80:83], v[48:51], v[144:147]
    v_add_f32 v200, v200, v201
    v_add_f32 v202, v202, v203
    v_mfma_f32_16x16x32_bf16 v[148:151], v[80:83], v[52:55], v[148:151]
    ds_read_b128 v[80:83], v248 offset:55296
    v_add_f32 v200, v200, v202
    v_mfma_f32_16x16x32_bf16 v[160:163], v[84:87], v[48:51], v[160:163]
    v_mov_b32 v201, v200
    v_add_f32 v204, v204, v205
    v_mfma_f32_16x16x32_bf16 v[164:167], v[84:87], v[52:55], v[164:167]
    ds_read_b128 v[84:87], v248 offset:56320
    v_add_f32 v206, v206, v207
    v_mfma_f32_16x16x32_bf16 v[176:179], v[88:91], v[48:51], v[176:179]
    v_add_f32 v204, v204, v206
    v_mov_b32 v205, v204
    v_mfma_f32_16x16x32_bf16 v[180:183], v[88:91], v[52:55], v[180:183]
    ds_read_b128 v[88:91], v248 offset:57344
    buffer_load_dwordx4 v[36:39], v246, s[8:11], s67 offen offset:1024 sc1
    v_mfma_f32_16x16x32_bf16 v[152:155], v[92:95], v[48:51], v[152:155]
    v_add_f32 v208, v208, v209
    v_add_f32 v210, v210, v211
    v_mfma_f32_16x16x32_bf16 v[156:159], v[92:95], v[52:55], v[156:159]
    ds_read_b128 v[92:95], v248 offset:55552
    v_add_f32 v208, v208, v210
    v_mfma_f32_16x16x32_bf16 v[168:171], v[96:99], v[48:51], v[168:171]
    v_mov_b32 v209, v208
    v_permlane32_swap_b32 v200, v201
    v_mfma_f32_16x16x32_bf16 v[172:175], v[96:99], v[52:55], v[172:175]
    s_waitcnt lgkmcnt(4)
    ds_read_b128 v[96:99], v248 offset:56576
    buffer_load_dwordx4 v[40:43], v246, s[8:11], s67 offen offset:2048 sc1
    v_mfma_f32_16x16x32_bf16 v[184:187], v[100:103], v[48:51], v[184:187]
    v_add_f32 v200, v200, v201
    v_cvt_pk_bf16_f32 v201, v200, v200
    v_mfma_f32_16x16x32_bf16 v[188:191], v[100:103], v[52:55], v[188:191]
    s_waitcnt vmcnt(7) lgkmcnt(4)
    ds_read_b128 v[100:103], v248 offset:57600
    v_and_b32 v201, 0xffff0000, v201
    v_mfma_f32_16x16x32_bf16 v[144:147], v[80:83], v[56:59], v[144:147]
    v_sub_f32 v200, v200, v201
    v_cvt_pk_bf16_f32 v25, v201, v200
    v_mfma_f32_16x16x32_bf16 v[148:151], v[80:83], v[60:63], v[148:151]
    s_waitcnt lgkmcnt(4)
    ds_read_b128 v[80:83], v249 offset:0
    v_permlane32_swap_b32 v204, v205
    v_mfma_f32_16x16x32_bf16 v[160:163], v[84:87], v[56:59], v[160:163]
    v_add_f32 v204, v204, v205
    v_cvt_pk_bf16_f32 v205, v204, v204
    v_mfma_f32_16x16x32_bf16 v[164:167], v[84:87], v[60:63], v[164:167]
    s_waitcnt lgkmcnt(4)
    ds_read_b128 v[84:87], v249 offset:1024
    buffer_load_dwordx4 v[44:47], v246, s[8:11], s67 offen offset:3072 sc1
    v_mfma_f32_16x16x32_bf16 v[176:179], v[88:91], v[56:59], v[176:179]
    buffer_load_dword v14, v9, s[4:7], s72 offen offset:1024 sc1
    v_and_b32 v205, 0xffff0000, v205
    v_mfma_f32_16x16x32_bf16 v[180:183], v[88:91], v[60:63], v[180:183]
    s_waitcnt lgkmcnt(4)
    ds_read_b128 v[88:91], v249 offset:2048
    v_sub_f32 v204, v204, v205
    v_mfma_f32_16x16x32_bf16 v[152:155], v[92:95], v[56:59], v[152:155]
    v_cvt_pk_bf16_f32 v27, v205, v204
    v_permlane32_swap_b32 v208, v209
    v_mfma_f32_16x16x32_bf16 v[156:159], v[92:95], v[60:63], v[156:159]
    s_waitcnt lgkmcnt(4)
    ds_read_b128 v[92:95], v249 offset:256
    buffer_load_dwordx4 v[48:51], v247, s[8:11], s67 offen offset:0 sc1
    v_mfma_f32_16x16x32_bf16 v[168:171], v[96:99], v[56:59], v[168:171]
    v_add_f32 v208, v208, v209
    v_cvt_pk_bf16_f32 v209, v208, v208
    v_mfma_f32_16x16x32_bf16 v[172:175], v[96:99], v[60:63], v[172:175]
    s_waitcnt lgkmcnt(4)
    ds_read_b128 v[96:99], v249 offset:1280
    v_and_b32 v209, 0xffff0000, v209
    v_mfma_f32_16x16x32_bf16 v[184:187], v[100:103], v[56:59], v[184:187]
    v_sub_f32 v208, v208, v209
    v_cvt_pk_bf16_f32 v29, v209, v208
    v_mfma_f32_16x16x32_bf16 v[188:191], v[100:103], v[60:63], v[188:191]
    s_waitcnt vmcnt(8) lgkmcnt(4)
    ds_read_b128 v[100:103], v249 offset:2304
    buffer_load_dwordx4 v[52:55], v247, s[8:11], s67 offen offset:1024 sc1
    v_mfma_f32_16x16x32_bf16 v[144:147], v[80:83], v[64:67], v[144:147]
    v_mfma_f32_16x16x32_bf16 v[148:151], v[80:83], v[68:71], v[148:151]
    s_waitcnt lgkmcnt(4)
    ds_read_b128 v[80:83], v249 offset:6144
    v_mfma_f32_16x16x32_bf16 v[160:163], v[84:87], v[64:67], v[160:163]
    v_mfma_f32_16x16x32_bf16 v[164:167], v[84:87], v[68:71], v[164:167]
    s_waitcnt lgkmcnt(4)
    ds_read_b128 v[84:87], v249 offset:7168
    v_mfma_f32_16x16x32_bf16 v[176:179], v[88:91], v[64:67], v[176:179]
    v_mfma_f32_16x16x32_bf16 v[180:183], v[88:91], v[68:71], v[180:183]
    s_waitcnt lgkmcnt(4)
    ds_read_b128 v[88:91], v249 offset:8192
    buffer_load_dwordx4 v[56:59], v247, s[8:11], s67 offen offset:2048 sc1
    v_mfma_f32_16x16x32_bf16 v[152:155], v[92:95], v[64:67], v[152:155]
    v_mfma_f32_16x16x32_bf16 v[156:159], v[92:95], v[68:71], v[156:159]
    s_waitcnt lgkmcnt(4)
    ds_read_b128 v[92:95], v249 offset:6400
    v_mfma_f32_16x16x32_bf16 v[168:171], v[96:99], v[64:67], v[168:171]
    v_mfma_f32_16x16x32_bf16 v[172:175], v[96:99], v[68:71], v[172:175]
    s_waitcnt lgkmcnt(4)
    ds_read_b128 v[96:99], v249 offset:7424
    buffer_load_dwordx4 v[60:63], v247, s[8:11], s67 offen offset:3072 sc1
    v_mfma_f32_16x16x32_bf16 v[184:187], v[100:103], v[64:67], v[184:187]
    v_mfma_f32_16x16x32_bf16 v[188:191], v[100:103], v[68:71], v[188:191]
    s_waitcnt vmcnt(4) lgkmcnt(4)
    ds_read_b128 v[100:103], v249 offset:8448
    v_mfma_f32_16x16x32_bf16 v[144:147], v[80:83], v[72:75], v[144:147]
    v_cmp_gt_u32 vcc, s34, v14
    s_cbranch_vccnz SPIN_109
BACK_110:
    v_mfma_f32_16x16x32_bf16 v[148:151], v[80:83], v[76:79], v[148:151]
    s_waitcnt lgkmcnt(4)
    ds_read_b128 v[80:83], v249 offset:12288
    buffer_load_dwordx4 v[104:107], v16, s[4:7], s69 offen offset:0 sc1
    v_mfma_f32_16x16x32_bf16 v[160:163], v[84:87], v[72:75], v[160:163]
    v_mfma_f32_16x16x32_bf16 v[164:167], v[84:87], v[76:79], v[164:167]
    s_waitcnt lgkmcnt(4)
    ds_read_b128 v[84:87], v249 offset:13312
    v_mfma_f32_16x16x32_bf16 v[176:179], v[88:91], v[72:75], v[176:179]
    v_mfma_f32_16x16x32_bf16 v[180:183], v[88:91], v[76:79], v[180:183]
    s_waitcnt lgkmcnt(4)
    ds_read_b128 v[88:91], v249 offset:14336
    buffer_load_dwordx4 v[108:111], v16, s[4:7], s69 offen offset:1024 sc1
    v_mfma_f32_16x16x32_bf16 v[152:155], v[92:95], v[72:75], v[152:155]
    v_mfma_f32_16x16x32_bf16 v[156:159], v[92:95], v[76:79], v[156:159]
    s_waitcnt lgkmcnt(4)
    ds_read_b128 v[92:95], v249 offset:12544
    v_mfma_f32_16x16x32_bf16 v[168:171], v[96:99], v[72:75], v[168:171]
    v_mfma_f32_16x16x32_bf16 v[172:175], v[96:99], v[76:79], v[172:175]
    s_waitcnt lgkmcnt(4)
    ds_read_b128 v[96:99], v249 offset:13568
    v_mfma_f32_16x16x32_bf16 v[184:187], v[100:103], v[72:75], v[184:187]
    v_mfma_f32_16x16x32_bf16 v[188:191], v[100:103], v[76:79], v[188:191]
    s_waitcnt lgkmcnt(4)
    ds_read_b128 v[100:103], v249 offset:14592
    buffer_load_dwordx4 v[64:67], v240, s[8:11], s68 offen offset:0 sc1
    v_mfma_f32_16x16x32_bf16 v[144:147], v[80:83], v[32:35], v[144:147]
    v_mfma_f32_16x16x32_bf16 v[148:151], v[80:83], v[36:39], v[148:151]
    s_waitcnt lgkmcnt(4)
    ds_read_b128 v[80:83], v249 offset:18432
    v_mfma_f32_16x16x32_bf16 v[160:163], v[84:87], v[32:35], v[160:163]
    v_mfma_f32_16x16x32_bf16 v[164:167], v[84:87], v[36:39], v[164:167]
    s_waitcnt lgkmcnt(4)
    ds_read_b128 v[84:87], v249 offset:19456
    buffer_load_dwordx4 v[68:71], v240, s[8:11], s68 offen offset:1024 sc1
    v_mfma_f32_16x16x32_bf16 v[176:179], v[88:91], v[32:35], v[176:179]
    v_mfma_f32_16x16x32_bf16 v[180:183], v[88:91], v[36:39], v[180:183]
    s_waitcnt lgkmcnt(4)
    ds_read_b128 v[88:91], v249 offset:20480
    v_mfma_f32_16x16x32_bf16 v[152:155], v[92:95], v[32:35], v[152:155]
    v_mfma_f32_16x16x32_bf16 v[156:159], v[92:95], v[36:39], v[156:159]
    s_waitcnt lgkmcnt(4)
    ds_read_b128 v[92:95], v249 offset:18688
    v_mfma_f32_16x16x32_bf16 v[168:171], v[96:99], v[32:35], v[168:171]
    v_mfma_f32_16x16x32_bf16 v[172:175], v[96:99], v[36:39], v[172:175]
    s_waitcnt lgkmcnt(4)
    ds_read_b128 v[96:99], v249 offset:19712
    buffer_load_dwordx4 v[72:75], v240, s[8:11], s68 offen offset:2048 sc1
    v_mfma_f32_16x16x32_bf16 v[184:187], v[100:103], v[32:35], v[184:187]
    v_mfma_f32_16x16x32_bf16 v[188:191], v[100:103], v[36:39], v[188:191]
    s_waitcnt lgkmcnt(4)
    ds_read_b128 v[100:103], v249 offset:20736
    v_mfma_f32_16x16x32_bf16 v[144:147], v[80:83], v[40:43], v[144:147]
    v_mfma_f32_16x16x32_bf16 v[148:151], v[80:83], v[44:47], v[148:151]
    s_waitcnt lgkmcnt(4)
    ds_read_b128 v[80:83], v249 offset:24576
    buffer_load_dwordx4 v[76:79], v240, s[8:11], s68 offen offset:3072 sc1
    v_mfma_f32_16x16x32_bf16 v[160:163], v[84:87], v[40:43], v[160:163]
    v_mfma_f32_16x16x32_bf16 v[164:167], v[84:87], v[44:47], v[164:167]
    s_waitcnt lgkmcnt(4)
    ds_read_b128 v[84:87], v249 offset:25600
    v_mfma_f32_16x16x32_bf16 v[176:179], v[88:91], v[40:43], v[176:179]
    v_mfma_f32_16x16x32_bf16 v[180:183], v[88:91], v[44:47], v[180:183]
    s_waitcnt lgkmcnt(4)
    ds_read_b128 v[88:91], v249 offset:26624
    buffer_load_dwordx4 v[32:35], v241, s[8:11], s68 offen offset:0 sc1
    v_mfma_f32_16x16x32_bf16 v[152:155], v[92:95], v[40:43], v[152:155]
    v_mfma_f32_16x16x32_bf16 v[156:159], v[92:95], v[44:47], v[156:159]
    s_waitcnt lgkmcnt(4)
    ds_read_b128 v[92:95], v249 offset:24832
    v_mfma_f32_16x16x32_bf16 v[168:171], v[96:99], v[40:43], v[168:171]
    v_mfma_f32_16x16x32_bf16 v[172:175], v[96:99], v[44:47], v[172:175]
    s_waitcnt vmcnt(5) lgkmcnt(4)
    ds_read_b128 v[96:99], v249 offset:25856
    v_add_f32 v104, v104, v106
    v_mfma_f32_16x16x32_bf16 v[184:187], v[100:103], v[40:43], v[184:187]
    v_add_f32 v105, v105, v107
    v_add_f32 v108, v108, v110
    v_mfma_f32_16x16x32_bf16 v[188:191], v[100:103], v[44:47], v[188:191]
    s_waitcnt lgkmcnt(4)
    ds_read_b128 v[100:103], v249 offset:26880
    buffer_load_dwordx4 v[36:39], v241, s[8:11], s68 offen offset:1024 sc1
    v_mfma_f32_16x16x32_bf16 v[144:147], v[80:83], v[48:51], v[144:147]
    v_add_f32 v109, v109, v111
    v_add_f32 v104, v104, v108
    v_mfma_f32_16x16x32_bf16 v[148:151], v[80:83], v[52:55], v[148:151]
    s_waitcnt lgkmcnt(4)
    ds_read_b128 v[80:83], v249 offset:30720
    v_add_f32 v105, v105, v109
    v_mfma_f32_16x16x32_bf16 v[160:163], v[84:87], v[48:51], v[160:163]
    s_nop 0
    v_permlane32_swap_b32 v104, v105
    v_add_f32 v104, v104, v105
    v_mfma_f32_16x16x32_bf16 v[164:167], v[84:87], v[52:55], v[164:167]
    s_waitcnt lgkmcnt(4)
    ds_read_b128 v[84:87], v249 offset:31744
    buffer_load_dwordx4 v[40:43], v241, s[8:11], s68 offen offset:2048 sc1
    v_mfma_f32_16x16x32_bf16 v[176:179], v[88:91], v[48:51], v[176:179]
    v_mul_f32 v104, 0x3b000000, v104
    v_mov_b32 v105, v104
    v_mfma_f32_16x16x32_bf16 v[180:183], v[88:91], v[52:55], v[180:183]
    s_waitcnt lgkmcnt(4)
    ds_read_b128 v[88:91], v249 offset:32768
    v_permlane32_swap_b32 v104, v105
    v_mfma_f32_16x16x32_bf16 v[152:155], v[92:95], v[48:51], v[152:155]
    v_fma_f32 v105, -v104, v104, v105
    v_max_f32 v105, 0, v105
    v_mfma_f32_16x16x32_bf16 v[156:159], v[92:95], v[52:55], v[156:159]
    s_waitcnt lgkmcnt(4)
    ds_read_b128 v[92:95], v249 offset:30976
    v_add_f32 v105, 0x3727c5ac, v105
    v_mfma_f32_16x16x32_bf16 v[168:171], v[96:99], v[48:51], v[168:171]
    v_rsq_f32 v120, v105
    v_mfma_f32_16x16x32_bf16 v[172:175], v[96:99], v[52:55], v[172:175]
    s_waitcnt lgkmcnt(4)
    ds_read_b128 v[96:99], v249 offset:32000
    buffer_load_dwordx4 v[44:47], v241, s[8:11], s68 offen offset:3072 sc1
    v_mfma_f32_16x16x32_bf16 v[184:187], v[100:103], v[48:51], v[184:187]
    v_cvt_pk_bf16_f32 v106, -v104, -v104
    v_and_b32 v107, 0xffff0000, v106
    v_mfma_f32_16x16x32_bf16 v[188:191], v[100:103], v[52:55], v[188:191]
    s_waitcnt lgkmcnt(4)
    ds_read_b128 v[100:103], v249 offset:33024
    v_sub_f32 v107, -v104, v107
    v_mfma_f32_16x16x32_bf16 v[144:147], v[80:83], v[56:59], v[144:147]
    v_cvt_pk_bf16_f32 v107, v107, v107
    v_cndmask_b32 v124, v107, v106, s[24:25]
    v_mfma_f32_16x16x32_bf16 v[148:151], v[80:83], v[60:63], v[148:151]
    s_waitcnt lgkmcnt(4)
    ds_read_b128 v[80:83], v248 offset:0
    buffer_load_dwordx4 v[112:115], v16, s[4:7], s70 offen offset:0 sc1
    v_mfma_f32_16x16x32_bf16 v[160:163], v[84:87], v[56:59], v[160:163]
    v_mul_f32 v120, v120, v120
    v_mov_b32 v105, v124
    v_mfma_f32_16x16x32_bf16 v[164:167], v[84:87], v[60:63], v[164:167]
    s_waitcnt lgkmcnt(4)
    ds_read_b128 v[84:87], v248 offset:1024
    v_mov_b32 v107, 0
    v_mfma_f32_16x16x32_bf16 v[176:179], v[88:91], v[56:59], v[176:179]
    v_mov_b32 v121, v120
    v_mov_b32 v109, 0
    v_mfma_f32_16x16x32_bf16 v[180:183], v[88:91], v[60:63], v[180:183]
    s_waitcnt lgkmcnt(4)
    ds_read_b128 v[88:91], v248 offset:2048
    buffer_load_dwordx4 v[116:119], v16, s[4:7], s70 offen offset:1024 sc1
    v_mfma_f32_16x16x32_bf16 v[152:155], v[92:95], v[56:59], v[152:155]
    v_mov_b32 v111, v124
    v_permlane16_swap_b32 v105, v107
    v_mfma_f32_16x16x32_bf16 v[156:159], v[92:95], v[60:63], v[156:159]
    s_waitcnt lgkmcnt(4)
    ds_read_b128 v[92:95], v248 offset:256
    v_mov_b32 v104, 0
    v_mfma_f32_16x16x32_bf16 v[168:171], v[96:99], v[56:59], v[168:171]
    v_permlane16_swap_b32 v120, v121
    v_permlane16_swap_b32 v109, v111
    v_mfma_f32_16x16x32_bf16 v[172:175], v[96:99], v[60:63], v[172:175]
    s_waitcnt lgkmcnt(4)
    ds_read_b128 v[96:99], v248 offset:1280
    buffer_load_dwordx4 v[48:51], v242, s[8:11], s68 offen offset:0 sc1
    v_mfma_f32_16x16x32_bf16 v[184:187], v[100:103], v[56:59], v[184:187]
    v_mov_b32 v106, 0
    v_mov_b32 v108, 0
    v_mfma_f32_16x16x32_bf16 v[188:191], v[100:103], v[60:63], v[188:191]
    ds_read_b128 v[100:103], v248 offset:2304
    v_mov_b32 v110, 0
    v_mfma_f32_16x16x16_bf16 v[144:147], v[24:25], v[104:105], v[144:147]
    v_mfma_f32_16x16x16_bf16 v[148:151], v[24:25], v[106:107], v[148:151]
    buffer_load_dwordx4 v[52:55], v242, s[8:11], s68 offen offset:1024 sc1
    v_mfma_f32_16x16x16_bf16 v[152:155], v[24:25], v[108:109], v[152:155]
    v_mfma_f32_16x16x16_bf16 v[156:159], v[24:25], v[110:111], v[156:159]
    v_mfma_f32_16x16x16_bf16 v[160:163], v[26:27], v[104:105], v[160:163]
    v_mfma_f32_16x16x16_bf16 v[164:167], v[26:27], v[106:107], v[164:167]
    s_nop 4
    v_mul_f32 v144, v144, v152
    v_mul_f32 v145, v145, v153
    v_mfma_f32_16x16x16_bf16 v[168:171], v[26:27], v[108:109], v[168:171]
    v_mul_f32 v144, v144, v120
    v_mul_f32 v145, v145, v120
    v_mfma_f32_16x16x16_bf16 v[172:175], v[26:27], v[110:111], v[172:175]
    buffer_load_dwordx4 v[56:59], v242, s[8:11], s68 offen offset:2048 sc1
    v_cvt_pk_bf16_f32 v152, v144, v145
    v_mfma_f32_16x16x16_bf16 v[176:179], v[28:29], v[104:105], v[176:179]
    v_mul_f32 v146, v146, v154
    v_mul_f32 v147, v147, v155
    v_mfma_f32_16x16x16_bf16 v[180:183], v[28:29], v[106:107], v[180:183]
    v_mul_f32 v146, v146, v120
    v_mul_f32 v147, v147, v120
    v_mfma_f32_16x16x16_bf16 v[184:187], v[28:29], v[108:109], v[184:187]
    v_cvt_pk_bf16_f32 v153, v146, v147
    v_mul_f32 v148, v148, v156
    v_mfma_f32_16x16x16_bf16 v[188:191], v[28:29], v[110:111], v[188:191]
    s_waitcnt vmcnt(11) lgkmcnt(5)
    buffer_load_dwordx4 v[60:63], v242, s[8:11], s68 offen offset:3072 sc1
    v_mul_f32 v149, v149, v157
    v_mfma_f32_16x16x32_bf16 v[192:195], v[80:83], v[64:67], 0
    v_mul_f32 v148, v148, v121
    v_mul_f32 v149, v149, v121
    v_mfma_f32_16x16x32_bf16 v[196:199], v[80:83], v[68:71], 0
    s_waitcnt lgkmcnt(4)
    ds_read_b128 v[80:83], v248 offset:6144
    v_cvt_pk_bf16_f32 v154, v148, v149
    v_mfma_f32_16x16x32_bf16 v[208:211], v[84:87], v[64:67], 0
    v_mul_f32 v150, v150, v158
    v_mul_f32 v151, v151, v159
    v_mfma_f32_16x16x32_bf16 v[212:215], v[84:87], v[68:71], 0
    s_waitcnt lgkmcnt(4)
    ds_read_b128 v[84:87], v248 offset:7168
    v_mul_f32 v150, v150, v121
    v_mfma_f32_16x16x32_bf16 v[224:227], v[88:91], v[64:67], 0
    v_mul_f32 v151, v151, v121
    v_cvt_pk_bf16_f32 v155, v150, v151
    v_mfma_f32_16x16x32_bf16 v[228:231], v[88:91], v[68:71], 0
    s_waitcnt lgkmcnt(4)
    ds_read_b128 v[88:91], v248 offset:8192
    v_permlane32_swap_b32 v152, v154
    v_mfma_f32_16x16x32_bf16 v[200:203], v[92:95], v[64:67], 0
    v_permlane32_swap_b32 v153, v155
    v_mfma_f32_16x16x32_bf16 v[204:207], v[92:95], v[68:71], 0
    s_waitcnt lgkmcnt(4)
    ds_read_b128 v[92:95], v248 offset:6400
    buffer_store_dwordx4 v[152:155], v250, s[4:7], s73 offen offset:0
    v_mfma_f32_16x16x32_bf16 v[216:219], v[96:99], v[64:67], 0
    v_mul_f32 v160, v160, v168
    v_mul_f32 v161, v161, v169
    v_mfma_f32_16x16x32_bf16 v[220:223], v[96:99], v[68:71], 0
    s_waitcnt lgkmcnt(4)
    ds_read_b128 v[96:99], v248 offset:7424
    v_mul_f32 v160, v160, v120
    v_mfma_f32_16x16x32_bf16 v[232:235], v[100:103], v[64:67], 0
    v_mul_f32 v161, v161, v120
    v_cvt_pk_bf16_f32 v168, v160, v161
    v_mfma_f32_16x16x32_bf16 v[236:239], v[100:103], v[68:71], 0
    s_waitcnt vmcnt(11) lgkmcnt(4)
    ds_read_b128 v[100:103], v248 offset:8448
    buffer_load_dwordx4 v[64:67], v243, s[8:11], s68 offen offset:0 sc1
    v_mfma_f32_16x16x32_bf16 v[192:195], v[80:83], v[72:75], v[192:195]
    v_mul_f32 v162, v162, v170
    v_mul_f32 v163, v163, v171
    v_mfma_f32_16x16x32_bf16 v[196:199], v[80:83], v[76:79], v[196:199]
    s_waitcnt lgkmcnt(4)
    ds_read_b128 v[80:83], v248 offset:12288
    v_mul_f32 v162, v162, v120
    v_mfma_f32_16x16x32_bf16 v[208:211], v[84:87], v[72:75], v[208:211]
    v_mul_f32 v163, v163, v120
    v_cvt_pk_bf16_f32 v169, v162, v163
    v_mfma_f32_16x16x32_bf16 v[212:215], v[84:87], v[76:79], v[212:215]
    s_waitcnt lgkmcnt(4)
    ds_read_b128 v[84:87], v248 offset:13312
    buffer_load_dwordx4 v[68:71], v243, s[8:11], s68 offen offset:1024 sc1
    v_mfma_f32_16x16x32_bf16 v[224:227], v[88:91], v[72:75], v[224:227]
    v_mul_f32 v164, v164, v172
    v_mul_f32 v165, v165, v173
    v_mfma_f32_16x16x32_bf16 v[228:231], v[88:91], v[76:79], v[228:231]
    s_waitcnt lgkmcnt(4)
    ds_read_b128 v[88:91], v248 offset:14336
    v_mul_f32 v164, v164, v121
    v_mfma_f32_16x16x32_bf16 v[200:203], v[92:95], v[72:75], v[200:203]
    v_mul_f32 v165, v165, v121
    v_cvt_pk_bf16_f32 v170, v164, v165
    v_mfma_f32_16x16x32_bf16 v[204:207], v[92:95], v[76:79], v[204:207]
    s_waitcnt lgkmcnt(4)
    ds_read_b128 v[92:95], v248 offset:12544
    v_mul_f32 v166, v166, v174
    v_mfma_f32_16x16x32_bf16 v[216:219], v[96:99], v[72:75], v[216:219]
    v_mul_f32 v167, v167, v175
    v_mul_f32 v166, v166, v121
    v_mfma_f32_16x16x32_bf16 v[220:223], v[96:99], v[76:79], v[220:223]
    s_waitcnt lgkmcnt(4)
    ds_read_b128 v[96:99], v248 offset:13568
    v_mul_f32 v167, v167, v121
    v_mfma_f32_16x16x32_bf16 v[232:235], v[100:103], v[72:75], v[232:235]
    v_cvt_pk_bf16_f32 v171, v166, v167
    v_permlane32_swap_b32 v168, v170
    v_mfma_f32_16x16x32_bf16 v[236:239], v[100:103], v[76:79], v[236:239]
    s_waitcnt vmcnt(11) lgkmcnt(4)
    ds_read_b128 v[100:103], v248 offset:14592
    buffer_load_dwordx4 v[72:75], v243, s[8:11], s68 offen offset:2048 sc1
    v_mfma_f32_16x16x32_bf16 v[192:195], v[80:83], v[32:35], v[192:195]
    v_permlane32_swap_b32 v169, v171
    v_mfma_f32_16x16x32_bf16 v[196:199], v[80:83], v[36:39], v[196:199]
    s_waitcnt lgkmcnt(4)
    ds_read_b128 v[80:83], v248 offset:18432
    buffer_store_dwordx4 v[168:171], v251, s[4:7], s73 offen offset:512
    v_mfma_f32_16x16x32_bf16 v[208:211], v[84:87], v[32:35], v[208:211]
    v_mul_f32 v176, v176, v184
    v_mul_f32 v177, v177, v185
    v_mfma_f32_16x16x32_bf16 v[212:215], v[84:87], v[36:39], v[212:215]
    s_waitcnt lgkmcnt(4)
    ds_read_b128 v[84:87], v248 offset:19456
    buffer_load_dwordx4 v[76:79], v243, s[8:11], s68 offen offset:3072 sc1
    v_mfma_f32_16x16x32_bf16 v[224:227], v[88:91], v[32:35], v[224:227]
    v_mul_f32 v176, v176, v120
    v_mul_f32 v177, v177, v120
    v_mfma_f32_16x16x32_bf16 v[228:231], v[88:91], v[36:39], v[228:231]
    s_waitcnt lgkmcnt(4)
    ds_read_b128 v[88:91], v248 offset:20480
    v_cvt_pk_bf16_f32 v184, v176, v177
    v_mfma_f32_16x16x32_bf16 v[200:203], v[92:95], v[32:35], v[200:203]
    v_mul_f32 v178, v178, v186
    v_mul_f32 v179, v179, v187
    v_mfma_f32_16x16x32_bf16 v[204:207], v[92:95], v[36:39], v[204:207]
    s_waitcnt lgkmcnt(4)
    ds_read_b128 v[92:95], v248 offset:18688
    v_mul_f32 v178, v178, v120
    v_mfma_f32_16x16x32_bf16 v[216:219], v[96:99], v[32:35], v[216:219]
    v_mul_f32 v179, v179, v120
    v_cvt_pk_bf16_f32 v185, v178, v179
    v_mfma_f32_16x16x32_bf16 v[220:223], v[96:99], v[36:39], v[220:223]
    s_waitcnt lgkmcnt(4)
    ds_read_b128 v[96:99], v248 offset:19712
    v_mul_f32 v180, v180, v188
    v_mfma_f32_16x16x32_bf16 v[232:235], v[100:103], v[32:35], v[232:235]
    v_mul_f32 v181, v181, v189
    v_mul_f32 v180, v180, v121
    v_mfma_f32_16x16x32_bf16 v[236:239], v[100:103], v[36:39], v[236:239]
    s_waitcnt vmcnt(12) lgkmcnt(4)
    ds_read_b128 v[100:103], v248 offset:20736
    buffer_load_dwordx4 v[32:35], v244, s[8:11], s68 offen offset:0 sc1
    v_mfma_f32_16x16x32_bf16 v[192:195], v[80:83], v[40:43], v[192:195]
    v_mul_f32 v181, v181, v121
    v_cvt_pk_bf16_f32 v186, v180, v181
    v_mfma_f32_16x16x32_bf16 v[196:199], v[80:83], v[44:47], v[196:199]
    s_waitcnt lgkmcnt(4)
    ds_read_b128 v[80:83], v248 offset:24576
    v_mul_f32 v182, v182, v190
    v_mfma_f32_16x16x32_bf16 v[208:211], v[84:87], v[40:43], v[208:211]
    v_mul_f32 v183, v183, v191
    v_mul_f32 v182, v182, v121
    v_mfma_f32_16x16x32_bf16 v[212:215], v[84:87], v[44:47], v[212:215]
    s_waitcnt lgkmcnt(4)
    ds_read_b128 v[84:87], v248 offset:25600
    buffer_load_dwordx4 v[36:39], v244, s[8:11], s68 offen offset:1024 sc1
    v_mfma_f32_16x16x32_bf16 v[224:227], v[88:91], v[40:43], v[224:227]
    v_mul_f32 v183, v183, v121
    v_cvt_pk_bf16_f32 v187, v182, v183
    v_mfma_f32_16x16x32_bf16 v[228:231], v[88:91], v[44:47], v[228:231]
    s_waitcnt lgkmcnt(4)
    ds_read_b128 v[88:91], v248 offset:26624
    v_permlane32_swap_b32 v184, v186
    v_mfma_f32_16x16x32_bf16 v[200:203], v[92:95], v[40:43], v[200:203]
    v_permlane32_swap_b32 v185, v187
    v_mfma_f32_16x16x32_bf16 v[204:207], v[92:95], v[44:47], v[204:207]
    s_waitcnt lgkmcnt(4)
    ds_read_b128 v[92:95], v248 offset:24832
    buffer_store_dwordx4 v[184:187], v125, s[4:7], s73 offen offset:2048
    v_mfma_f32_16x16x32_bf16 v[216:219], v[96:99], v[40:43], v[216:219]
    s_barrier
    v_mfma_f32_16x16x32_bf16 v[220:223], v[96:99], v[44:47], v[220:223]
    s_waitcnt vmcnt(13) lgkmcnt(4)
    ds_read_b128 v[96:99], v248 offset:25856
    v_add_f32 v112, v112, v114
    v_mfma_f32_16x16x32_bf16 v[232:235], v[100:103], v[40:43], v[232:235]
    v_add_f32 v113, v113, v115
    v_add_f32 v116, v116, v118
    v_mfma_f32_16x16x32_bf16 v[236:239], v[100:103], v[44:47], v[236:239]
    s_waitcnt vmcnt(11) lgkmcnt(4)
    ds_read_b128 v[100:103], v248 offset:26880
    buffer_load_dwordx4 v[40:43], v244, s[8:11], s68 offen offset:2048 sc1
    v_mfma_f32_16x16x32_bf16 v[192:195], v[80:83], v[48:51], v[192:195]
    v_add_f32 v117, v117, v119
    v_add_f32 v112, v112, v116
    v_mfma_f32_16x16x32_bf16 v[196:199], v[80:83], v[52:55], v[196:199]
    s_waitcnt lgkmcnt(4)
    ds_read_b128 v[80:83], v248 offset:30720
    v_add_f32 v113, v113, v117
    v_mfma_f32_16x16x32_bf16 v[208:211], v[84:87], v[48:51], v[208:211]
    s_nop 0
    v_permlane32_swap_b32 v112, v113
    v_add_f32 v112, v112, v113
    v_mfma_f32_16x16x32_bf16 v[212:215], v[84:87], v[52:55], v[212:215]
    s_waitcnt lgkmcnt(4)
    ds_read_b128 v[84:87], v248 offset:31744
    buffer_load_dwordx4 v[44:47], v244, s[8:11], s68 offen offset:3072 sc1
    v_mfma_f32_16x16x32_bf16 v[224:227], v[88:91], v[48:51], v[224:227]
    v_mul_f32 v112, 0x3b000000, v112
    v_mov_b32 v113, v112
    v_mfma_f32_16x16x32_bf16 v[228:231], v[88:91], v[52:55], v[228:231]
    s_waitcnt lgkmcnt(4)
    ds_read_b128 v[88:91], v248 offset:32768
    v_permlane32_swap_b32 v112, v113
    v_mfma_f32_16x16x32_bf16 v[200:203], v[92:95], v[48:51], v[200:203]
    v_fma_f32 v113, -v112, v112, v113
    v_max_f32 v113, 0, v113
    v_mfma_f32_16x16x32_bf16 v[204:207], v[92:95], v[52:55], v[204:207]
    s_waitcnt lgkmcnt(4)
    ds_read_b128 v[92:95], v248 offset:30976
    v_add_f32 v113, 0x3727c5ac, v113
    v_mfma_f32_16x16x32_bf16 v[216:219], v[96:99], v[48:51], v[216:219]
    v_rsq_f32 v122, v113
    v_mfma_f32_16x16x32_bf16 v[220:223], v[96:99], v[52:55], v[220:223]
    s_waitcnt lgkmcnt(4)
    ds_read_b128 v[96:99], v248 offset:32000
    v_cvt_pk_bf16_f32 v114, -v112, -v112
    v_mfma_f32_16x16x32_bf16 v[232:235], v[100:103], v[48:51], v[232:235]
    v_and_b32 v115, 0xffff0000, v114
    v_sub_f32 v115, -v112, v115
    v_mfma_f32_16x16x32_bf16 v[236:239], v[100:103], v[52:55], v[236:239]
    s_waitcnt vmcnt(11) lgkmcnt(4)
    ds_read_b128 v[100:103], v248 offset:33024
    buffer_load_dwordx4 v[48:51], v245, s[8:11], s68 offen offset:0 sc1
    v_mfma_f32_16x16x32_bf16 v[192:195], v[80:83], v[56:59], v[192:195]
    v_cvt_pk_bf16_f32 v115, v115, v115
    v_cndmask_b32 v124, v115, v114, s[24:25]
    v_mfma_f32_16x16x32_bf16 v[196:199], v[80:83], v[60:63], v[196:199]
    s_waitcnt lgkmcnt(4)
    ds_read_b128 v[80:83], v248 offset:36864
    v_mul_f32 v122, v122, v122
    v_mfma_f32_16x16x32_bf16 v[208:211], v[84:87], v[56:59], v[208:211]
    v_mov_b32 v113, v124
    v_mov_b32 v115, 0
    v_mfma_f32_16x16x32_bf16 v[212:215], v[84:87], v[60:63], v[212:215]
    s_waitcnt lgkmcnt(4)
    ds_read_b128 v[84:87], v248 offset:37888
    buffer_load_dwordx4 v[52:55], v245, s[8:11], s68 offen offset:1024 sc1
    v_mfma_f32_16x16x32_bf16 v[224:227], v[88:91], v[56:59], v[224:227]
    v_mov_b32 v123, v122
    v_mov_b32 v117, 0
    v_mfma_f32_16x16x32_bf16 v[228:231], v[88:91], v[60:63], v[228:231]
    s_waitcnt lgkmcnt(4)
    ds_read_b128 v[88:91], v248 offset:38912
    v_mov_b32 v119, v124
    v_mfma_f32_16x16x32_bf16 v[200:203], v[92:95], v[56:59], v[200:203]
    v_permlane16_swap_b32 v113, v115
    v_mov_b32 v112, 0
    v_mfma_f32_16x16x32_bf16 v[204:207], v[92:95], v[60:63], v[204:207]
    s_waitcnt lgkmcnt(4)
    ds_read_b128 v[92:95], v248 offset:37120
    v_permlane16_swap_b32 v122, v123
    v_mfma_f32_16x16x32_bf16 v[216:219], v[96:99], v[56:59], v[216:219]
    v_permlane16_swap_b32 v117, v119
    v_mov_b32 v114, 0
    v_mfma_f32_16x16x32_bf16 v[220:223], v[96:99], v[60:63], v[220:223]
    s_waitcnt lgkmcnt(4)
    ds_read_b128 v[96:99], v248 offset:38144
    v_mov_b32 v116, 0
    v_mfma_f32_16x16x32_bf16 v[232:235], v[100:103], v[56:59], v[232:235]
    v_mov_b32 v118, 0
    v_mfma_f32_16x16x32_bf16 v[236:239], v[100:103], v[60:63], v[236:239]
    s_waitcnt vmcnt(10) lgkmcnt(4)
    ds_read_b128 v[100:103], v248 offset:39168
    buffer_load_dwordx4 v[56:59], v245, s[8:11], s68 offen offset:2048 sc1
    v_mfma_f32_16x16x32_bf16 v[192:195], v[80:83], v[64:67], v[192:195]
    v_mfma_f32_16x16x32_bf16 v[196:199], v[80:83], v[68:71], v[196:199]
    s_waitcnt vmcnt(5) lgkmcnt(4)
    ds_read_b128 v[80:83], v248 offset:43008
    v_mfma_f32_16x16x32_bf16 v[208:211], v[84:87], v[64:67], v[208:211]
    s_cbranch_vccnz SAFE_114
    buffer_store_dword v11, v10, s[4:7], s75 offen offset:2048
BACK_115:
    v_mfma_f32_16x16x32_bf16 v[212:215], v[84:87], v[68:71], v[212:215]
    s_waitcnt lgkmcnt(4)
    ds_read_b128 v[84:87], v248 offset:44032
    buffer_load_dwordx4 v[60:63], v245, s[8:11], s68 offen offset:3072 sc1
    v_mfma_f32_16x16x32_bf16 v[224:227], v[88:91], v[64:67], v[224:227]
    v_mfma_f32_16x16x32_bf16 v[228:231], v[88:91], v[68:71], v[228:231]
    s_waitcnt lgkmcnt(4)
    ds_read_b128 v[88:91], v248 offset:45056
    v_mfma_f32_16x16x32_bf16 v[200:203], v[92:95], v[64:67], v[200:203]
    v_mfma_f32_16x16x32_bf16 v[204:207], v[92:95], v[68:71], v[204:207]
    s_waitcnt lgkmcnt(4)
    ds_read_b128 v[92:95], v248 offset:43264
    v_mfma_f32_16x16x32_bf16 v[216:219], v[96:99], v[64:67], v[216:219]
    v_mfma_f32_16x16x32_bf16 v[220:223], v[96:99], v[68:71], v[220:223]
    s_waitcnt lgkmcnt(4)
    ds_read_b128 v[96:99], v248 offset:44288
    v_mfma_f32_16x16x32_bf16 v[232:235], v[100:103], v[64:67], v[232:235]
    v_mfma_f32_16x16x32_bf16 v[236:239], v[100:103], v[68:71], v[236:239]
    s_waitcnt lgkmcnt(4)
    ds_read_b128 v[100:103], v248 offset:45312
    buffer_load_dwordx4 v[64:67], v246, s[8:11], s68 offen offset:0 sc1
    v_mfma_f32_16x16x32_bf16 v[192:195], v[80:83], v[72:75], v[192:195]
    v_mfma_f32_16x16x32_bf16 v[196:199], v[80:83], v[76:79], v[196:199]
    s_waitcnt lgkmcnt(4)
    ds_read_b128 v[80:83], v248 offset:49152
    v_mfma_f32_16x16x32_bf16 v[208:211], v[84:87], v[72:75], v[208:211]
    v_mfma_f32_16x16x32_bf16 v[212:215], v[84:87], v[76:79], v[212:215]
    s_waitcnt lgkmcnt(4)
    ds_read_b128 v[84:87], v248 offset:50176
    buffer_load_dwordx4 v[68:71], v246, s[8:11], s68 offen offset:1024 sc1
    v_mfma_f32_16x16x32_bf16 v[224:227], v[88:91], v[72:75], v[224:227]
    v_mfma_f32_16x16x32_bf16 v[228:231], v[88:91], v[76:79], v[228:231]
    s_waitcnt lgkmcnt(4)
    ds_read_b128 v[88:91], v248 offset:51200
    v_mfma_f32_16x16x32_bf16 v[200:203], v[92:95], v[72:75], v[200:203]
    v_mfma_f32_16x16x32_bf16 v[204:207], v[92:95], v[76:79], v[204:207]
    s_waitcnt lgkmcnt(4)
    ds_read_b128 v[92:95], v248 offset:49408
    v_mfma_f32_16x16x32_bf16 v[216:219], v[96:99], v[72:75], v[216:219]
    v_mfma_f32_16x16x32_bf16 v[220:223], v[96:99], v[76:79], v[220:223]
    s_waitcnt lgkmcnt(4)
    ds_read_b128 v[96:99], v248 offset:50432
    v_mfma_f32_16x16x32_bf16 v[232:235], v[100:103], v[72:75], v[232:235]
    v_mfma_f32_16x16x32_bf16 v[236:239], v[100:103], v[76:79], v[236:239]
    s_waitcnt lgkmcnt(4)
    ds_read_b128 v[100:103], v248 offset:51456
    buffer_load_dwordx4 v[72:75], v246, s[8:11], s68 offen offset:2048 sc1
    v_mfma_f32_16x16x32_bf16 v[192:195], v[80:83], v[32:35], v[192:195]
    v_mfma_f32_16x16x32_bf16 v[196:199], v[80:83], v[36:39], v[196:199]
    s_waitcnt lgkmcnt(4)
    ds_read_b128 v[80:83], v248 offset:55296
    v_mfma_f32_16x16x32_bf16 v[208:211], v[84:87], v[32:35], v[208:211]
    v_mfma_f32_16x16x32_bf16 v[212:215], v[84:87], v[36:39], v[212:215]
    s_waitcnt lgkmcnt(4)
    ds_read_b128 v[84:87], v248 offset:56320
    buffer_load_dwordx4 v[76:79], v246, s[8:11], s68 offen offset:3072 sc1
    v_mfma_f32_16x16x32_bf16 v[224:227], v[88:91], v[32:35], v[224:227]
    v_mfma_f32_16x16x32_bf16 v[228:231], v[88:91], v[36:39], v[228:231]
    s_waitcnt lgkmcnt(4)
    ds_read_b128 v[88:91], v248 offset:57344
    v_mfma_f32_16x16x32_bf16 v[200:203], v[92:95], v[32:35], v[200:203]
    v_mfma_f32_16x16x32_bf16 v[204:207], v[92:95], v[36:39], v[204:207]
    s_waitcnt lgkmcnt(4)
    ds_read_b128 v[92:95], v248 offset:55552
    v_mfma_f32_16x16x32_bf16 v[216:219], v[96:99], v[32:35], v[216:219]
    v_mfma_f32_16x16x32_bf16 v[220:223], v[96:99], v[36:39], v[220:223]
    s_waitcnt lgkmcnt(4)
    ds_read_b128 v[96:99], v248 offset:56576
    v_mfma_f32_16x16x32_bf16 v[232:235], v[100:103], v[32:35], v[232:235]
    v_mfma_f32_16x16x32_bf16 v[236:239], v[100:103], v[36:39], v[236:239]
    s_waitcnt vmcnt(9) lgkmcnt(4)
    ds_read_b128 v[100:103], v248 offset:57600
    buffer_load_dwordx4 v[32:35], v247, s[8:11], s68 offen offset:0 sc1
    v_mfma_f32_16x16x32_bf16 v[192:195], v[80:83], v[40:43], v[192:195]
    v_mfma_f32_16x16x32_bf16 v[196:199], v[80:83], v[44:47], v[196:199]
    s_waitcnt lgkmcnt(4)
    ds_read_b128 v[80:83], v249 offset:0
    v_mfma_f32_16x16x32_bf16 v[208:211], v[84:87], v[40:43], v[208:211]
    v_mfma_f32_16x16x32_bf16 v[212:215], v[84:87], v[44:47], v[212:215]
    s_waitcnt lgkmcnt(4)
    ds_read_b128 v[84:87], v249 offset:1024
    buffer_load_dwordx4 v[36:39], v247, s[8:11], s68 offen offset:1024 sc1
    v_mfma_f32_16x16x32_bf16 v[224:227], v[88:91], v[40:43], v[224:227]
    v_mfma_f32_16x16x32_bf16 v[228:231], v[88:91], v[44:47], v[228:231]
    s_waitcnt lgkmcnt(4)
    ds_read_b128 v[88:91], v249 offset:2048
    v_mfma_f32_16x16x32_bf16 v[200:203], v[92:95], v[40:43], v[200:203]
    v_mfma_f32_16x16x32_bf16 v[204:207], v[92:95], v[44:47], v[204:207]
    s_waitcnt lgkmcnt(4)
    ds_read_b128 v[92:95], v249 offset:256
    v_mfma_f32_16x16x32_bf16 v[216:219], v[96:99], v[40:43], v[216:219]
    v_mfma_f32_16x16x32_bf16 v[220:223], v[96:99], v[44:47], v[220:223]
    s_waitcnt lgkmcnt(4)
    ds_read_b128 v[96:99], v249 offset:1280
    buffer_load_dword v14, v9, s[4:7], s79 offen offset:2048 sc1
    v_mfma_f32_16x16x32_bf16 v[232:235], v[100:103], v[40:43], v[232:235]
    v_mfma_f32_16x16x32_bf16 v[236:239], v[100:103], v[44:47], v[236:239]
    s_waitcnt vmcnt(10) lgkmcnt(4)
    ds_read_b128 v[100:103], v249 offset:2304
    buffer_load_dwordx4 v[40:43], v247, s[8:11], s68 offen offset:2048 sc1
    v_mfma_f32_16x16x32_bf16 v[192:195], v[80:83], v[48:51], v[192:195]
    v_mfma_f32_16x16x32_bf16 v[196:199], v[80:83], v[52:55], v[196:199]
    s_waitcnt lgkmcnt(4)
    ds_read_b128 v[80:83], v249 offset:6144
    v_mfma_f32_16x16x32_bf16 v[208:211], v[84:87], v[48:51], v[208:211]
    v_mfma_f32_16x16x32_bf16 v[212:215], v[84:87], v[52:55], v[212:215]
    s_waitcnt lgkmcnt(4)
    ds_read_b128 v[84:87], v249 offset:7168
    buffer_load_dwordx4 v[44:47], v247, s[8:11], s68 offen offset:3072 sc1
    v_mfma_f32_16x16x32_bf16 v[224:227], v[88:91], v[48:51], v[224:227]
    v_mfma_f32_16x16x32_bf16 v[228:231], v[88:91], v[52:55], v[228:231]
    s_waitcnt lgkmcnt(4)
    ds_read_b128 v[88:91], v249 offset:8192
    v_mfma_f32_16x16x32_bf16 v[200:203], v[92:95], v[48:51], v[200:203]
    v_mfma_f32_16x16x32_bf16 v[204:207], v[92:95], v[52:55], v[204:207]
    s_waitcnt lgkmcnt(4)
    ds_read_b128 v[92:95], v249 offset:6400
    v_mfma_f32_16x16x32_bf16 v[216:219], v[96:99], v[48:51], v[216:219]
    v_mfma_f32_16x16x32_bf16 v[220:223], v[96:99], v[52:55], v[220:223]
    s_waitcnt lgkmcnt(4)
    ds_read_b128 v[96:99], v249 offset:7424
    v_mfma_f32_16x16x32_bf16 v[232:235], v[100:103], v[48:51], v[232:235]
    v_mfma_f32_16x16x32_bf16 v[236:239], v[100:103], v[52:55], v[236:239]
    ds_read_b128 v[100:103], v249 offset:8448
    v_mfma_f32_16x16x16_bf16 v[192:195], v[24:25], v[112:113], v[192:195]
    v_mfma_f32_16x16x16_bf16 v[196:199], v[24:25], v[114:115], v[196:199]
    v_mfma_f32_16x16x16_bf16 v[200:203], v[24:25], v[116:117], v[200:203]
    v_mfma_f32_16x16x16_bf16 v[204:207], v[24:25], v[118:119], v[204:207]
    s_waitcnt vmcnt(2)
    v_cmp_gt_u32 vcc, s34, v14
    s_cbranch_vccnz SPIN_116
BACK_117:
    v_mfma_f32_16x16x16_bf16 v[208:211], v[26:27], v[112:113], v[208:211]
    v_mfma_f32_16x16x16_bf16 v[212:215], v[26:27], v[114:115], v[212:215]
    buffer_load_dwordx4 v[128:131], v16, s[4:7], s77 offen offset:0 sc1
    v_mfma_f32_16x16x16_bf16 v[216:219], v[26:27], v[116:117], v[216:219]
    v_mfma_f32_16x16x16_bf16 v[220:223], v[26:27], v[118:119], v[220:223]
    v_mfma_f32_16x16x16_bf16 v[224:227], v[28:29], v[112:113], v[224:227]
    v_mfma_f32_16x16x16_bf16 v[228:231], v[28:29], v[114:115], v[228:231]
    buffer_load_dwordx4 v[132:135], v16, s[4:7], s77 offen offset:2048 sc1
    v_mfma_f32_16x16x16_bf16 v[232:235], v[28:29], v[116:117], v[232:235]
    v_mfma_f32_16x16x16_bf16 v[236:239], v[28:29], v[118:119], v[236:239]
    s_waitcnt lgkmcnt(5)
    v_mfma_f32_16x16x32_bf16 v[192:195], v[80:83], v[56:59], v[192:195]
    v_mfma_f32_16x16x32_bf16 v[196:199], v[80:83], v[60:63], v[196:199]
    s_waitcnt lgkmcnt(4)
    ds_read_b128 v[80:83], v249 offset:12288
    buffer_load_dwordx4 v[136:139], v17, s[4:7], s77 offen offset:0 sc1
    v_mfma_f32_16x16x32_bf16 v[208:211], v[84:87], v[56:59], v[208:211]
    v_mfma_f32_16x16x32_bf16 v[212:215], v[84:87], v[60:63], v[212:215]
    s_waitcnt lgkmcnt(4)
    ds_read_b128 v[84:87], v249 offset:12544
    v_mfma_f32_16x16x32_bf16 v[224:227], v[88:91], v[56:59], v[224:227]
    v_mfma_f32_16x16x32_bf16 v[228:231], v[88:91], v[60:63], v[228:231]
    s_waitcnt lgkmcnt(4)
    ds_read_b128 v[88:91], v249 offset:18432
    buffer_load_dwordx4 v[140:143], v17, s[4:7], s77 offen offset:2048 sc1
    v_mfma_f32_16x16x32_bf16 v[200:203], v[92:95], v[56:59], v[200:203]
    v_mfma_f32_16x16x32_bf16 v[204:207], v[92:95], v[60:63], v[204:207]
    s_waitcnt lgkmcnt(4)
    ds_read_b128 v[92:95], v249 offset:18688
    v_mfma_f32_16x16x32_bf16 v[216:219], v[96:99], v[56:59], v[216:219]
    v_mfma_f32_16x16x32_bf16 v[220:223], v[96:99], v[60:63], v[220:223]
    s_waitcnt lgkmcnt(4)
    ds_read_b128 v[96:99], v249 offset:24576
    buffer_load_dwordx4 v[144:147], v18, s[4:7], s77 offen offset:0 sc1
    v_mfma_f32_16x16x32_bf16 v[232:235], v[100:103], v[56:59], v[232:235]
    v_mfma_f32_16x16x32_bf16 v[236:239], v[100:103], v[60:63], v[236:239]
    s_waitcnt lgkmcnt(4)
    ds_read_b128 v[100:103], v249 offset:24832
    v_mfma_f32_16x16x32_bf16 v[192:195], v[80:83], v[64:67], v[192:195]
    v_mfma_f32_16x16x32_bf16 v[196:199], v[80:83], v[68:71], v[196:199]
    s_waitcnt lgkmcnt(4)
    ds_read_b128 v[80:83], v249 offset:30720
    buffer_load_dwordx4 v[148:151], v18, s[4:7], s77 offen offset:2048 sc1
    v_mfma_f32_16x16x32_bf16 v[200:203], v[84:87], v[64:67], v[200:203]
    v_mfma_f32_16x16x32_bf16 v[204:207], v[84:87], v[68:71], v[204:207]
    s_waitcnt lgkmcnt(4)
    ds_read_b128 v[84:87], v249 offset:30976
    v_mfma_f32_16x16x32_bf16 v[192:195], v[88:91], v[72:75], v[192:195]
    v_mfma_f32_16x16x32_bf16 v[196:199], v[88:91], v[76:79], v[196:199]
    s_waitcnt lgkmcnt(4)
    ds_read_b128 v[88:91], v249 offset:13312
    buffer_load_dwordx4 v[152:155], v19, s[4:7], s77 offen offset:0 sc1
    v_mfma_f32_16x16x32_bf16 v[200:203], v[92:95], v[72:75], v[200:203]
    v_mfma_f32_16x16x32_bf16 v[204:207], v[92:95], v[76:79], v[204:207]
    s_waitcnt lgkmcnt(4)
    ds_read_b128 v[92:95], v249 offset:13568
    v_mfma_f32_16x16x32_bf16 v[192:195], v[96:99], v[32:35], v[192:195]
    v_mfma_f32_16x16x32_bf16 v[196:199], v[96:99], v[36:39], v[196:199]
    s_waitcnt lgkmcnt(4)
    ds_read_b128 v[96:99], v249 offset:19456
    buffer_load_dwordx4 v[156:159], v19, s[4:7], s77 offen offset:2048 sc1
    v_mfma_f32_16x16x32_bf16 v[200:203], v[100:103], v[32:35], v[200:203]
    v_mfma_f32_16x16x32_bf16 v[204:207], v[100:103], v[36:39], v[204:207]
    s_waitcnt vmcnt(8) lgkmcnt(4)
    ds_read_b128 v[100:103], v249 offset:19712
    v_mfma_f32_16x16x32_bf16 v[192:195], v[80:83], v[40:43], v[192:195]
    v_mfma_f32_16x16x32_bf16 v[196:199], v[80:83], v[44:47], v[196:199]
    s_waitcnt lgkmcnt(4)
    ds_read_b128 v[80:83], v249 offset:25600
    buffer_load_dwordx4 v[160:163], v20, s[4:7], s77 offen offset:0 sc1
    v_mfma_f32_16x16x32_bf16 v[200:203], v[84:87], v[40:43], v[200:203]
    v_mfma_f32_16x16x32_bf16 v[204:207], v[84:87], v[44:47], v[204:207]
    s_waitcnt lgkmcnt(4)
    ds_read_b128 v[84:87], v249 offset:25856
    v_mfma_f32_16x16x32_bf16 v[208:211], v[88:91], v[64:67], v[208:211]
    v_mfma_f32_16x16x32_bf16 v[212:215], v[88:91], v[68:71], v[212:215]
    s_waitcnt lgkmcnt(4)
    ds_read_b128 v[88:91], v249 offset:31744
    buffer_load_dwordx4 v[164:167], v20, s[4:7], s77 offen offset:2048 sc1
    v_mfma_f32_16x16x32_bf16 v[216:219], v[92:95], v[64:67], v[216:219]
    v_mul_f32 v192, v192, v200
    v_mul_f32 v193, v193, v201
    v_mfma_f32_16x16x32_bf16 v[220:223], v[92:95], v[68:71], v[220:223]
    s_waitcnt lgkmcnt(4)
    ds_read_b128 v[92:95], v249 offset:32000
    v_mul_f32 v192, v192, v122
    v_mfma_f32_16x16x32_bf16 v[208:211], v[96:99], v[72:75], v[208:211]
    v_mul_f32 v193, v193, v122
    v_cvt_pk_bf16_f32 v200, v192, v193
    v_mfma_f32_16x16x32_bf16 v[212:215], v[96:99], v[76:79], v[212:215]
    s_waitcnt lgkmcnt(4)
    ds_read_b128 v[96:99], v249 offset:14336
    buffer_load_dwordx4 v[168:171], v21, s[4:7], s77 offen offset:0 sc1
    v_mfma_f32_16x16x32_bf16 v[216:219], v[100:103], v[72:75], v[216:219]
    v_mul_f32 v194, v194, v202
    v_mul_f32 v195, v195, v203
    v_mfma_f32_16x16x32_bf16 v[220:223], v[100:103], v[76:79], v[220:223]
    s_waitcnt lgkmcnt(4)
    ds_read_b128 v[100:103], v249 offset:14592
    v_mul_f32 v194, v194, v122
    v_mfma_f32_16x16x32_bf16 v[208:211], v[80:83], v[32:35], v[208:211]
    v_mul_f32 v195, v195, v122
    v_cvt_pk_bf16_f32 v201, v194, v195
    v_mfma_f32_16x16x32_bf16 v[212:215], v[80:83], v[36:39], v[212:215]
    s_waitcnt lgkmcnt(4)
    ds_read_b128 v[80:83], v249 offset:20480
    buffer_load_dwordx4 v[172:175], v16, s[4:7], s77 offen offset:1024 sc1
    v_mfma_f32_16x16x32_bf16 v[216:219], v[84:87], v[32:35], v[216:219]
    v_mul_f32 v196, v196, v204
    v_mul_f32 v197, v197, v205
    v_mfma_f32_16x16x32_bf16 v[220:223], v[84:87], v[36:39], v[220:223]
    s_waitcnt lgkmcnt(4)
    ds_read_b128 v[84:87], v249 offset:20736
    v_mul_f32 v196, v196, v123
    v_mfma_f32_16x16x32_bf16 v[208:211], v[88:91], v[40:43], v[208:211]
    v_mul_f32 v197, v197, v123
    v_cvt_pk_bf16_f32 v202, v196, v197
    v_mfma_f32_16x16x32_bf16 v[212:215], v[88:91], v[44:47], v[212:215]
    s_waitcnt lgkmcnt(4)
    ds_read_b128 v[88:91], v249 offset:26624
    buffer_load_dwordx4 v[176:179], v16, s[4:7], s77 offen offset:3072 sc1
    v_mfma_f32_16x16x32_bf16 v[216:219], v[92:95], v[40:43], v[216:219]
    v_mul_f32 v198, v198, v206
    v_mul_f32 v199, v199, v207
    v_mfma_f32_16x16x32_bf16 v[220:223], v[92:95], v[44:47], v[220:223]
    s_waitcnt lgkmcnt(4)
    ds_read_b128 v[92:95], v249 offset:26880
    v_mul_f32 v198, v198, v123
    v_mfma_f32_16x16x32_bf16 v[224:227], v[96:99], v[64:67], v[224:227]
    v_mul_f32 v199, v199, v123
    v_cvt_pk_bf16_f32 v203, v198, v199
    v_mfma_f32_16x16x32_bf16 v[228:231], v[96:99], v[68:71], v[228:231]
    s_waitcnt lgkmcnt(4)
    ds_read_b128 v[96:99], v249 offset:32768
    buffer_load_dwordx4 v[180:183], v17, s[4:7], s77 offen offset:1024 sc1
    v_mfma_f32_16x16x32_bf16 v[232:235], v[100:103], v[64:67], v[232:235]
    v_permlane32_swap_b32 v200, v202
    v_permlane32_swap_b32 v201, v203
    v_mfma_f32_16x16x32_bf16 v[236:239], v[100:103], v[68:71], v[236:239]
    s_waitcnt lgkmcnt(4)
    ds_read_b128 v[100:103], v249 offset:33024
    buffer_store_dwordx4 v[200:203], v250, s[4:7], s74 offen offset:0
    v_mfma_f32_16x16x32_bf16 v[224:227], v[80:83], v[72:75], v[224:227]
    v_mul_f32 v208, v208, v216
    v_mul_f32 v209, v209, v217
    v_mfma_f32_16x16x32_bf16 v[228:231], v[80:83], v[76:79], v[228:231]
    s_waitcnt lgkmcnt(4)
    buffer_load_dwordx4 v[184:187], v17, s[4:7], s77 offen offset:3072 sc1
    v_mul_f32 v208, v208, v122
    v_mfma_f32_16x16x32_bf16 v[232:235], v[84:87], v[72:75], v[232:235]
    v_mul_f32 v209, v209, v122
    v_cvt_pk_bf16_f32 v216, v208, v209
    v_mfma_f32_16x16x32_bf16 v[236:239], v[84:87], v[76:79], v[236:239]
    s_waitcnt lgkmcnt(3)
    v_mul_f32 v210, v210, v218
    v_mul_f32 v211, v211, v219
    v_mfma_f32_16x16x32_bf16 v[224:227], v[88:91], v[32:35], v[224:227]
    v_mul_f32 v210, v210, v122
    v_mul_f32 v211, v211, v122
    v_mfma_f32_16x16x32_bf16 v[228:231], v[88:91], v[36:39], v[228:231]
    s_waitcnt lgkmcnt(2)
    buffer_load_dwordx4 v[188:191], v18, s[4:7], s77 offen offset:1024 sc1
    v_cvt_pk_bf16_f32 v217, v210, v211
    v_mfma_f32_16x16x32_bf16 v[232:235], v[92:95], v[32:35], v[232:235]
    v_mul_f32 v212, v212, v220
    v_mul_f32 v213, v213, v221
    v_mfma_f32_16x16x32_bf16 v[236:239], v[92:95], v[36:39], v[236:239]
    s_waitcnt lgkmcnt(1)
    v_mul_f32 v212, v212, v123
    v_mul_f32 v213, v213, v123
    v_mfma_f32_16x16x32_bf16 v[224:227], v[96:99], v[40:43], v[224:227]
    v_cvt_pk_bf16_f32 v218, v212, v213
    v_mul_f32 v214, v214, v222
    v_mfma_f32_16x16x32_bf16 v[228:231], v[96:99], v[44:47], v[228:231]
    s_waitcnt lgkmcnt(0)
    v_mul_f32 v215, v215, v223
    v_mul_f32 v214, v214, v123
    v_mfma_f32_16x16x32_bf16 v[232:235], v[100:103], v[40:43], v[232:235]
    v_mul_f32 v215, v215, v123
    v_cvt_pk_bf16_f32 v219, v214, v215
    v_mfma_f32_16x16x32_bf16 v[236:239], v[100:103], v[44:47], v[236:239]
    v_permlane32_swap_b32 v216, v218
    v_permlane32_swap_b32 v217, v219
    s_waitcnt vmcnt(16)
    v_mfma_f32_16x16x32_bf16 v[48:51], a[0:3], v[128:131], 0
    buffer_store_dwordx4 v[216:219], v251, s[4:7], s74 offen offset:512
    v_mfma_f32_16x16x32_bf16 v[56:59], a[4:7], v[128:131], 0
    v_mul_f32 v224, v224, v232
    v_mul_f32 v225, v225, v233
    v_mfma_f32_16x16x32_bf16 v[64:67], a[8:11], v[128:131], 0
    v_mul_f32 v224, v224, v122
    v_mul_f32 v225, v225, v122
    v_mfma_f32_16x16x32_bf16 v[72:75], a[12:15], v[128:131], 0
    s_waitcnt vmcnt(16)
    buffer_load_dwordx4 v[128:131], v18, s[4:7], s77 offen offset:3072 sc1
    v_cvt_pk_bf16_f32 v232, v224, v225
    v_mfma_f32_16x16x32_bf16 v[48:51], a[16:19], v[132:135], v[48:51]
    v_mul_f32 v226, v226, v234
    v_mul_f32 v227, v227, v235
    v_mfma_f32_16x16x32_bf16 v[56:59], a[20:23], v[132:135], v[56:59]
    v_mul_f32 v226, v226, v122
    v_mul_f32 v227, v227, v122
    v_mfma_f32_16x16x32_bf16 v[64:67], a[24:27], v[132:135], v[64:67]
    v_cvt_pk_bf16_f32 v233, v226, v227
    v_mul_f32 v228, v228, v236
    v_mfma_f32_16x16x32_bf16 v[72:75], a[28:31], v[132:135], v[72:75]
    s_waitcnt vmcnt(16)
    buffer_load_dwordx4 v[132:135], v19, s[4:7], s77 offen offset:1024 sc1
    v_mul_f32 v229, v229, v237
    v_mfma_f32_16x16x32_bf16 v[48:51], a[32:35], v[136:139], v[48:51]
    v_mul_f32 v228, v228, v123
    v_mul_f32 v229, v229, v123
    v_mfma_f32_16x16x32_bf16 v[56:59], a[36:39], v[136:139], v[56:59]
    v_cvt_pk_bf16_f32 v234, v228, v229
    v_mul_f32 v230, v230, v238
    v_mfma_f32_16x16x32_bf16 v[64:67], a[40:43], v[136:139], v[64:67]
    v_mul_f32 v231, v231, v239
    v_mul_f32 v230, v230, v123
    v_mfma_f32_16x16x32_bf16 v[72:75], a[44:47], v[136:139], v[72:75]
    s_waitcnt vmcnt(16)
    buffer_load_dwordx4 v[136:139], v19, s[4:7], s77 offen offset:3072 sc1
    v_mul_f32 v231, v231, v123
    v_mfma_f32_16x16x32_bf16 v[48:51], a[48:51], v[140:143], v[48:51]
    v_cvt_pk_bf16_f32 v235, v230, v231
    v_permlane32_swap_b32 v232, v234
    v_mfma_f32_16x16x32_bf16 v[56:59], a[52:55], v[140:143], v[56:59]
    v_permlane32_swap_b32 v233, v235
    v_mfma_f32_16x16x32_bf16 v[64:67], a[56:59], v[140:143], v[64:67]
    buffer_store_dwordx4 v[232:235], v125, s[4:7], s74 offen offset:2048
    v_mfma_f32_16x16x32_bf16 v[72:75], a[60:63], v[140:143], v[72:75]
    s_waitcnt vmcnt(17)
    buffer_load_dwordx4 v[140:143], v20, s[4:7], s77 offen offset:1024 sc1
    v_mfma_f32_16x16x32_bf16 v[48:51], a[64:67], v[144:147], v[48:51]
    v_mfma_f32_16x16x32_bf16 v[56:59], a[68:71], v[144:147], v[56:59]
    v_mfma_f32_16x16x32_bf16 v[64:67], a[72:75], v[144:147], v[64:67]
    v_mfma_f32_16x16x32_bf16 v[72:75], a[76:79], v[144:147], v[72:75]
    s_waitcnt vmcnt(17)
    buffer_load_dwordx4 v[144:147], v20, s[4:7], s77 offen offset:3072 sc1
    v_mfma_f32_16x16x32_bf16 v[48:51], a[80:83], v[148:151], v[48:51]
    v_mfma_f32_16x16x32_bf16 v[56:59], a[84:87], v[148:151], v[56:59]
    v_mfma_f32_16x16x32_bf16 v[64:67], a[88:91], v[148:151], v[64:67]
    v_mfma_f32_16x16x32_bf16 v[72:75], a[92:95], v[148:151], v[72:75]
    s_waitcnt vmcnt(17)
    buffer_load_dwordx4 v[148:151], v21, s[4:7], s77 offen offset:1024 sc1
    v_mfma_f32_16x16x32_bf16 v[48:51], a[96:99], v[152:155], v[48:51]
    v_mfma_f32_16x16x32_bf16 v[56:59], a[100:103], v[152:155], v[56:59]
    v_mfma_f32_16x16x32_bf16 v[64:67], a[104:107], v[152:155], v[64:67]
    v_mfma_f32_16x16x32_bf16 v[72:75], a[108:111], v[152:155], v[72:75]
    s_waitcnt vmcnt(17)
    v_mfma_f32_16x16x32_bf16 v[48:51], a[112:115], v[156:159], v[48:51]
    v_mfma_f32_16x16x32_bf16 v[56:59], a[116:119], v[156:159], v[56:59]
    v_mfma_f32_16x16x32_bf16 v[64:67], a[120:123], v[156:159], v[64:67]
    v_mfma_f32_16x16x32_bf16 v[72:75], a[124:127], v[156:159], v[72:75]
    s_waitcnt vmcnt(16)
    v_mfma_f32_16x16x32_bf16 v[48:51], a[128:131], v[160:163], v[48:51]
    v_mfma_f32_16x16x32_bf16 v[56:59], a[132:135], v[160:163], v[56:59]
    s_waitcnt vmcnt(3)
    s_cbranch_vccnz SAFE_119
    buffer_store_dword v11, v10, s[4:7], s76 offen offset:2048
BACK_120:
    v_mfma_f32_16x16x32_bf16 v[64:67], a[136:139], v[160:163], v[64:67]
    v_mfma_f32_16x16x32_bf16 v[72:75], a[140:143], v[160:163], v[72:75]
    v_mfma_f32_16x16x32_bf16 v[48:51], a[144:147], v[164:167], v[48:51]
    v_mfma_f32_16x16x32_bf16 v[56:59], a[148:151], v[164:167], v[56:59]
    v_mfma_f32_16x16x32_bf16 v[64:67], a[152:155], v[164:167], v[64:67]
    v_mfma_f32_16x16x32_bf16 v[72:75], a[156:159], v[164:167], v[72:75]
    v_mfma_f32_16x16x32_bf16 v[48:51], a[160:163], v[168:171], v[48:51]
    v_mfma_f32_16x16x32_bf16 v[56:59], a[164:167], v[168:171], v[56:59]
    v_mfma_f32_16x16x32_bf16 v[64:67], a[168:171], v[168:171], v[64:67]
    v_mfma_f32_16x16x32_bf16 v[72:75], a[172:175], v[168:171], v[72:75]
    v_mfma_f32_16x16x32_bf16 v[52:55], a[0:3], v[172:175], 0
    v_mfma_f32_16x16x32_bf16 v[60:63], a[4:7], v[172:175], 0
    v_mfma_f32_16x16x32_bf16 v[68:71], a[8:11], v[172:175], 0
    v_mfma_f32_16x16x32_bf16 v[76:79], a[12:15], v[172:175], 0
    v_mfma_f32_16x16x32_bf16 v[52:55], a[16:19], v[176:179], v[52:55]
    v_mfma_f32_16x16x32_bf16 v[60:63], a[20:23], v[176:179], v[60:63]
    ds_write_b128 v5, v[48:51] offset:0
    v_mfma_f32_16x16x32_bf16 v[68:71], a[24:27], v[176:179], v[68:71]
    v_mfma_f32_16x16x32_bf16 v[76:79], a[28:31], v[176:179], v[76:79]
    v_mfma_f32_16x16x32_bf16 v[52:55], a[32:35], v[180:183], v[52:55]
    v_mfma_f32_16x16x32_bf16 v[60:63], a[36:39], v[180:183], v[60:63]
    ds_write_b128 v5, v[56:59] offset:2048
    v_mfma_f32_16x16x32_bf16 v[68:71], a[40:43], v[180:183], v[68:71]
    v_mfma_f32_16x16x32_bf16 v[76:79], a[44:47], v[180:183], v[76:79]
    v_mfma_f32_16x16x32_bf16 v[52:55], a[48:51], v[184:187], v[52:55]
    v_mfma_f32_16x16x32_bf16 v[60:63], a[52:55], v[184:187], v[60:63]
    buffer_load_dword v14, v9, s[4:7], s80 offen offset:2048 sc1
    ds_write_b128 v5, v[64:67] offset:4096
    v_mfma_f32_16x16x32_bf16 v[68:71], a[56:59], v[184:187], v[68:71]
    v_mfma_f32_16x16x32_bf16 v[76:79], a[60:63], v[184:187], v[76:79]
    v_mfma_f32_16x16x32_bf16 v[52:55], a[64:67], v[188:191], v[52:55]
    v_mfma_f32_16x16x32_bf16 v[60:63], a[68:71], v[188:191], v[60:63]
    ds_write_b128 v5, v[72:75] offset:6144
    v_mfma_f32_16x16x32_bf16 v[68:71], a[72:75], v[188:191], v[68:71]
    v_mfma_f32_16x16x32_bf16 v[76:79], a[76:79], v[188:191], v[76:79]
    v_mfma_f32_16x16x32_bf16 v[52:55], a[80:83], v[128:131], v[52:55]
    v_mfma_f32_16x16x32_bf16 v[60:63], a[84:87], v[128:131], v[60:63]
    v_mfma_f32_16x16x32_bf16 v[68:71], a[88:91], v[128:131], v[68:71]
    v_mfma_f32_16x16x32_bf16 v[76:79], a[92:95], v[128:131], v[76:79]
    v_mfma_f32_16x16x32_bf16 v[52:55], a[96:99], v[132:135], v[52:55]
    v_mfma_f32_16x16x32_bf16 v[60:63], a[100:103], v[132:135], v[60:63]
    v_mfma_f32_16x16x32_bf16 v[68:71], a[104:107], v[132:135], v[68:71]
    v_mfma_f32_16x16x32_bf16 v[76:79], a[108:111], v[132:135], v[76:79]
    s_branch PJ_124
.p2align 12
PJ_124:
    v_mfma_f32_16x16x32_bf16 v[52:55], a[112:115], v[136:139], v[52:55]
    v_mfma_f32_16x16x32_bf16 v[60:63], a[116:119], v[136:139], v[60:63]
    s_waitcnt vmcnt(0)
    v_cmp_gt_u32 vcc, s34, v14
    s_cbranch_vccnz SPIN_121
BACK_122:
    v_mfma_f32_16x16x32_bf16 v[68:71], a[120:123], v[136:139], v[68:71]
    buffer_load_dwordx4 v[152:155], v16, s[4:7], s78 offen offset:0 sc1
    v_mfma_f32_16x16x32_bf16 v[76:79], a[124:127], v[136:139], v[76:79]
    buffer_load_dwordx4 v[156:159], v16, s[4:7], s78 offen offset:2048 sc1
    v_mfma_f32_16x16x32_bf16 v[52:55], a[128:131], v[140:143], v[52:55]
    buffer_load_dwordx4 v[160:163], v17, s[4:7], s78 offen offset:0 sc1
    v_mfma_f32_16x16x32_bf16 v[60:63], a[132:135], v[140:143], v[60:63]
    buffer_load_dwordx4 v[164:167], v17, s[4:7], s78 offen offset:2048 sc1
    v_mfma_f32_16x16x32_bf16 v[68:71], a[136:139], v[140:143], v[68:71]
    buffer_load_dwordx4 v[168:171], v18, s[4:7], s78 offen offset:0 sc1
    v_mfma_f32_16x16x32_bf16 v[76:79], a[140:143], v[140:143], v[76:79]
    buffer_load_dwordx4 v[172:175], v18, s[4:7], s78 offen offset:2048 sc1
    v_mfma_f32_16x16x32_bf16 v[52:55], a[144:147], v[144:147], v[52:55]
    buffer_load_dwordx4 v[176:179], v19, s[4:7], s78 offen offset:0 sc1
    v_mfma_f32_16x16x32_bf16 v[60:63], a[148:151], v[144:147], v[60:63]
    buffer_load_dwordx4 v[180:183], v19, s[4:7], s78 offen offset:2048 sc1
    v_mfma_f32_16x16x32_bf16 v[68:71], a[152:155], v[144:147], v[68:71]
    buffer_load_dwordx4 v[184:187], v20, s[4:7], s78 offen offset:0 sc1
    v_mfma_f32_16x16x32_bf16 v[76:79], a[156:159], v[144:147], v[76:79]
    buffer_load_dwordx4 v[188:191], v20, s[4:7], s78 offen offset:2048 sc1
    v_mfma_f32_16x16x32_bf16 v[52:55], a[160:163], v[148:151], v[52:55]
    v_mfma_f32_16x16x32_bf16 v[60:63], a[164:167], v[148:151], v[60:63]
    v_mfma_f32_16x16x32_bf16 v[68:71], a[168:171], v[148:151], v[68:71]
    v_mfma_f32_16x16x32_bf16 v[76:79], a[172:175], v[148:151], v[76:79]
C0_done:
    s_waitcnt vmcnt(9)
    v_mfma_f32_16x16x32_bf16 v[80:83], a[0:3], v[152:155], 0
    v_mfma_f32_16x16x32_bf16 v[88:91], a[4:7], v[152:155], 0
    buffer_load_dwordx4 v[128:131], v21, s[4:7], s78 offen offset:0 sc1
    v_mfma_f32_16x16x32_bf16 v[96:99], a[8:11], v[152:155], 0
    s_sub_u32 s30, s48, s46
    s_lshl_b32 s30, s30, 5
    v_mul_lo_u32 v31, v3, s30
    v_mfma_f32_16x16x32_bf16 v[104:107], a[12:15], v[152:155], 0
    s_waitcnt vmcnt(9)
    ds_write_b128 v5, v[52:55] offset:1024
    v_add_u32 v31, v31, v9
    v_mfma_f32_16x16x32_bf16 v[80:83], a[16:19], v[156:159], v[80:83]
    v_add_u32 v31, 1024, v31
    v_accvgpr_read_b32 v224, a240
    v_mfma_f32_16x16x32_bf16 v[88:91], a[20:23], v[156:159], v[88:91]
    buffer_load_dwordx4 v[132:135], v16, s[4:7], s78 offen offset:1024 sc1
    v_accvgpr_read_b32 v225, a241
    v_mfma_f32_16x16x32_bf16 v[96:99], a[24:27], v[156:159], v[96:99]
    v_accvgpr_read_b32 v226, a242
    v_accvgpr_read_b32 v227, a243
    v_mfma_f32_16x16x32_bf16 v[104:107], a[28:31], v[156:159], v[104:107]
    s_waitcnt vmcnt(9)
    ds_write_b128 v5, v[60:63] offset:3072
    v_accvgpr_read_b32 v228, a244
    v_mfma_f32_16x16x32_bf16 v[80:83], a[32:35], v[160:163], v[80:83]
    v_accvgpr_read_b32 v229, a245
    v_accvgpr_read_b32 v230, a246
    v_mfma_f32_16x16x32_bf16 v[88:91], a[36:39], v[160:163], v[88:91]
    buffer_load_dwordx4 v[136:139], v16, s[4:7], s78 offen offset:3072 sc1
    v_accvgpr_read_b32 v231, a247
    v_mfma_f32_16x16x32_bf16 v[96:99], a[40:43], v[160:163], v[96:99]
    v_accvgpr_read_b32 v232, a248
    v_accvgpr_read_b32 v233, a249
    v_mfma_f32_16x16x32_bf16 v[104:107], a[44:47], v[160:163], v[104:107]
    s_waitcnt vmcnt(9)
    ds_write_b128 v5, v[68:71] offset:5120
    v_accvgpr_read_b32 v234, a250
    v_mfma_f32_16x16x32_bf16 v[80:83], a[48:51], v[164:167], v[80:83]
    v_accvgpr_read_b32 v235, a251
    v_accvgpr_read_b32 v236, a252
    v_mfma_f32_16x16x32_bf16 v[88:91], a[52:55], v[164:167], v[88:91]
    buffer_load_dwordx4 v[140:143], v17, s[4:7], s78 offen offset:1024 sc1
    v_accvgpr_read_b32 v237, a253
    v_mfma_f32_16x16x32_bf16 v[96:99], a[56:59], v[164:167], v[96:99]
    v_accvgpr_read_b32 v238, a254
    v_accvgpr_read_b32 v239, a255
    v_mfma_f32_16x16x32_bf16 v[104:107], a[60:63], v[164:167], v[104:107]
    s_waitcnt vmcnt(9)
    ds_write_b128 v5, v[76:79] offset:7168
    v_mfma_f32_16x16x32_bf16 v[80:83], a[64:67], v[168:171], v[80:83]
    v_mfma_f32_16x16x32_bf16 v[88:91], a[68:71], v[168:171], v[88:91]
    buffer_load_dwordx4 v[144:147], v17, s[4:7], s78 offen offset:3072 sc1
    v_mfma_f32_16x16x32_bf16 v[96:99], a[72:75], v[168:171], v[96:99]
    v_mfma_f32_16x16x32_bf16 v[104:107], a[76:79], v[168:171], v[104:107]
    s_waitcnt vmcnt(9) lgkmcnt(0)
    s_barrier
    v_mfma_f32_16x16x32_bf16 v[80:83], a[80:83], v[172:175], v[80:83]
    v_mfma_f32_16x16x32_bf16 v[88:91], a[84:87], v[172:175], v[88:91]
    buffer_load_dwordx4 v[148:151], v18, s[4:7], s78 offen offset:1024 sc1
    ds_read_b128 v[192:195], v6 offset:0
    v_mfma_f32_16x16x32_bf16 v[96:99], a[88:91], v[172:175], v[96:99]
    ds_read_b128 v[196:199], v6 offset:512
    v_mfma_f32_16x16x32_bf16 v[104:107], a[92:95], v[172:175], v[104:107]
    s_waitcnt vmcnt(9)
    ds_read_b128 v[200:203], v6 offset:8192
    ds_read_b128 v[204:207], v6 offset:8704
    v_mfma_f32_16x16x32_bf16 v[80:83], a[96:99], v[176:179], v[80:83]
    v_mfma_f32_16x16x32_bf16 v[88:91], a[100:103], v[176:179], v[88:91]
    buffer_load_dwordx4 v[152:155], v18, s[4:7], s78 offen offset:3072 sc1
    ds_read_b128 v[208:211], v6 offset:16384
    v_mfma_f32_16x16x32_bf16 v[96:99], a[104:107], v[176:179], v[96:99]
    ds_read_b128 v[212:215], v6 offset:16896
    v_mfma_f32_16x16x32_bf16 v[104:107], a[108:111], v[176:179], v[104:107]
    s_waitcnt vmcnt(9)
    ds_read_b128 v[216:219], v6 offset:24576
    ds_read_b128 v[220:223], v6 offset:25088
    v_mfma_f32_16x16x32_bf16 v[80:83], a[112:115], v[180:183], v[80:83]
    v_mfma_f32_16x16x32_bf16 v[88:91], a[116:119], v[180:183], v[88:91]
    s_waitcnt lgkmcnt(4)
    buffer_load_dwordx4 v[156:159], v19, s[4:7], s78 offen offset:1024 sc1
    v_add_f32 v224, v224, v192
    v_mfma_f32_16x16x32_bf16 v[96:99], a[120:123], v[180:183], v[96:99]
    v_add_f32 v225, v225, v193
    v_add_f32 v226, v226, v194
    v_mfma_f32_16x16x32_bf16 v[104:107], a[124:127], v[180:183], v[104:107]
    s_waitcnt vmcnt(9)
    v_add_f32 v227, v227, v195
    v_add_f32 v228, v228, v196
    v_mfma_f32_16x16x32_bf16 v[80:83], a[128:131], v[184:187], v[80:83]
    v_add_f32 v229, v229, v197
    v_add_f32 v230, v230, v198
    v_mfma_f32_16x16x32_bf16 v[88:91], a[132:135], v[184:187], v[88:91]
    buffer_load_dwordx4 v[160:163], v19, s[4:7], s78 offen offset:3072 sc1
    v_add_f32 v231, v231, v199
    v_mfma_f32_16x16x32_bf16 v[96:99], a[136:139], v[184:187], v[96:99]
    v_add_f32 v224, v224, v200
    v_add_f32 v225, v225, v201
    v_mfma_f32_16x16x32_bf16 v[104:107], a[140:143], v[184:187], v[104:107]
    s_waitcnt vmcnt(9)
    v_add_f32 v226, v226, v202
    v_add_f32 v227, v227, v203
    v_mfma_f32_16x16x32_bf16 v[80:83], a[144:147], v[188:191], v[80:83]
    v_add_f32 v228, v228, v204
    v_add_f32 v229, v229, v205
    v_mfma_f32_16x16x32_bf16 v[88:91], a[148:151], v[188:191], v[88:91]
    buffer_load_dwordx4 v[164:167], v20, s[4:7], s78 offen offset:1024 sc1
    v_add_f32 v230, v230, v206
    v_mfma_f32_16x16x32_bf16 v[96:99], a[152:155], v[188:191], v[96:99]
    v_add_f32 v231, v231, v207
    v_mfma_f32_16x16x32_bf16 v[104:107], a[156:159], v[188:191], v[104:107]
    s_waitcnt vmcnt(9) lgkmcnt(0)
    v_add_f32 v224, v224, v208
    v_add_f32 v225, v225, v209
    v_mfma_f32_16x16x32_bf16 v[80:83], a[160:163], v[128:131], v[80:83]
    v_add_f32 v226, v226, v210
    v_add_f32 v227, v227, v211
    v_mfma_f32_16x16x32_bf16 v[88:91], a[164:167], v[128:131], v[88:91]
    buffer_load_dwordx4 v[168:171], v20, s[4:7], s78 offen offset:3072 sc1
    v_add_f32 v228, v228, v212
    v_mfma_f32_16x16x32_bf16 v[96:99], a[168:171], v[128:131], v[96:99]
    v_add_f32 v229, v229, v213
    v_add_f32 v230, v230, v214
    v_mfma_f32_16x16x32_bf16 v[104:107], a[172:175], v[128:131], v[104:107]
    s_waitcnt vmcnt(9)
    v_add_f32 v231, v231, v215
    v_add_f32 v224, v224, v216
    v_mfma_f32_16x16x32_bf16 v[84:87], a[0:3], v[132:135], 0
    v_add_f32 v225, v225, v217
    v_add_f32 v226, v226, v218
    v_mfma_f32_16x16x32_bf16 v[92:95], a[4:7], v[132:135], 0
    buffer_load_dwordx4 v[172:175], v21, s[4:7], s78 offen offset:1024 sc1
    v_add_f32 v227, v227, v219
    v_mfma_f32_16x16x32_bf16 v[100:103], a[8:11], v[132:135], 0
    v_add_f32 v228, v228, v220
    v_add_f32 v229, v229, v221
    v_mfma_f32_16x16x32_bf16 v[108:111], a[12:15], v[132:135], 0
    s_waitcnt vmcnt(9)
    v_add_f32 v230, v230, v222
    v_add_f32 v231, v231, v223
    v_mfma_f32_16x16x32_bf16 v[84:87], a[16:19], v[136:139], v[84:87]
    v_cvt_pk_bf16_f32 v192, v224, v225
    v_cvt_pk_bf16_f32 v193, v226, v227
    v_mfma_f32_16x16x32_bf16 v[92:95], a[20:23], v[136:139], v[92:95]
    v_cvt_pk_bf16_f32 v194, v228, v229
    v_cvt_pk_bf16_f32 v195, v230, v231
    v_mfma_f32_16x16x32_bf16 v[100:103], a[24:27], v[136:139], v[100:103]
    buffer_store_dwordx4 v[192:195], v7, s[8:11], s61 offen
    v_dot2_f32_bf16 v196, v192, s36, 0
    v_dot2_f32_bf16 v197, v192, v192, 0
    v_dot2_f32_bf16 v196, v193, s36, v196
    v_dot2_f32_bf16 v197, v193, v193, v197
    v_dot2_f32_bf16 v196, v194, s36, v196
    v_dot2_f32_bf16 v197, v194, v194, v197
    v_dot2_f32_bf16 v196, v195, s36, v196
    v_dot2_f32_bf16 v197, v195, v195, v197
    v_mfma_f32_16x16x32_bf16 v[108:111], a[28:31], v[136:139], v[108:111]
    s_waitcnt vmcnt(9)
    v_accvgpr_write_b32 a240, v224
    v_accvgpr_write_b32 a241, v225
    v_mfma_f32_16x16x32_bf16 v[84:87], a[32:35], v[140:143], v[84:87]
    v_accvgpr_write_b32 a242, v226
    v_permlane16_swap_b32 v196, v197
    v_mfma_f32_16x16x32_bf16 v[92:95], a[36:39], v[140:143], v[92:95]
    v_add_f32 v196, v196, v197
    v_mov_b32 v197, v196
    v_mfma_f32_16x16x32_bf16 v[100:103], a[40:43], v[140:143], v[100:103]
    v_accvgpr_write_b32 a243, v227
    v_accvgpr_write_b32 a244, v228
    v_mfma_f32_16x16x32_bf16 v[108:111], a[44:47], v[140:143], v[108:111]
    s_waitcnt vmcnt(8)
    v_permlane32_swap_b32 v196, v197
    v_add_f32 v196, v196, v197
    v_mfma_f32_16x16x32_bf16 v[84:87], a[48:51], v[144:147], v[84:87]
    v_accvgpr_write_b32 a245, v229
    v_accvgpr_write_b32 a246, v230
    v_mfma_f32_16x16x32_bf16 v[92:95], a[52:55], v[144:147], v[92:95]
    v_add_f32_dpp v196, v196, v196 row_ror:8 row_mask:0xf bank_mask:0xf
    v_mfma_f32_16x16x32_bf16 v[100:103], a[56:59], v[144:147], v[100:103]
    s_cbranch_vccnz SAFE_145
    buffer_store_dword v196, v8, s[4:7], s63 offen
BACK_146:
    v_mfma_f32_16x16x32_bf16 v[108:111], a[60:63], v[144:147], v[108:111]
    s_waitcnt vmcnt(8)
    v_accvgpr_write_b32 a247, v231
    v_mfma_f32_16x16x32_bf16 v[84:87], a[64:67], v[148:151], v[84:87]
    v_mfma_f32_16x16x32_bf16 v[92:95], a[68:71], v[148:151], v[92:95]
    ds_write_b128 v5, v[80:83] offset:32768
    v_mfma_f32_16x16x32_bf16 v[100:103], a[72:75], v[148:151], v[100:103]
    v_mfma_f32_16x16x32_bf16 v[108:111], a[76:79], v[148:151], v[108:111]
    s_waitcnt vmcnt(7)
    v_mfma_f32_16x16x32_bf16 v[84:87], a[80:83], v[152:155], v[84:87]
    v_mfma_f32_16x16x32_bf16 v[92:95], a[84:87], v[152:155], v[92:95]
    v_mfma_f32_16x16x32_bf16 v[100:103], a[88:91], v[152:155], v[100:103]
    v_mfma_f32_16x16x32_bf16 v[108:111], a[92:95], v[152:155], v[108:111]
    s_waitcnt vmcnt(6)
    ds_write_b128 v5, v[88:91] offset:34816
    v_mfma_f32_16x16x32_bf16 v[84:87], a[96:99], v[156:159], v[84:87]
    v_mfma_f32_16x16x32_bf16 v[92:95], a[100:103], v[156:159], v[92:95]
    v_mfma_f32_16x16x32_bf16 v[100:103], a[104:107], v[156:159], v[100:103]
    v_mfma_f32_16x16x32_bf16 v[108:111], a[108:111], v[156:159], v[108:111]
    s_waitcnt vmcnt(5)
    v_mfma_f32_16x16x32_bf16 v[84:87], a[112:115], v[160:163], v[84:87]
    v_mfma_f32_16x16x32_bf16 v[92:95], a[116:119], v[160:163], v[92:95]
    ds_write_b128 v5, v[96:99] offset:36864
    s_barrier
    v_mfma_f32_16x16x32_bf16 v[100:103], a[120:123], v[160:163], v[100:103]
    s_lshr_b32 s31, 0x2010010, s43
    s_and_b32 s31, s31, 31
    s_lshl_b32 s31, s31, 12
    s_add_u32 m0, s82, 98304
    s_add_u32 s31, s31, s40
    v_mfma_f32_16x16x32_bf16 v[108:111], a[124:127], v[160:163], v[108:111]
    s_waitcnt vmcnt(4)
    buffer_load_dwordx4 v16, s[4:7], s31 offen offset:0 sc1 lds
    v_mfma_f32_16x16x32_bf16 v[84:87], a[128:131], v[164:167], v[84:87]
    v_mfma_f32_16x16x32_bf16 v[92:95], a[132:135], v[164:167], v[92:95]
    buffer_load_dwordx4 v16, s[4:7], s31 offen offset:1024 sc1 lds
    v_mfma_f32_16x16x32_bf16 v[100:103], a[136:139], v[164:167], v[100:103]
    v_mfma_f32_16x16x32_bf16 v[108:111], a[140:143], v[164:167], v[108:111]
    s_waitcnt vmcnt(5)
    ds_write_b128 v5, v[104:107] offset:38912
    buffer_load_dwordx4 v16, s[4:7], s31 offen offset:2048 sc1 lds
    v_mfma_f32_16x16x32_bf16 v[84:87], a[144:147], v[168:171], v[84:87]
    v_mfma_f32_16x16x32_bf16 v[92:95], a[148:151], v[168:171], v[92:95]
    buffer_load_dwordx4 v16, s[4:7], s31 offen offset:3072 sc1 lds
    v_mfma_f32_16x16x32_bf16 v[100:103], a[152:155], v[168:171], v[100:103]
    v_mfma_f32_16x16x32_bf16 v[108:111], a[156:159], v[168:171], v[108:111]
    s_waitcnt vmcnt(6)
    s_lshr_b32 s31, 0x5040311, s43
    s_and_b32 s31, s31, 31
    s_lshl_b32 s31, s31, 12
    s_add_u32 m0, s82, 114688
    s_add_u32 s31, s31, s40
    v_mfma_f32_16x16x32_bf16 v[84:87], a[160:163], v[172:175], v[84:87]
    v_mfma_f32_16x16x32_bf16 v[92:95], a[164:167], v[172:175], v[92:95]
    buffer_load_dwordx4 v16, s[4:7], s31 offen offset:0 sc1 lds
    v_mfma_f32_16x16x32_bf16 v[100:103], a[168:171], v[172:175], v[100:103]
    v_mfma_f32_16x16x32_bf16 v[108:111], a[172:175], v[172:175], v[108:111]
    buffer_load_dwordx4 v16, s[4:7], s31 offen offset:1024 sc1 lds
    buffer_load_dwordx4 v16, s[4:7], s31 offen offset:2048 sc1 lds
    buffer_load_dwordx4 v16, s[4:7], s31 offen offset:3072 sc1 lds
    s_nop 0
    ds_write_b128 v5, v[84:87] offset:33792
    ds_write_b128 v5, v[92:95] offset:35840
    s_nop 0
    ds_write_b128 v5, v[100:103] offset:37888
    ds_write_b128 v5, v[108:111] offset:39936
    s_waitcnt vmcnt(8)
    s_cbranch_vccnz SAFE_149
    buffer_store_dword v11, v10, s[4:7], s65 offen offset:3072
BACK_150:
    s_waitcnt lgkmcnt(0)
    s_barrier
    ds_read_b128 v[192:195], v6 offset:32768
    ds_read_b128 v[196:199], v6 offset:33280
    ds_read_b128 v[200:203], v6 offset:40960
    ds_read_b128 v[204:207], v6 offset:41472
    ds_read_b128 v[208:211], v6 offset:49152
    ds_read_b128 v[212:215], v6 offset:49664
    ds_read_b128 v[216:219], v6 offset:57344
    ds_read_b128 v[220:223], v6 offset:57856
    s_waitcnt lgkmcnt(6)
    v_pk_add_f32 v[232:233], v[232:233], v[192:193]
    v_pk_add_f32 v[234:235], v[234:235], v[194:195]
    v_pk_add_f32 v[236:237], v[236:237], v[196:197]
    v_pk_add_f32 v[238:239], v[238:239], v[198:199]
    s_waitcnt lgkmcnt(4)
    v_pk_add_f32 v[232:233], v[232:233], v[200:201]
    v_pk_add_f32 v[234:235], v[234:235], v[202:203]
    v_pk_add_f32 v[236:237], v[236:237], v[204:205]
    v_pk_add_f32 v[238:239], v[238:239], v[206:207]
    s_waitcnt lgkmcnt(2)
    v_pk_add_f32 v[232:233], v[232:233], v[208:209]
    v_pk_add_f32 v[234:235], v[234:235], v[210:211]
    v_pk_add_f32 v[236:237], v[236:237], v[212:213]
    v_pk_add_f32 v[238:239], v[238:239], v[214:215]
    s_waitcnt lgkmcnt(0)
    v_pk_add_f32 v[232:233], v[232:233], v[216:217]
    v_pk_add_f32 v[234:235], v[234:235], v[218:219]
    v_pk_add_f32 v[236:237], v[236:237], v[220:221]
    v_pk_add_f32 v[238:239], v[238:239], v[222:223]
    v_cvt_pk_bf16_f32 v192, v232, v233
    v_cvt_pk_bf16_f32 v193, v234, v235
    v_cvt_pk_bf16_f32 v194, v236, v237
    v_cvt_pk_bf16_f32 v195, v238, v239
    buffer_store_dwordx4 v[192:195], v7, s[8:11], s62 offen
    v_dot2_f32_bf16 v196, v192, s36, 0
    v_dot2_f32_bf16 v197, v192, v192, 0
    v_dot2_f32_bf16 v196, v193, s36, v196
    v_dot2_f32_bf16 v197, v193, v193, v197
    v_dot2_f32_bf16 v196, v194, s36, v196
    v_dot2_f32_bf16 v197, v194, v194, v197
    v_dot2_f32_bf16 v196, v195, s36, v196
    v_dot2_f32_bf16 v197, v195, v195, v197
    v_accvgpr_write_b32 a248, v232
    v_accvgpr_write_b32 a249, v233
    v_accvgpr_write_b32 a250, v234
    v_permlane16_swap_b32 v196, v197
    v_add_f32 v196, v196, v197
    v_mov_b32 v197, v196
    v_accvgpr_write_b32 a251, v235
    v_accvgpr_write_b32 a252, v236
    v_permlane32_swap_b32 v196, v197
    v_add_f32 v196, v196, v197
    v_accvgpr_write_b32 a253, v237
    v_accvgpr_write_b32 a254, v238
    v_add_f32_dpp v196, v196, v196 row_ror:8 row_mask:0xf bank_mask:0xf
    s_cbranch_vccnz SAFE_147
    buffer_store_dword v196, v8, s[4:7], s64 offen
BACK_148:
    v_accvgpr_write_b32 a255, v239
    s_lshr_b32 s31, 0x9080706, s43
    s_and_b32 s31, s31, 31
    s_lshl_b32 s31, s31, 12
    s_add_u32 m0, s82, 131072
    s_add_u32 s31, s31, s40
    s_barrier
    buffer_load_dwordx4 v16, s[4:7], s31 offen offset:0 sc1 lds
    buffer_load_dwordx4 v16, s[4:7], s31 offen offset:1024 sc1 lds
    buffer_load_dwordx4 v16, s[4:7], s31 offen offset:2048 sc1 lds
    buffer_load_dwordx4 v16, s[4:7], s31 offen offset:3072 sc1 lds
    s_waitcnt vmcnt(4)
    s_cbranch_vccnz SAFE_151
    buffer_store_dword v11, v10, s[4:7], s66 offen offset:3072
BACK_152:
    s_lshr_b32 s31, 0xd0c0b0a, s43
    s_and_b32 s31, s31, 31
    s_lshl_b32 s31, s31, 12
    s_add_u32 m0, s82, 147456
    s_add_u32 s31, s31, s40
    buffer_load_dwordx4 v16, s[4:7], s31 offen offset:0 sc1 lds
    buffer_load_dwordx4 v16, s[4:7], s31 offen offset:1024 sc1 lds
    buffer_load_dwordx4 v16, s[4:7], s31 offen offset:2048 sc1 lds
    buffer_load_dwordx4 v16, s[4:7], s31 offen offset:3072 sc1 lds
    buffer_load_dword v14, v31, s[4:7], s39 offen offset:0 sc1
    s_branch PJ_156
.p2align 12
PJ_156:
    s_waitcnt vmcnt(0)
    v_cmp_gt_u32 vcc, s34, v14
    s_cbranch_vccnz SPIN_153
BACK_154:
    buffer_load_dwordx4 v[32:35], v16, s[8:11], s37 offen offset:0 sc1
    buffer_load_dwordx4 v[36:39], v16, s[8:11], s37 offen offset:1024 sc1
    buffer_load_dwordx4 v[40:43], v16, s[8:11], s37 offen offset:2048 sc1
    buffer_load_dwordx4 v[44:47], v16, s[8:11], s37 offen offset:3072 sc1
    buffer_load_dwordx4 v[48:51], v17, s[8:11], s37 offen offset:0 sc1
    buffer_load_dwordx4 v[52:55], v17, s[8:11], s37 offen offset:1024 sc1
    v_mov_b32 v11, 2
    s_barrier
    ds_read_b128 v[208:211], v30 offset:4096
    ds_read_b128 v[212:215], v30 offset:6144
    ds_read_b128 v[216:219], v30 offset:0
    ds_read_b128 v[220:223], v30 offset:5120
    ds_read_b128 v[224:227], v30 offset:7168
    ds_read_b128 v[228:231], v30 offset:1024
    s_waitcnt vmcnt(4) lgkmcnt(5)
    v_mfma_f32_16x16x32_bf16 v[160:163], v[208:211], v[32:35], 0
    v_mfma_f32_16x16x32_bf16 v[164:167], v[208:211], v[36:39], 0
    s_waitcnt lgkmcnt(4)
    ds_read_b128 v[208:211], v30 offset:8192
    buffer_load_dwordx4 v[56:59], v17, s[8:11], s37 offen offset:2048 sc1
    v_mfma_f32_16x16x32_bf16 v[176:179], v[32:35], v[212:215], 0
    v_mfma_f32_16x16x32_bf16 v[184:187], v[36:39], v[212:215], 0
    s_waitcnt lgkmcnt(4)
    ds_read_b128 v[212:215], v30 offset:10240
    buffer_load_dwordx4 v[232:235], v16, s[4:7], s38 offen offset:0 sc1
    v_mfma_f32_16x16x32_bf16 v[192:195], v[216:219], v[32:35], 0
    v_mfma_f32_16x16x32_bf16 v[196:199], v[216:219], v[36:39], 0
    s_waitcnt lgkmcnt(4)
    ds_read_b128 v[216:219], v30 offset:2048
    v_mfma_f32_16x16x32_bf16 v[168:171], v[220:223], v[32:35], 0
    v_mfma_f32_16x16x32_bf16 v[172:175], v[220:223], v[36:39], 0
    s_waitcnt lgkmcnt(4)
    ds_read_b128 v[220:223], v30 offset:9216
    buffer_load_dwordx4 v[236:239], v16, s[4:7], s38 offen offset:1024 sc1
    v_mfma_f32_16x16x32_bf16 v[180:183], v[32:35], v[224:227], 0
    v_mfma_f32_16x16x32_bf16 v[188:191], v[36:39], v[224:227], 0
    s_waitcnt lgkmcnt(4)
    ds_read_b128 v[224:227], v30 offset:11264
    buffer_load_dwordx4 v[60:63], v17, s[8:11], s37 offen offset:3072 sc1
    v_mfma_f32_16x16x32_bf16 v[200:203], v[228:231], v[32:35], 0
    v_mfma_f32_16x16x32_bf16 v[204:207], v[228:231], v[36:39], 0
    s_waitcnt vmcnt(6) lgkmcnt(4)
    ds_read_b128 v[228:231], v30 offset:3072
    v_mfma_f32_16x16x32_bf16 v[160:163], v[208:211], v[40:43], v[160:163]
    v_mfma_f32_16x16x32_bf16 v[164:167], v[208:211], v[44:47], v[164:167]
    s_waitcnt lgkmcnt(4)
    ds_read_b128 v[208:211], v30 offset:12288
    buffer_load_dwordx4 v[64:67], v18, s[8:11], s37 offen offset:0 sc1
    v_mfma_f32_16x16x32_bf16 v[176:179], v[40:43], v[212:215], v[176:179]
    v_mfma_f32_16x16x32_bf16 v[184:187], v[44:47], v[212:215], v[184:187]
    s_waitcnt lgkmcnt(4)
    ds_read_b128 v[212:215], v30 offset:14336
    buffer_load_dwordx4 v[68:71], v18, s[8:11], s37 offen offset:1024 sc1
    v_mfma_f32_16x16x32_bf16 v[192:195], v[216:219], v[40:43], v[192:195]
    v_mfma_f32_16x16x32_bf16 v[196:199], v[216:219], v[44:47], v[196:199]
    s_waitcnt lgkmcnt(4)
    ds_read_b128 v[216:219], v30 offset:16384
    v_mfma_f32_16x16x32_bf16 v[168:171], v[220:223], v[40:43], v[168:171]
    v_mfma_f32_16x16x32_bf16 v[172:175], v[220:223], v[44:47], v[172:175]
    s_waitcnt lgkmcnt(4)
    ds_read_b128 v[220:223], v30 offset:13312
    buffer_load_dwordx4 v[72:75], v18, s[8:11], s37 offen offset:2048 sc1
    v_mfma_f32_16x16x32_bf16 v[180:183], v[40:43], v[224:227], v[180:183]
    v_mfma_f32_16x16x32_bf16 v[188:191], v[44:47], v[224:227], v[188:191]
    s_waitcnt lgkmcnt(4)
    ds_read_b128 v[224:227], v30 offset:15360
    buffer_load_dwordx4 v[76:79], v18, s[8:11], s37 offen offset:3072 sc1
    v_mfma_f32_16x16x32_bf16 v[200:203], v[228:231], v[40:43], v[200:203]
    v_mfma_f32_16x16x32_bf16 v[204:207], v[228:231], v[44:47], v[204:207]
    s_waitcnt vmcnt(8) lgkmcnt(4)
    ds_read_b128 v[228:231], v30 offset:17408
    v_mfma_f32_16x16x32_bf16 v[160:163], v[208:211], v[48:51], v[160:163]
    v_mfma_f32_16x16x32_bf16 v[164:167], v[208:211], v[52:55], v[164:167]
    s_waitcnt lgkmcnt(4)
    ds_read_b128 v[208:211], v30 offset:20480
    buffer_load_dwordx4 v[80:83], v19, s[8:11], s37 offen offset:0 sc1
    v_mfma_f32_16x16x32_bf16 v[176:179], v[48:51], v[212:215], v[176:179]
    v_mfma_f32_16x16x32_bf16 v[184:187], v[52:55], v[212:215], v[184:187]
    s_waitcnt lgkmcnt(4)
    ds_read_b128 v[212:215], v30 offset:22528
    buffer_load_dwordx4 v[84:87], v19, s[8:11], s37 offen offset:1024 sc1
    v_mfma_f32_16x16x32_bf16 v[192:195], v[216:219], v[48:51], v[192:195]
    v_mfma_f32_16x16x32_bf16 v[196:199], v[216:219], v[52:55], v[196:199]
    s_waitcnt lgkmcnt(4)
    ds_read_b128 v[216:219], v30 offset:18432
    v_mfma_f32_16x16x32_bf16 v[168:171], v[220:223], v[48:51], v[168:171]
    v_mfma_f32_16x16x32_bf16 v[172:175], v[220:223], v[52:55], v[172:175]
    s_waitcnt lgkmcnt(4)
    ds_read_b128 v[220:223], v30 offset:21504
    buffer_load_dwordx4 v[88:91], v19, s[8:11], s37 offen offset:2048 sc1
    v_mfma_f32_16x16x32_bf16 v[180:183], v[48:51], v[224:227], v[180:183]
    v_mfma_f32_16x16x32_bf16 v[188:191], v[52:55], v[224:227], v[188:191]
    s_waitcnt lgkmcnt(4)
    ds_read_b128 v[224:227], v30 offset:23552
    buffer_load_dwordx4 v[92:95], v19, s[8:11], s37 offen offset:3072 sc1
    v_mfma_f32_16x16x32_bf16 v[200:203], v[228:231], v[48:51], v[200:203]
    v_mfma_f32_16x16x32_bf16 v[204:207], v[228:231], v[52:55], v[204:207]
    s_waitcnt vmcnt(8) lgkmcnt(4)
    ds_read_b128 v[228:231], v30 offset:19456
    v_mfma_f32_16x16x32_bf16 v[160:163], v[208:211], v[56:59], v[160:163]
    v_mfma_f32_16x16x32_bf16 v[164:167], v[208:211], v[60:63], v[164:167]
    s_waitcnt lgkmcnt(4)
    ds_read_b128 v[208:211], v30 offset:24576
    buffer_load_dwordx4 v[96:99], v20, s[8:11], s37 offen offset:0 sc1
    v_mfma_f32_16x16x32_bf16 v[176:179], v[56:59], v[212:215], v[176:179]
    v_mfma_f32_16x16x32_bf16 v[184:187], v[60:63], v[212:215], v[184:187]
    s_waitcnt lgkmcnt(4)
    ds_read_b128 v[212:215], v30 offset:26624
    buffer_load_dwordx4 v[100:103], v20, s[8:11], s37 offen offset:1024 sc1
    v_mfma_f32_16x16x32_bf16 v[192:195], v[216:219], v[56:59], v[192:195]
    v_mfma_f32_16x16x32_bf16 v[196:199], v[216:219], v[60:63], v[196:199]
    s_waitcnt lgkmcnt(4)
    ds_read_b128 v[216:219], v30 offset:25600
    v_mfma_f32_16x16x32_bf16 v[168:171], v[220:223], v[56:59], v[168:171]
    v_mfma_f32_16x16x32_bf16 v[172:175], v[220:223], v[60:63], v[172:175]
    s_waitcnt lgkmcnt(4)
    ds_read_b128 v[220:223], v30 offset:27648
    buffer_load_dwordx4 v[104:107], v20, s[8:11], s37 offen offset:2048 sc1
    v_mfma_f32_16x16x32_bf16 v[180:183], v[56:59], v[224:227], v[180:183]
    v_mfma_f32_16x16x32_bf16 v[188:191], v[60:63], v[224:227], v[188:191]
    s_waitcnt lgkmcnt(4)
    ds_read_b128 v[224:227], v30 offset:28672
    buffer_load_dwordx4 v[108:111], v20, s[8:11], s37 offen offset:3072 sc1
    v_mfma_f32_16x16x32_bf16 v[200:203], v[228:231], v[56:59], v[200:203]
    v_mfma_f32_16x16x32_bf16 v[204:207], v[228:231], v[60:63], v[204:207]
    s_waitcnt vmcnt(10) lgkmcnt(4)
    ds_read_b128 v[228:231], v30 offset:30720
    v_mfma_f32_16x16x32_bf16 v[160:163], v[208:211], v[64:67], v[160:163]
    v_mfma_f32_16x16x32_bf16 v[164:167], v[208:211], v[68:71], v[164:167]
    s_waitcnt lgkmcnt(4)
    ds_read_b128 v[208:211], v30 offset:29696
    buffer_load_dwordx4 v[112:115], v21, s[8:11], s37 offen offset:0 sc1
    v_mfma_f32_16x16x32_bf16 v[176:179], v[64:67], v[212:215], v[176:179]
    v_add_f32 v232, v232, v234
    v_add_f32 v233, v233, v235
    v_mfma_f32_16x16x32_bf16 v[184:187], v[68:71], v[212:215], v[184:187]
    s_waitcnt lgkmcnt(4)
    ds_read_b128 v[212:215], v30 offset:31744
    buffer_load_dwordx4 v[116:119], v21, s[8:11], s37 offen offset:1024 sc1
    v_mfma_f32_16x16x32_bf16 v[168:171], v[216:219], v[64:67], v[168:171]
    v_add_f32 v236, v236, v238
    v_add_f32 v237, v237, v239
    v_mfma_f32_16x16x32_bf16 v[172:175], v[216:219], v[68:71], v[172:175]
    s_waitcnt lgkmcnt(4)
    ds_read_b128 v[216:219], v30 offset:32768
    v_add_f32 v232, v232, v236
    v_mfma_f32_16x16x32_bf16 v[180:183], v[64:67], v[220:223], v[180:183]
    v_add_f32 v233, v233, v237
    s_nop 1
    v_permlane32_swap_b32 v232, v233
    v_mfma_f32_16x16x32_bf16 v[188:191], v[68:71], v[220:223], v[188:191]
    s_waitcnt vmcnt(10) lgkmcnt(4)
    ds_read_b128 v[220:223], v30 offset:34816
    buffer_load_dwordx4 v[120:123], v21, s[8:11], s37 offen offset:2048 sc1
    v_mfma_f32_16x16x32_bf16 v[160:163], v[224:227], v[72:75], v[160:163]
    v_add_f32 v232, v232, v233
    v_mul_f32 v232, 0x3b000000, v232
    v_mfma_f32_16x16x32_bf16 v[164:167], v[224:227], v[76:79], v[164:167]
    s_waitcnt lgkmcnt(4)
    ds_read_b128 v[224:227], v30 offset:33792
    buffer_load_dwordx4 v[124:127], v21, s[8:11], s37 offen offset:3072 sc1
    v_mfma_f32_16x16x32_bf16 v[176:179], v[72:75], v[228:231], v[176:179]
    v_mov_b32 v233, v232
    s_nop 1
    v_permlane32_swap_b32 v232, v233
    v_mfma_f32_16x16x32_bf16 v[184:187], v[76:79], v[228:231], v[184:187]
    s_waitcnt lgkmcnt(4)
    ds_read_b128 v[228:231], v30 offset:35840
    v_fma_f32 v233, -v232, v232, v233
    v_mfma_f32_16x16x32_bf16 v[168:171], v[208:211], v[72:75], v[168:171]
    v_max_f32 v233, 0, v233
    v_add_f32 v233, 0x3727c5ac, v233
    v_mfma_f32_16x16x32_bf16 v[172:175], v[208:211], v[76:79], v[172:175]
    s_waitcnt lgkmcnt(4)
    ds_read_b128 v[208:211], v30 offset:36864
    buffer_load_dwordx4 v[128:131], v22, s[8:11], s37 offen offset:0 sc1
    v_mfma_f32_16x16x32_bf16 v[180:183], v[72:75], v[212:215], v[180:183]
    v_rsq_f32 v240, v233
    v_mfma_f32_16x16x32_bf16 v[188:191], v[76:79], v[212:215], v[188:191]
    s_waitcnt vmcnt(11) lgkmcnt(4)
    ds_read_b128 v[212:215], v30 offset:38912
    buffer_load_dwordx4 v[132:135], v22, s[8:11], s37 offen offset:1024 sc1
    v_mfma_f32_16x16x32_bf16 v[160:163], v[216:219], v[80:83], v[160:163]
    s_lshr_b32 s31, 0x13120f0e, s43
    s_and_b32 s31, s31, 31
    s_lshl_b32 s31, s31, 12
    s_add_u32 m0, s82, 98304
    s_add_u32 s31, s31, s40
    v_mfma_f32_16x16x32_bf16 v[164:167], v[216:219], v[84:87], v[164:167]
    s_waitcnt lgkmcnt(4)
    s_barrier
    ds_read_b128 v[216:219], v30 offset:37888
    v_mfma_f32_16x16x32_bf16 v[176:179], v[80:83], v[220:223], v[176:179]
    v_cvt_pk_bf16_f32 v234, -v232, -v232
    v_and_b32 v235, 0xffff0000, v234
    v_mfma_f32_16x16x32_bf16 v[184:187], v[84:87], v[220:223], v[184:187]
    s_waitcnt lgkmcnt(4)
    ds_read_b128 v[220:223], v30 offset:39936
    buffer_load_dwordx4 v16, s[4:7], s31 offen offset:0 sc1 lds
    v_mfma_f32_16x16x32_bf16 v[168:171], v[224:227], v[80:83], v[168:171]
    v_sub_f32 v235, -v232, v235
    v_cvt_pk_bf16_f32 v235, v235, v235
    v_mfma_f32_16x16x32_bf16 v[172:175], v[224:227], v[84:87], v[172:175]
    s_waitcnt lgkmcnt(4)
    ds_read_b128 v[224:227], v30 offset:40960
    buffer_load_dwordx4 v16, s[4:7], s31 offen offset:1024 sc1 lds
    v_mfma_f32_16x16x32_bf16 v[180:183], v[80:83], v[228:231], v[180:183]
    v_cndmask_b32 v236, v235, v234, s[24:25]
    v_cvt_pk_bf16_f32 v232, v240, v240
    v_mfma_f32_16x16x32_bf16 v[188:191], v[84:87], v[228:231], v[188:191]
    s_waitcnt vmcnt(12) lgkmcnt(4)
    ds_read_b128 v[228:231], v30 offset:43008
    v_and_b32 v232, 0xffff0000, v232
    v_mfma_f32_16x16x32_bf16 v[160:163], v[208:211], v[88:91], v[160:163]
    v_sub_f32 v233, v240, v232
    v_cvt_pk_bf16_f32 v232, v232, v233
    v_mfma_f32_16x16x32_bf16 v[164:167], v[208:211], v[92:95], v[164:167]
    s_waitcnt lgkmcnt(4)
    ds_read_b128 v[208:211], v30 offset:41984
    buffer_load_dwordx4 v16, s[4:7], s31 offen offset:2048 sc1 lds
    v_mfma_f32_16x16x32_bf16 v[176:179], v[88:91], v[212:215], v[176:179]
    v_mov_b32 v241, v240
    v_cndmask_b32 v242, 0, v232, s[24:25]
    v_mfma_f32_16x16x32_bf16 v[184:187], v[92:95], v[212:215], v[184:187]
    s_waitcnt lgkmcnt(4)
    ds_read_b128 v[212:215], v30 offset:44032
    buffer_load_dwordx4 v16, s[4:7], s31 offen offset:3072 sc1 lds
    v_mfma_f32_16x16x32_bf16 v[168:171], v[216:219], v[88:91], v[168:171]
    v_mov_b32 v244, 0
    v_permlane16_swap_b32 v240, v241
    v_mfma_f32_16x16x32_bf16 v[172:175], v[216:219], v[92:95], v[172:175]
    s_waitcnt lgkmcnt(4)
    ds_read_b128 v[216:219], v30 offset:45056
    v_mov_b32 v243, 0
    v_mfma_f32_16x16x32_bf16 v[180:183], v[88:91], v[220:223], v[180:183]
    v_permlane16_swap_b32 v242, v244
    v_mov_b32 v245, 0
    v_mfma_f32_16x16x32_bf16 v[188:191], v[92:95], v[220:223], v[188:191]
    s_waitcnt vmcnt(12) lgkmcnt(4)
    ds_read_b128 v[220:223], v30 offset:47104
    buffer_load_dwordx4 v[136:139], v22, s[8:11], s37 offen offset:2048 sc1
    v_mfma_f32_16x16x32_bf16 v[160:163], v[224:227], v[96:99], v[160:163]
    v_mul_f32 v238, 0x3eb8aa3b, v240
    v_mul_f32 v239, 0x3eb8aa3b, v241
    v_mfma_f32_16x16x32_bf16 v[164:167], v[224:227], v[100:103], v[164:167]
    s_waitcnt lgkmcnt(4)
    ds_read_b128 v[224:227], v30 offset:46080
    buffer_load_dwordx4 v[140:143], v22, s[8:11], s37 offen offset:3072 sc1
    v_mfma_f32_16x16x32_bf16 v[176:179], v[96:99], v[228:231], v[176:179]
    s_add_u32 s44, s44, 4325376
    s_add_u32 s52, s52, 4325376
    s_add_u32 s47, s47, 0x20000
    s_add_u32 s51, s51, 0x20000
    v_mfma_f32_16x16x32_bf16 v[184:187], v[100:103], v[228:231], v[184:187]
    s_waitcnt lgkmcnt(4)
    ds_read_b128 v[228:231], v30 offset:48128
    v_mfma_f32_16x16x32_bf16 v[168:171], v[208:211], v[96:99], v[168:171]
    s_add_u32 s96, s52, 270336
    s_cmp_eq_u32 s12, 0
    s_cselect_b32 s96, s49, s96
    s_cselect_b32 s97, s49, s52
    v_mfma_f32_16x16x32_bf16 v[172:175], v[208:211], v[100:103], v[172:175]
    s_waitcnt lgkmcnt(4)
    ds_read_b128 v[208:211], v30 offset:49152
    buffer_load_dwordx4 v[144:147], v23, s[8:11], s37 offen offset:0 sc1
    v_mfma_f32_16x16x32_bf16 v[180:183], v[96:99], v[212:215], v[180:183]
    v_and_b32 v237, 0xf0, v16
    v_lshl_add_u32 v237, v3, 8, v237
    v_mfma_f32_16x16x32_bf16 v[188:191], v[100:103], v[212:215], v[188:191]
    s_waitcnt vmcnt(13) lgkmcnt(4)
    ds_read_b128 v[212:215], v30 offset:51200
    buffer_load_dwordx4 v[148:151], v23, s[8:11], s37 offen offset:1024 sc1
    v_mfma_f32_16x16x32_bf16 v[160:163], v[216:219], v[104:107], v[160:163]
    v_bfe_u32 v1, v13, 4, 1
    v_lshl_add_u32 v237, v1, 9, v237
    v_mfma_f32_16x16x32_bf16 v[164:167], v[216:219], v[108:111], v[164:167]
    s_waitcnt lgkmcnt(4)
    ds_read_b128 v[216:219], v30 offset:50176
    v_mfma_f32_16x16x32_bf16 v[176:179], v[104:107], v[220:223], v[176:179]
    s_lshl_b32 s28, s19, 12
    s_add_u32 s28, s28, 131072
    v_add_u32 v2, s28, v237
    v_mfma_f32_16x16x32_bf16 v[184:187], v[108:111], v[220:223], v[184:187]
    s_waitcnt lgkmcnt(4)
    ds_read_b128 v[220:223], v30 offset:52224
    buffer_load_dwordx4 v[152:155], v23, s[8:11], s37 offen offset:2048 sc1
    v_mfma_f32_16x16x32_bf16 v[168:171], v[224:227], v[104:107], v[168:171]
    v_and_b32 v0, 31, v13
    v_lshlrev_b32 v1, 2, v3
    v_mfma_f32_16x16x32_bf16 v[172:175], v[224:227], v[108:111], v[172:175]
    s_waitcnt lgkmcnt(4)
    ds_read_b128 v[224:227], v30 offset:53248
    buffer_load_dwordx4 v[156:159], v23, s[8:11], s37 offen offset:3072 sc1
    v_mfma_f32_16x16x32_bf16 v[180:183], v[104:107], v[228:231], v[180:183]
    s_lshr_b32 s31, 0x17161514, s43
    s_and_b32 s31, s31, 31
    s_lshl_b32 s31, s31, 12
    s_add_u32 m0, s82, 114688
    s_add_u32 s31, s31, s40
    v_mfma_f32_16x16x32_bf16 v[188:191], v[108:111], v[228:231], v[188:191]
    ds_read_b128 v[228:231], v30 offset:55296
    v_sub_u32 v0, v0, v1
    v_mov_b32 v1, 0xff800000
    s_lshr_b32 s28, s14, 1
    s_lshl_b32 s29, s28, 10
    v_add_u32 v248, s29, v30
    v_xor_b32 v249, 1024, v248
    s_lshl_b32 s29, s28, 8
    s_add_u32 s29, s29, 2048
    v_add_u32 v250, s29, v30
    v_xor_b32 v251, 256, v250
    v_add_u32 v252, s50, v237
    s_xor_b32 s29, s50, 28672
    v_add_u32 v254, s29, v237
    s_lshl_b32 s29, s28, 10
    s_add_u32 s29, s29, s50
    v_add_u32 v247, s29, v16
    v_mov_b32 v56, v236
    v_mov_b32 v58, 0
    v_mov_b32 v60, 0
    v_mov_b32 v62, v236
    v_mov_b32 v57, 0
    v_permlane16_swap_b32 v56, v58
    v_mov_b32 v59, 0
    v_permlane16_swap_b32 v60, v62
    v_mov_b32 v61, 0
    v_mov_b32 v63, 0
    v_cmp_le_i32 s[26:27], 0, v0
    v_cmp_le_i32 s[28:29], 1, v0
    v_mov_b32 v246, 0x3f803f80
    v_cndmask_b32 v32, v1, 0, s[26:27]
    v_cndmask_b32 v33, v1, 0, s[28:29]
    v_cmp_le_i32 s[26:27], 2, v0
    v_cmp_le_i32 s[28:29], 3, v0
    v_mov_b32 v246, 0x3f803f80
    v_cndmask_b32 v34, v1, 0, s[26:27]
    v_cndmask_b32 v35, v1, 0, s[28:29]
    v_cmp_le_i32 s[26:27], 8, v0
    v_cmp_le_i32 s[28:29], 9, v0
    v_mov_b32 v246, 0x3f803f80
    v_cndmask_b32 v36, v1, 0, s[26:27]
    v_cndmask_b32 v37, v1, 0, s[28:29]
    v_cmp_le_i32 s[26:27], 10, v0
    v_cmp_le_i32 s[28:29], 11, v0
    v_mov_b32 v246, 0x3f803f80
    v_cndmask_b32 v38, v1, 0, s[26:27]
    v_cndmask_b32 v39, v1, 0, s[28:29]
    v_cmp_le_i32 s[26:27], 16, v0
    v_cmp_le_i32 s[28:29], 17, v0
    v_mov_b32 v246, 0x3f803f80
    v_cndmask_b32 v40, v1, 0, s[26:27]
    v_cndmask_b32 v41, v1, 0, s[28:29]
    v_cmp_le_i32 s[26:27], 18, v0
    v_cmp_le_i32 s[28:29], 19, v0
    v_mov_b32 v246, 0x3f803f80
    v_cndmask_b32 v42, v1, 0, s[26:27]
    v_cndmask_b32 v43, v1, 0, s[28:29]
    v_cmp_le_i32 s[26:27], 24, v0
    v_cmp_le_i32 s[28:29], 25, v0
    v_mov_b32 v246, 0x3f803f80
    v_cndmask_b32 v44, v1, 0, s[26:27]
    v_cndmask_b32 v45, v1, 0, s[28:29]
    v_cmp_le_i32 s[26:27], 26, v0
    v_cmp_le_i32 s[28:29], 27, v0
    v_mov_b32 v246, 0x3f803f80
    v_cndmask_b32 v46, v1, 0, s[26:27]
    v_cndmask_b32 v47, v1, 0, s[28:29]
    v_and_b32 v0, 0xf0, v16
    v_lshl_add_u32 v0, v3, 8, v0
    v_bfe_u32 v1, v13, 4, 1
    v_lshl_add_u32 v0, v1, 10, v0
    v_mov_b32 v1, 0
    s_nop 0
    v_mfma_f32_16x16x16_bf16 v[160:163], v[24:25], v[56:57], v[160:163]
    v_mfma_f32_16x16x16_bf16 v[164:167], v[24:25], v[58:59], v[164:167]
    buffer_load_dwordx4 v16, s[4:7], s31 offen offset:0 sc1 lds
    v_mfma_f32_16x16x16_bf16 v[168:171], v[24:25], v[60:61], v[168:171]
    v_mfma_f32_16x16x16_bf16 v[172:175], v[24:25], v[62:63], v[172:175]
    v_mfma_f32_16x16x16_bf16 v[176:179], v[56:57], v[26:27], v[176:179]
    v_mfma_f32_16x16x16_bf16 v[184:187], v[58:59], v[26:27], v[184:187]
    buffer_load_dwordx4 v16, s[4:7], s31 offen offset:1024 sc1 lds
    v_mfma_f32_16x16x16_bf16 v[180:183], v[60:61], v[26:27], v[180:183]
    v_mfma_f32_16x16x16_bf16 v[188:191], v[62:63], v[26:27], v[188:191]
    v_mfma_f32_16x16x16_bf16 v[192:195], v[28:29], v[56:57], v[192:195]
    v_mfma_f32_16x16x16_bf16 v[196:199], v[28:29], v[58:59], v[196:199]
    buffer_load_dwordx4 v16, s[4:7], s31 offen offset:2048 sc1 lds
    v_mfma_f32_16x16x16_bf16 v[200:203], v[28:29], v[60:61], v[200:203]
    v_mfma_f32_16x16x16_bf16 v[204:207], v[28:29], v[62:63], v[204:207]
    v_mfma_f32_16x16x16_bf16 v[48:51], v[242:243], v[246:247], 0
    v_mfma_f32_16x16x16_bf16 v[52:55], v[244:245], v[246:247], 0
    s_waitcnt vmcnt(17) lgkmcnt(5)
    buffer_load_dwordx4 v16, s[4:7], s31 offen offset:3072 sc1 lds
    v_mfma_f32_16x16x32_bf16 v[160:163], v[208:211], v[112:115], v[160:163]
    v_mfma_f32_16x16x32_bf16 v[164:167], v[208:211], v[116:119], v[164:167]
    s_waitcnt lgkmcnt(4)
    ds_read_b128 v[208:211], v30 offset:54272
    v_mfma_f32_16x16x32_bf16 v[176:179], v[112:115], v[212:215], v[176:179]
    v_mfma_f32_16x16x32_bf16 v[184:187], v[116:119], v[212:215], v[184:187]
    s_waitcnt lgkmcnt(4)
    ds_read_b128 v[212:215], v30 offset:56320
    v_mfma_f32_16x16x32_bf16 v[168:171], v[216:219], v[112:115], v[168:171]
    v_mfma_f32_16x16x32_bf16 v[172:175], v[216:219], v[116:119], v[172:175]
    s_waitcnt lgkmcnt(4)
    ds_read_b128 v[216:219], v30 offset:57344
    v_mfma_f32_16x16x32_bf16 v[180:183], v[112:115], v[220:223], v[180:183]
    v_mfma_f32_16x16x32_bf16 v[188:191], v[116:119], v[220:223], v[188:191]
    s_waitcnt vmcnt(16) lgkmcnt(4)
    ds_read_b128 v[220:223], v30 offset:59392
    v_mfma_f32_16x16x32_bf16 v[160:163], v[224:227], v[120:123], v[160:163]
    v_mfma_f32_16x16x32_bf16 v[164:167], v[224:227], v[124:127], v[164:167]
    s_waitcnt lgkmcnt(4)
    ds_read_b128 v[224:227], v30 offset:58368
    v_mfma_f32_16x16x32_bf16 v[176:179], v[120:123], v[228:231], v[176:179]
    v_mfma_f32_16x16x32_bf16 v[184:187], v[124:127], v[228:231], v[184:187]
    s_waitcnt lgkmcnt(4)
    ds_read_b128 v[228:231], v30 offset:60416
    v_mfma_f32_16x16x32_bf16 v[168:171], v[208:211], v[120:123], v[168:171]
    v_mfma_f32_16x16x32_bf16 v[172:175], v[208:211], v[124:127], v[172:175]
    s_waitcnt lgkmcnt(4)
    ds_read_b128 v[208:211], v30 offset:61440
    v_mfma_f32_16x16x32_bf16 v[180:183], v[120:123], v[212:215], v[180:183]
    v_mfma_f32_16x16x32_bf16 v[188:191], v[124:127], v[212:215], v[188:191]
    s_waitcnt vmcnt(14) lgkmcnt(4)
    ds_read_b128 v[212:215], v30 offset:63488
    v_mfma_f32_16x16x32_bf16 v[160:163], v[216:219], v[128:131], v[160:163]
    v_mfma_f32_16x16x32_bf16 v[164:167], v[216:219], v[132:135], v[164:167]
    s_waitcnt lgkmcnt(4)
    ds_read_b128 v[216:219], v30 offset:62464
    v_mfma_f32_16x16x32_bf16 v[176:179], v[128:131], v[220:223], v[176:179]
    v_mfma_f32_16x16x32_bf16 v[184:187], v[132:135], v[220:223], v[184:187]
    s_waitcnt lgkmcnt(4)
    ds_read_b128 v[220:223], v30 offset:64512
    v_mfma_f32_16x16x32_bf16 v[168:171], v[224:227], v[128:131], v[168:171]
    v_mfma_f32_16x16x32_bf16 v[172:175], v[224:227], v[132:135], v[172:175]
    s_waitcnt vmcnt(10) lgkmcnt(4)
    s_barrier
    ds_read_b128 v[224:227], v30 offset:0
    v_mfma_f32_16x16x32_bf16 v[180:183], v[128:131], v[228:231], v[180:183]
    v_mfma_f32_16x16x32_bf16 v[188:191], v[132:135], v[228:231], v[188:191]
    s_waitcnt vmcnt(8) lgkmcnt(4)
    ds_read_b128 v[228:231], v30 offset:2048
    v_mfma_f32_16x16x32_bf16 v[160:163], v[208:211], v[136:139], v[160:163]
    v_mfma_f32_16x16x32_bf16 v[164:167], v[208:211], v[140:143], v[164:167]
    s_waitcnt lgkmcnt(4)
    ds_read_b128 v[208:211], v30 offset:1024
    v_mfma_f32_16x16x32_bf16 v[176:179], v[136:139], v[212:215], v[176:179]
    v_mfma_f32_16x16x32_bf16 v[184:187], v[140:143], v[212:215], v[184:187]
    s_waitcnt lgkmcnt(4)
    ds_read_b128 v[212:215], v30 offset:3072
    v_mfma_f32_16x16x32_bf16 v[168:171], v[216:219], v[136:139], v[168:171]
    v_mfma_f32_16x16x32_bf16 v[172:175], v[216:219], v[140:143], v[172:175]
    s_waitcnt lgkmcnt(4)
    ds_read_b128 v[216:219], v30 offset:4096
    v_mfma_f32_16x16x32_bf16 v[180:183], v[136:139], v[220:223], v[180:183]
    v_mfma_f32_16x16x32_bf16 v[188:191], v[140:143], v[220:223], v[188:191]
    s_waitcnt vmcnt(6) lgkmcnt(4)
    ds_read_b128 v[220:223], v30 offset:6144
    v_mfma_f32_16x16x32_bf16 v[160:163], v[224:227], v[144:147], v[160:163]
    v_mfma_f32_16x16x32_bf16 v[164:167], v[224:227], v[148:151], v[164:167]
    s_waitcnt lgkmcnt(4)
    ds_read_b128 v[224:227], v30 offset:5120
    v_mfma_f32_16x16x32_bf16 v[176:179], v[144:147], v[228:231], v[176:179]
    v_mfma_f32_16x16x32_bf16 v[184:187], v[148:151], v[228:231], v[184:187]
    s_waitcnt lgkmcnt(4)
    ds_read_b128 v[228:231], v30 offset:7168
    v_mfma_f32_16x16x32_bf16 v[168:171], v[208:211], v[144:147], v[168:171]
    v_mfma_f32_16x16x32_bf16 v[172:175], v[208:211], v[148:151], v[172:175]
    s_waitcnt lgkmcnt(4)
    ds_read_b128 v[208:211], v30 offset:8192
    v_mfma_f32_16x16x32_bf16 v[180:183], v[144:147], v[212:215], v[180:183]
    v_mfma_f32_16x16x32_bf16 v[188:191], v[148:151], v[212:215], v[188:191]
    s_waitcnt vmcnt(4) lgkmcnt(4)
    ds_read_b128 v[212:215], v30 offset:9216
    v_mfma_f32_16x16x32_bf16 v[160:163], v[216:219], v[152:155], v[160:163]
    v_mfma_f32_16x16x32_bf16 v[164:167], v[216:219], v[156:159], v[164:167]
    s_waitcnt lgkmcnt(4)
    ds_read_b128 v[216:219], v30 offset:10240
    v_mfma_f32_16x16x32_bf16 v[176:179], v[152:155], v[220:223], v[176:179]
    v_mfma_f32_16x16x32_bf16 v[184:187], v[156:159], v[220:223], v[184:187]
    s_waitcnt lgkmcnt(4)
    ds_read_b128 v[220:223], v30 offset:11264
    v_mfma_f32_16x16x32_bf16 v[168:171], v[224:227], v[152:155], v[168:171]
    v_mfma_f32_16x16x32_bf16 v[172:175], v[224:227], v[156:159], v[172:175]
    s_waitcnt lgkmcnt(4)
    ds_read_b128 v[224:227], v30 offset:12288
    v_mfma_f32_16x16x32_bf16 v[180:183], v[152:155], v[228:231], v[180:183]
    v_mfma_f32_16x16x32_bf16 v[188:191], v[156:159], v[228:231], v[188:191]
    s_waitcnt lgkmcnt(4)
    ds_read_b128 v[228:231], v30 offset:13312
    v_pk_mul_f32 v[160:161], v[160:161], v[240:241] op_sel_hi:[1,0]
    v_cvt_pk_bf16_f32 v160, v160, v161
    v_pk_mul_f32 v[162:163], v[162:163], v[240:241] op_sel_hi:[1,0]
    v_cvt_pk_bf16_f32 v161, v162, v163
    v_pk_mul_f32 v[164:165], v[164:165], v[240:241] op_sel:[0,1] op_sel_hi:[1,1]
    v_cvt_pk_bf16_f32 v162, v164, v165
    v_pk_mul_f32 v[166:167], v[166:167], v[240:241] op_sel:[0,1] op_sel_hi:[1,1]
    v_cvt_pk_bf16_f32 v163, v166, v167
    v_pk_mul_f32 v[168:169], v[168:169], v[240:241] op_sel_hi:[1,0]
    v_cvt_pk_bf16_f32 v164, v168, v169
    v_permlane32_swap_b32 v160, v162
    v_permlane32_swap_b32 v161, v163
    buffer_store_dwordx4 v[160:163], v237, s[4:7], s44 offen offset:0 sc1
    v_pk_mul_f32 v[170:171], v[170:171], v[240:241] op_sel_hi:[1,0]
    v_cvt_pk_bf16_f32 v165, v170, v171
    v_pk_mul_f32 v[172:173], v[172:173], v[240:241] op_sel:[0,1] op_sel_hi:[1,1]
    v_cvt_pk_bf16_f32 v166, v172, v173
    v_pk_mul_f32 v[174:175], v[174:175], v[240:241] op_sel:[0,1] op_sel_hi:[1,1]
    v_cvt_pk_bf16_f32 v167, v174, v175
    v_pk_mul_f32 v[176:177], v[176:177], v[48:49]
    v_cvt_pk_bf16_f32 v176, v176, v177
    v_permlane32_swap_b32 v164, v166
    v_permlane32_swap_b32 v165, v167
    buffer_store_dwordx4 v[164:167], v237, s[4:7], s44 offen offset:1024 sc1
    v_pk_mul_f32 v[178:179], v[178:179], v[50:51]
    v_cvt_pk_bf16_f32 v177, v178, v179
    v_pk_mul_f32 v[180:181], v[180:181], v[48:49]
    v_cvt_pk_bf16_f32 v178, v180, v181
    v_pk_mul_f32 v[182:183], v[182:183], v[50:51]
    v_cvt_pk_bf16_f32 v179, v182, v183
    v_pk_mul_f32 v[184:185], v[184:185], v[52:53]
    v_cvt_pk_bf16_f32 v180, v184, v185
    v_permlane32_swap_b32 v176, v178
    v_permlane32_swap_b32 v177, v179
    buffer_store_dwordx4 v[176:179], v237, s[4:7], s44 offen offset:2048 sc1
    v_pk_mul_f32 v[186:187], v[186:187], v[54:55]
    v_cvt_pk_bf16_f32 v181, v186, v187
    v_pk_mul_f32 v[188:189], v[188:189], v[52:53]
    v_cvt_pk_bf16_f32 v182, v188, v189
    v_pk_mul_f32 v[190:191], v[190:191], v[54:55]
    v_cvt_pk_bf16_f32 v183, v190, v191
    v_permlane32_swap_b32 v180, v182
    s_nop 0
    v_permlane32_swap_b32 v181, v183
    buffer_store_dwordx4 v[180:183], v237, s[4:7], s44 offen offset:3072 sc1
    v_mfma_f32_16x16x32_bf16 v[192:195], v[208:211], v[64:67], v[192:195]
    v_mfma_f32_16x16x32_bf16 v[196:199], v[208:211], v[68:71], v[196:199]
    s_waitcnt lgkmcnt(4)
    ds_read_b128 v[208:211], v30 offset:14336
    v_mfma_f32_16x16x32_bf16 v[200:203], v[212:215], v[64:67], v[200:203]
    v_mfma_f32_16x16x32_bf16 v[204:207], v[212:215], v[68:71], v[204:207]
    s_waitcnt lgkmcnt(4)
    ds_read_b128 v[212:215], v30 offset:15360
    v_mfma_f32_16x16x32_bf16 v[192:195], v[216:219], v[72:75], v[192:195]
    v_mfma_f32_16x16x32_bf16 v[196:199], v[216:219], v[76:79], v[196:199]
    s_waitcnt vmcnt(4) lgkmcnt(4)
    s_barrier
    ds_read_b128 v[216:219], v30 offset:16384
    v_mfma_f32_16x16x32_bf16 v[200:203], v[220:223], v[72:75], v[200:203]
    v_mfma_f32_16x16x32_bf16 v[204:207], v[220:223], v[76:79], v[204:207]
    s_waitcnt lgkmcnt(4)
    ds_read_b128 v[220:223], v30 offset:17408
    ds_write_b128 v2, v[160:163] offset:0
    v_mfma_f32_16x16x32_bf16 v[192:195], v[224:227], v[80:83], v[192:195]
    v_xor_b32 v48, 0xff800000, v32
    v_xor_b32 v49, 0xff800000, v33
    v_mfma_f32_16x16x32_bf16 v[196:199], v[224:227], v[84:87], v[196:199]
    s_waitcnt lgkmcnt(5)
    ds_read_b128 v[224:227], v30 offset:18432
    v_xor_b32 v50, 0xff800000, v34
    v_mfma_f32_16x16x32_bf16 v[200:203], v[228:231], v[80:83], v[200:203]
    v_xor_b32 v51, 0xff800000, v35
    v_mfma_f32_16x16x32_bf16 v[204:207], v[228:231], v[84:87], v[204:207]
    s_waitcnt lgkmcnt(5)
    ds_read_b128 v[228:231], v30 offset:19456
    buffer_store_dwordx4 v[160:163], v237, s[4:7], s45 offen offset:0
    v_mfma_f32_16x16x32_bf16 v[192:195], v[208:211], v[88:91], v[192:195]
    v_mov_b32 v64, 0x3f803f80
    v_mov_b32 v65, 0x3f803f80
    v_mfma_f32_16x16x32_bf16 v[196:199], v[208:211], v[92:95], v[196:199]
    s_waitcnt lgkmcnt(5)
    ds_read_b128 v[208:211], v30 offset:20480
    v_mov_b32 v66, 0x3f803f80
    v_mfma_f32_16x16x32_bf16 v[200:203], v[212:215], v[88:91], v[200:203]
    v_mov_b32 v67, 0x3f803f80
    v_mfma_f32_16x16x32_bf16 v[204:207], v[212:215], v[92:95], v[204:207]
    s_waitcnt lgkmcnt(5)
    ds_read_b128 v[212:215], v30 offset:21504
    ds_write_b128 v2, v[164:167] offset:1024
    v_mfma_f32_16x16x32_bf16 v[192:195], v[216:219], v[96:99], v[192:195]
    v_xor_b32 v52, 0xff800000, v36
    v_xor_b32 v53, 0xff800000, v37
    v_mfma_f32_16x16x32_bf16 v[196:199], v[216:219], v[100:103], v[196:199]
    s_waitcnt lgkmcnt(6)
    ds_read_b128 v[216:219], v30 offset:22528
    v_xor_b32 v54, 0xff800000, v38
    v_mfma_f32_16x16x32_bf16 v[200:203], v[220:223], v[96:99], v[200:203]
    v_xor_b32 v55, 0xff800000, v39
    v_mfma_f32_16x16x32_bf16 v[204:207], v[220:223], v[100:103], v[204:207]
    s_waitcnt lgkmcnt(5)
    ds_read_b128 v[220:223], v30 offset:23552
    buffer_store_dwordx4 v[164:167], v237, s[4:7], s45 offen offset:1024
    v_mfma_f32_16x16x32_bf16 v[192:195], v[224:227], v[104:107], v[192:195]
    v_mov_b32 v68, 0x3f803f80
    v_mov_b32 v69, 0x3f803f80
    v_mfma_f32_16x16x32_bf16 v[196:199], v[224:227], v[108:111], v[196:199]
    s_waitcnt lgkmcnt(5)
    ds_read_b128 v[224:227], v30 offset:24576
    v_mov_b32 v70, 0x3f803f80
    v_mfma_f32_16x16x32_bf16 v[200:203], v[228:231], v[104:107], v[200:203]
    v_mov_b32 v71, 0x3f803f80
    v_mfma_f32_16x16x32_bf16 v[204:207], v[228:231], v[108:111], v[204:207]
    s_waitcnt lgkmcnt(5)
    ds_read_b128 v[228:231], v30 offset:25600
    ds_write_b128 v2, v[176:179] offset:2048
    v_mfma_f32_16x16x32_bf16 v[192:195], v[208:211], v[112:115], v[192:195]
    v_xor_b32 v56, 0xff800000, v40
    v_xor_b32 v57, 0xff800000, v41
    v_mfma_f32_16x16x32_bf16 v[196:199], v[208:211], v[116:119], v[196:199]
    s_waitcnt lgkmcnt(6)
    ds_read_b128 v[208:211], v30 offset:26624
    v_xor_b32 v58, 0xff800000, v42
    v_mfma_f32_16x16x32_bf16 v[200:203], v[212:215], v[112:115], v[200:203]
    v_xor_b32 v59, 0xff800000, v43
    v_mfma_f32_16x16x32_bf16 v[204:207], v[212:215], v[116:119], v[204:207]
    s_waitcnt lgkmcnt(5)
    ds_read_b128 v[212:215], v30 offset:27648
    buffer_store_dwordx4 v[176:179], v237, s[4:7], s45 offen offset:2048
    v_mfma_f32_16x16x32_bf16 v[192:195], v[216:219], v[120:123], v[192:195]
    v_mov_b32 v72, 0x3f803f80
    v_mov_b32 v73, 0x3f803f80
    v_mfma_f32_16x16x32_bf16 v[196:199], v[216:219], v[124:127], v[196:199]
    s_waitcnt lgkmcnt(5)
    ds_read_b128 v[216:219], v30 offset:28672
    v_mov_b32 v74, 0x3f803f80
    v_mfma_f32_16x16x32_bf16 v[200:203], v[220:223], v[120:123], v[200:203]
    v_mov_b32 v75, 0x3f803f80
    v_mfma_f32_16x16x32_bf16 v[204:207], v[220:223], v[124:127], v[204:207]
    s_waitcnt lgkmcnt(5)
    ds_read_b128 v[220:223], v30 offset:29696
    ds_write_b128 v2, v[180:183] offset:3072
    v_mfma_f32_16x16x32_bf16 v[192:195], v[224:227], v[128:131], v[192:195]
    v_xor_b32 v60, 0xff800000, v44
    v_xor_b32 v61, 0xff800000, v45
    v_mfma_f32_16x16x32_bf16 v[196:199], v[224:227], v[132:135], v[196:199]
    s_waitcnt lgkmcnt(6)
    ds_read_b128 v[224:227], v30 offset:30720
    v_xor_b32 v62, 0xff800000, v46
    v_mfma_f32_16x16x32_bf16 v[200:203], v[228:231], v[128:131], v[200:203]
    v_xor_b32 v63, 0xff800000, v47
    v_mfma_f32_16x16x32_bf16 v[204:207], v[228:231], v[132:135], v[204:207]
    s_waitcnt lgkmcnt(5)
    ds_read_b128 v[228:231], v30 offset:31744
    buffer_store_dwordx4 v[180:183], v237, s[4:7], s45 offen offset:3072
    v_mfma_f32_16x16x32_bf16 v[192:195], v[208:211], v[136:139], v[192:195]
    v_mov_b32 v76, 0x3f803f80
    v_mov_b32 v77, 0x3f803f80
    v_mfma_f32_16x16x32_bf16 v[196:199], v[208:211], v[140:143], v[196:199]
    s_waitcnt lgkmcnt(5)
    v_mov_b32 v78, 0x3f803f80
    v_mov_b32 v79, 0x3f803f80
    v_mfma_f32_16x16x32_bf16 v[200:203], v[212:215], v[136:139], v[200:203]
    v_mfma_f32_16x16x32_bf16 v[204:207], v[212:215], v[140:143], v[204:207]
    s_waitcnt lgkmcnt(4)
    v_mfma_f32_16x16x32_bf16 v[192:195], v[216:219], v[144:147], v[192:195]
    v_mfma_f32_16x16x32_bf16 v[196:199], v[216:219], v[148:151], v[196:199]
    s_waitcnt lgkmcnt(3)
    v_mfma_f32_16x16x32_bf16 v[200:203], v[220:223], v[144:147], v[200:203]
    v_mfma_f32_16x16x32_bf16 v[204:207], v[220:223], v[148:151], v[204:207]
    s_waitcnt lgkmcnt(1)
    v_mfma_f32_16x16x32_bf16 v[192:195], v[224:227], v[152:155], v[192:195]
    v_mfma_f32_16x16x32_bf16 v[196:199], v[224:227], v[156:159], v[196:199]
    s_waitcnt lgkmcnt(0)
    v_mfma_f32_16x16x32_bf16 v[200:203], v[228:231], v[152:155], v[200:203]
    v_mfma_f32_16x16x32_bf16 v[204:207], v[228:231], v[156:159], v[204:207]
    s_nop 3
    v_pk_mul_f32 v[192:193], v[192:193], v[238:239] op_sel_hi:[1,0]
    v_cvt_pk_bf16_f32 v192, v192, v193
    v_pk_mul_f32 v[194:195], v[194:195], v[238:239] op_sel_hi:[1,0]
    v_cvt_pk_bf16_f32 v193, v194, v195
    v_pk_mul_f32 v[196:197], v[196:197], v[238:239] op_sel:[0,1] op_sel_hi:[1,1]
    v_cvt_pk_bf16_f32 v194, v196, v197
    v_pk_mul_f32 v[198:199], v[198:199], v[238:239] op_sel:[0,1] op_sel_hi:[1,1]
    v_cvt_pk_bf16_f32 v195, v198, v199
    v_pk_mul_f32 v[200:201], v[200:201], v[238:239] op_sel_hi:[1,0]
    v_cvt_pk_bf16_f32 v196, v200, v201
    v_permlane32_swap_b32 v192, v194
    v_permlane32_swap_b32 v193, v195
    ds_write_b128 v252, v[192:195]
    v_pk_mul_f32 v[202:203], v[202:203], v[238:239] op_sel_hi:[1,0]
    v_cvt_pk_bf16_f32 v197, v202, v203
    v_pk_mul_f32 v[204:205], v[204:205], v[238:239] op_sel:[0,1] op_sel_hi:[1,1]
    v_cvt_pk_bf16_f32 v198, v204, v205
    v_pk_mul_f32 v[206:207], v[206:207], v[238:239] op_sel:[0,1] op_sel_hi:[1,1]
    v_cvt_pk_bf16_f32 v199, v206, v207
    v_permlane32_swap_b32 v196, v198
    s_nop 0
    v_permlane32_swap_b32 v197, v199
    ds_write_b128 v254, v[196:199] offset:1024
    v_xor_b32 v252, 1024, v247
    s_mov_b32 s87, 671088640
    s_cmp_eq_u32 s17, 1
    s_cbranch_scc1 ATT1_1
    s_cmp_eq_u32 s17, 2
    s_cbranch_scc1 ATT1_2
    s_cmp_eq_u32 s17, 3
    s_cbranch_scc1 ATT1_3
    s_branch ATT1_0
.p2align 12
ATT1_0:
    s_waitcnt vmcnt(4)
    buffer_store_dword v11, v9, s[4:7], s47 offen offset:0 sc1
    s_waitcnt lgkmcnt(0)
    s_barrier
    ds_read_b128 v[144:147], v247
    ds_read_b128 v[148:151], v252
    ds_read_b128 v[136:139], v249 offset:32768
    ds_read_b128 v[140:143], v249 offset:36864
    s_mov_b64 exec, s[20:21]
    ds_read_b128 v[64:67], v251 offset:32768
    ds_read_b128 v[68:71], v251 offset:33792
    s_mov_b64 exec, -1
    s_waitcnt vmcnt(1)
    s_cbranch_vccnz SAFE_163
    buffer_store_dword v11, v10, s[4:7], s46 offen offset:0
BACK_164:
    s_waitcnt lgkmcnt(3)
    v_mfma_f32_32x32x16_bf16 v[96:111], v[136:139], v[148:151], 0
    ds_read_b128 v[136:139], v249 offset:57344
    s_waitcnt lgkmcnt(3)
    v_mfma_f32_32x32x16_bf16 v[112:127], v[140:143], v[148:151], 0
    s_waitcnt lgkmcnt(1)
    ds_read_b128 v[140:143], v249 offset:61440
    s_nop 6
    v_exp_f32 v96, v96
    v_exp_f32 v97, v97
    v_exp_f32 v98, v98
    v_exp_f32 v99, v99
    s_mov_b64 exec, s[20:21]
    ds_read_b128 v[72:75], v251 offset:36864
    ds_read_b128 v[76:79], v251 offset:37888
    s_mov_b64 exec, -1
    v_cvt_pk_bf16_f32 v128, v96, v97
    v_exp_f32 v100, v100
    v_exp_f32 v101, v101
    v_cvt_pk_bf16_f32 v129, v98, v99
    v_exp_f32 v102, v102
    v_exp_f32 v103, v103
    v_exp_f32 v104, v104
    v_cvt_pk_bf16_f32 v130, v100, v101
    v_cvt_pk_bf16_f32 v131, v102, v103
    v_exp_f32 v105, v105
    v_exp_f32 v106, v106
    v_mfma_f32_32x32x16_bf16 v[208:223], v[64:67], v[128:131], 0
    buffer_load_dword v14, v1, s[4:7], s48 offen offset:0 sc1
    v_exp_f32 v107, v107
    v_cvt_pk_bf16_f32 v132, v104, v105
    v_exp_f32 v108, v108
    v_exp_f32 v109, v109
    v_cvt_pk_bf16_f32 v133, v106, v107
    v_exp_f32 v110, v110
    v_exp_f32 v111, v111
    v_cvt_pk_bf16_f32 v134, v108, v109
    v_cvt_pk_bf16_f32 v135, v110, v111
    s_waitcnt lgkmcnt(3)
    v_mfma_f32_32x32x16_bf16 v[96:111], v[136:139], v[148:151], 0
    s_waitcnt lgkmcnt(0)
    ds_read_b128 v[136:139], v248 offset:32768
    v_exp_f32 v112, v112
    v_exp_f32 v113, v113
    v_exp_f32 v114, v114
    v_exp_f32 v115, v115
    v_mfma_f32_32x32x16_bf16 v[208:223], v[68:71], v[132:135], v[208:223]
    s_mov_b64 exec, s[20:21]
    ds_read_b128 v[64:67], v251 offset:57344
    ds_read_b128 v[68:71], v251 offset:58368
    s_mov_b64 exec, -1
    v_cvt_pk_bf16_f32 v128, v112, v113
    v_exp_f32 v116, v116
    v_exp_f32 v117, v117
    v_cvt_pk_bf16_f32 v129, v114, v115
    v_exp_f32 v118, v118
    v_exp_f32 v119, v119
    v_exp_f32 v120, v120
    v_cvt_pk_bf16_f32 v130, v116, v117
    v_cvt_pk_bf16_f32 v131, v118, v119
    v_exp_f32 v121, v121
    v_exp_f32 v122, v122
    v_mfma_f32_32x32x16_bf16 v[208:223], v[72:75], v[128:131], v[208:223]
    s_waitcnt vmcnt(0)
    v_cmp_gt_u32 vcc, s35, v14
    s_cbranch_vccnz SPIN_157
BACK_158:
    s_mov_b32 m0, s50
    s_nop 0
    buffer_load_dwordx4 v16, s[4:7], s49 offen offset:0 sc1 lds
    buffer_load_dwordx4 v16, s[4:7], s49 offen offset:1024 sc1 lds
    buffer_load_dwordx4 v16, s[4:7], s49 offen offset:2048 sc1 lds
    buffer_load_dwordx4 v16, s[4:7], s49 offen offset:3072 sc1 lds
    v_exp_f32 v123, v123
    v_cvt_pk_bf16_f32 v132, v120, v121
    v_exp_f32 v124, v124
    v_exp_f32 v125, v125
    v_cvt_pk_bf16_f32 v133, v122, v123
    v_exp_f32 v126, v126
    v_exp_f32 v127, v127
    v_cvt_pk_bf16_f32 v134, v124, v125
    v_cvt_pk_bf16_f32 v135, v126, v127
    v_mfma_f32_32x32x16_bf16 v[112:127], v[140:143], v[148:151], v[32:47]
    s_waitcnt lgkmcnt(0)
    v_exp_f32 v96, v96
    v_exp_f32 v97, v97
    v_exp_f32 v98, v98
    v_exp_f32 v99, v99
    v_mfma_f32_32x32x16_bf16 v[208:223], v[76:79], v[132:135], v[208:223]
    s_mov_b64 exec, s[20:21]
    ds_read_b128 v[72:75], v251 offset:61440
    ds_read_b128 v[76:79], v251 offset:62464
    s_mov_b64 exec, -1
    v_cvt_pk_bf16_f32 v128, v96, v97
    v_exp_f32 v100, v100
    v_exp_f32 v101, v101
    v_cvt_pk_bf16_f32 v129, v98, v99
    v_exp_f32 v102, v102
    v_exp_f32 v103, v103
    v_exp_f32 v104, v104
    v_cvt_pk_bf16_f32 v130, v100, v101
    v_cvt_pk_bf16_f32 v131, v102, v103
    v_exp_f32 v105, v105
    v_exp_f32 v106, v106
    v_mfma_f32_32x32x16_bf16 v[208:223], v[64:67], v[128:131], v[208:223]
    buffer_load_dword v2, v4, s[4:7], s51 offen offset:0 sc1
    v_exp_f32 v107, v107
    v_cvt_pk_bf16_f32 v132, v104, v105
    v_exp_f32 v108, v108
    v_exp_f32 v109, v109
    v_cvt_pk_bf16_f32 v133, v106, v107
    v_exp_f32 v110, v110
    v_exp_f32 v111, v111
    v_cvt_pk_bf16_f32 v134, v108, v109
    v_cvt_pk_bf16_f32 v135, v110, v111
    v_mfma_f32_32x32x16_bf16 v[96:111], v[136:139], v[144:147], v[32:47]
    s_waitcnt lgkmcnt(0)
    v_exp_f32 v112, v112
    v_exp_f32 v113, v113
    v_exp_f32 v114, v114
    v_exp_f32 v115, v115
    v_mfma_f32_32x32x16_bf16 v[208:223], v[68:71], v[132:135], v[208:223]
    s_mov_b64 exec, s[20:21]
    ds_read_b128 v[64:67], v250 offset:32768
    ds_read_b128 v[68:71], v250 offset:33792
    s_mov_b64 exec, -1
    v_cvt_pk_bf16_f32 v128, v112, v113
    v_exp_f32 v116, v116
    v_exp_f32 v117, v117
    v_cvt_pk_bf16_f32 v129, v114, v115
    v_exp_f32 v118, v118
    v_exp_f32 v119, v119
    v_exp_f32 v120, v120
    v_cvt_pk_bf16_f32 v130, v116, v117
    v_cvt_pk_bf16_f32 v131, v118, v119
    v_exp_f32 v121, v121
    v_exp_f32 v122, v122
    v_mfma_f32_32x32x16_bf16 v[208:223], v[72:75], v[128:131], v[208:223]
    s_waitcnt vmcnt(1)
    s_barrier
    ds_read_b128 v[140:143], v249 offset:40960
    ds_read_b128 v[136:139], v249 offset:45056
    v_exp_f32 v123, v123
    v_cvt_pk_bf16_f32 v132, v120, v121
    v_exp_f32 v124, v124
    v_exp_f32 v125, v125
    v_cvt_pk_bf16_f32 v133, v122, v123
    v_exp_f32 v126, v126
    v_exp_f32 v127, v127
    v_cvt_pk_bf16_f32 v134, v124, v125
    v_cvt_pk_bf16_f32 v135, v126, v127
    s_waitcnt lgkmcnt(1)
    v_mfma_f32_32x32x16_bf16 v[112:127], v[140:143], v[148:151], 0
    ds_read_b128 v[140:143], v249 offset:49152
    v_exp_f32 v96, v96
    v_exp_f32 v97, v97
    v_exp_f32 v98, v98
    v_exp_f32 v99, v99
    v_mfma_f32_32x32x16_bf16 v[208:223], v[76:79], v[132:135], v[208:223]
    s_mov_b64 exec, s[20:21]
    ds_read_b128 v[72:75], v251 offset:40960
    ds_read_b128 v[76:79], v251 offset:41984
    s_mov_b64 exec, -1
    v_cvt_pk_bf16_f32 v128, v96, v97
    v_exp_f32 v100, v100
    v_exp_f32 v101, v101
    v_cvt_pk_bf16_f32 v129, v98, v99
    v_exp_f32 v102, v102
    v_exp_f32 v103, v103
    v_exp_f32 v104, v104
    v_cvt_pk_bf16_f32 v130, v100, v101
    v_cvt_pk_bf16_f32 v131, v102, v103
    v_exp_f32 v105, v105
    v_exp_f32 v106, v106
    v_mfma_f32_32x32x16_bf16 v[192:207], v[64:67], v[128:131], 0
    s_waitcnt vmcnt(0)
    v_cmp_gt_u32 vcc, s35, v2
    s_cbranch_vccnz SPIN_160
BACK_161:
    s_add_u32 m0, s82, 114688
    s_nop 0
    buffer_load_dwordx4 v16, s[4:7], s96 offen offset:0 sc1 lds
    buffer_load_dwordx4 v16, s[4:7], s96 offen offset:1024 sc1 lds
    buffer_load_dwordx4 v16, s[4:7], s96 offen offset:2048 sc1 lds
    buffer_load_dwordx4 v16, s[4:7], s96 offen offset:3072 sc1 lds
    v_exp_f32 v107, v107
    v_cvt_pk_bf16_f32 v132, v104, v105
    v_exp_f32 v108, v108
    v_exp_f32 v109, v109
    v_cvt_pk_bf16_f32 v133, v106, v107
    v_exp_f32 v110, v110
    v_exp_f32 v111, v111
    v_cvt_pk_bf16_f32 v134, v108, v109
    v_cvt_pk_bf16_f32 v135, v110, v111
    s_waitcnt lgkmcnt(3)
    v_mfma_f32_32x32x16_bf16 v[96:111], v[136:139], v[148:151], 0
    s_waitcnt lgkmcnt(0)
    ds_read_b128 v[136:139], v249 offset:53248
    v_exp_f32 v112, v112
    v_exp_f32 v113, v113
    v_exp_f32 v114, v114
    v_exp_f32 v115, v115
    v_mfma_f32_32x32x16_bf16 v[192:207], v[68:71], v[132:135], v[192:207]
    s_mov_b64 exec, s[20:21]
    ds_read_b128 v[64:67], v251 offset:45056
    ds_read_b128 v[68:71], v251 offset:46080
    s_mov_b64 exec, -1
    v_cvt_pk_bf16_f32 v128, v112, v113
    v_exp_f32 v116, v116
    v_exp_f32 v117, v117
    v_cvt_pk_bf16_f32 v129, v114, v115
    v_exp_f32 v118, v118
    v_exp_f32 v119, v119
    v_exp_f32 v120, v120
    v_cvt_pk_bf16_f32 v130, v116, v117
    v_cvt_pk_bf16_f32 v131, v118, v119
    v_exp_f32 v121, v121
    v_exp_f32 v122, v122
    v_mfma_f32_32x32x16_bf16 v[208:223], v[72:75], v[128:131], v[208:223]
    v_exp_f32 v123, v123
    v_cvt_pk_bf16_f32 v132, v120, v121
    v_exp_f32 v124, v124
    v_exp_f32 v125, v125
    v_cvt_pk_bf16_f32 v133, v122, v123
    v_exp_f32 v126, v126
    v_exp_f32 v127, v127
    v_cvt_pk_bf16_f32 v134, v124, v125
    v_cvt_pk_bf16_f32 v135, v126, v127
    v_mfma_f32_32x32x16_bf16 v[112:127], v[140:143], v[148:151], 0
    s_waitcnt lgkmcnt(0)
    s_add_u32 m0, s82, 98304
    s_nop 0
    buffer_load_dwordx4 v16, s[4:7], s97 offen offset:0 sc1 lds
    buffer_load_dwordx4 v16, s[4:7], s97 offen offset:1024 sc1 lds
    buffer_load_dwordx4 v16, s[4:7], s97 offen offset:2048 sc1 lds
    buffer_load_dwordx4 v16, s[4:7], s97 offen offset:3072 sc1 lds
    v_exp_f32 v96, v96
    v_exp_f32 v97, v97
    v_exp_f32 v98, v98
    v_exp_f32 v99, v99
    v_mfma_f32_32x32x16_bf16 v[208:223], v[76:79], v[132:135], v[208:223]
    s_mov_b64 exec, s[20:21]
    ds_read_b128 v[72:75], v251 offset:49152
    ds_read_b128 v[76:79], v251 offset:50176
    s_mov_b64 exec, -1
    v_cvt_pk_bf16_f32 v128, v96, v97
    v_exp_f32 v100, v100
    v_exp_f32 v101, v101
    v_cvt_pk_bf16_f32 v129, v98, v99
    v_exp_f32 v102, v102
    v_exp_f32 v103, v103
    v_exp_f32 v104, v104
    v_cvt_pk_bf16_f32 v130, v100, v101
    v_cvt_pk_bf16_f32 v131, v102, v103
    v_exp_f32 v105, v105
    v_exp_f32 v106, v106
    v_mfma_f32_32x32x16_bf16 v[208:223], v[64:67], v[128:131], v[208:223]
    v_exp_f32 v107, v107
    v_cvt_pk_bf16_f32 v132, v104, v105
    v_exp_f32 v108, v108
    v_exp_f32 v109, v109
    v_cvt_pk_bf16_f32 v133, v106, v107
    v_exp_f32 v110, v110
    v_exp_f32 v111, v111
    v_cvt_pk_bf16_f32 v134, v108, v109
    v_cvt_pk_bf16_f32 v135, v110, v111
    s_cmp_eq_u32 s12, 0
    s_cbranch_scc1 ATTG01_0
    v_mfma_f32_32x32x16_bf16 v[96:111], v[136:139], v[148:151], 0
    s_waitcnt lgkmcnt(0)
    v_exp_f32 v112, v112
    v_exp_f32 v113, v113
    v_exp_f32 v114, v114
    v_exp_f32 v115, v115
    v_mfma_f32_32x32x16_bf16 v[208:223], v[68:71], v[132:135], v[208:223]
    s_mov_b64 exec, s[20:21]
    ds_read_b128 v[64:67], v251 offset:53248
    ds_read_b128 v[68:71], v251 offset:54272
    s_mov_b64 exec, -1
    v_cvt_pk_bf16_f32 v128, v112, v113
    v_exp_f32 v116, v116
    v_exp_f32 v117, v117
    v_cvt_pk_bf16_f32 v129, v114, v115
    v_exp_f32 v118, v118
    v_exp_f32 v119, v119
    v_exp_f32 v120, v120
    v_cvt_pk_bf16_f32 v130, v116, v117
    v_cvt_pk_bf16_f32 v131, v118, v119
    v_exp_f32 v121, v121
    v_exp_f32 v122, v122
    v_mfma_f32_32x32x16_bf16 v[208:223], v[72:75], v[128:131], v[208:223]
    s_waitcnt vmcnt(4)
    s_barrier
    ds_read_b128 v[140:143], v249 offset:28672
    ds_read_b128 v[136:139], v248 offset:28672
    v_exp_f32 v123, v123
    v_cvt_pk_bf16_f32 v132, v120, v121
    v_exp_f32 v124, v124
    v_exp_f32 v125, v125
    v_cvt_pk_bf16_f32 v133, v122, v123
    v_exp_f32 v126, v126
    v_exp_f32 v127, v127
    v_cvt_pk_bf16_f32 v134, v124, v125
    v_cvt_pk_bf16_f32 v135, v126, v127
    s_waitcnt lgkmcnt(1)
    v_mfma_f32_32x32x16_bf16 v[112:127], v[140:143], v[148:151], v[48:63]
    ds_read_b128 v[140:143], v248 offset:24576
    v_exp_f32 v96, v96
    v_exp_f32 v97, v97
    v_exp_f32 v98, v98
    v_exp_f32 v99, v99
    v_mfma_f32_32x32x16_bf16 v[208:223], v[76:79], v[132:135], v[208:223]
    s_mov_b64 exec, s[20:21]
    ds_read_b128 v[72:75], v251 offset:28672
    ds_read_b128 v[76:79], v251 offset:29696
    s_mov_b64 exec, -1
    v_cvt_pk_bf16_f32 v128, v96, v97
    v_exp_f32 v100, v100
    v_exp_f32 v101, v101
    v_cvt_pk_bf16_f32 v129, v98, v99
    v_exp_f32 v102, v102
    v_exp_f32 v103, v103
    v_exp_f32 v104, v104
    v_cvt_pk_bf16_f32 v130, v100, v101
    v_cvt_pk_bf16_f32 v131, v102, v103
    v_exp_f32 v105, v105
    v_exp_f32 v106, v106
    v_mfma_f32_32x32x16_bf16 v[208:223], v[64:67], v[128:131], v[208:223]
    v_exp_f32 v107, v107
    v_cvt_pk_bf16_f32 v132, v104, v105
    v_exp_f32 v108, v108
    v_exp_f32 v109, v109
    v_cvt_pk_bf16_f32 v133, v106, v107
    v_exp_f32 v110, v110
    v_exp_f32 v111, v111
    v_cvt_pk_bf16_f32 v134, v108, v109
    v_cvt_pk_bf16_f32 v135, v110, v111
    s_waitcnt lgkmcnt(3)
    v_mfma_f32_32x32x16_bf16 v[96:111], v[136:139], v[144:147], 0
    s_waitcnt lgkmcnt(0)
    ds_read_b128 v[136:139], v248 offset:20480
    v_exp_f32 v112, v112
    v_exp_f32 v113, v113
    v_exp_f32 v114, v114
    v_exp_f32 v115, v115
    v_mfma_f32_32x32x16_bf16 v[208:223], v[68:71], v[132:135], v[208:223]
    s_mov_b64 exec, s[20:21]
    ds_read_b128 v[64:67], v250 offset:28672
    ds_read_b128 v[68:71], v250 offset:29696
    s_mov_b64 exec, -1
    v_cvt_pk_bf16_f32 v128, v112, v113
    v_exp_f32 v116, v116
    v_exp_f32 v117, v117
    v_cvt_pk_bf16_f32 v129, v114, v115
    v_exp_f32 v118, v118
    v_exp_f32 v119, v119
    v_exp_f32 v120, v120
    v_cvt_pk_bf16_f32 v130, v116, v117
    v_cvt_pk_bf16_f32 v131, v118, v119
    v_exp_f32 v121, v121
    v_exp_f32 v122, v122
    v_mfma_f32_32x32x16_bf16 v[208:223], v[72:75], v[128:131], v[208:223]
    v_exp_f32 v123, v123
    v_cvt_pk_bf16_f32 v132, v120, v121
    v_exp_f32 v124, v124
    v_exp_f32 v125, v125
    v_cvt_pk_bf16_f32 v133, v122, v123
    v_exp_f32 v126, v126
    v_exp_f32 v127, v127
    v_cvt_pk_bf16_f32 v134, v124, v125
    v_cvt_pk_bf16_f32 v135, v126, v127
    v_mfma_f32_32x32x16_bf16 v[112:127], v[140:143], v[144:147], 0
    s_waitcnt lgkmcnt(0)
    ds_read_b128 v[140:143], v248 offset:16384
    v_exp_f32 v96, v96
    v_exp_f32 v97, v97
    v_exp_f32 v98, v98
    v_exp_f32 v99, v99
    v_mfma_f32_32x32x16_bf16 v[208:223], v[76:79], v[132:135], v[208:223]
    s_mov_b64 exec, s[20:21]
    ds_read_b128 v[72:75], v250 offset:24576
    ds_read_b128 v[76:79], v250 offset:25600
    s_mov_b64 exec, -1
    v_cvt_pk_bf16_f32 v128, v96, v97
    v_exp_f32 v100, v100
    v_exp_f32 v101, v101
    v_cvt_pk_bf16_f32 v129, v98, v99
    v_exp_f32 v102, v102
    v_exp_f32 v103, v103
    v_exp_f32 v104, v104
    v_cvt_pk_bf16_f32 v130, v100, v101
    v_cvt_pk_bf16_f32 v131, v102, v103
    v_exp_f32 v105, v105
    v_exp_f32 v106, v106
    v_mfma_f32_32x32x16_bf16 v[192:207], v[64:67], v[128:131], v[192:207]
    s_waitcnt vmcnt(0)
    s_barrier
    v_subrev_u32 v217, 0x2b800000, v216
    v_cmp_lt_u32 s[26:27], s87, v217
    s_nop 0
    s_cmp_lg_u64 s[26:27], 0
    s_cbranch_scc1 SLOW_165
BACK_166:
    v_rcp_f32 v217, v216
    s_nop 0
    v_mul_f32 v208, v208, v217
    v_mul_f32 v209, v209, v217
    v_cvt_pk_bf16_f32 v220, v208, v209
    v_mul_f32 v210, v210, v217
    v_mul_f32 v211, v211, v217
    v_cvt_pk_bf16_f32 v221, v210, v211
    v_mul_f32 v212, v212, v217
    v_mul_f32 v213, v213, v217
    v_cvt_pk_bf16_f32 v222, v212, v213
    v_mul_f32 v214, v214, v217
    v_mul_f32 v215, v215, v217
    v_cvt_pk_bf16_f32 v223, v214, v215
    v_exp_f32 v107, v107
    v_cvt_pk_bf16_f32 v132, v104, v105
    v_exp_f32 v108, v108
    v_exp_f32 v109, v109
    v_cvt_pk_bf16_f32 v133, v106, v107
    v_exp_f32 v110, v110
    v_exp_f32 v111, v111
    v_cvt_pk_bf16_f32 v134, v108, v109
    v_cvt_pk_bf16_f32 v135, v110, v111
    v_mfma_f32_32x32x16_bf16 v[96:111], v[136:139], v[144:147], 0
    s_waitcnt lgkmcnt(0)
    ds_read_b128 v[136:139], v248 offset:12288
    buffer_store_dwordx4 v[220:223], v0, s[4:7], s54 offen
    v_exp_f32 v112, v112
    v_exp_f32 v113, v113
    v_exp_f32 v114, v114
    v_exp_f32 v115, v115
    v_mfma_f32_32x32x16_bf16 v[192:207], v[68:71], v[132:135], v[192:207]
    s_mov_b64 exec, s[20:21]
    ds_read_b128 v[64:67], v250 offset:20480
    ds_read_b128 v[68:71], v250 offset:21504
    s_mov_b64 exec, -1
    v_cvt_pk_bf16_f32 v128, v112, v113
    v_exp_f32 v116, v116
    v_exp_f32 v117, v117
    v_cvt_pk_bf16_f32 v129, v114, v115
    v_exp_f32 v118, v118
    v_exp_f32 v119, v119
    v_exp_f32 v120, v120
    v_cvt_pk_bf16_f32 v130, v116, v117
    v_cvt_pk_bf16_f32 v131, v118, v119
    v_exp_f32 v121, v121
    v_exp_f32 v122, v122
    v_mfma_f32_32x32x16_bf16 v[192:207], v[72:75], v[128:131], v[192:207]
    v_exp_f32 v123, v123
    v_cvt_pk_bf16_f32 v132, v120, v121
    v_exp_f32 v124, v124
    v_exp_f32 v125, v125
    v_cvt_pk_bf16_f32 v133, v122, v123
    v_exp_f32 v126, v126
    v_exp_f32 v127, v127
    v_cvt_pk_bf16_f32 v134, v124, v125
    v_cvt_pk_bf16_f32 v135, v126, v127
    v_mfma_f32_32x32x16_bf16 v[112:127], v[140:143], v[144:147], 0
    s_waitcnt lgkmcnt(0)
    ds_read_b128 v[140:143], v248 offset:8192
    v_exp_f32 v96, v96
    v_exp_f32 v97, v97
    v_exp_f32 v98, v98
    v_exp_f32 v99, v99
    v_mfma_f32_32x32x16_bf16 v[192:207], v[76:79], v[132:135], v[192:207]
    s_mov_b64 exec, s[20:21]
    ds_read_b128 v[72:75], v250 offset:16384
    ds_read_b128 v[76:79], v250 offset:17408
    s_mov_b64 exec, -1
    v_cvt_pk_bf16_f32 v128, v96, v97
    v_exp_f32 v100, v100
    v_exp_f32 v101, v101
    v_cvt_pk_bf16_f32 v129, v98, v99
    v_exp_f32 v102, v102
    v_exp_f32 v103, v103
    v_exp_f32 v104, v104
    v_cvt_pk_bf16_f32 v130, v100, v101
    v_cvt_pk_bf16_f32 v131, v102, v103
    v_exp_f32 v105, v105
    v_exp_f32 v106, v106
    v_mfma_f32_32x32x16_bf16 v[192:207], v[64:67], v[128:131], v[192:207]
    s_waitcnt vmcnt(0)
    s_cbranch_vccnz SAFE_167
    buffer_store_dword v11, v10, s[4:7], s56 offen offset:0
BACK_168:
    v_exp_f32 v107, v107
    v_cvt_pk_bf16_f32 v132, v104, v105
    v_exp_f32 v108, v108
    v_exp_f32 v109, v109
    v_cvt_pk_bf16_f32 v133, v106, v107
    v_exp_f32 v110, v110
    v_exp_f32 v111, v111
    v_cvt_pk_bf16_f32 v134, v108, v109
    v_cvt_pk_bf16_f32 v135, v110, v111
    v_mfma_f32_32x32x16_bf16 v[96:111], v[136:139], v[144:147], 0
    s_waitcnt lgkmcnt(0)
    ds_read_b128 v[136:139], v248 offset:4096
    v_exp_f32 v112, v112
    v_exp_f32 v113, v113
    v_exp_f32 v114, v114
    v_exp_f32 v115, v115
    v_mfma_f32_32x32x16_bf16 v[192:207], v[68:71], v[132:135], v[192:207]
    s_mov_b64 exec, s[20:21]
    ds_read_b128 v[64:67], v250 offset:12288
    ds_read_b128 v[68:71], v250 offset:13312
    s_mov_b64 exec, -1
    v_cvt_pk_bf16_f32 v128, v112, v113
    v_exp_f32 v116, v116
    v_exp_f32 v117, v117
    v_cvt_pk_bf16_f32 v129, v114, v115
    v_exp_f32 v118, v118
    v_exp_f32 v119, v119
    v_exp_f32 v120, v120
    v_cvt_pk_bf16_f32 v130, v116, v117
    v_cvt_pk_bf16_f32 v131, v118, v119
    v_exp_f32 v121, v121
    v_exp_f32 v122, v122
    v_mfma_f32_32x32x16_bf16 v[192:207], v[72:75], v[128:131], v[192:207]
    v_exp_f32 v123, v123
    v_cvt_pk_bf16_f32 v132, v120, v121
    v_exp_f32 v124, v124
    v_exp_f32 v125, v125
    v_cvt_pk_bf16_f32 v133, v122, v123
    v_exp_f32 v126, v126
    v_exp_f32 v127, v127
    v_cvt_pk_bf16_f32 v134, v124, v125
    v_cvt_pk_bf16_f32 v135, v126, v127
    v_mfma_f32_32x32x16_bf16 v[112:127], v[140:143], v[144:147], 0
    s_waitcnt lgkmcnt(0)
    ds_read_b128 v[140:143], v248 offset:0
    v_exp_f32 v96, v96
    v_exp_f32 v97, v97
    v_exp_f32 v98, v98
    v_exp_f32 v99, v99
    v_mfma_f32_32x32x16_bf16 v[192:207], v[76:79], v[132:135], v[192:207]
    s_mov_b64 exec, s[20:21]
    ds_read_b128 v[72:75], v250 offset:8192
    ds_read_b128 v[76:79], v250 offset:9216
    s_mov_b64 exec, -1
    v_cvt_pk_bf16_f32 v128, v96, v97
    v_exp_f32 v100, v100
    v_exp_f32 v101, v101
    v_cvt_pk_bf16_f32 v129, v98, v99
    v_exp_f32 v102, v102
    v_exp_f32 v103, v103
    v_exp_f32 v104, v104
    v_cvt_pk_bf16_f32 v130, v100, v101
    v_cvt_pk_bf16_f32 v131, v102, v103
    v_exp_f32 v105, v105
    v_exp_f32 v106, v106
    v_mfma_f32_32x32x16_bf16 v[192:207], v[64:67], v[128:131], v[192:207]
    v_exp_f32 v107, v107
    v_cvt_pk_bf16_f32 v132, v104, v105
    v_exp_f32 v108, v108
    v_exp_f32 v109, v109
    v_cvt_pk_bf16_f32 v133, v106, v107
    v_exp_f32 v110, v110
    v_exp_f32 v111, v111
    v_cvt_pk_bf16_f32 v134, v108, v109
    v_cvt_pk_bf16_f32 v135, v110, v111
    v_mfma_f32_32x32x16_bf16 v[96:111], v[136:139], v[144:147], 0
    s_waitcnt lgkmcnt(0)
    v_exp_f32 v112, v112
    v_exp_f32 v113, v113
    v_exp_f32 v114, v114
    v_exp_f32 v115, v115
    v_mfma_f32_32x32x16_bf16 v[192:207], v[68:71], v[132:135], v[192:207]
    s_mov_b64 exec, s[20:21]
    ds_read_b128 v[64:67], v250 offset:4096
    ds_read_b128 v[68:71], v250 offset:5120
    s_mov_b64 exec, -1
    v_cvt_pk_bf16_f32 v128, v112, v113
    v_exp_f32 v116, v116
    v_exp_f32 v117, v117
    v_cvt_pk_bf16_f32 v129, v114, v115
    v_exp_f32 v118, v118
    v_exp_f32 v119, v119
    v_exp_f32 v120, v120
    v_cvt_pk_bf16_f32 v130, v116, v117
    v_cvt_pk_bf16_f32 v131, v118, v119
    v_exp_f32 v121, v121
    v_exp_f32 v122, v122
    v_mfma_f32_32x32x16_bf16 v[192:207], v[72:75], v[128:131], v[192:207]
    v_exp_f32 v123, v123
    v_cvt_pk_bf16_f32 v132, v120, v121
    v_exp_f32 v124, v124
    v_exp_f32 v125, v125
    v_cvt_pk_bf16_f32 v133, v122, v123
    v_exp_f32 v126, v126
    v_exp_f32 v127, v127
    v_cvt_pk_bf16_f32 v134, v124, v125
    v_cvt_pk_bf16_f32 v135, v126, v127
    v_mfma_f32_32x32x16_bf16 v[112:127], v[140:143], v[144:147], v[48:63]
    s_waitcnt lgkmcnt(0)
    v_exp_f32 v96, v96
    v_exp_f32 v97, v97
    v_exp_f32 v98, v98
    v_exp_f32 v99, v99
    v_mfma_f32_32x32x16_bf16 v[192:207], v[76:79], v[132:135], v[192:207]
    s_mov_b64 exec, s[20:21]
    ds_read_b128 v[72:75], v250 offset:0
    ds_read_b128 v[76:79], v250 offset:1024
    s_mov_b64 exec, -1
    v_cvt_pk_bf16_f32 v128, v96, v97
    v_exp_f32 v100, v100
    v_exp_f32 v101, v101
    v_cvt_pk_bf16_f32 v129, v98, v99
    v_exp_f32 v102, v102
    v_exp_f32 v103, v103
    v_exp_f32 v104, v104
    v_cvt_pk_bf16_f32 v130, v100, v101
    v_cvt_pk_bf16_f32 v131, v102, v103
    v_exp_f32 v105, v105
    v_exp_f32 v106, v106
    v_mfma_f32_32x32x16_bf16 v[192:207], v[64:67], v[128:131], v[192:207]
    v_exp_f32 v107, v107
    v_cvt_pk_bf16_f32 v132, v104, v105
    v_exp_f32 v108, v108
    v_exp_f32 v109, v109
    v_cvt_pk_bf16_f32 v133, v106, v107
    v_exp_f32 v110, v110
    v_exp_f32 v111, v111
    v_cvt_pk_bf16_f32 v134, v108, v109
    v_cvt_pk_bf16_f32 v135, v110, v111
    buffer_load_dword v14, v15, s[4:7], s59 offen offset:0 sc1
    v_exp_f32 v112, v112
    v_exp_f32 v113, v113
    v_exp_f32 v114, v114
    v_exp_f32 v115, v115
    v_mfma_f32_32x32x16_bf16 v[192:207], v[68:71], v[132:135], v[192:207]
    v_cvt_pk_bf16_f32 v128, v112, v113
    v_exp_f32 v116, v116
    v_exp_f32 v117, v117
    v_cvt_pk_bf16_f32 v129, v114, v115
    v_exp_f32 v118, v118
    v_exp_f32 v119, v119
    v_exp_f32 v120, v120
    v_cvt_pk_bf16_f32 v130, v116, v117
    v_cvt_pk_bf16_f32 v131, v118, v119
    v_exp_f32 v121, v121
    v_exp_f32 v122, v122
    s_waitcnt lgkmcnt(0)
    v_mfma_f32_32x32x16_bf16 v[192:207], v[72:75], v[128:131], v[192:207]
    v_exp_f32 v123, v123
    v_cvt_pk_bf16_f32 v132, v120, v121
    v_exp_f32 v124, v124
    v_exp_f32 v125, v125
    v_cvt_pk_bf16_f32 v133, v122, v123
    v_exp_f32 v126, v126
    v_exp_f32 v127, v127
    v_cvt_pk_bf16_f32 v134, v124, v125
    v_cvt_pk_bf16_f32 v135, v126, v127
    s_nop 1
    v_mfma_f32_32x32x16_bf16 v[192:207], v[76:79], v[132:135], v[192:207]
    s_branch ATT1_done
.p2align 12
ATT1_1:
    s_waitcnt vmcnt(4)
    buffer_store_dword v11, v9, s[4:7], s47 offen offset:0 sc1
    s_waitcnt lgkmcnt(0)
    s_barrier
    ds_read_b128 v[144:147], v247
    ds_read_b128 v[148:151], v252
    ds_read_b128 v[136:139], v249 offset:32768
    ds_read_b128 v[140:143], v249 offset:36864
    s_mov_b64 exec, s[20:21]
    ds_read_b128 v[64:67], v251 offset:32768
    ds_read_b128 v[68:71], v251 offset:33792
    s_mov_b64 exec, -1
    s_waitcnt vmcnt(1)
    s_cbranch_vccnz SAFE_185
    buffer_store_dword v11, v10, s[4:7], s46 offen offset:0
BACK_186:
    s_waitcnt lgkmcnt(3)
    v_mfma_f32_32x32x16_bf16 v[96:111], v[136:139], v[148:151], 0
    ds_read_b128 v[136:139], v249 offset:57344
    s_waitcnt lgkmcnt(3)
    v_mfma_f32_32x32x16_bf16 v[112:127], v[140:143], v[148:151], 0
    s_waitcnt lgkmcnt(1)
    ds_read_b128 v[140:143], v248 offset:32768
    s_nop 6
    v_exp_f32 v96, v96
    v_exp_f32 v97, v97
    v_exp_f32 v98, v98
    v_exp_f32 v99, v99
    s_mov_b64 exec, s[20:21]
    ds_read_b128 v[72:75], v251 offset:36864
    ds_read_b128 v[76:79], v251 offset:37888
    s_mov_b64 exec, -1
    v_cvt_pk_bf16_f32 v128, v96, v97
    v_exp_f32 v100, v100
    v_exp_f32 v101, v101
    v_cvt_pk_bf16_f32 v129, v98, v99
    v_exp_f32 v102, v102
    v_exp_f32 v103, v103
    v_exp_f32 v104, v104
    v_cvt_pk_bf16_f32 v130, v100, v101
    v_cvt_pk_bf16_f32 v131, v102, v103
    v_exp_f32 v105, v105
    v_exp_f32 v106, v106
    v_mfma_f32_32x32x16_bf16 v[208:223], v[64:67], v[128:131], 0
    buffer_load_dword v14, v1, s[4:7], s48 offen offset:0 sc1
    v_exp_f32 v107, v107
    v_cvt_pk_bf16_f32 v132, v104, v105
    v_exp_f32 v108, v108
    v_exp_f32 v109, v109
    v_cvt_pk_bf16_f32 v133, v106, v107
    v_exp_f32 v110, v110
    v_exp_f32 v111, v111
    v_cvt_pk_bf16_f32 v134, v108, v109
    v_cvt_pk_bf16_f32 v135, v110, v111
    s_waitcnt lgkmcnt(3)
    v_mfma_f32_32x32x16_bf16 v[96:111], v[136:139], v[148:151], v[32:47]
    s_waitcnt lgkmcnt(0)
    ds_read_b128 v[136:139], v248 offset:36864
    v_exp_f32 v112, v112
    v_exp_f32 v113, v113
    v_exp_f32 v114, v114
    v_exp_f32 v115, v115
    v_mfma_f32_32x32x16_bf16 v[208:223], v[68:71], v[132:135], v[208:223]
    s_mov_b64 exec, s[20:21]
    ds_read_b128 v[64:67], v251 offset:57344
    ds_read_b128 v[68:71], v251 offset:58368
    s_mov_b64 exec, -1
    v_cvt_pk_bf16_f32 v128, v112, v113
    v_exp_f32 v116, v116
    v_exp_f32 v117, v117
    v_cvt_pk_bf16_f32 v129, v114, v115
    v_exp_f32 v118, v118
    v_exp_f32 v119, v119
    v_exp_f32 v120, v120
    v_cvt_pk_bf16_f32 v130, v116, v117
    v_cvt_pk_bf16_f32 v131, v118, v119
    v_exp_f32 v121, v121
    v_exp_f32 v122, v122
    v_mfma_f32_32x32x16_bf16 v[208:223], v[72:75], v[128:131], v[208:223]
    s_waitcnt vmcnt(0)
    v_cmp_gt_u32 vcc, s35, v14
    s_cbranch_vccnz SPIN_179
BACK_180:
    s_mov_b32 m0, s50
    s_nop 0
    buffer_load_dwordx4 v16, s[4:7], s49 offen offset:0 sc1 lds
    buffer_load_dwordx4 v16, s[4:7], s49 offen offset:1024 sc1 lds
    buffer_load_dwordx4 v16, s[4:7], s49 offen offset:2048 sc1 lds
    buffer_load_dwordx4 v16, s[4:7], s49 offen offset:3072 sc1 lds
    v_exp_f32 v123, v123
    v_cvt_pk_bf16_f32 v132, v120, v121
    v_exp_f32 v124, v124
    v_exp_f32 v125, v125
    v_cvt_pk_bf16_f32 v133, v122, v123
    v_exp_f32 v126, v126
    v_exp_f32 v127, v127
    v_cvt_pk_bf16_f32 v134, v124, v125
    v_cvt_pk_bf16_f32 v135, v126, v127
    v_mfma_f32_32x32x16_bf16 v[112:127], v[140:143], v[144:147], 0
    s_waitcnt lgkmcnt(0)
    v_exp_f32 v96, v96
    v_exp_f32 v97, v97
    v_exp_f32 v98, v98
    v_exp_f32 v99, v99
    v_mfma_f32_32x32x16_bf16 v[208:223], v[76:79], v[132:135], v[208:223]
    s_mov_b64 exec, s[20:21]
    ds_read_b128 v[72:75], v250 offset:32768
    ds_read_b128 v[76:79], v250 offset:33792
    s_mov_b64 exec, -1
    v_cvt_pk_bf16_f32 v128, v96, v97
    v_exp_f32 v100, v100
    v_exp_f32 v101, v101
    v_cvt_pk_bf16_f32 v129, v98, v99
    v_exp_f32 v102, v102
    v_exp_f32 v103, v103
    v_exp_f32 v104, v104
    v_cvt_pk_bf16_f32 v130, v100, v101
    v_cvt_pk_bf16_f32 v131, v102, v103
    v_exp_f32 v105, v105
    v_exp_f32 v106, v106
    v_mfma_f32_32x32x16_bf16 v[208:223], v[64:67], v[128:131], v[208:223]
    buffer_load_dword v2, v4, s[4:7], s51 offen offset:0 sc1
    v_exp_f32 v107, v107
    v_cvt_pk_bf16_f32 v132, v104, v105
    v_exp_f32 v108, v108
    v_exp_f32 v109, v109
    v_cvt_pk_bf16_f32 v133, v106, v107
    v_exp_f32 v110, v110
    v_exp_f32 v111, v111
    v_cvt_pk_bf16_f32 v134, v108, v109
    v_cvt_pk_bf16_f32 v135, v110, v111
    v_mfma_f32_32x32x16_bf16 v[96:111], v[136:139], v[144:147], v[32:47]
    s_waitcnt lgkmcnt(0)
    v_exp_f32 v112, v112
    v_exp_f32 v113, v113
    v_exp_f32 v114, v114
    v_exp_f32 v115, v115
    v_mfma_f32_32x32x16_bf16 v[208:223], v[68:71], v[132:135], v[208:223]
    s_mov_b64 exec, s[20:21]
    ds_read_b128 v[64:67], v250 offset:36864
    ds_read_b128 v[68:71], v250 offset:37888
    s_mov_b64 exec, -1
    v_cvt_pk_bf16_f32 v128, v112, v113
    v_exp_f32 v116, v116
    v_exp_f32 v117, v117
    v_cvt_pk_bf16_f32 v129, v114, v115
    v_exp_f32 v118, v118
    v_exp_f32 v119, v119
    v_exp_f32 v120, v120
    v_cvt_pk_bf16_f32 v130, v116, v117
    v_cvt_pk_bf16_f32 v131, v118, v119
    v_exp_f32 v121, v121
    v_exp_f32 v122, v122
    v_mfma_f32_32x32x16_bf16 v[192:207], v[72:75], v[128:131], 0
    s_waitcnt vmcnt(1)
    s_barrier
    ds_read_b128 v[140:143], v249 offset:40960
    ds_read_b128 v[136:139], v249 offset:45056
    v_exp_f32 v123, v123
    v_cvt_pk_bf16_f32 v132, v120, v121
    v_exp_f32 v124, v124
    v_exp_f32 v125, v125
    v_cvt_pk_bf16_f32 v133, v122, v123
    v_exp_f32 v126, v126
    v_exp_f32 v127, v127
    v_cvt_pk_bf16_f32 v134, v124, v125
    v_cvt_pk_bf16_f32 v135, v126, v127
    s_waitcnt lgkmcnt(1)
    v_mfma_f32_32x32x16_bf16 v[112:127], v[140:143], v[148:151], 0
    ds_read_b128 v[140:143], v249 offset:49152
    v_exp_f32 v96, v96
    v_exp_f32 v97, v97
    v_exp_f32 v98, v98
    v_exp_f32 v99, v99
    v_mfma_f32_32x32x16_bf16 v[192:207], v[76:79], v[132:135], v[192:207]
    s_mov_b64 exec, s[20:21]
    ds_read_b128 v[72:75], v251 offset:40960
    ds_read_b128 v[76:79], v251 offset:41984
    s_mov_b64 exec, -1
    v_cvt_pk_bf16_f32 v128, v96, v97
    v_exp_f32 v100, v100
    v_exp_f32 v101, v101
    v_cvt_pk_bf16_f32 v129, v98, v99
    v_exp_f32 v102, v102
    v_exp_f32 v103, v103
    v_exp_f32 v104, v104
    v_cvt_pk_bf16_f32 v130, v100, v101
    v_cvt_pk_bf16_f32 v131, v102, v103
    v_exp_f32 v105, v105
    v_exp_f32 v106, v106
    v_mfma_f32_32x32x16_bf16 v[192:207], v[64:67], v[128:131], v[192:207]
    s_waitcnt vmcnt(0)
    v_cmp_gt_u32 vcc, s35, v2
    s_cbranch_vccnz SPIN_182
BACK_183:
    s_add_u32 m0, s82, 114688
    s_nop 0
    buffer_load_dwordx4 v16, s[4:7], s96 offen offset:0 sc1 lds
    buffer_load_dwordx4 v16, s[4:7], s96 offen offset:1024 sc1 lds
    buffer_load_dwordx4 v16, s[4:7], s96 offen offset:2048 sc1 lds
    buffer_load_dwordx4 v16, s[4:7], s96 offen offset:3072 sc1 lds
    v_exp_f32 v107, v107
    v_cvt_pk_bf16_f32 v132, v104, v105
    v_exp_f32 v108, v108
    v_exp_f32 v109, v109
    v_cvt_pk_bf16_f32 v133, v106, v107
    v_exp_f32 v110, v110
    v_exp_f32 v111, v111
    v_cvt_pk_bf16_f32 v134, v108, v109
    v_cvt_pk_bf16_f32 v135, v110, v111
    s_waitcnt lgkmcnt(3)
    v_mfma_f32_32x32x16_bf16 v[96:111], v[136:139], v[148:151], 0
    s_waitcnt lgkmcnt(0)
    ds_read_b128 v[136:139], v249 offset:53248
    v_exp_f32 v112, v112
    v_exp_f32 v113, v113
    v_exp_f32 v114, v114
    v_exp_f32 v115, v115
    v_mfma_f32_32x32x16_bf16 v[192:207], v[68:71], v[132:135], v[192:207]
    s_mov_b64 exec, s[20:21]
    ds_read_b128 v[64:67], v251 offset:45056
    ds_read_b128 v[68:71], v251 offset:46080
    s_mov_b64 exec, -1
    v_cvt_pk_bf16_f32 v128, v112, v113
    v_exp_f32 v116, v116
    v_exp_f32 v117, v117
    v_cvt_pk_bf16_f32 v129, v114, v115
    v_exp_f32 v118, v118
    v_exp_f32 v119, v119
    v_exp_f32 v120, v120
    v_cvt_pk_bf16_f32 v130, v116, v117
    v_cvt_pk_bf16_f32 v131, v118, v119
    v_exp_f32 v121, v121
    v_exp_f32 v122, v122
    v_mfma_f32_32x32x16_bf16 v[208:223], v[72:75], v[128:131], v[208:223]
    v_exp_f32 v123, v123
    v_cvt_pk_bf16_f32 v132, v120, v121
    v_exp_f32 v124, v124
    v_exp_f32 v125, v125
    v_cvt_pk_bf16_f32 v133, v122, v123
    v_exp_f32 v126, v126
    v_exp_f32 v127, v127
    v_cvt_pk_bf16_f32 v134, v124, v125
    v_cvt_pk_bf16_f32 v135, v126, v127
    v_mfma_f32_32x32x16_bf16 v[112:127], v[140:143], v[148:151], 0
    s_waitcnt lgkmcnt(0)
    s_add_u32 m0, s82, 98304
    s_nop 0
    buffer_load_dwordx4 v16, s[4:7], s97 offen offset:0 sc1 lds
    buffer_load_dwordx4 v16, s[4:7], s97 offen offset:1024 sc1 lds
    buffer_load_dwordx4 v16, s[4:7], s97 offen offset:2048 sc1 lds
    buffer_load_dwordx4 v16, s[4:7], s97 offen offset:3072 sc1 lds
    v_exp_f32 v96, v96
    v_exp_f32 v97, v97
    v_exp_f32 v98, v98
    v_exp_f32 v99, v99
    v_mfma_f32_32x32x16_bf16 v[208:223], v[76:79], v[132:135], v[208:223]
    s_mov_b64 exec, s[20:21]
    ds_read_b128 v[72:75], v251 offset:49152
    ds_read_b128 v[76:79], v251 offset:50176
    s_mov_b64 exec, -1
    v_cvt_pk_bf16_f32 v128, v96, v97
    v_exp_f32 v100, v100
    v_exp_f32 v101, v101
    v_cvt_pk_bf16_f32 v129, v98, v99
    v_exp_f32 v102, v102
    v_exp_f32 v103, v103
    v_exp_f32 v104, v104
    v_cvt_pk_bf16_f32 v130, v100, v101
    v_cvt_pk_bf16_f32 v131, v102, v103
    v_exp_f32 v105, v105
    v_exp_f32 v106, v106
    v_mfma_f32_32x32x16_bf16 v[208:223], v[64:67], v[128:131], v[208:223]
    v_exp_f32 v107, v107
    v_cvt_pk_bf16_f32 v132, v104, v105
    v_exp_f32 v108, v108
    v_exp_f32 v109, v109
    v_cvt_pk_bf16_f32 v133, v106, v107
    v_exp_f32 v110, v110
    v_exp_f32 v111, v111
    v_cvt_pk_bf16_f32 v134, v108, v109
    v_cvt_pk_bf16_f32 v135, v110, v111
    s_cmp_eq_u32 s12, 0
    s_cbranch_scc1 ATTG01_1
    v_mfma_f32_32x32x16_bf16 v[96:111], v[136:139], v[148:151], 0
    s_waitcnt lgkmcnt(0)
    v_exp_f32 v112, v112
    v_exp_f32 v113, v113
    v_exp_f32 v114, v114
    v_exp_f32 v115, v115
    v_mfma_f32_32x32x16_bf16 v[208:223], v[68:71], v[132:135], v[208:223]
    s_mov_b64 exec, s[20:21]
    ds_read_b128 v[64:67], v251 offset:53248
    ds_read_b128 v[68:71], v251 offset:54272
    s_mov_b64 exec, -1
    v_cvt_pk_bf16_f32 v128, v112, v113
    v_exp_f32 v116, v116
    v_exp_f32 v117, v117
    v_cvt_pk_bf16_f32 v129, v114, v115
    v_exp_f32 v118, v118
    v_exp_f32 v119, v119
    v_exp_f32 v120, v120
    v_cvt_pk_bf16_f32 v130, v116, v117
    v_cvt_pk_bf16_f32 v131, v118, v119
    v_exp_f32 v121, v121
    v_exp_f32 v122, v122
    v_mfma_f32_32x32x16_bf16 v[208:223], v[72:75], v[128:131], v[208:223]
    s_waitcnt vmcnt(4)
    s_barrier
    ds_read_b128 v[140:143], v249 offset:24576
    ds_read_b128 v[136:139], v249 offset:28672
    v_exp_f32 v123, v123
    v_cvt_pk_bf16_f32 v132, v120, v121
    v_exp_f32 v124, v124
    v_exp_f32 v125, v125
    v_cvt_pk_bf16_f32 v133, v122, v123
    v_exp_f32 v126, v126
    v_exp_f32 v127, v127
    v_cvt_pk_bf16_f32 v134, v124, v125
    v_cvt_pk_bf16_f32 v135, v126, v127
    s_waitcnt lgkmcnt(1)
    v_mfma_f32_32x32x16_bf16 v[112:127], v[140:143], v[148:151], v[48:63]
    ds_read_b128 v[140:143], v248 offset:28672
    v_exp_f32 v96, v96
    v_exp_f32 v97, v97
    v_exp_f32 v98, v98
    v_exp_f32 v99, v99
    v_mfma_f32_32x32x16_bf16 v[208:223], v[76:79], v[132:135], v[208:223]
    s_mov_b64 exec, s[20:21]
    ds_read_b128 v[72:75], v251 offset:24576
    ds_read_b128 v[76:79], v251 offset:25600
    s_mov_b64 exec, -1
    v_cvt_pk_bf16_f32 v128, v96, v97
    v_exp_f32 v100, v100
    v_exp_f32 v101, v101
    v_cvt_pk_bf16_f32 v129, v98, v99
    v_exp_f32 v102, v102
    v_exp_f32 v103, v103
    v_exp_f32 v104, v104
    v_cvt_pk_bf16_f32 v130, v100, v101
    v_cvt_pk_bf16_f32 v131, v102, v103
    v_exp_f32 v105, v105
    v_exp_f32 v106, v106
    v_mfma_f32_32x32x16_bf16 v[208:223], v[64:67], v[128:131], v[208:223]
    v_exp_f32 v107, v107
    v_cvt_pk_bf16_f32 v132, v104, v105
    v_exp_f32 v108, v108
    v_exp_f32 v109, v109
    v_cvt_pk_bf16_f32 v133, v106, v107
    v_exp_f32 v110, v110
    v_exp_f32 v111, v111
    v_cvt_pk_bf16_f32 v134, v108, v109
    v_cvt_pk_bf16_f32 v135, v110, v111
    s_waitcnt lgkmcnt(3)
    v_mfma_f32_32x32x16_bf16 v[96:111], v[136:139], v[148:151], 0
    s_waitcnt lgkmcnt(0)
    ds_read_b128 v[136:139], v248 offset:24576
    v_exp_f32 v112, v112
    v_exp_f32 v113, v113
    v_exp_f32 v114, v114
    v_exp_f32 v115, v115
    v_mfma_f32_32x32x16_bf16 v[208:223], v[68:71], v[132:135], v[208:223]
    s_mov_b64 exec, s[20:21]
    ds_read_b128 v[64:67], v251 offset:28672
    ds_read_b128 v[68:71], v251 offset:29696
    s_mov_b64 exec, -1
    v_cvt_pk_bf16_f32 v128, v112, v113
    v_exp_f32 v116, v116
    v_exp_f32 v117, v117
    v_cvt_pk_bf16_f32 v129, v114, v115
    v_exp_f32 v118, v118
    v_exp_f32 v119, v119
    v_exp_f32 v120, v120
    v_cvt_pk_bf16_f32 v130, v116, v117
    v_cvt_pk_bf16_f32 v131, v118, v119
    v_exp_f32 v121, v121
    v_exp_f32 v122, v122
    v_mfma_f32_32x32x16_bf16 v[208:223], v[72:75], v[128:131], v[208:223]
    v_exp_f32 v123, v123
    v_cvt_pk_bf16_f32 v132, v120, v121
    v_exp_f32 v124, v124
    v_exp_f32 v125, v125
    v_cvt_pk_bf16_f32 v133, v122, v123
    v_exp_f32 v126, v126
    v_exp_f32 v127, v127
    v_cvt_pk_bf16_f32 v134, v124, v125
    v_cvt_pk_bf16_f32 v135, v126, v127
    v_mfma_f32_32x32x16_bf16 v[112:127], v[140:143], v[144:147], 0
    s_waitcnt lgkmcnt(0)
    ds_read_b128 v[140:143], v248 offset:20480
    v_exp_f32 v96, v96
    v_exp_f32 v97, v97
    v_exp_f32 v98, v98
    v_exp_f32 v99, v99
    v_mfma_f32_32x32x16_bf16 v[208:223], v[76:79], v[132:135], v[208:223]
    s_mov_b64 exec, s[20:21]
    ds_read_b128 v[72:75], v250 offset:28672
    ds_read_b128 v[76:79], v250 offset:29696
    s_mov_b64 exec, -1
    v_cvt_pk_bf16_f32 v128, v96, v97
    v_exp_f32 v100, v100
    v_exp_f32 v101, v101
    v_cvt_pk_bf16_f32 v129, v98, v99
    v_exp_f32 v102, v102
    v_exp_f32 v103, v103
    v_exp_f32 v104, v104
    v_cvt_pk_bf16_f32 v130, v100, v101
    v_cvt_pk_bf16_f32 v131, v102, v103
    v_exp_f32 v105, v105
    v_exp_f32 v106, v106
    v_mfma_f32_32x32x16_bf16 v[208:223], v[64:67], v[128:131], v[208:223]
    s_waitcnt vmcnt(0)
    s_barrier
    v_exp_f32 v107, v107
    v_cvt_pk_bf16_f32 v132, v104, v105
    v_exp_f32 v108, v108
    v_exp_f32 v109, v109
    v_cvt_pk_bf16_f32 v133, v106, v107
    v_exp_f32 v110, v110
    v_exp_f32 v111, v111
    v_cvt_pk_bf16_f32 v134, v108, v109
    v_cvt_pk_bf16_f32 v135, v110, v111
    v_mfma_f32_32x32x16_bf16 v[96:111], v[136:139], v[144:147], 0
    s_waitcnt lgkmcnt(0)
    ds_read_b128 v[136:139], v248 offset:16384
    v_exp_f32 v112, v112
    v_exp_f32 v113, v113
    v_exp_f32 v114, v114
    v_exp_f32 v115, v115
    v_mfma_f32_32x32x16_bf16 v[208:223], v[68:71], v[132:135], v[208:223]
    s_mov_b64 exec, s[20:21]
    ds_read_b128 v[64:67], v250 offset:24576
    ds_read_b128 v[68:71], v250 offset:25600
    s_mov_b64 exec, -1
    v_cvt_pk_bf16_f32 v128, v112, v113
    v_exp_f32 v116, v116
    v_exp_f32 v117, v117
    v_cvt_pk_bf16_f32 v129, v114, v115
    v_exp_f32 v118, v118
    v_exp_f32 v119, v119
    v_exp_f32 v120, v120
    v_cvt_pk_bf16_f32 v130, v116, v117
    v_cvt_pk_bf16_f32 v131, v118, v119
    v_exp_f32 v121, v121
    v_exp_f32 v122, v122
    v_mfma_f32_32x32x16_bf16 v[192:207], v[72:75], v[128:131], v[192:207]
    v_subrev_u32 v217, 0x2b800000, v216
    v_cmp_lt_u32 s[26:27], s87, v217
    s_nop 0
    s_cmp_lg_u64 s[26:27], 0
    s_cbranch_scc1 SLOW_187
BACK_188:
    v_rcp_f32 v217, v216
    s_nop 0
    v_mul_f32 v208, v208, v217
    v_mul_f32 v209, v209, v217
    v_cvt_pk_bf16_f32 v220, v208, v209
    v_mul_f32 v210, v210, v217
    v_mul_f32 v211, v211, v217
    v_cvt_pk_bf16_f32 v221, v210, v211
    v_mul_f32 v212, v212, v217
    v_mul_f32 v213, v213, v217
    v_cvt_pk_bf16_f32 v222, v212, v213
    v_mul_f32 v214, v214, v217
    v_mul_f32 v215, v215, v217
    v_cvt_pk_bf16_f32 v223, v214, v215
    v_exp_f32 v123, v123
    v_cvt_pk_bf16_f32 v132, v120, v121
    v_exp_f32 v124, v124
    v_exp_f32 v125, v125
    v_cvt_pk_bf16_f32 v133, v122, v123
    v_exp_f32 v126, v126
    v_exp_f32 v127, v127
    v_cvt_pk_bf16_f32 v134, v124, v125
    v_cvt_pk_bf16_f32 v135, v126, v127
    v_mfma_f32_32x32x16_bf16 v[112:127], v[140:143], v[144:147], 0
    s_waitcnt lgkmcnt(0)
    ds_read_b128 v[140:143], v248 offset:12288
    buffer_store_dwordx4 v[220:223], v0, s[4:7], s54 offen
    v_exp_f32 v96, v96
    v_exp_f32 v97, v97
    v_exp_f32 v98, v98
    v_exp_f32 v99, v99
    v_mfma_f32_32x32x16_bf16 v[192:207], v[76:79], v[132:135], v[192:207]
    s_mov_b64 exec, s[20:21]
    ds_read_b128 v[72:75], v250 offset:20480
    ds_read_b128 v[76:79], v250 offset:21504
    s_mov_b64 exec, -1
    v_cvt_pk_bf16_f32 v128, v96, v97
    v_exp_f32 v100, v100
    v_exp_f32 v101, v101
    v_cvt_pk_bf16_f32 v129, v98, v99
    v_exp_f32 v102, v102
    v_exp_f32 v103, v103
    v_exp_f32 v104, v104
    v_cvt_pk_bf16_f32 v130, v100, v101
    v_cvt_pk_bf16_f32 v131, v102, v103
    v_exp_f32 v105, v105
    v_exp_f32 v106, v106
    v_mfma_f32_32x32x16_bf16 v[192:207], v[64:67], v[128:131], v[192:207]
    v_exp_f32 v107, v107
    v_cvt_pk_bf16_f32 v132, v104, v105
    v_exp_f32 v108, v108
    v_exp_f32 v109, v109
    v_cvt_pk_bf16_f32 v133, v106, v107
    v_exp_f32 v110, v110
    v_exp_f32 v111, v111
    v_cvt_pk_bf16_f32 v134, v108, v109
    v_cvt_pk_bf16_f32 v135, v110, v111
    v_mfma_f32_32x32x16_bf16 v[96:111], v[136:139], v[144:147], 0
    s_waitcnt lgkmcnt(0)
    ds_read_b128 v[136:139], v248 offset:8192
    v_exp_f32 v112, v112
    v_exp_f32 v113, v113
    v_exp_f32 v114, v114
    v_exp_f32 v115, v115
    v_mfma_f32_32x32x16_bf16 v[192:207], v[68:71], v[132:135], v[192:207]
    s_mov_b64 exec, s[20:21]
    ds_read_b128 v[64:67], v250 offset:16384
    ds_read_b128 v[68:71], v250 offset:17408
    s_mov_b64 exec, -1
    v_cvt_pk_bf16_f32 v128, v112, v113
    v_exp_f32 v116, v116
    v_exp_f32 v117, v117
    v_cvt_pk_bf16_f32 v129, v114, v115
    v_exp_f32 v118, v118
    v_exp_f32 v119, v119
    v_exp_f32 v120, v120
    v_cvt_pk_bf16_f32 v130, v116, v117
    v_cvt_pk_bf16_f32 v131, v118, v119
    v_exp_f32 v121, v121
    v_exp_f32 v122, v122
    v_mfma_f32_32x32x16_bf16 v[192:207], v[72:75], v[128:131], v[192:207]
    s_waitcnt vmcnt(0)
    s_cbranch_vccnz SAFE_189
    buffer_store_dword v11, v10, s[4:7], s56 offen offset:0
BACK_190:
    v_exp_f32 v123, v123
    v_cvt_pk_bf16_f32 v132, v120, v121
    v_exp_f32 v124, v124
    v_exp_f32 v125, v125
    v_cvt_pk_bf16_f32 v133, v122, v123
    v_exp_f32 v126, v126
    v_exp_f32 v127, v127
    v_cvt_pk_bf16_f32 v134, v124, v125
    v_cvt_pk_bf16_f32 v135, v126, v127
    v_mfma_f32_32x32x16_bf16 v[112:127], v[140:143], v[144:147], 0
    s_waitcnt lgkmcnt(0)
    ds_read_b128 v[140:143], v248 offset:4096
    v_exp_f32 v96, v96
    v_exp_f32 v97, v97
    v_exp_f32 v98, v98
    v_exp_f32 v99, v99
    v_mfma_f32_32x32x16_bf16 v[192:207], v[76:79], v[132:135], v[192:207]
    s_mov_b64 exec, s[20:21]
    ds_read_b128 v[72:75], v250 offset:12288
    ds_read_b128 v[76:79], v250 offset:13312
    s_mov_b64 exec, -1
    v_cvt_pk_bf16_f32 v128, v96, v97
    v_exp_f32 v100, v100
    v_exp_f32 v101, v101
    v_cvt_pk_bf16_f32 v129, v98, v99
    v_exp_f32 v102, v102
    v_exp_f32 v103, v103
    v_exp_f32 v104, v104
    v_cvt_pk_bf16_f32 v130, v100, v101
    v_cvt_pk_bf16_f32 v131, v102, v103
    v_exp_f32 v105, v105
    v_exp_f32 v106, v106
    v_mfma_f32_32x32x16_bf16 v[192:207], v[64:67], v[128:131], v[192:207]
    v_exp_f32 v107, v107
    v_cvt_pk_bf16_f32 v132, v104, v105
    v_exp_f32 v108, v108
    v_exp_f32 v109, v109
    v_cvt_pk_bf16_f32 v133, v106, v107
    v_exp_f32 v110, v110
    v_exp_f32 v111, v111
    v_cvt_pk_bf16_f32 v134, v108, v109
    v_cvt_pk_bf16_f32 v135, v110, v111
    v_mfma_f32_32x32x16_bf16 v[96:111], v[136:139], v[144:147], 0
    s_waitcnt lgkmcnt(0)
    v_exp_f32 v112, v112
    v_exp_f32 v113, v113
    v_exp_f32 v114, v114
    v_exp_f32 v115, v115
    v_mfma_f32_32x32x16_bf16 v[192:207], v[68:71], v[132:135], v[192:207]
    s_mov_b64 exec, s[20:21]
    ds_read_b128 v[64:67], v250 offset:8192
    ds_read_b128 v[68:71], v250 offset:9216
    s_mov_b64 exec, -1
    v_cvt_pk_bf16_f32 v128, v112, v113
    v_exp_f32 v116, v116
    v_exp_f32 v117, v117
    v_cvt_pk_bf16_f32 v129, v114, v115
    v_exp_f32 v118, v118
    v_exp_f32 v119, v119
    v_exp_f32 v120, v120
    v_cvt_pk_bf16_f32 v130, v116, v117
    v_cvt_pk_bf16_f32 v131, v118, v119
    v_exp_f32 v121, v121
    v_exp_f32 v122, v122
    v_mfma_f32_32x32x16_bf16 v[192:207], v[72:75], v[128:131], v[192:207]
    v_exp_f32 v123, v123
    v_cvt_pk_bf16_f32 v132, v120, v121
    v_exp_f32 v124, v124
    v_exp_f32 v125, v125
    v_cvt_pk_bf16_f32 v133, v122, v123
    v_exp_f32 v126, v126
    v_exp_f32 v127, v127
    v_cvt_pk_bf16_f32 v134, v124, v125
    v_cvt_pk_bf16_f32 v135, v126, v127
    v_mfma_f32_32x32x16_bf16 v[112:127], v[140:143], v[144:147], v[48:63]
    s_waitcnt lgkmcnt(0)
    v_exp_f32 v96, v96
    v_exp_f32 v97, v97
    v_exp_f32 v98, v98
    v_exp_f32 v99, v99
    v_mfma_f32_32x32x16_bf16 v[192:207], v[76:79], v[132:135], v[192:207]
    s_mov_b64 exec, s[20:21]
    ds_read_b128 v[72:75], v250 offset:4096
    ds_read_b128 v[76:79], v250 offset:5120
    s_mov_b64 exec, -1
    v_cvt_pk_bf16_f32 v128, v96, v97
    v_exp_f32 v100, v100
    v_exp_f32 v101, v101
    v_cvt_pk_bf16_f32 v129, v98, v99
    v_exp_f32 v102, v102
    v_exp_f32 v103, v103
    v_exp_f32 v104, v104
    v_cvt_pk_bf16_f32 v130, v100, v101
    v_cvt_pk_bf16_f32 v131, v102, v103
    v_exp_f32 v105, v105
    v_exp_f32 v106, v106
    v_mfma_f32_32x32x16_bf16 v[192:207], v[64:67], v[128:131], v[192:207]
    v_exp_f32 v107, v107
    v_cvt_pk_bf16_f32 v132, v104, v105
    v_exp_f32 v108, v108
    v_exp_f32 v109, v109
    v_cvt_pk_bf16_f32 v133, v106, v107
    v_exp_f32 v110, v110
    v_exp_f32 v111, v111
    v_cvt_pk_bf16_f32 v134, v108, v109
    v_cvt_pk_bf16_f32 v135, v110, v111
    buffer_load_dword v14, v15, s[4:7], s59 offen offset:0 sc1
    v_exp_f32 v112, v112
    v_exp_f32 v113, v113
    v_exp_f32 v114, v114
    v_exp_f32 v115, v115
    v_mfma_f32_32x32x16_bf16 v[192:207], v[68:71], v[132:135], v[192:207]
    v_cvt_pk_bf16_f32 v128, v112, v113
    v_exp_f32 v116, v116
    v_exp_f32 v117, v117
    v_cvt_pk_bf16_f32 v129, v114, v115
    v_exp_f32 v118, v118
    v_exp_f32 v119, v119
    v_exp_f32 v120, v120
    v_cvt_pk_bf16_f32 v130, v116, v117
    v_cvt_pk_bf16_f32 v131, v118, v119
    v_exp_f32 v121, v121
    v_exp_f32 v122, v122
    s_waitcnt lgkmcnt(0)
    v_mfma_f32_32x32x16_bf16 v[192:207], v[72:75], v[128:131], v[192:207]
    v_exp_f32 v123, v123
    v_cvt_pk_bf16_f32 v132, v120, v121
    v_exp_f32 v124, v124
    v_exp_f32 v125, v125
    v_cvt_pk_bf16_f32 v133, v122, v123
    v_exp_f32 v126, v126
    v_exp_f32 v127, v127
    v_cvt_pk_bf16_f32 v134, v124, v125
    v_cvt_pk_bf16_f32 v135, v126, v127
    s_nop 1
    v_mfma_f32_32x32x16_bf16 v[192:207], v[76:79], v[132:135], v[192:207]
    s_branch ATT1_done
.p2align 12
ATT1_2:
    s_waitcnt vmcnt(4)
    buffer_store_dword v11, v9, s[4:7], s47 offen offset:0 sc1
    s_waitcnt lgkmcnt(0)
    s_barrier
    ds_read_b128 v[144:147], v247
    ds_read_b128 v[148:151], v252
    ds_read_b128 v[136:139], v249 offset:40960
    ds_read_b128 v[140:143], v249 offset:45056
    s_mov_b64 exec, s[20:21]
    ds_read_b128 v[64:67], v251 offset:40960
    ds_read_b128 v[68:71], v251 offset:41984
    s_mov_b64 exec, -1
    s_waitcnt vmcnt(1)
    s_cbranch_vccnz SAFE_207
    buffer_store_dword v11, v10, s[4:7], s46 offen offset:0
BACK_208:
    s_waitcnt lgkmcnt(3)
    v_mfma_f32_32x32x16_bf16 v[96:111], v[136:139], v[148:151], 0
    ds_read_b128 v[136:139], v249 offset:49152
    s_waitcnt lgkmcnt(3)
    v_mfma_f32_32x32x16_bf16 v[112:127], v[140:143], v[148:151], 0
    s_waitcnt lgkmcnt(1)
    ds_read_b128 v[140:143], v249 offset:53248
    s_nop 6
    v_exp_f32 v96, v96
    v_exp_f32 v97, v97
    v_exp_f32 v98, v98
    v_exp_f32 v99, v99
    s_mov_b64 exec, s[20:21]
    ds_read_b128 v[72:75], v251 offset:45056
    ds_read_b128 v[76:79], v251 offset:46080
    s_mov_b64 exec, -1
    v_cvt_pk_bf16_f32 v128, v96, v97
    v_exp_f32 v100, v100
    v_exp_f32 v101, v101
    v_cvt_pk_bf16_f32 v129, v98, v99
    v_exp_f32 v102, v102
    v_exp_f32 v103, v103
    v_exp_f32 v104, v104
    v_cvt_pk_bf16_f32 v130, v100, v101
    v_cvt_pk_bf16_f32 v131, v102, v103
    v_exp_f32 v105, v105
    v_exp_f32 v106, v106
    v_mfma_f32_32x32x16_bf16 v[208:223], v[64:67], v[128:131], 0
    buffer_load_dword v14, v1, s[4:7], s48 offen offset:0 sc1
    v_exp_f32 v107, v107
    v_cvt_pk_bf16_f32 v132, v104, v105
    v_exp_f32 v108, v108
    v_exp_f32 v109, v109
    v_cvt_pk_bf16_f32 v133, v106, v107
    v_exp_f32 v110, v110
    v_exp_f32 v111, v111
    v_cvt_pk_bf16_f32 v134, v108, v109
    v_cvt_pk_bf16_f32 v135, v110, v111
    s_waitcnt lgkmcnt(3)
    v_mfma_f32_32x32x16_bf16 v[96:111], v[136:139], v[148:151], 0
    s_waitcnt lgkmcnt(0)
    ds_read_b128 v[136:139], v248 offset:40960
    v_exp_f32 v112, v112
    v_exp_f32 v113, v113
    v_exp_f32 v114, v114
    v_exp_f32 v115, v115
    v_mfma_f32_32x32x16_bf16 v[208:223], v[68:71], v[132:135], v[208:223]
    s_mov_b64 exec, s[20:21]
    ds_read_b128 v[64:67], v251 offset:49152
    ds_read_b128 v[68:71], v251 offset:50176
    s_mov_b64 exec, -1
    v_cvt_pk_bf16_f32 v128, v112, v113
    v_exp_f32 v116, v116
    v_exp_f32 v117, v117
    v_cvt_pk_bf16_f32 v129, v114, v115
    v_exp_f32 v118, v118
    v_exp_f32 v119, v119
    v_exp_f32 v120, v120
    v_cvt_pk_bf16_f32 v130, v116, v117
    v_cvt_pk_bf16_f32 v131, v118, v119
    v_exp_f32 v121, v121
    v_exp_f32 v122, v122
    v_mfma_f32_32x32x16_bf16 v[208:223], v[72:75], v[128:131], v[208:223]
    s_waitcnt vmcnt(0)
    v_cmp_gt_u32 vcc, s35, v14
    s_cbranch_vccnz SPIN_201
BACK_202:
    s_mov_b32 m0, s50
    s_nop 0
    buffer_load_dwordx4 v16, s[4:7], s49 offen offset:0 sc1 lds
    buffer_load_dwordx4 v16, s[4:7], s49 offen offset:1024 sc1 lds
    buffer_load_dwordx4 v16, s[4:7], s49 offen offset:2048 sc1 lds
    buffer_load_dwordx4 v16, s[4:7], s49 offen offset:3072 sc1 lds
    v_exp_f32 v123, v123
    v_cvt_pk_bf16_f32 v132, v120, v121
    v_exp_f32 v124, v124
    v_exp_f32 v125, v125
    v_cvt_pk_bf16_f32 v133, v122, v123
    v_exp_f32 v126, v126
    v_exp_f32 v127, v127
    v_cvt_pk_bf16_f32 v134, v124, v125
    v_cvt_pk_bf16_f32 v135, v126, v127
    v_mfma_f32_32x32x16_bf16 v[112:127], v[140:143], v[148:151], v[32:47]
    s_waitcnt lgkmcnt(0)
    v_exp_f32 v96, v96
    v_exp_f32 v97, v97
    v_exp_f32 v98, v98
    v_exp_f32 v99, v99
    v_mfma_f32_32x32x16_bf16 v[208:223], v[76:79], v[132:135], v[208:223]
    s_mov_b64 exec, s[20:21]
    ds_read_b128 v[72:75], v251 offset:53248
    ds_read_b128 v[76:79], v251 offset:54272
    s_mov_b64 exec, -1
    v_cvt_pk_bf16_f32 v128, v96, v97
    v_exp_f32 v100, v100
    v_exp_f32 v101, v101
    v_cvt_pk_bf16_f32 v129, v98, v99
    v_exp_f32 v102, v102
    v_exp_f32 v103, v103
    v_exp_f32 v104, v104
    v_cvt_pk_bf16_f32 v130, v100, v101
    v_cvt_pk_bf16_f32 v131, v102, v103
    v_exp_f32 v105, v105
    v_exp_f32 v106, v106
    v_mfma_f32_32x32x16_bf16 v[208:223], v[64:67], v[128:131], v[208:223]
    buffer_load_dword v2, v4, s[4:7], s51 offen offset:0 sc1
    v_exp_f32 v107, v107
    v_cvt_pk_bf16_f32 v132, v104, v105
    v_exp_f32 v108, v108
    v_exp_f32 v109, v109
    v_cvt_pk_bf16_f32 v133, v106, v107
    v_exp_f32 v110, v110
    v_exp_f32 v111, v111
    v_cvt_pk_bf16_f32 v134, v108, v109
    v_cvt_pk_bf16_f32 v135, v110, v111
    v_mfma_f32_32x32x16_bf16 v[96:111], v[136:139], v[144:147], v[32:47]
    s_waitcnt lgkmcnt(0)
    v_exp_f32 v112, v112
    v_exp_f32 v113, v113
    v_exp_f32 v114, v114
    v_exp_f32 v115, v115
    v_mfma_f32_32x32x16_bf16 v[208:223], v[68:71], v[132:135], v[208:223]
    s_mov_b64 exec, s[20:21]
    ds_read_b128 v[64:67], v250 offset:40960
    ds_read_b128 v[68:71], v250 offset:41984
    s_mov_b64 exec, -1
    v_cvt_pk_bf16_f32 v128, v112, v113
    v_exp_f32 v116, v116
    v_exp_f32 v117, v117
    v_cvt_pk_bf16_f32 v129, v114, v115
    v_exp_f32 v118, v118
    v_exp_f32 v119, v119
    v_exp_f32 v120, v120
    v_cvt_pk_bf16_f32 v130, v116, v117
    v_cvt_pk_bf16_f32 v131, v118, v119
    v_exp_f32 v121, v121
    v_exp_f32 v122, v122
    v_mfma_f32_32x32x16_bf16 v[208:223], v[72:75], v[128:131], v[208:223]
    s_waitcnt vmcnt(1)
    s_barrier
    ds_read_b128 v[140:143], v249 offset:32768
    ds_read_b128 v[136:139], v249 offset:36864
    v_exp_f32 v123, v123
    v_cvt_pk_bf16_f32 v132, v120, v121
    v_exp_f32 v124, v124
    v_exp_f32 v125, v125
    v_cvt_pk_bf16_f32 v133, v122, v123
    v_exp_f32 v126, v126
    v_exp_f32 v127, v127
    v_cvt_pk_bf16_f32 v134, v124, v125
    v_cvt_pk_bf16_f32 v135, v126, v127
    s_waitcnt lgkmcnt(1)
    v_mfma_f32_32x32x16_bf16 v[112:127], v[140:143], v[148:151], 0
    ds_read_b128 v[140:143], v248 offset:32768
    v_exp_f32 v96, v96
    v_exp_f32 v97, v97
    v_exp_f32 v98, v98
    v_exp_f32 v99, v99
    v_mfma_f32_32x32x16_bf16 v[208:223], v[76:79], v[132:135], v[208:223]
    s_mov_b64 exec, s[20:21]
    ds_read_b128 v[72:75], v251 offset:32768
    ds_read_b128 v[76:79], v251 offset:33792
    s_mov_b64 exec, -1
    v_cvt_pk_bf16_f32 v128, v96, v97
    v_exp_f32 v100, v100
    v_exp_f32 v101, v101
    v_cvt_pk_bf16_f32 v129, v98, v99
    v_exp_f32 v102, v102
    v_exp_f32 v103, v103
    v_exp_f32 v104, v104
    v_cvt_pk_bf16_f32 v130, v100, v101
    v_cvt_pk_bf16_f32 v131, v102, v103
    v_exp_f32 v105, v105
    v_exp_f32 v106, v106
    v_mfma_f32_32x32x16_bf16 v[192:207], v[64:67], v[128:131], 0
    s_waitcnt vmcnt(0)
    v_cmp_gt_u32 vcc, s35, v2
    s_cbranch_vccnz SPIN_204
BACK_205:
    s_add_u32 m0, s82, 114688
    s_nop 0
    buffer_load_dwordx4 v16, s[4:7], s96 offen offset:0 sc1 lds
    buffer_load_dwordx4 v16, s[4:7], s96 offen offset:1024 sc1 lds
    buffer_load_dwordx4 v16, s[4:7], s96 offen offset:2048 sc1 lds
    buffer_load_dwordx4 v16, s[4:7], s96 offen offset:3072 sc1 lds
    v_exp_f32 v107, v107
    v_cvt_pk_bf16_f32 v132, v104, v105
    v_exp_f32 v108, v108
    v_exp_f32 v109, v109
    v_cvt_pk_bf16_f32 v133, v106, v107
    v_exp_f32 v110, v110
    v_exp_f32 v111, v111
    v_cvt_pk_bf16_f32 v134, v108, v109
    v_cvt_pk_bf16_f32 v135, v110, v111
    s_waitcnt lgkmcnt(3)
    v_mfma_f32_32x32x16_bf16 v[96:111], v[136:139], v[148:151], 0
    s_waitcnt lgkmcnt(0)
    ds_read_b128 v[136:139], v248 offset:36864
    v_exp_f32 v112, v112
    v_exp_f32 v113, v113
    v_exp_f32 v114, v114
    v_exp_f32 v115, v115
    v_mfma_f32_32x32x16_bf16 v[192:207], v[68:71], v[132:135], v[192:207]
    s_mov_b64 exec, s[20:21]
    ds_read_b128 v[64:67], v251 offset:36864
    ds_read_b128 v[68:71], v251 offset:37888
    s_mov_b64 exec, -1
    v_cvt_pk_bf16_f32 v128, v112, v113
    v_exp_f32 v116, v116
    v_exp_f32 v117, v117
    v_cvt_pk_bf16_f32 v129, v114, v115
    v_exp_f32 v118, v118
    v_exp_f32 v119, v119
    v_exp_f32 v120, v120
    v_cvt_pk_bf16_f32 v130, v116, v117
    v_cvt_pk_bf16_f32 v131, v118, v119
    v_exp_f32 v121, v121
    v_exp_f32 v122, v122
    v_mfma_f32_32x32x16_bf16 v[208:223], v[72:75], v[128:131], v[208:223]
    v_exp_f32 v123, v123
    v_cvt_pk_bf16_f32 v132, v120, v121
    v_exp_f32 v124, v124
    v_exp_f32 v125, v125
    v_cvt_pk_bf16_f32 v133, v122, v123
    v_exp_f32 v126, v126
    v_exp_f32 v127, v127
    v_cvt_pk_bf16_f32 v134, v124, v125
    v_cvt_pk_bf16_f32 v135, v126, v127
    v_mfma_f32_32x32x16_bf16 v[112:127], v[140:143], v[144:147], 0
    s_waitcnt lgkmcnt(0)
    s_add_u32 m0, s82, 98304
    s_nop 0
    buffer_load_dwordx4 v16, s[4:7], s97 offen offset:0 sc1 lds
    buffer_load_dwordx4 v16, s[4:7], s97 offen offset:1024 sc1 lds
    buffer_load_dwordx4 v16, s[4:7], s97 offen offset:2048 sc1 lds
    buffer_load_dwordx4 v16, s[4:7], s97 offen offset:3072 sc1 lds
    v_exp_f32 v96, v96
    v_exp_f32 v97, v97
    v_exp_f32 v98, v98
    v_exp_f32 v99, v99
    v_mfma_f32_32x32x16_bf16 v[208:223], v[76:79], v[132:135], v[208:223]
    s_mov_b64 exec, s[20:21]
    ds_read_b128 v[72:75], v250 offset:32768
    ds_read_b128 v[76:79], v250 offset:33792
    s_mov_b64 exec, -1
    v_cvt_pk_bf16_f32 v128, v96, v97
    v_exp_f32 v100, v100
    v_exp_f32 v101, v101
    v_cvt_pk_bf16_f32 v129, v98, v99
    v_exp_f32 v102, v102
    v_exp_f32 v103, v103
    v_exp_f32 v104, v104
    v_cvt_pk_bf16_f32 v130, v100, v101
    v_cvt_pk_bf16_f32 v131, v102, v103
    v_exp_f32 v105, v105
    v_exp_f32 v106, v106
    v_mfma_f32_32x32x16_bf16 v[208:223], v[64:67], v[128:131], v[208:223]
    v_exp_f32 v107, v107
    v_cvt_pk_bf16_f32 v132, v104, v105
    v_exp_f32 v108, v108
    v_exp_f32 v109, v109
    v_cvt_pk_bf16_f32 v133, v106, v107
    v_exp_f32 v110, v110
    v_exp_f32 v111, v111
    v_cvt_pk_bf16_f32 v134, v108, v109
    v_cvt_pk_bf16_f32 v135, v110, v111
    s_cmp_eq_u32 s12, 0
    s_cbranch_scc1 ATTG01_2
    v_mfma_f32_32x32x16_bf16 v[96:111], v[136:139], v[144:147], 0
    s_waitcnt lgkmcnt(0)
    v_exp_f32 v112, v112
    v_exp_f32 v113, v113
    v_exp_f32 v114, v114
    v_exp_f32 v115, v115
    v_mfma_f32_32x32x16_bf16 v[208:223], v[68:71], v[132:135], v[208:223]
    s_mov_b64 exec, s[20:21]
    ds_read_b128 v[64:67], v250 offset:36864
    ds_read_b128 v[68:71], v250 offset:37888
    s_mov_b64 exec, -1
    v_cvt_pk_bf16_f32 v128, v112, v113
    v_exp_f32 v116, v116
    v_exp_f32 v117, v117
    v_cvt_pk_bf16_f32 v129, v114, v115
    v_exp_f32 v118, v118
    v_exp_f32 v119, v119
    v_exp_f32 v120, v120
    v_cvt_pk_bf16_f32 v130, v116, v117
    v_cvt_pk_bf16_f32 v131, v118, v119
    v_exp_f32 v121, v121
    v_exp_f32 v122, v122
    v_mfma_f32_32x32x16_bf16 v[192:207], v[72:75], v[128:131], v[192:207]
    s_waitcnt vmcnt(4)
    s_barrier
    ds_read_b128 v[140:143], v249 offset:20480
    ds_read_b128 v[136:139], v249 offset:24576
    v_exp_f32 v123, v123
    v_cvt_pk_bf16_f32 v132, v120, v121
    v_exp_f32 v124, v124
    v_exp_f32 v125, v125
    v_cvt_pk_bf16_f32 v133, v122, v123
    v_exp_f32 v126, v126
    v_exp_f32 v127, v127
    v_cvt_pk_bf16_f32 v134, v124, v125
    v_cvt_pk_bf16_f32 v135, v126, v127
    s_waitcnt lgkmcnt(1)
    v_mfma_f32_32x32x16_bf16 v[112:127], v[140:143], v[148:151], v[48:63]
    ds_read_b128 v[140:143], v249 offset:28672
    v_exp_f32 v96, v96
    v_exp_f32 v97, v97
    v_exp_f32 v98, v98
    v_exp_f32 v99, v99
    v_mfma_f32_32x32x16_bf16 v[192:207], v[76:79], v[132:135], v[192:207]
    s_mov_b64 exec, s[20:21]
    ds_read_b128 v[72:75], v251 offset:20480
    ds_read_b128 v[76:79], v251 offset:21504
    s_mov_b64 exec, -1
    v_cvt_pk_bf16_f32 v128, v96, v97
    v_exp_f32 v100, v100
    v_exp_f32 v101, v101
    v_cvt_pk_bf16_f32 v129, v98, v99
    v_exp_f32 v102, v102
    v_exp_f32 v103, v103
    v_exp_f32 v104, v104
    v_cvt_pk_bf16_f32 v130, v100, v101
    v_cvt_pk_bf16_f32 v131, v102, v103
    v_exp_f32 v105, v105
    v_exp_f32 v106, v106
    v_mfma_f32_32x32x16_bf16 v[192:207], v[64:67], v[128:131], v[192:207]
    v_exp_f32 v107, v107
    v_cvt_pk_bf16_f32 v132, v104, v105
    v_exp_f32 v108, v108
    v_exp_f32 v109, v109
    v_cvt_pk_bf16_f32 v133, v106, v107
    v_exp_f32 v110, v110
    v_exp_f32 v111, v111
    v_cvt_pk_bf16_f32 v134, v108, v109
    v_cvt_pk_bf16_f32 v135, v110, v111
    s_waitcnt lgkmcnt(3)
    v_mfma_f32_32x32x16_bf16 v[96:111], v[136:139], v[148:151], 0
    s_waitcnt lgkmcnt(0)
    ds_read_b128 v[136:139], v248 offset:28672
    v_exp_f32 v112, v112
    v_exp_f32 v113, v113
    v_exp_f32 v114, v114
    v_exp_f32 v115, v115
    v_mfma_f32_32x32x16_bf16 v[192:207], v[68:71], v[132:135], v[192:207]
    s_mov_b64 exec, s[20:21]
    ds_read_b128 v[64:67], v251 offset:24576
    ds_read_b128 v[68:71], v251 offset:25600
    s_mov_b64 exec, -1
    v_cvt_pk_bf16_f32 v128, v112, v113
    v_exp_f32 v116, v116
    v_exp_f32 v117, v117
    v_cvt_pk_bf16_f32 v129, v114, v115
    v_exp_f32 v118, v118
    v_exp_f32 v119, v119
    v_exp_f32 v120, v120
    v_cvt_pk_bf16_f32 v130, v116, v117
    v_cvt_pk_bf16_f32 v131, v118, v119
    v_exp_f32 v121, v121
    v_exp_f32 v122, v122
    v_mfma_f32_32x32x16_bf16 v[208:223], v[72:75], v[128:131], v[208:223]
    v_exp_f32 v123, v123
    v_cvt_pk_bf16_f32 v132, v120, v121
    v_exp_f32 v124, v124
    v_exp_f32 v125, v125
    v_cvt_pk_bf16_f32 v133, v122, v123
    v_exp_f32 v126, v126
    v_exp_f32 v127, v127
    v_cvt_pk_bf16_f32 v134, v124, v125
    v_cvt_pk_bf16_f32 v135, v126, v127
    v_mfma_f32_32x32x16_bf16 v[112:127], v[140:143], v[148:151], 0
    s_waitcnt lgkmcnt(0)
    ds_read_b128 v[140:143], v248 offset:24576
    v_exp_f32 v96, v96
    v_exp_f32 v97, v97
    v_exp_f32 v98, v98
    v_exp_f32 v99, v99
    v_mfma_f32_32x32x16_bf16 v[208:223], v[76:79], v[132:135], v[208:223]
    s_mov_b64 exec, s[20:21]
    ds_read_b128 v[72:75], v251 offset:28672
    ds_read_b128 v[76:79], v251 offset:29696
    s_mov_b64 exec, -1
    v_cvt_pk_bf16_f32 v128, v96, v97
    v_exp_f32 v100, v100
    v_exp_f32 v101, v101
    v_cvt_pk_bf16_f32 v129, v98, v99
    v_exp_f32 v102, v102
    v_exp_f32 v103, v103
    v_exp_f32 v104, v104
    v_cvt_pk_bf16_f32 v130, v100, v101
    v_cvt_pk_bf16_f32 v131, v102, v103
    v_exp_f32 v105, v105
    v_exp_f32 v106, v106
    v_mfma_f32_32x32x16_bf16 v[208:223], v[64:67], v[128:131], v[208:223]
    s_waitcnt vmcnt(0)
    s_barrier
    v_exp_f32 v107, v107
    v_cvt_pk_bf16_f32 v132, v104, v105
    v_exp_f32 v108, v108
    v_exp_f32 v109, v109
    v_cvt_pk_bf16_f32 v133, v106, v107
    v_exp_f32 v110, v110
    v_exp_f32 v111, v111
    v_cvt_pk_bf16_f32 v134, v108, v109
    v_cvt_pk_bf16_f32 v135, v110, v111
    v_mfma_f32_32x32x16_bf16 v[96:111], v[136:139], v[144:147], 0
    s_waitcnt lgkmcnt(0)
    ds_read_b128 v[136:139], v248 offset:20480
    v_exp_f32 v112, v112
    v_exp_f32 v113, v113
    v_exp_f32 v114, v114
    v_exp_f32 v115, v115
    v_mfma_f32_32x32x16_bf16 v[208:223], v[68:71], v[132:135], v[208:223]
    s_mov_b64 exec, s[20:21]
    ds_read_b128 v[64:67], v250 offset:28672
    ds_read_b128 v[68:71], v250 offset:29696
    s_mov_b64 exec, -1
    v_cvt_pk_bf16_f32 v128, v112, v113
    v_exp_f32 v116, v116
    v_exp_f32 v117, v117
    v_cvt_pk_bf16_f32 v129, v114, v115
    v_exp_f32 v118, v118
    v_exp_f32 v119, v119
    v_exp_f32 v120, v120
    v_cvt_pk_bf16_f32 v130, v116, v117
    v_cvt_pk_bf16_f32 v131, v118, v119
    v_exp_f32 v121, v121
    v_exp_f32 v122, v122
    v_mfma_f32_32x32x16_bf16 v[208:223], v[72:75], v[128:131], v[208:223]
    v_exp_f32 v123, v123
    v_cvt_pk_bf16_f32 v132, v120, v121
    v_exp_f32 v124, v124
    v_exp_f32 v125, v125
    v_cvt_pk_bf16_f32 v133, v122, v123
    v_exp_f32 v126, v126
    v_exp_f32 v127, v127
    v_cvt_pk_bf16_f32 v134, v124, v125
    v_cvt_pk_bf16_f32 v135, v126, v127
    v_mfma_f32_32x32x16_bf16 v[112:127], v[140:143], v[144:147], 0
    s_waitcnt lgkmcnt(0)
    ds_read_b128 v[140:143], v248 offset:16384
    v_exp_f32 v96, v96
    v_exp_f32 v97, v97
    v_exp_f32 v98, v98
    v_exp_f32 v99, v99
    v_mfma_f32_32x32x16_bf16 v[208:223], v[76:79], v[132:135], v[208:223]
    s_mov_b64 exec, s[20:21]
    ds_read_b128 v[72:75], v250 offset:24576
    ds_read_b128 v[76:79], v250 offset:25600
    s_mov_b64 exec, -1
    v_cvt_pk_bf16_f32 v128, v96, v97
    v_exp_f32 v100, v100
    v_exp_f32 v101, v101
    v_cvt_pk_bf16_f32 v129, v98, v99
    v_exp_f32 v102, v102
    v_exp_f32 v103, v103
    v_exp_f32 v104, v104
    v_cvt_pk_bf16_f32 v130, v100, v101
    v_cvt_pk_bf16_f32 v131, v102, v103
    v_exp_f32 v105, v105
    v_exp_f32 v106, v106
    v_mfma_f32_32x32x16_bf16 v[192:207], v[64:67], v[128:131], v[192:207]
    v_subrev_u32 v217, 0x2b800000, v216
    v_cmp_lt_u32 s[26:27], s87, v217
    s_nop 0
    s_cmp_lg_u64 s[26:27], 0
    s_cbranch_scc1 SLOW_209
BACK_210:
    v_rcp_f32 v217, v216
    s_nop 0
    v_mul_f32 v208, v208, v217
    v_mul_f32 v209, v209, v217
    v_cvt_pk_bf16_f32 v220, v208, v209
    v_mul_f32 v210, v210, v217
    v_mul_f32 v211, v211, v217
    v_cvt_pk_bf16_f32 v221, v210, v211
    v_mul_f32 v212, v212, v217
    v_mul_f32 v213, v213, v217
    v_cvt_pk_bf16_f32 v222, v212, v213
    v_mul_f32 v214, v214, v217
    v_mul_f32 v215, v215, v217
    v_cvt_pk_bf16_f32 v223, v214, v215
    v_exp_f32 v107, v107
    v_cvt_pk_bf16_f32 v132, v104, v105
    v_exp_f32 v108, v108
    v_exp_f32 v109, v109
    v_cvt_pk_bf16_f32 v133, v106, v107
    v_exp_f32 v110, v110
    v_exp_f32 v111, v111
    v_cvt_pk_bf16_f32 v134, v108, v109
    v_cvt_pk_bf16_f32 v135, v110, v111
    v_mfma_f32_32x32x16_bf16 v[96:111], v[136:139], v[144:147], 0
    s_waitcnt lgkmcnt(0)
    ds_read_b128 v[136:139], v248 offset:12288
    buffer_store_dwordx4 v[220:223], v0, s[4:7], s54 offen
    v_exp_f32 v112, v112
    v_exp_f32 v113, v113
    v_exp_f32 v114, v114
    v_exp_f32 v115, v115
    v_mfma_f32_32x32x16_bf16 v[192:207], v[68:71], v[132:135], v[192:207]
    s_mov_b64 exec, s[20:21]
    ds_read_b128 v[64:67], v250 offset:20480
    ds_read_b128 v[68:71], v250 offset:21504
    s_mov_b64 exec, -1
    v_cvt_pk_bf16_f32 v128, v112, v113
    v_exp_f32 v116, v116
    v_exp_f32 v117, v117
    v_cvt_pk_bf16_f32 v129, v114, v115
    v_exp_f32 v118, v118
    v_exp_f32 v119, v119
    v_exp_f32 v120, v120
    v_cvt_pk_bf16_f32 v130, v116, v117
    v_cvt_pk_bf16_f32 v131, v118, v119
    v_exp_f32 v121, v121
    v_exp_f32 v122, v122
    v_mfma_f32_32x32x16_bf16 v[192:207], v[72:75], v[128:131], v[192:207]
    v_exp_f32 v123, v123
    v_cvt_pk_bf16_f32 v132, v120, v121
    v_exp_f32 v124, v124
    v_exp_f32 v125, v125
    v_cvt_pk_bf16_f32 v133, v122, v123
    v_exp_f32 v126, v126
    v_exp_f32 v127, v127
    v_cvt_pk_bf16_f32 v134, v124, v125
    v_cvt_pk_bf16_f32 v135, v126, v127
    v_mfma_f32_32x32x16_bf16 v[112:127], v[140:143], v[144:147], 0
    s_waitcnt lgkmcnt(0)
    ds_read_b128 v[140:143], v248 offset:8192
    v_exp_f32 v96, v96
    v_exp_f32 v97, v97
    v_exp_f32 v98, v98
    v_exp_f32 v99, v99
    v_mfma_f32_32x32x16_bf16 v[192:207], v[76:79], v[132:135], v[192:207]
    s_mov_b64 exec, s[20:21]
    ds_read_b128 v[72:75], v250 offset:16384
    ds_read_b128 v[76:79], v250 offset:17408
    s_mov_b64 exec, -1
    v_cvt_pk_bf16_f32 v128, v96, v97
    v_exp_f32 v100, v100
    v_exp_f32 v101, v101
    v_cvt_pk_bf16_f32 v129, v98, v99
    v_exp_f32 v102, v102
    v_exp_f32 v103, v103
    v_exp_f32 v104, v104
    v_cvt_pk_bf16_f32 v130, v100, v101
    v_cvt_pk_bf16_f32 v131, v102, v103
    v_exp_f32 v105, v105
    v_exp_f32 v106, v106
    v_mfma_f32_32x32x16_bf16 v[192:207], v[64:67], v[128:131], v[192:207]
    s_waitcnt vmcnt(0)
    s_cbranch_vccnz SAFE_211
    buffer_store_dword v11, v10, s[4:7], s56 offen offset:0
BACK_212:
    v_exp_f32 v107, v107
    v_cvt_pk_bf16_f32 v132, v104, v105
    v_exp_f32 v108, v108
    v_exp_f32 v109, v109
    v_cvt_pk_bf16_f32 v133, v106, v107
    v_exp_f32 v110, v110
    v_exp_f32 v111, v111
    v_cvt_pk_bf16_f32 v134, v108, v109
    v_cvt_pk_bf16_f32 v135, v110, v111
    v_mfma_f32_32x32x16_bf16 v[96:111], v[136:139], v[144:147], 0
    s_waitcnt lgkmcnt(0)
    v_exp_f32 v112, v112
    v_exp_f32 v113, v113
    v_exp_f32 v114, v114
    v_exp_f32 v115, v115
    v_mfma_f32_32x32x16_bf16 v[192:207], v[68:71], v[132:135], v[192:207]
    s_mov_b64 exec, s[20:21]
    ds_read_b128 v[64:67], v250 offset:12288
    ds_read_b128 v[68:71], v250 offset:13312
    s_mov_b64 exec, -1
    v_cvt_pk_bf16_f32 v128, v112, v113
    v_exp_f32 v116, v116
    v_exp_f32 v117, v117
    v_cvt_pk_bf16_f32 v129, v114, v115
    v_exp_f32 v118, v118
    v_exp_f32 v119, v119
    v_exp_f32 v120, v120
    v_cvt_pk_bf16_f32 v130, v116, v117
    v_cvt_pk_bf16_f32 v131, v118, v119
    v_exp_f32 v121, v121
    v_exp_f32 v122, v122
    v_mfma_f32_32x32x16_bf16 v[192:207], v[72:75], v[128:131], v[192:207]
    v_exp_f32 v123, v123
    v_cvt_pk_bf16_f32 v132, v120, v121
    v_exp_f32 v124, v124
    v_exp_f32 v125, v125
    v_cvt_pk_bf16_f32 v133, v122, v123
    v_exp_f32 v126, v126
    v_exp_f32 v127, v127
    v_cvt_pk_bf16_f32 v134, v124, v125
    v_cvt_pk_bf16_f32 v135, v126, v127
    v_mfma_f32_32x32x16_bf16 v[112:127], v[140:143], v[144:147], v[48:63]
    s_waitcnt lgkmcnt(0)
    v_exp_f32 v96, v96
    v_exp_f32 v97, v97
    v_exp_f32 v98, v98
    v_exp_f32 v99, v99
    v_mfma_f32_32x32x16_bf16 v[192:207], v[76:79], v[132:135], v[192:207]
    s_mov_b64 exec, s[20:21]
    ds_read_b128 v[72:75], v250 offset:8192
    ds_read_b128 v[76:79], v250 offset:9216
    s_mov_b64 exec, -1
    v_cvt_pk_bf16_f32 v128, v96, v97
    v_exp_f32 v100, v100
    v_exp_f32 v101, v101
    v_cvt_pk_bf16_f32 v129, v98, v99
    v_exp_f32 v102, v102
    v_exp_f32 v103, v103
    v_exp_f32 v104, v104
    v_cvt_pk_bf16_f32 v130, v100, v101
    v_cvt_pk_bf16_f32 v131, v102, v103
    v_exp_f32 v105, v105
    v_exp_f32 v106, v106
    v_mfma_f32_32x32x16_bf16 v[192:207], v[64:67], v[128:131], v[192:207]
    v_exp_f32 v107, v107
    v_cvt_pk_bf16_f32 v132, v104, v105
    v_exp_f32 v108, v108
    v_exp_f32 v109, v109
    v_cvt_pk_bf16_f32 v133, v106, v107
    v_exp_f32 v110, v110
    v_exp_f32 v111, v111
    v_cvt_pk_bf16_f32 v134, v108, v109
    v_cvt_pk_bf16_f32 v135, v110, v111
    buffer_load_dword v14, v15, s[4:7], s59 offen offset:0 sc1
    v_exp_f32 v112, v112
    v_exp_f32 v113, v113
    v_exp_f32 v114, v114
    v_exp_f32 v115, v115
    v_mfma_f32_32x32x16_bf16 v[192:207], v[68:71], v[132:135], v[192:207]
    v_cvt_pk_bf16_f32 v128, v112, v113
    v_exp_f32 v116, v116
    v_exp_f32 v117, v117
    v_cvt_pk_bf16_f32 v129, v114, v115
    v_exp_f32 v118, v118
    v_exp_f32 v119, v119
    v_exp_f32 v120, v120
    v_cvt_pk_bf16_f32 v130, v116, v117
    v_cvt_pk_bf16_f32 v131, v118, v119
    v_exp_f32 v121, v121
    v_exp_f32 v122, v122
    s_waitcnt lgkmcnt(0)
    v_mfma_f32_32x32x16_bf16 v[192:207], v[72:75], v[128:131], v[192:207]
    v_exp_f32 v123, v123
    v_cvt_pk_bf16_f32 v132, v120, v121
    v_exp_f32 v124, v124
    v_exp_f32 v125, v125
    v_cvt_pk_bf16_f32 v133, v122, v123
    v_exp_f32 v126, v126
    v_exp_f32 v127, v127
    v_cvt_pk_bf16_f32 v134, v124, v125
    v_cvt_pk_bf16_f32 v135, v126, v127
    s_nop 1
    v_mfma_f32_32x32x16_bf16 v[192:207], v[76:79], v[132:135], v[192:207]
    s_branch ATT1_done
.p2align 12
ATT1_3:
    s_waitcnt vmcnt(4)
    buffer_store_dword v11, v9, s[4:7], s47 offen offset:0 sc1
    s_waitcnt lgkmcnt(0)
    s_barrier
    ds_read_b128 v[144:147], v247
    ds_read_b128 v[148:151], v252
    ds_read_b128 v[136:139], v249 offset:40960
    ds_read_b128 v[140:143], v249 offset:45056
    s_mov_b64 exec, s[20:21]
    ds_read_b128 v[64:67], v251 offset:40960
    ds_read_b128 v[68:71], v251 offset:41984
    s_mov_b64 exec, -1
    s_waitcnt vmcnt(1)
    s_cbranch_vccnz SAFE_229
    buffer_store_dword v11, v10, s[4:7], s46 offen offset:0
BACK_230:
    s_waitcnt lgkmcnt(3)
    v_mfma_f32_32x32x16_bf16 v[96:111], v[136:139], v[148:151], 0
    ds_read_b128 v[136:139], v249 offset:49152
    s_waitcnt lgkmcnt(3)
    v_mfma_f32_32x32x16_bf16 v[112:127], v[140:143], v[148:151], 0
    s_waitcnt lgkmcnt(1)
    ds_read_b128 v[140:143], v248 offset:40960
    s_nop 6
    v_exp_f32 v96, v96
    v_exp_f32 v97, v97
    v_exp_f32 v98, v98
    v_exp_f32 v99, v99
    s_mov_b64 exec, s[20:21]
    ds_read_b128 v[72:75], v251 offset:45056
    ds_read_b128 v[76:79], v251 offset:46080
    s_mov_b64 exec, -1
    v_cvt_pk_bf16_f32 v128, v96, v97
    v_exp_f32 v100, v100
    v_exp_f32 v101, v101
    v_cvt_pk_bf16_f32 v129, v98, v99
    v_exp_f32 v102, v102
    v_exp_f32 v103, v103
    v_exp_f32 v104, v104
    v_cvt_pk_bf16_f32 v130, v100, v101
    v_cvt_pk_bf16_f32 v131, v102, v103
    v_exp_f32 v105, v105
    v_exp_f32 v106, v106
    v_mfma_f32_32x32x16_bf16 v[208:223], v[64:67], v[128:131], 0
    buffer_load_dword v14, v1, s[4:7], s48 offen offset:0 sc1
    v_exp_f32 v107, v107
    v_cvt_pk_bf16_f32 v132, v104, v105
    v_exp_f32 v108, v108
    v_exp_f32 v109, v109
    v_cvt_pk_bf16_f32 v133, v106, v107
    v_exp_f32 v110, v110
    v_exp_f32 v111, v111
    v_cvt_pk_bf16_f32 v134, v108, v109
    v_cvt_pk_bf16_f32 v135, v110, v111
    s_waitcnt lgkmcnt(3)
    v_mfma_f32_32x32x16_bf16 v[96:111], v[136:139], v[148:151], v[32:47]
    s_waitcnt lgkmcnt(0)
    ds_read_b128 v[136:139], v248 offset:45056
    v_exp_f32 v112, v112
    v_exp_f32 v113, v113
    v_exp_f32 v114, v114
    v_exp_f32 v115, v115
    v_mfma_f32_32x32x16_bf16 v[208:223], v[68:71], v[132:135], v[208:223]
    s_mov_b64 exec, s[20:21]
    ds_read_b128 v[64:67], v251 offset:49152
    ds_read_b128 v[68:71], v251 offset:50176
    s_mov_b64 exec, -1
    v_cvt_pk_bf16_f32 v128, v112, v113
    v_exp_f32 v116, v116
    v_exp_f32 v117, v117
    v_cvt_pk_bf16_f32 v129, v114, v115
    v_exp_f32 v118, v118
    v_exp_f32 v119, v119
    v_exp_f32 v120, v120
    v_cvt_pk_bf16_f32 v130, v116, v117
    v_cvt_pk_bf16_f32 v131, v118, v119
    v_exp_f32 v121, v121
    v_exp_f32 v122, v122
    v_mfma_f32_32x32x16_bf16 v[208:223], v[72:75], v[128:131], v[208:223]
    s_waitcnt vmcnt(0)
    v_cmp_gt_u32 vcc, s35, v14
    s_cbranch_vccnz SPIN_223
BACK_224:
    s_mov_b32 m0, s50
    s_nop 0
    buffer_load_dwordx4 v16, s[4:7], s49 offen offset:0 sc1 lds
    buffer_load_dwordx4 v16, s[4:7], s49 offen offset:1024 sc1 lds
    buffer_load_dwordx4 v16, s[4:7], s49 offen offset:2048 sc1 lds
    buffer_load_dwordx4 v16, s[4:7], s49 offen offset:3072 sc1 lds
    v_exp_f32 v123, v123
    v_cvt_pk_bf16_f32 v132, v120, v121
    v_exp_f32 v124, v124
    v_exp_f32 v125, v125
    v_cvt_pk_bf16_f32 v133, v122, v123
    v_exp_f32 v126, v126
    v_exp_f32 v127, v127
    v_cvt_pk_bf16_f32 v134, v124, v125
    v_cvt_pk_bf16_f32 v135, v126, v127
    v_mfma_f32_32x32x16_bf16 v[112:127], v[140:143], v[144:147], 0
    s_waitcnt lgkmcnt(0)
    v_exp_f32 v96, v96
    v_exp_f32 v97, v97
    v_exp_f32 v98, v98
    v_exp_f32 v99, v99
    v_mfma_f32_32x32x16_bf16 v[208:223], v[76:79], v[132:135], v[208:223]
    s_mov_b64 exec, s[20:21]
    ds_read_b128 v[72:75], v250 offset:40960
    ds_read_b128 v[76:79], v250 offset:41984
    s_mov_b64 exec, -1
    v_cvt_pk_bf16_f32 v128, v96, v97
    v_exp_f32 v100, v100
    v_exp_f32 v101, v101
    v_cvt_pk_bf16_f32 v129, v98, v99
    v_exp_f32 v102, v102
    v_exp_f32 v103, v103
    v_exp_f32 v104, v104
    v_cvt_pk_bf16_f32 v130, v100, v101
    v_cvt_pk_bf16_f32 v131, v102, v103
    v_exp_f32 v105, v105
    v_exp_f32 v106, v106
    v_mfma_f32_32x32x16_bf16 v[208:223], v[64:67], v[128:131], v[208:223]
    buffer_load_dword v2, v4, s[4:7], s51 offen offset:0 sc1
    v_exp_f32 v107, v107
    v_cvt_pk_bf16_f32 v132, v104, v105
    v_exp_f32 v108, v108
    v_exp_f32 v109, v109
    v_cvt_pk_bf16_f32 v133, v106, v107
    v_exp_f32 v110, v110
    v_exp_f32 v111, v111
    v_cvt_pk_bf16_f32 v134, v108, v109
    v_cvt_pk_bf16_f32 v135, v110, v111
    v_mfma_f32_32x32x16_bf16 v[96:111], v[136:139], v[144:147], v[32:47]
    s_waitcnt lgkmcnt(0)
    v_exp_f32 v112, v112
    v_exp_f32 v113, v113
    v_exp_f32 v114, v114
    v_exp_f32 v115, v115
    v_mfma_f32_32x32x16_bf16 v[208:223], v[68:71], v[132:135], v[208:223]
    s_mov_b64 exec, s[20:21]
    ds_read_b128 v[64:67], v250 offset:45056
    ds_read_b128 v[68:71], v250 offset:46080
    s_mov_b64 exec, -1
    v_cvt_pk_bf16_f32 v128, v112, v113
    v_exp_f32 v116, v116
    v_exp_f32 v117, v117
    v_cvt_pk_bf16_f32 v129, v114, v115
    v_exp_f32 v118, v118
    v_exp_f32 v119, v119
    v_exp_f32 v120, v120
    v_cvt_pk_bf16_f32 v130, v116, v117
    v_cvt_pk_bf16_f32 v131, v118, v119
    v_exp_f32 v121, v121
    v_exp_f32 v122, v122
    v_mfma_f32_32x32x16_bf16 v[192:207], v[72:75], v[128:131], 0
    s_waitcnt vmcnt(1)
    s_barrier
    ds_read_b128 v[140:143], v249 offset:32768
    ds_read_b128 v[136:139], v249 offset:36864
    v_exp_f32 v123, v123
    v_cvt_pk_bf16_f32 v132, v120, v121
    v_exp_f32 v124, v124
    v_exp_f32 v125, v125
    v_cvt_pk_bf16_f32 v133, v122, v123
    v_exp_f32 v126, v126
    v_exp_f32 v127, v127
    v_cvt_pk_bf16_f32 v134, v124, v125
    v_cvt_pk_bf16_f32 v135, v126, v127
    s_waitcnt lgkmcnt(1)
    v_mfma_f32_32x32x16_bf16 v[112:127], v[140:143], v[148:151], 0
    ds_read_b128 v[140:143], v248 offset:32768
    v_exp_f32 v96, v96
    v_exp_f32 v97, v97
    v_exp_f32 v98, v98
    v_exp_f32 v99, v99
    v_mfma_f32_32x32x16_bf16 v[192:207], v[76:79], v[132:135], v[192:207]
    s_mov_b64 exec, s[20:21]
    ds_read_b128 v[72:75], v251 offset:32768
    ds_read_b128 v[76:79], v251 offset:33792
    s_mov_b64 exec, -1
    v_cvt_pk_bf16_f32 v128, v96, v97
    v_exp_f32 v100, v100
    v_exp_f32 v101, v101
    v_cvt_pk_bf16_f32 v129, v98, v99
    v_exp_f32 v102, v102
    v_exp_f32 v103, v103
    v_exp_f32 v104, v104
    v_cvt_pk_bf16_f32 v130, v100, v101
    v_cvt_pk_bf16_f32 v131, v102, v103
    v_exp_f32 v105, v105
    v_exp_f32 v106, v106
    v_mfma_f32_32x32x16_bf16 v[192:207], v[64:67], v[128:131], v[192:207]
    s_waitcnt vmcnt(0)
    v_cmp_gt_u32 vcc, s35, v2
    s_cbranch_vccnz SPIN_226
BACK_227:
    s_add_u32 m0, s82, 114688
    s_nop 0
    buffer_load_dwordx4 v16, s[4:7], s96 offen offset:0 sc1 lds
    buffer_load_dwordx4 v16, s[4:7], s96 offen offset:1024 sc1 lds
    buffer_load_dwordx4 v16, s[4:7], s96 offen offset:2048 sc1 lds
    buffer_load_dwordx4 v16, s[4:7], s96 offen offset:3072 sc1 lds
    v_exp_f32 v107, v107
    v_cvt_pk_bf16_f32 v132, v104, v105
    v_exp_f32 v108, v108
    v_exp_f32 v109, v109
    v_cvt_pk_bf16_f32 v133, v106, v107
    v_exp_f32 v110, v110
    v_exp_f32 v111, v111
    v_cvt_pk_bf16_f32 v134, v108, v109
    v_cvt_pk_bf16_f32 v135, v110, v111
    s_waitcnt lgkmcnt(3)
    v_mfma_f32_32x32x16_bf16 v[96:111], v[136:139], v[148:151], 0
    s_waitcnt lgkmcnt(0)
    ds_read_b128 v[136:139], v248 offset:36864
    v_exp_f32 v112, v112
    v_exp_f32 v113, v113
    v_exp_f32 v114, v114
    v_exp_f32 v115, v115
    v_mfma_f32_32x32x16_bf16 v[192:207], v[68:71], v[132:135], v[192:207]
    s_mov_b64 exec, s[20:21]
    ds_read_b128 v[64:67], v251 offset:36864
    ds_read_b128 v[68:71], v251 offset:37888
    s_mov_b64 exec, -1
    v_cvt_pk_bf16_f32 v128, v112, v113
    v_exp_f32 v116, v116
    v_exp_f32 v117, v117
    v_cvt_pk_bf16_f32 v129, v114, v115
    v_exp_f32 v118, v118
    v_exp_f32 v119, v119
    v_exp_f32 v120, v120
    v_cvt_pk_bf16_f32 v130, v116, v117
    v_cvt_pk_bf16_f32 v131, v118, v119
    v_exp_f32 v121, v121
    v_exp_f32 v122, v122
    v_mfma_f32_32x32x16_bf16 v[208:223], v[72:75], v[128:131], v[208:223]
    v_exp_f32 v123, v123
    v_cvt_pk_bf16_f32 v132, v120, v121
    v_exp_f32 v124, v124
    v_exp_f32 v125, v125
    v_cvt_pk_bf16_f32 v133, v122, v123
    v_exp_f32 v126, v126
    v_exp_f32 v127, v127
    v_cvt_pk_bf16_f32 v134, v124, v125
    v_cvt_pk_bf16_f32 v135, v126, v127
    v_mfma_f32_32x32x16_bf16 v[112:127], v[140:143], v[144:147], 0
    s_waitcnt lgkmcnt(0)
    s_add_u32 m0, s82, 98304
    s_nop 0
    buffer_load_dwordx4 v16, s[4:7], s97 offen offset:0 sc1 lds
    buffer_load_dwordx4 v16, s[4:7], s97 offen offset:1024 sc1 lds
    buffer_load_dwordx4 v16, s[4:7], s97 offen offset:2048 sc1 lds
    buffer_load_dwordx4 v16, s[4:7], s97 offen offset:3072 sc1 lds
    v_exp_f32 v96, v96
    v_exp_f32 v97, v97
    v_exp_f32 v98, v98
    v_exp_f32 v99, v99
    v_mfma_f32_32x32x16_bf16 v[208:223], v[76:79], v[132:135], v[208:223]
    s_mov_b64 exec, s[20:21]
    ds_read_b128 v[72:75], v250 offset:32768
    ds_read_b128 v[76:79], v250 offset:33792
    s_mov_b64 exec, -1
    v_cvt_pk_bf16_f32 v128, v96, v97
    v_exp_f32 v100, v100
    v_exp_f32 v101, v101
    v_cvt_pk_bf16_f32 v129, v98, v99
    v_exp_f32 v102, v102
    v_exp_f32 v103, v103
    v_exp_f32 v104, v104
    v_cvt_pk_bf16_f32 v130, v100, v101
    v_cvt_pk_bf16_f32 v131, v102, v103
    v_exp_f32 v105, v105
    v_exp_f32 v106, v106
    v_mfma_f32_32x32x16_bf16 v[208:223], v[64:67], v[128:131], v[208:223]
    v_exp_f32 v107, v107
    v_cvt_pk_bf16_f32 v132, v104, v105
    v_exp_f32 v108, v108
    v_exp_f32 v109, v109
    v_cvt_pk_bf16_f32 v133, v106, v107
    v_exp_f32 v110, v110
    v_exp_f32 v111, v111
    v_cvt_pk_bf16_f32 v134, v108, v109
    v_cvt_pk_bf16_f32 v135, v110, v111
    s_cmp_eq_u32 s12, 0
    s_cbranch_scc1 ATTG01_3
    v_mfma_f32_32x32x16_bf16 v[96:111], v[136:139], v[144:147], 0
    s_waitcnt lgkmcnt(0)
    v_exp_f32 v112, v112
    v_exp_f32 v113, v113
    v_exp_f32 v114, v114
    v_exp_f32 v115, v115
    v_mfma_f32_32x32x16_bf16 v[208:223], v[68:71], v[132:135], v[208:223]
    s_mov_b64 exec, s[20:21]
    ds_read_b128 v[64:67], v250 offset:36864
    ds_read_b128 v[68:71], v250 offset:37888
    s_mov_b64 exec, -1
    v_cvt_pk_bf16_f32 v128, v112, v113
    v_exp_f32 v116, v116
    v_exp_f32 v117, v117
    v_cvt_pk_bf16_f32 v129, v114, v115
    v_exp_f32 v118, v118
    v_exp_f32 v119, v119
    v_exp_f32 v120, v120
    v_cvt_pk_bf16_f32 v130, v116, v117
    v_cvt_pk_bf16_f32 v131, v118, v119
    v_exp_f32 v121, v121
    v_exp_f32 v122, v122
    v_mfma_f32_32x32x16_bf16 v[192:207], v[72:75], v[128:131], v[192:207]
    s_waitcnt vmcnt(4)
    s_barrier
    ds_read_b128 v[140:143], v249 offset:16384
    ds_read_b128 v[136:139], v249 offset:20480
    v_exp_f32 v123, v123
    v_cvt_pk_bf16_f32 v132, v120, v121
    v_exp_f32 v124, v124
    v_exp_f32 v125, v125
    v_cvt_pk_bf16_f32 v133, v122, v123
    v_exp_f32 v126, v126
    v_exp_f32 v127, v127
    v_cvt_pk_bf16_f32 v134, v124, v125
    v_cvt_pk_bf16_f32 v135, v126, v127
    s_waitcnt lgkmcnt(1)
    v_mfma_f32_32x32x16_bf16 v[112:127], v[140:143], v[148:151], v[48:63]
    ds_read_b128 v[140:143], v249 offset:24576
    v_exp_f32 v96, v96
    v_exp_f32 v97, v97
    v_exp_f32 v98, v98
    v_exp_f32 v99, v99
    v_mfma_f32_32x32x16_bf16 v[192:207], v[76:79], v[132:135], v[192:207]
    s_mov_b64 exec, s[20:21]
    ds_read_b128 v[72:75], v251 offset:16384
    ds_read_b128 v[76:79], v251 offset:17408
    s_mov_b64 exec, -1
    v_cvt_pk_bf16_f32 v128, v96, v97
    v_exp_f32 v100, v100
    v_exp_f32 v101, v101
    v_cvt_pk_bf16_f32 v129, v98, v99
    v_exp_f32 v102, v102
    v_exp_f32 v103, v103
    v_exp_f32 v104, v104
    v_cvt_pk_bf16_f32 v130, v100, v101
    v_cvt_pk_bf16_f32 v131, v102, v103
    v_exp_f32 v105, v105
    v_exp_f32 v106, v106
    v_mfma_f32_32x32x16_bf16 v[192:207], v[64:67], v[128:131], v[192:207]
    v_exp_f32 v107, v107
    v_cvt_pk_bf16_f32 v132, v104, v105
    v_exp_f32 v108, v108
    v_exp_f32 v109, v109
    v_cvt_pk_bf16_f32 v133, v106, v107
    v_exp_f32 v110, v110
    v_exp_f32 v111, v111
    v_cvt_pk_bf16_f32 v134, v108, v109
    v_cvt_pk_bf16_f32 v135, v110, v111
    s_waitcnt lgkmcnt(3)
    v_mfma_f32_32x32x16_bf16 v[96:111], v[136:139], v[148:151], 0
    s_waitcnt lgkmcnt(0)
    ds_read_b128 v[136:139], v249 offset:28672
    v_exp_f32 v112, v112
    v_exp_f32 v113, v113
    v_exp_f32 v114, v114
    v_exp_f32 v115, v115
    v_mfma_f32_32x32x16_bf16 v[192:207], v[68:71], v[132:135], v[192:207]
    s_mov_b64 exec, s[20:21]
    ds_read_b128 v[64:67], v251 offset:20480
    ds_read_b128 v[68:71], v251 offset:21504
    s_mov_b64 exec, -1
    v_cvt_pk_bf16_f32 v128, v112, v113
    v_exp_f32 v116, v116
    v_exp_f32 v117, v117
    v_cvt_pk_bf16_f32 v129, v114, v115
    v_exp_f32 v118, v118
    v_exp_f32 v119, v119
    v_exp_f32 v120, v120
    v_cvt_pk_bf16_f32 v130, v116, v117
    v_cvt_pk_bf16_f32 v131, v118, v119
    v_exp_f32 v121, v121
    v_exp_f32 v122, v122
    v_mfma_f32_32x32x16_bf16 v[208:223], v[72:75], v[128:131], v[208:223]
    v_exp_f32 v123, v123
    v_cvt_pk_bf16_f32 v132, v120, v121
    v_exp_f32 v124, v124
    v_exp_f32 v125, v125
    v_cvt_pk_bf16_f32 v133, v122, v123
    v_exp_f32 v126, v126
    v_exp_f32 v127, v127
    v_cvt_pk_bf16_f32 v134, v124, v125
    v_cvt_pk_bf16_f32 v135, v126, v127
    v_mfma_f32_32x32x16_bf16 v[112:127], v[140:143], v[148:151], 0
    s_waitcnt lgkmcnt(0)
    ds_read_b128 v[140:143], v248 offset:28672
    v_exp_f32 v96, v96
    v_exp_f32 v97, v97
    v_exp_f32 v98, v98
    v_exp_f32 v99, v99
    v_mfma_f32_32x32x16_bf16 v[208:223], v[76:79], v[132:135], v[208:223]
    s_mov_b64 exec, s[20:21]
    ds_read_b128 v[72:75], v251 offset:24576
    ds_read_b128 v[76:79], v251 offset:25600
    s_mov_b64 exec, -1
    v_cvt_pk_bf16_f32 v128, v96, v97
    v_exp_f32 v100, v100
    v_exp_f32 v101, v101
    v_cvt_pk_bf16_f32 v129, v98, v99
    v_exp_f32 v102, v102
    v_exp_f32 v103, v103
    v_exp_f32 v104, v104
    v_cvt_pk_bf16_f32 v130, v100, v101
    v_cvt_pk_bf16_f32 v131, v102, v103
    v_exp_f32 v105, v105
    v_exp_f32 v106, v106
    v_mfma_f32_32x32x16_bf16 v[208:223], v[64:67], v[128:131], v[208:223]
    s_waitcnt vmcnt(0)
    s_barrier
    v_exp_f32 v107, v107
    v_cvt_pk_bf16_f32 v132, v104, v105
    v_exp_f32 v108, v108
    v_exp_f32 v109, v109
    v_cvt_pk_bf16_f32 v133, v106, v107
    v_exp_f32 v110, v110
    v_exp_f32 v111, v111
    v_cvt_pk_bf16_f32 v134, v108, v109
    v_cvt_pk_bf16_f32 v135, v110, v111
    v_mfma_f32_32x32x16_bf16 v[96:111], v[136:139], v[148:151], 0
    s_waitcnt lgkmcnt(0)
    ds_read_b128 v[136:139], v248 offset:24576
    v_exp_f32 v112, v112
    v_exp_f32 v113, v113
    v_exp_f32 v114, v114
    v_exp_f32 v115, v115
    v_mfma_f32_32x32x16_bf16 v[208:223], v[68:71], v[132:135], v[208:223]
    s_mov_b64 exec, s[20:21]
    ds_read_b128 v[64:67], v251 offset:28672
    ds_read_b128 v[68:71], v251 offset:29696
    s_mov_b64 exec, -1
    v_cvt_pk_bf16_f32 v128, v112, v113
    v_exp_f32 v116, v116
    v_exp_f32 v117, v117
    v_cvt_pk_bf16_f32 v129, v114, v115
    v_exp_f32 v118, v118
    v_exp_f32 v119, v119
    v_exp_f32 v120, v120
    v_cvt_pk_bf16_f32 v130, v116, v117
    v_cvt_pk_bf16_f32 v131, v118, v119
    v_exp_f32 v121, v121
    v_exp_f32 v122, v122
    v_mfma_f32_32x32x16_bf16 v[208:223], v[72:75], v[128:131], v[208:223]
    v_exp_f32 v123, v123
    v_cvt_pk_bf16_f32 v132, v120, v121
    v_exp_f32 v124, v124
    v_exp_f32 v125, v125
    v_cvt_pk_bf16_f32 v133, v122, v123
    v_exp_f32 v126, v126
    v_exp_f32 v127, v127
    v_cvt_pk_bf16_f32 v134, v124, v125
    v_cvt_pk_bf16_f32 v135, v126, v127
    v_mfma_f32_32x32x16_bf16 v[112:127], v[140:143], v[144:147], 0
    s_waitcnt lgkmcnt(0)
    ds_read_b128 v[140:143], v248 offset:20480
    v_exp_f32 v96, v96
    v_exp_f32 v97, v97
    v_exp_f32 v98, v98
    v_exp_f32 v99, v99
    v_mfma_f32_32x32x16_bf16 v[208:223], v[76:79], v[132:135], v[208:223]
    s_mov_b64 exec, s[20:21]
    ds_read_b128 v[72:75], v250 offset:28672
    ds_read_b128 v[76:79], v250 offset:29696
    s_mov_b64 exec, -1
    v_cvt_pk_bf16_f32 v128, v96, v97
    v_exp_f32 v100, v100
    v_exp_f32 v101, v101
    v_cvt_pk_bf16_f32 v129, v98, v99
    v_exp_f32 v102, v102
    v_exp_f32 v103, v103
    v_exp_f32 v104, v104
    v_cvt_pk_bf16_f32 v130, v100, v101
    v_cvt_pk_bf16_f32 v131, v102, v103
    v_exp_f32 v105, v105
    v_exp_f32 v106, v106
    v_mfma_f32_32x32x16_bf16 v[208:223], v[64:67], v[128:131], v[208:223]
    v_exp_f32 v107, v107
    v_cvt_pk_bf16_f32 v132, v104, v105
    v_exp_f32 v108, v108
    v_exp_f32 v109, v109
    v_cvt_pk_bf16_f32 v133, v106, v107
    v_exp_f32 v110, v110
    v_exp_f32 v111, v111
    v_cvt_pk_bf16_f32 v134, v108, v109
    v_cvt_pk_bf16_f32 v135, v110, v111
    v_mfma_f32_32x32x16_bf16 v[96:111], v[136:139], v[144:147], 0
    s_waitcnt lgkmcnt(0)
    ds_read_b128 v[136:139], v248 offset:16384
    v_exp_f32 v112, v112
    v_exp_f32 v113, v113
    v_exp_f32 v114, v114
    v_exp_f32 v115, v115
    v_mfma_f32_32x32x16_bf16 v[208:223], v[68:71], v[132:135], v[208:223]
    s_mov_b64 exec, s[20:21]
    ds_read_b128 v[64:67], v250 offset:24576
    ds_read_b128 v[68:71], v250 offset:25600
    s_mov_b64 exec, -1
    v_cvt_pk_bf16_f32 v128, v112, v113
    v_exp_f32 v116, v116
    v_exp_f32 v117, v117
    v_cvt_pk_bf16_f32 v129, v114, v115
    v_exp_f32 v118, v118
    v_exp_f32 v119, v119
    v_exp_f32 v120, v120
    v_cvt_pk_bf16_f32 v130, v116, v117
    v_cvt_pk_bf16_f32 v131, v118, v119
    v_exp_f32 v121, v121
    v_exp_f32 v122, v122
    v_mfma_f32_32x32x16_bf16 v[192:207], v[72:75], v[128:131], v[192:207]
    v_subrev_u32 v217, 0x2b800000, v216
    v_cmp_lt_u32 s[26:27], s87, v217
    s_nop 0
    s_cmp_lg_u64 s[26:27], 0
    s_cbranch_scc1 SLOW_231
BACK_232:
    v_rcp_f32 v217, v216
    s_nop 0
    v_mul_f32 v208, v208, v217
    v_mul_f32 v209, v209, v217
    v_cvt_pk_bf16_f32 v220, v208, v209
    v_mul_f32 v210, v210, v217
    v_mul_f32 v211, v211, v217
    v_cvt_pk_bf16_f32 v221, v210, v211
    v_mul_f32 v212, v212, v217
    v_mul_f32 v213, v213, v217
    v_cvt_pk_bf16_f32 v222, v212, v213
    v_mul_f32 v214, v214, v217
    v_mul_f32 v215, v215, v217
    v_cvt_pk_bf16_f32 v223, v214, v215
    v_exp_f32 v123, v123
    v_cvt_pk_bf16_f32 v132, v120, v121
    v_exp_f32 v124, v124
    v_exp_f32 v125, v125
    v_cvt_pk_bf16_f32 v133, v122, v123
    v_exp_f32 v126, v126
    v_exp_f32 v127, v127
    v_cvt_pk_bf16_f32 v134, v124, v125
    v_cvt_pk_bf16_f32 v135, v126, v127
    v_mfma_f32_32x32x16_bf16 v[112:127], v[140:143], v[144:147], 0
    s_waitcnt lgkmcnt(0)
    ds_read_b128 v[140:143], v248 offset:12288
    buffer_store_dwordx4 v[220:223], v0, s[4:7], s54 offen
    v_exp_f32 v96, v96
    v_exp_f32 v97, v97
    v_exp_f32 v98, v98
    v_exp_f32 v99, v99
    v_mfma_f32_32x32x16_bf16 v[192:207], v[76:79], v[132:135], v[192:207]
    s_mov_b64 exec, s[20:21]
    ds_read_b128 v[72:75], v250 offset:20480
    ds_read_b128 v[76:79], v250 offset:21504
    s_mov_b64 exec, -1
    v_cvt_pk_bf16_f32 v128, v96, v97
    v_exp_f32 v100, v100
    v_exp_f32 v101, v101
    v_cvt_pk_bf16_f32 v129, v98, v99
    v_exp_f32 v102, v102
    v_exp_f32 v103, v103
    v_exp_f32 v104, v104
    v_cvt_pk_bf16_f32 v130, v100, v101
    v_cvt_pk_bf16_f32 v131, v102, v103
    v_exp_f32 v105, v105
    v_exp_f32 v106, v106
    v_mfma_f32_32x32x16_bf16 v[192:207], v[64:67], v[128:131], v[192:207]
    v_exp_f32 v107, v107
    v_cvt_pk_bf16_f32 v132, v104, v105
    v_exp_f32 v108, v108
    v_exp_f32 v109, v109
    v_cvt_pk_bf16_f32 v133, v106, v107
    v_exp_f32 v110, v110
    v_exp_f32 v111, v111
    v_cvt_pk_bf16_f32 v134, v108, v109
    v_cvt_pk_bf16_f32 v135, v110, v111
    v_mfma_f32_32x32x16_bf16 v[96:111], v[136:139], v[144:147], 0
    s_waitcnt lgkmcnt(0)
    v_exp_f32 v112, v112
    v_exp_f32 v113, v113
    v_exp_f32 v114, v114
    v_exp_f32 v115, v115
    v_mfma_f32_32x32x16_bf16 v[192:207], v[68:71], v[132:135], v[192:207]
    s_mov_b64 exec, s[20:21]
    ds_read_b128 v[64:67], v250 offset:16384
    ds_read_b128 v[68:71], v250 offset:17408
    s_mov_b64 exec, -1
    v_cvt_pk_bf16_f32 v128, v112, v113
    v_exp_f32 v116, v116
    v_exp_f32 v117, v117
    v_cvt_pk_bf16_f32 v129, v114, v115
    v_exp_f32 v118, v118
    v_exp_f32 v119, v119
    v_exp_f32 v120, v120
    v_cvt_pk_bf16_f32 v130, v116, v117
    v_cvt_pk_bf16_f32 v131, v118, v119
    v_exp_f32 v121, v121
    v_exp_f32 v122, v122
    v_mfma_f32_32x32x16_bf16 v[192:207], v[72:75], v[128:131], v[192:207]
    s_waitcnt vmcnt(0)
    s_cbranch_vccnz SAFE_233
    buffer_store_dword v11, v10, s[4:7], s56 offen offset:0
BACK_234:
    v_exp_f32 v123, v123
    v_cvt_pk_bf16_f32 v132, v120, v121
    v_exp_f32 v124, v124
    v_exp_f32 v125, v125
    v_cvt_pk_bf16_f32 v133, v122, v123
    v_exp_f32 v126, v126
    v_exp_f32 v127, v127
    v_cvt_pk_bf16_f32 v134, v124, v125
    v_cvt_pk_bf16_f32 v135, v126, v127
    v_mfma_f32_32x32x16_bf16 v[112:127], v[140:143], v[144:147], v[48:63]
    s_waitcnt lgkmcnt(0)
    v_exp_f32 v96, v96
    v_exp_f32 v97, v97
    v_exp_f32 v98, v98
    v_exp_f32 v99, v99
    v_mfma_f32_32x32x16_bf16 v[192:207], v[76:79], v[132:135], v[192:207]
    s_mov_b64 exec, s[20:21]
    ds_read_b128 v[72:75], v250 offset:12288
    ds_read_b128 v[76:79], v250 offset:13312
    s_mov_b64 exec, -1
    v_cvt_pk_bf16_f32 v128, v96, v97
    v_exp_f32 v100, v100
    v_exp_f32 v101, v101
    v_cvt_pk_bf16_f32 v129, v98, v99
    v_exp_f32 v102, v102
    v_exp_f32 v103, v103
    v_exp_f32 v104, v104
    v_cvt_pk_bf16_f32 v130, v100, v101
    v_cvt_pk_bf16_f32 v131, v102, v103
    v_exp_f32 v105, v105
    v_exp_f32 v106, v106
    v_mfma_f32_32x32x16_bf16 v[192:207], v[64:67], v[128:131], v[192:207]
    v_exp_f32 v107, v107
    v_cvt_pk_bf16_f32 v132, v104, v105
    v_exp_f32 v108, v108
    v_exp_f32 v109, v109
    v_cvt_pk_bf16_f32 v133, v106, v107
    v_exp_f32 v110, v110
    v_exp_f32 v111, v111
    v_cvt_pk_bf16_f32 v134, v108, v109
    v_cvt_pk_bf16_f32 v135, v110, v111
    buffer_load_dword v14, v15, s[4:7], s59 offen offset:0 sc1
    v_exp_f32 v112, v112
    v_exp_f32 v113, v113
    v_exp_f32 v114, v114
    v_exp_f32 v115, v115
    v_mfma_f32_32x32x16_bf16 v[192:207], v[68:71], v[132:135], v[192:207]
    v_cvt_pk_bf16_f32 v128, v112, v113
    v_exp_f32 v116, v116
    v_exp_f32 v117, v117
    v_cvt_pk_bf16_f32 v129, v114, v115
    v_exp_f32 v118, v118
    v_exp_f32 v119, v119
    v_exp_f32 v120, v120
    v_cvt_pk_bf16_f32 v130, v116, v117
    v_cvt_pk_bf16_f32 v131, v118, v119
    v_exp_f32 v121, v121
    v_exp_f32 v122, v122
    s_waitcnt lgkmcnt(0)
    v_mfma_f32_32x32x16_bf16 v[192:207], v[72:75], v[128:131], v[192:207]
    v_exp_f32 v123, v123
    v_cvt_pk_bf16_f32 v132, v120, v121
    v_exp_f32 v124, v124
    v_exp_f32 v125, v125
    v_cvt_pk_bf16_f32 v133, v122, v123
    v_exp_f32 v126, v126
    v_exp_f32 v127, v127
    v_cvt_pk_bf16_f32 v134, v124, v125
    v_cvt_pk_bf16_f32 v135, v126, v127
    s_nop 1
    v_mfma_f32_32x32x16_bf16 v[192:207], v[76:79], v[132:135], v[192:207]
    s_branch ATT1_done
.p2align 12
ATT1_done:
    s_waitcnt vmcnt(0)
    v_cmp_gt_u32 vcc, s35, v14
    s_cbranch_vccz BACK_236
SPIN_235:
    buffer_load_dword v14, v15, s[4:7], s59 offen offset:0 sc1
    s_sub_u32 s16, s16, 1
    s_cbranch_scc1 M_end
    s_waitcnt vmcnt(0)
    v_cmp_gt_u32 vcc, 2, v14
    s_cbranch_vccnz SPIN_235
    s_cmp_lg_u32 s15, 0
    s_cbranch_scc1 SPIN2_237
BACK_236:
    buffer_load_dwordx4 v[160:163], v16, s[4:7], s57 offen offset:0 sc1
    buffer_load_dwordx4 v[164:167], v17, s[4:7], s57 offen offset:0 sc1
    buffer_load_dwordx4 v[168:171], v18, s[4:7], s57 offen offset:0 sc1
    buffer_load_dwordx4 v[172:175], v19, s[4:7], s57 offen offset:0 sc1
    s_nop 3
    v_subrev_u32 v201, 0x2b800000, v200
    v_cmp_lt_u32 s[26:27], s87, v201
    s_nop 0
    s_cmp_lg_u64 s[26:27], 0
    s_cbranch_scc1 SLOW_245
BACK_246:
    v_rcp_f32 v201, v200
    s_nop 0
    v_mul_f32 v192, v192, v201
    v_mul_f32 v193, v193, v201
    v_cvt_pk_bf16_f32 v204, v192, v193
    v_mul_f32 v194, v194, v201
    v_mul_f32 v195, v195, v201
    v_cvt_pk_bf16_f32 v205, v194, v195
    v_mul_f32 v196, v196, v201
    v_mul_f32 v197, v197, v201
    v_cvt_pk_bf16_f32 v206, v196, v197
    v_mul_f32 v198, v198, v201
    v_mul_f32 v199, v199, v201
    v_cvt_pk_bf16_f32 v207, v198, v199
    buffer_store_dwordx4 v[204:207], v0, s[4:7], s53 offen
    buffer_load_dwordx4 v[176:179], v16, s[4:7], s57 offen offset:1024 sc1
    buffer_load_dwordx4 v[180:183], v17, s[4:7], s57 offen offset:1024 sc1
    s_waitcnt vmcnt(6)
    v_mfma_f32_16x16x32_bf16 v[96:99], a[176:179], v[160:163], 0
    v_mfma_f32_16x16x32_bf16 v[104:107], a[180:183], v[160:163], 0
    buffer_load_dwordx4 v[184:187], v18, s[4:7], s57 offen offset:1024 sc1
    v_accvgpr_read_b32 v224, a240
    v_mfma_f32_16x16x32_bf16 v[112:115], a[184:187], v[160:163], 0
    v_accvgpr_read_b32 v225, a241
    v_accvgpr_read_b32 v226, a242
    v_mfma_f32_16x16x32_bf16 v[120:123], a[188:191], v[160:163], 0
    s_waitcnt vmcnt(6)
    buffer_load_dwordx4 v[188:191], v19, s[4:7], s57 offen offset:1024 sc1
    v_accvgpr_read_b32 v227, a243
    v_mfma_f32_16x16x32_bf16 v[96:99], a[192:195], v[164:167], v[96:99]
    v_accvgpr_read_b32 v228, a244
    v_accvgpr_read_b32 v229, a245
    v_mfma_f32_16x16x32_bf16 v[104:107], a[196:199], v[164:167], v[104:107]
    s_barrier
    v_accvgpr_read_b32 v230, a246
    v_accvgpr_read_b32 v231, a247
    v_mfma_f32_16x16x32_bf16 v[112:115], a[200:203], v[164:167], v[112:115]
    v_mfma_f32_16x16x32_bf16 v[120:123], a[204:207], v[164:167], v[120:123]
    s_waitcnt vmcnt(6)
    v_mfma_f32_16x16x32_bf16 v[96:99], a[208:211], v[168:171], v[96:99]
    v_mfma_f32_16x16x32_bf16 v[104:107], a[212:215], v[168:171], v[104:107]
    v_mfma_f32_16x16x32_bf16 v[112:115], a[216:219], v[168:171], v[112:115]
    v_mfma_f32_16x16x32_bf16 v[120:123], a[220:223], v[168:171], v[120:123]
    s_waitcnt vmcnt(5)
    v_mfma_f32_16x16x32_bf16 v[96:99], a[224:227], v[172:175], v[96:99]
    v_mfma_f32_16x16x32_bf16 v[104:107], a[228:231], v[172:175], v[104:107]
    v_mfma_f32_16x16x32_bf16 v[112:115], a[232:235], v[172:175], v[112:115]
    v_mfma_f32_16x16x32_bf16 v[120:123], a[236:239], v[172:175], v[120:123]
    s_waitcnt vmcnt(3)
    s_cbranch_vccnz SAFE_252
    buffer_store_dword v11, v10, s[4:7], s55 offen offset:0
BACK_253:
    v_mfma_f32_16x16x32_bf16 v[100:103], a[176:179], v[176:179], 0
    v_mfma_f32_16x16x32_bf16 v[108:111], a[180:183], v[176:179], 0
    v_mfma_f32_16x16x32_bf16 v[116:119], a[184:187], v[176:179], 0
    v_mfma_f32_16x16x32_bf16 v[124:127], a[188:191], v[176:179], 0
    s_waitcnt vmcnt(3)
    ds_write_b128 v5, v[96:99] offset:0
    v_mfma_f32_16x16x32_bf16 v[100:103], a[192:195], v[180:183], v[100:103]
    v_mfma_f32_16x16x32_bf16 v[108:111], a[196:199], v[180:183], v[108:111]
    v_mfma_f32_16x16x32_bf16 v[116:119], a[200:203], v[180:183], v[116:119]
    v_mfma_f32_16x16x32_bf16 v[124:127], a[204:207], v[180:183], v[124:127]
    s_waitcnt vmcnt(2)
    ds_write_b128 v5, v[104:107] offset:2048
    v_mfma_f32_16x16x32_bf16 v[100:103], a[208:211], v[184:187], v[100:103]
    v_mfma_f32_16x16x32_bf16 v[108:111], a[212:215], v[184:187], v[108:111]
    v_mfma_f32_16x16x32_bf16 v[116:119], a[216:219], v[184:187], v[116:119]
    v_mfma_f32_16x16x32_bf16 v[124:127], a[220:223], v[184:187], v[124:127]
    s_waitcnt vmcnt(1)
    ds_write_b128 v5, v[112:115] offset:4096
    v_mfma_f32_16x16x32_bf16 v[100:103], a[224:227], v[188:191], v[100:103]
    v_mfma_f32_16x16x32_bf16 v[108:111], a[228:231], v[188:191], v[108:111]
    v_mfma_f32_16x16x32_bf16 v[116:119], a[232:235], v[188:191], v[116:119]
    v_mfma_f32_16x16x32_bf16 v[124:127], a[236:239], v[188:191], v[124:127]
    buffer_load_dword v14, v15, s[4:7], s60 offen offset:0 sc1
    ds_write_b128 v5, v[120:123] offset:6144
    s_nop 2
    ds_write_b128 v5, v[100:103] offset:1024
    ds_write_b128 v5, v[108:111] offset:3072
    ds_write_b128 v5, v[116:119] offset:5120
    ds_write_b128 v5, v[124:127] offset:7168
    s_waitcnt vmcnt(0)
    v_cmp_gt_u32 vcc, s35, v14
    s_cbranch_vccz BACK_250
SPIN_249:
    buffer_load_dword v14, v15, s[4:7], s60 offen offset:0 sc1
    s_sub_u32 s16, s16, 1
    s_cbranch_scc1 M_end
    s_waitcnt vmcnt(0)
    v_cmp_gt_u32 vcc, 2, v14
    s_cbranch_vccnz SPIN_249
    s_cmp_lg_u32 s15, 0
    s_cbranch_scc1 SPIN2_251
BACK_250:
    buffer_load_dwordx4 v[32:35], v16, s[4:7], s58 offen offset:0 sc1
    buffer_load_dwordx4 v[36:39], v17, s[4:7], s58 offen offset:0 sc1
    buffer_load_dwordx4 v[40:43], v18, s[4:7], s58 offen offset:0 sc1
    buffer_load_dwordx4 v[44:47], v19, s[4:7], s58 offen offset:0 sc1
    s_waitcnt lgkmcnt(0)
    s_barrier
    ds_read_b128 v[192:195], v6 offset:0
    ds_read_b128 v[196:199], v6 offset:512
    ds_read_b128 v[200:203], v6 offset:8192
    ds_read_b128 v[204:207], v6 offset:8704
    ds_read_b128 v[208:211], v6 offset:16384
    ds_read_b128 v[212:215], v6 offset:16896
    ds_read_b128 v[216:219], v6 offset:24576
    ds_read_b128 v[220:223], v6 offset:25088
    buffer_load_dwordx4 v[48:51], v16, s[4:7], s58 offen offset:1024 sc1
    buffer_load_dwordx4 v[52:55], v17, s[4:7], s58 offen offset:1024 sc1
    s_waitcnt lgkmcnt(6)
    v_pk_add_f32 v[224:225], v[224:225], v[192:193]
    v_pk_add_f32 v[226:227], v[226:227], v[194:195]
    v_pk_add_f32 v[228:229], v[228:229], v[196:197]
    v_pk_add_f32 v[230:231], v[230:231], v[198:199]
    s_waitcnt lgkmcnt(4)
    v_pk_add_f32 v[224:225], v[224:225], v[200:201]
    v_pk_add_f32 v[226:227], v[226:227], v[202:203]
    v_pk_add_f32 v[228:229], v[228:229], v[204:205]
    v_pk_add_f32 v[230:231], v[230:231], v[206:207]
    s_waitcnt lgkmcnt(2)
    v_pk_add_f32 v[224:225], v[224:225], v[208:209]
    v_pk_add_f32 v[226:227], v[226:227], v[210:211]
    v_pk_add_f32 v[228:229], v[228:229], v[212:213]
    v_pk_add_f32 v[230:231], v[230:231], v[214:215]
    s_waitcnt lgkmcnt(0)
    v_pk_add_f32 v[224:225], v[224:225], v[216:217]
    v_pk_add_f32 v[226:227], v[226:227], v[218:219]
    v_pk_add_f32 v[228:229], v[228:229], v[220:221]
    v_pk_add_f32 v[230:231], v[230:231], v[222:223]
    v_cvt_pk_bf16_f32 v192, v224, v225
    v_cvt_pk_bf16_f32 v193, v226, v227
    v_cvt_pk_bf16_f32 v194, v228, v229
    v_cvt_pk_bf16_f32 v195, v230, v231
    buffer_store_dwordx4 v[192:195], v7, s[8:11], s61 offen
    buffer_load_dwordx4 v[56:59], v18, s[4:7], s58 offen offset:1024 sc1
    buffer_load_dwordx4 v[60:63], v19, s[4:7], s58 offen offset:1024 sc1
    s_waitcnt vmcnt(8)
    v_mfma_f32_16x16x32_bf16 v[128:131], a[176:179], v[32:35], 0
    v_mfma_f32_16x16x32_bf16 v[136:139], a[180:183], v[32:35], 0
    v_dot2_f32_bf16 v196, v192, s36, 0
    v_dot2_f32_bf16 v197, v192, v192, 0
    v_dot2_f32_bf16 v196, v193, s36, v196
    v_dot2_f32_bf16 v197, v193, v193, v197
    v_dot2_f32_bf16 v196, v194, s36, v196
    v_dot2_f32_bf16 v197, v194, v194, v197
    v_dot2_f32_bf16 v196, v195, s36, v196
    v_dot2_f32_bf16 v197, v195, v195, v197
    v_mfma_f32_16x16x32_bf16 v[144:147], a[184:187], v[32:35], 0
    v_accvgpr_write_b32 a240, v224
    v_accvgpr_write_b32 a241, v225
    v_mfma_f32_16x16x32_bf16 v[152:155], a[188:191], v[32:35], 0
    s_waitcnt vmcnt(7)
    v_accvgpr_write_b32 a242, v226
    v_permlane16_swap_b32 v196, v197
    v_mfma_f32_16x16x32_bf16 v[128:131], a[192:195], v[36:39], v[128:131]
    v_add_f32 v196, v196, v197
    v_mov_b32 v197, v196
    v_mfma_f32_16x16x32_bf16 v[136:139], a[196:199], v[36:39], v[136:139]
    v_accvgpr_write_b32 a243, v227
    v_accvgpr_write_b32 a244, v228
    v_mfma_f32_16x16x32_bf16 v[144:147], a[200:203], v[36:39], v[144:147]
    v_permlane32_swap_b32 v196, v197
    v_add_f32 v196, v196, v197
    v_mfma_f32_16x16x32_bf16 v[152:155], a[204:207], v[36:39], v[152:155]
    s_waitcnt vmcnt(6)
    v_accvgpr_write_b32 a245, v229
    v_accvgpr_write_b32 a246, v230
    v_mfma_f32_16x16x32_bf16 v[128:131], a[208:211], v[40:43], v[128:131]
    v_add_f32_dpp v196, v196, v196 row_ror:8 row_mask:0xf bank_mask:0xf
    v_mfma_f32_16x16x32_bf16 v[136:139], a[212:215], v[40:43], v[136:139]
    s_cbranch_vccnz SAFE_247
    buffer_store_dword v196, v8, s[4:7], s63 offen
BACK_248:
    v_mfma_f32_16x16x32_bf16 v[144:147], a[216:219], v[40:43], v[144:147]
    v_accvgpr_write_b32 a247, v231
    v_mfma_f32_16x16x32_bf16 v[152:155], a[220:223], v[40:43], v[152:155]
    s_waitcnt vmcnt(6)
    s_lshr_b32 s30, s13, 5
    s_add_u32 s30, s30, s12
    v_mfma_f32_16x16x32_bf16 v[128:131], a[224:227], v[44:47], v[128:131]
    s_lshl_b32 s30, s30, 13
    v_and_b32 v0, 0xf0, v16
    v_bfe_u32 v1, v13, 4, 1
    v_mfma_f32_16x16x32_bf16 v[136:139], a[228:231], v[44:47], v[136:139]
    v_lshl_add_u32 v0, v1, 9, v0
    v_mul_u32_u24 v1, 3072, v3
    v_mfma_f32_16x16x32_bf16 v[144:147], a[232:235], v[44:47], v[144:147]
    v_add_u32 v248, v1, v0
    v_add_u32 v249, 61440, v248
    v_mfma_f32_16x16x32_bf16 v[152:155], a[236:239], v[44:47], v[152:155]
    s_waitcnt vmcnt(5)
    v_add_u32 v240, s30, v16
    v_and_b32 v240, 0x7fff, v240
    v_mfma_f32_16x16x32_bf16 v[132:135], a[176:179], v[48:51], 0
    v_add_u32 v241, s30, v17
    v_and_b32 v241, 0x7fff, v241
    v_mfma_f32_16x16x32_bf16 v[140:143], a[180:183], v[48:51], 0
    s_waitcnt vmcnt(3)
    s_cbranch_vccnz SAFE_254
    buffer_store_dword v11, v10, s[4:7], s65 offen offset:1024
BACK_255:
    v_mfma_f32_16x16x32_bf16 v[148:151], a[184:187], v[48:51], 0
    v_add_u32 v242, s30, v18
    v_and_b32 v242, 0x7fff, v242
    v_mfma_f32_16x16x32_bf16 v[156:159], a[188:191], v[48:51], 0
    ds_write_b128 v5, v[128:131] offset:32768
    v_add_u32 v243, s30, v19
    v_mfma_f32_16x16x32_bf16 v[132:135], a[192:195], v[52:55], v[132:135]
    v_and_b32 v243, 0x7fff, v243
    v_add_u32 v244, s30, v20
    v_mfma_f32_16x16x32_bf16 v[140:143], a[196:199], v[52:55], v[140:143]
    v_and_b32 v244, 0x7fff, v244
    v_add_u32 v245, s30, v21
    v_mfma_f32_16x16x32_bf16 v[148:151], a[200:203], v[52:55], v[148:151]
    v_and_b32 v245, 0x7fff, v245
    v_add_u32 v246, s30, v22
    v_mfma_f32_16x16x32_bf16 v[156:159], a[204:207], v[52:55], v[156:159]
    s_waitcnt vmcnt(3)
    ds_write_b128 v5, v[136:139] offset:34816
    v_and_b32 v246, 0x7fff, v246
    v_mfma_f32_16x16x32_bf16 v[132:135], a[208:211], v[56:59], v[132:135]
    v_add_u32 v247, s30, v23
    v_and_b32 v247, 0x7fff, v247
    v_mfma_f32_16x16x32_bf16 v[140:143], a[212:215], v[56:59], v[140:143]
    v_lshl_add_u32 v250, v3, 9, v16
    v_mfma_f32_16x16x32_bf16 v[148:151], a[216:219], v[56:59], v[148:151]
    s_cmp_ge_u32 s13, 21
    s_cselect_b32 s30, 4259840, 0
    v_add_u32 v125, s30, v250
    v_mfma_f32_16x16x32_bf16 v[156:159], a[220:223], v[56:59], v[156:159]
    s_waitcnt vmcnt(2)
    s_cmp_ge_u32 s13, 22
    s_cselect_b32 s30, 4259840, 0
    v_mfma_f32_16x16x32_bf16 v[132:135], a[224:227], v[60:63], v[132:135]
    ds_write_b128 v5, v[144:147] offset:36864
    v_add_u32 v250, s30, v250
    v_mfma_f32_16x16x32_bf16 v[140:143], a[228:231], v[60:63], v[140:143]
    s_and_b32 s30, s73, 512
    s_lshl_b32 s30, s30, 1
    v_add_u32 v251, s30, v125
    v_mfma_f32_16x16x32_bf16 v[148:151], a[232:235], v[60:63], v[148:151]
    v_mfma_f32_16x16x32_bf16 v[156:159], a[236:239], v[60:63], v[156:159]
    ds_write_b128 v5, v[152:155] offset:38912
    buffer_load_dword v14, v9, s[4:7], s71 offen offset:1024 sc1
    s_cmp_eq_u32 s18, 2
    s_cbranch_scc1 C1_2
    v_accvgpr_read_b32 v224, a248
    v_accvgpr_read_b32 v225, a249
    v_accvgpr_read_b32 v226, a250
    v_accvgpr_read_b32 v227, a251
    v_accvgpr_read_b32 v228, a252
    v_accvgpr_read_b32 v229, a253
    v_accvgpr_read_b32 v230, a254
    v_accvgpr_read_b32 v231, a255
    ds_write_b128 v5, v[132:135] offset:33792
    ds_write_b128 v5, v[140:143] offset:35840
    ds_write_b128 v5, v[148:151] offset:37888
    ds_write_b128 v5, v[156:159] offset:39936
    s_waitcnt vmcnt(0)
    v_cmp_gt_u32 vcc, s35, v14
    s_cbranch_vccz BACK_257
SPIN_256:
    buffer_load_dword v14, v9, s[4:7], s71 offen offset:1024 sc1
    s_sub_u32 s16, s16, 1
    s_cbranch_scc1 M_end
    s_waitcnt vmcnt(0)
    v_cmp_gt_u32 vcc, 2, v14
    s_cbranch_vccnz SPIN_256
    s_cmp_lg_u32 s15, 0
    s_cbranch_scc1 SPIN2_258
BACK_257:
    buffer_load_dwordx4 v[32:35], v240, s[8:11], s67 offen offset:0 sc1
    buffer_load_dwordx4 v[36:39], v240, s[8:11], s67 offen offset:1024 sc1
    buffer_load_dwordx4 v[40:43], v240, s[8:11], s67 offen offset:2048 sc1
    buffer_load_dwordx4 v[44:47], v240, s[8:11], s67 offen offset:3072 sc1
    ds_read_b128 v[80:83], v248 offset:0
    ds_read_b128 v[84:87], v248 offset:1024
    ds_read_b128 v[88:91], v248 offset:2048
    ds_read_b128 v[92:95], v248 offset:256
    ds_read_b128 v[96:99], v248 offset:1280
    ds_read_b128 v[100:103], v248 offset:2304
    s_waitcnt lgkmcnt(6)
    s_barrier
    s_waitcnt vmcnt(2) lgkmcnt(5)
    v_mfma_f32_16x16x32_bf16 v[144:147], v[80:83], v[32:35], 0
    v_mfma_f32_16x16x32_bf16 v[148:151], v[80:83], v[36:39], 0
    s_waitcnt lgkmcnt(4)
    ds_read_b128 v[80:83], v248 offset:6144
    buffer_load_dwordx4 v[48:51], v241, s[8:11], s67 offen offset:0 sc1
    v_mfma_f32_16x16x32_bf16 v[160:163], v[84:87], v[32:35], 0
    ds_read_b128 v[192:195], v6 offset:32768
    ds_read_b128 v[196:199], v6 offset:33280
    v_mfma_f32_16x16x32_bf16 v[164:167], v[84:87], v[36:39], 0
    s_waitcnt lgkmcnt(6)
    ds_read_b128 v[84:87], v248 offset:7168
    ds_read_b128 v[200:203], v6 offset:40960
    v_mfma_f32_16x16x32_bf16 v[176:179], v[88:91], v[32:35], 0
    ds_read_b128 v[204:207], v6 offset:41472
    v_mfma_f32_16x16x32_bf16 v[180:183], v[88:91], v[36:39], 0
    s_waitcnt lgkmcnt(8)
    ds_read_b128 v[88:91], v248 offset:8192
    buffer_load_dwordx4 v[52:55], v241, s[8:11], s67 offen offset:1024 sc1
    v_mfma_f32_16x16x32_bf16 v[152:155], v[92:95], v[32:35], 0
    ds_read_b128 v[208:211], v6 offset:49152
    ds_read_b128 v[212:215], v6 offset:49664
    v_mfma_f32_16x16x32_bf16 v[156:159], v[92:95], v[36:39], 0
    s_waitcnt lgkmcnt(10)
    ds_read_b128 v[92:95], v248 offset:6400
    ds_read_b128 v[216:219], v6 offset:57344
    v_mfma_f32_16x16x32_bf16 v[168:171], v[96:99], v[32:35], 0
    ds_read_b128 v[220:223], v6 offset:57856
    v_mfma_f32_16x16x32_bf16 v[172:175], v[96:99], v[36:39], 0
    s_waitcnt lgkmcnt(12)
    ds_read_b128 v[96:99], v248 offset:7424
    buffer_load_dwordx4 v[56:59], v241, s[8:11], s67 offen offset:2048 sc1
    v_mfma_f32_16x16x32_bf16 v[184:187], v[100:103], v[32:35], 0
    v_mfma_f32_16x16x32_bf16 v[188:191], v[100:103], v[36:39], 0
    s_waitcnt vmcnt(3) lgkmcnt(7)
    ds_read_b128 v[100:103], v248 offset:8448
    v_add_f32 v224, v224, v192
    v_mfma_f32_16x16x32_bf16 v[144:147], v[80:83], v[40:43], v[144:147]
    v_add_f32 v225, v225, v193
    v_add_f32 v226, v226, v194
    v_mfma_f32_16x16x32_bf16 v[148:151], v[80:83], v[44:47], v[148:151]
    ds_read_b128 v[80:83], v248 offset:12288
    v_add_f32 v227, v227, v195
    v_mfma_f32_16x16x32_bf16 v[160:163], v[84:87], v[40:43], v[160:163]
    v_add_f32 v228, v228, v196
    v_add_f32 v229, v229, v197
    v_mfma_f32_16x16x32_bf16 v[164:167], v[84:87], v[44:47], v[164:167]
    s_waitcnt lgkmcnt(8)
    ds_read_b128 v[84:87], v248 offset:13312
    buffer_load_dwordx4 v[60:63], v241, s[8:11], s67 offen offset:3072 sc1
    v_mfma_f32_16x16x32_bf16 v[176:179], v[88:91], v[40:43], v[176:179]
    v_add_f32 v230, v230, v198
    v_add_f32 v231, v231, v199
    v_mfma_f32_16x16x32_bf16 v[180:183], v[88:91], v[44:47], v[180:183]
    s_waitcnt lgkmcnt(6)
    ds_read_b128 v[88:91], v248 offset:14336
    v_add_f32 v224, v224, v200
    v_mfma_f32_16x16x32_bf16 v[152:155], v[92:95], v[40:43], v[152:155]
    v_add_f32 v225, v225, v201
    v_add_f32 v226, v226, v202
    v_mfma_f32_16x16x32_bf16 v[156:159], v[92:95], v[44:47], v[156:159]
    s_waitcnt lgkmcnt(4)
    ds_read_b128 v[92:95], v248 offset:12544
    buffer_load_dwordx4 v[64:67], v242, s[8:11], s67 offen offset:0 sc1
    v_mfma_f32_16x16x32_bf16 v[168:171], v[96:99], v[40:43], v[168:171]
    v_add_f32 v227, v227, v203
    v_add_f32 v228, v228, v204
    v_mfma_f32_16x16x32_bf16 v[172:175], v[96:99], v[44:47], v[172:175]
    s_waitcnt lgkmcnt(4)
    ds_read_b128 v[96:99], v248 offset:13568
    v_add_f32 v229, v229, v205
    v_mfma_f32_16x16x32_bf16 v[184:187], v[100:103], v[40:43], v[184:187]
    v_add_f32 v230, v230, v206
    v_add_f32 v231, v231, v207
    v_mfma_f32_16x16x32_bf16 v[188:191], v[100:103], v[44:47], v[188:191]
    s_waitcnt vmcnt(3) lgkmcnt(4)
    ds_read_b128 v[100:103], v248 offset:14592
    v_add_f32 v224, v224, v208
    v_mfma_f32_16x16x32_bf16 v[144:147], v[80:83], v[48:51], v[144:147]
    v_add_f32 v225, v225, v209
    v_add_f32 v226, v226, v210
    v_mfma_f32_16x16x32_bf16 v[148:151], v[80:83], v[52:55], v[148:151]
    s_waitcnt lgkmcnt(4)
    ds_read_b128 v[80:83], v248 offset:18432
    buffer_load_dwordx4 v[68:71], v242, s[8:11], s67 offen offset:1024 sc1
    v_mfma_f32_16x16x32_bf16 v[160:163], v[84:87], v[48:51], v[160:163]
    v_add_f32 v227, v227, v211
    v_add_f32 v228, v228, v212
    v_mfma_f32_16x16x32_bf16 v[164:167], v[84:87], v[52:55], v[164:167]
    s_waitcnt lgkmcnt(4)
    ds_read_b128 v[84:87], v248 offset:19456
    v_add_f32 v229, v229, v213
    v_mfma_f32_16x16x32_bf16 v[176:179], v[88:91], v[48:51], v[176:179]
    v_add_f32 v230, v230, v214
    v_add_f32 v231, v231, v215
    v_mfma_f32_16x16x32_bf16 v[180:183], v[88:91], v[52:55], v[180:183]
    s_waitcnt lgkmcnt(4)
    ds_read_b128 v[88:91], v248 offset:20480
    buffer_load_dwordx4 v[72:75], v242, s[8:11], s67 offen offset:2048 sc1
    v_mfma_f32_16x16x32_bf16 v[152:155], v[92:95], v[48:51], v[152:155]
    v_add_f32 v224, v224, v216
    v_add_f32 v225, v225, v217
    v_mfma_f32_16x16x32_bf16 v[156:159], v[92:95], v[52:55], v[156:159]
    s_waitcnt lgkmcnt(4)
    ds_read_b128 v[92:95], v248 offset:18688
    v_add_f32 v226, v226, v218
    v_mfma_f32_16x16x32_bf16 v[168:171], v[96:99], v[48:51], v[168:171]
    v_add_f32 v227, v227, v219
    v_add_f32 v228, v228, v220
    v_mfma_f32_16x16x32_bf16 v[172:175], v[96:99], v[52:55], v[172:175]
    s_waitcnt lgkmcnt(4)
    ds_read_b128 v[96:99], v248 offset:19712
    buffer_load_dwordx4 v[76:79], v242, s[8:11], s67 offen offset:3072 sc1
    v_mfma_f32_16x16x32_bf16 v[184:187], v[100:103], v[48:51], v[184:187]
    v_add_f32 v229, v229, v221
    v_add_f32 v230, v230, v222
    v_mfma_f32_16x16x32_bf16 v[188:191], v[100:103], v[52:55], v[188:191]
    s_waitcnt vmcnt(4) lgkmcnt(4)
    ds_read_b128 v[100:103], v248 offset:20736
    v_add_f32 v231, v231, v223
    v_mfma_f32_16x16x32_bf16 v[144:147], v[80:83], v[56:59], v[144:147]
    v_cvt_pk_bf16_f32 v192, v224, v225
    v_cvt_pk_bf16_f32 v193, v226, v227
    v_mfma_f32_16x16x32_bf16 v[148:151], v[80:83], v[60:63], v[148:151]
    s_waitcnt lgkmcnt(4)
    ds_read_b128 v[80:83], v248 offset:24576
    v_cvt_pk_bf16_f32 v194, v228, v229
    v_mfma_f32_16x16x32_bf16 v[160:163], v[84:87], v[56:59], v[160:163]
    v_cvt_pk_bf16_f32 v195, v230, v231
    v_mfma_f32_16x16x32_bf16 v[164:167], v[84:87], v[60:63], v[164:167]
    s_waitcnt lgkmcnt(4)
    ds_read_b128 v[84:87], v248 offset:25600
    buffer_load_dwordx4 v[32:35], v243, s[8:11], s67 offen offset:0 sc1
    v_mfma_f32_16x16x32_bf16 v[176:179], v[88:91], v[56:59], v[176:179]
    buffer_store_dwordx4 v[192:195], v7, s[8:11], s62 offen
    v_dot2_f32_bf16 v196, v192, s36, 0
    v_dot2_f32_bf16 v197, v192, v192, 0
    v_dot2_f32_bf16 v196, v193, s36, v196
    v_dot2_f32_bf16 v197, v193, v193, v197
    v_dot2_f32_bf16 v196, v194, s36, v196
    v_dot2_f32_bf16 v197, v194, v194, v197
    v_dot2_f32_bf16 v196, v195, s36, v196
    v_dot2_f32_bf16 v197, v195, v195, v197
    v_mfma_f32_16x16x32_bf16 v[180:183], v[88:91], v[60:63], v[180:183]
    s_waitcnt lgkmcnt(4)
    ds_read_b128 v[88:91], v248 offset:26624
    v_accvgpr_write_b32 a248, v224
    v_mfma_f32_16x16x32_bf16 v[152:155], v[92:95], v[56:59], v[152:155]
    v_accvgpr_write_b32 a249, v225
    v_accvgpr_write_b32 a250, v226
    v_mfma_f32_16x16x32_bf16 v[156:159], v[92:95], v[60:63], v[156:159]
    s_waitcnt lgkmcnt(4)
    ds_read_b128 v[92:95], v248 offset:24832
    buffer_load_dwordx4 v[36:39], v243, s[8:11], s67 offen offset:1024 sc1
    v_mfma_f32_16x16x32_bf16 v[168:171], v[96:99], v[56:59], v[168:171]
    v_permlane16_swap_b32 v196, v197
    v_add_f32 v196, v196, v197
    v_mfma_f32_16x16x32_bf16 v[172:175], v[96:99], v[60:63], v[172:175]
    s_waitcnt lgkmcnt(4)
    ds_read_b128 v[96:99], v248 offset:25856
    v_mov_b32 v197, v196
    v_mfma_f32_16x16x32_bf16 v[184:187], v[100:103], v[56:59], v[184:187]
    v_accvgpr_write_b32 a251, v227
    v_accvgpr_write_b32 a252, v228
    v_mfma_f32_16x16x32_bf16 v[188:191], v[100:103], v[60:63], v[188:191]
    s_waitcnt vmcnt(5) lgkmcnt(4)
    ds_read_b128 v[100:103], v248 offset:26880
    buffer_load_dwordx4 v[40:43], v243, s[8:11], s67 offen offset:2048 sc1
    v_mfma_f32_16x16x32_bf16 v[144:147], v[80:83], v[64:67], v[144:147]
    v_permlane32_swap_b32 v196, v197
    v_add_f32 v196, v196, v197
    v_mfma_f32_16x16x32_bf16 v[148:151], v[80:83], v[68:71], v[148:151]
    s_waitcnt lgkmcnt(4)
    ds_read_b128 v[80:83], v248 offset:30720
    v_accvgpr_write_b32 a253, v229
    v_mfma_f32_16x16x32_bf16 v[160:163], v[84:87], v[64:67], v[160:163]
    v_accvgpr_write_b32 a254, v230
    v_add_f32_dpp v196, v196, v196 row_ror:8 row_mask:0xf bank_mask:0xf
    v_mfma_f32_16x16x32_bf16 v[164:167], v[84:87], v[68:71], v[164:167]
    s_waitcnt lgkmcnt(4)
    ds_read_b128 v[84:87], v248 offset:31744
    v_mfma_f32_16x16x32_bf16 v[176:179], v[88:91], v[64:67], v[176:179]
    s_cbranch_vccnz SAFE_259
    buffer_store_dword v196, v8, s[4:7], s64 offen
BACK_260:
    v_mfma_f32_16x16x32_bf16 v[180:183], v[88:91], v[68:71], v[180:183]
    s_waitcnt lgkmcnt(4)
    ds_read_b128 v[88:91], v248 offset:32768
    buffer_load_dwordx4 v[44:47], v243, s[8:11], s67 offen offset:3072 sc1
    v_mfma_f32_16x16x32_bf16 v[152:155], v[92:95], v[64:67], v[152:155]
    v_accvgpr_write_b32 a255, v231
    v_mfma_f32_16x16x32_bf16 v[156:159], v[92:95], v[68:71], v[156:159]
    s_waitcnt lgkmcnt(4)
    ds_read_b128 v[92:95], v248 offset:30976
    v_mfma_f32_16x16x32_bf16 v[168:171], v[96:99], v[64:67], v[168:171]
    v_mfma_f32_16x16x32_bf16 v[172:175], v[96:99], v[68:71], v[172:175]
    s_waitcnt lgkmcnt(4)
    ds_read_b128 v[96:99], v248 offset:32000
    buffer_load_dwordx4 v[48:51], v244, s[8:11], s67 offen offset:0 sc1
    v_mfma_f32_16x16x32_bf16 v[184:187], v[100:103], v[64:67], v[184:187]
    v_mfma_f32_16x16x32_bf16 v[188:191], v[100:103], v[68:71], v[188:191]
    s_waitcnt vmcnt(7) lgkmcnt(4)
    ds_read_b128 v[100:103], v248 offset:33024
    v_mfma_f32_16x16x32_bf16 v[144:147], v[80:83], v[72:75], v[144:147]
    v_mfma_f32_16x16x32_bf16 v[148:151], v[80:83], v[76:79], v[148:151]
    s_waitcnt lgkmcnt(4)
    ds_read_b128 v[80:83], v248 offset:36864
    v_mfma_f32_16x16x32_bf16 v[160:163], v[84:87], v[72:75], v[160:163]
    v_mfma_f32_16x16x32_bf16 v[164:167], v[84:87], v[76:79], v[164:167]
    s_waitcnt lgkmcnt(4)
    ds_read_b128 v[84:87], v248 offset:37888
    buffer_load_dwordx4 v[52:55], v244, s[8:11], s67 offen offset:1024 sc1
    v_mfma_f32_16x16x32_bf16 v[176:179], v[88:91], v[72:75], v[176:179]
    v_mfma_f32_16x16x32_bf16 v[180:183], v[88:91], v[76:79], v[180:183]
    s_waitcnt lgkmcnt(4)
    ds_read_b128 v[88:91], v248 offset:38912
    v_mfma_f32_16x16x32_bf16 v[152:155], v[92:95], v[72:75], v[152:155]
    v_mfma_f32_16x16x32_bf16 v[156:159], v[92:95], v[76:79], v[156:159]
    s_waitcnt lgkmcnt(4)
    ds_read_b128 v[92:95], v248 offset:37120
    buffer_load_dwordx4 v[56:59], v244, s[8:11], s67 offen offset:2048 sc1
    v_mfma_f32_16x16x32_bf16 v[168:171], v[96:99], v[72:75], v[168:171]
    v_mfma_f32_16x16x32_bf16 v[172:175], v[96:99], v[76:79], v[172:175]
    s_waitcnt vmcnt(4) lgkmcnt(4)
    ds_read_b128 v[96:99], v248 offset:38144
    v_mfma_f32_16x16x32_bf16 v[184:187], v[100:103], v[72:75], v[184:187]
    s_cbranch_vccnz SAFE_264
    buffer_store_dword v11, v10, s[4:7], s66 offen offset:1024
BACK_265:
    v_mfma_f32_16x16x32_bf16 v[188:191], v[100:103], v[76:79], v[188:191]
    s_waitcnt lgkmcnt(4)
    ds_read_b128 v[100:103], v248 offset:39168
    buffer_load_dwordx4 v[60:63], v244, s[8:11], s67 offen offset:3072 sc1
    v_mfma_f32_16x16x32_bf16 v[144:147], v[80:83], v[32:35], v[144:147]
    v_mfma_f32_16x16x32_bf16 v[148:151], v[80:83], v[36:39], v[148:151]
    s_waitcnt lgkmcnt(4)
    ds_read_b128 v[80:83], v248 offset:43008
    v_mfma_f32_16x16x32_bf16 v[160:163], v[84:87], v[32:35], v[160:163]
    v_mfma_f32_16x16x32_bf16 v[164:167], v[84:87], v[36:39], v[164:167]
    s_waitcnt lgkmcnt(4)
    ds_read_b128 v[84:87], v248 offset:44032
    v_mfma_f32_16x16x32_bf16 v[176:179], v[88:91], v[32:35], v[176:179]
    v_mfma_f32_16x16x32_bf16 v[180:183], v[88:91], v[36:39], v[180:183]
    s_waitcnt lgkmcnt(4)
    ds_read_b128 v[88:91], v248 offset:45056
    buffer_load_dwordx4 v[64:67], v245, s[8:11], s67 offen offset:0 sc1
    v_mfma_f32_16x16x32_bf16 v[152:155], v[92:95], v[32:35], v[152:155]
    v_mfma_f32_16x16x32_bf16 v[156:159], v[92:95], v[36:39], v[156:159]
    s_waitcnt lgkmcnt(4)
    ds_read_b128 v[92:95], v248 offset:43264
    v_mfma_f32_16x16x32_bf16 v[168:171], v[96:99], v[32:35], v[168:171]
    v_mfma_f32_16x16x32_bf16 v[172:175], v[96:99], v[36:39], v[172:175]
    s_waitcnt lgkmcnt(4)
    ds_read_b128 v[96:99], v248 offset:44288
    buffer_load_dwordx4 v[68:71], v245, s[8:11], s67 offen offset:1024 sc1
    v_mfma_f32_16x16x32_bf16 v[184:187], v[100:103], v[32:35], v[184:187]
    v_mfma_f32_16x16x32_bf16 v[188:191], v[100:103], v[36:39], v[188:191]
    s_waitcnt vmcnt(7) lgkmcnt(4)
    ds_read_b128 v[100:103], v248 offset:45312
    v_mfma_f32_16x16x32_bf16 v[144:147], v[80:83], v[40:43], v[144:147]
    v_mfma_f32_16x16x32_bf16 v[148:151], v[80:83], v[44:47], v[148:151]
    s_waitcnt lgkmcnt(4)
    ds_read_b128 v[80:83], v248 offset:49152
    v_mfma_f32_16x16x32_bf16 v[160:163], v[84:87], v[40:43], v[160:163]
    v_mfma_f32_16x16x32_bf16 v[164:167], v[84:87], v[44:47], v[164:167]
    s_waitcnt lgkmcnt(4)
    ds_read_b128 v[84:87], v248 offset:50176
    buffer_load_dwordx4 v[72:75], v245, s[8:11], s67 offen offset:2048 sc1
    v_mfma_f32_16x16x32_bf16 v[176:179], v[88:91], v[40:43], v[176:179]
    v_mfma_f32_16x16x32_bf16 v[180:183], v[88:91], v[44:47], v[180:183]
    s_waitcnt lgkmcnt(4)
    ds_read_b128 v[88:91], v248 offset:51200
    v_mfma_f32_16x16x32_bf16 v[152:155], v[92:95], v[40:43], v[152:155]
    v_mfma_f32_16x16x32_bf16 v[156:159], v[92:95], v[44:47], v[156:159]
    s_waitcnt lgkmcnt(4)
    ds_read_b128 v[92:95], v248 offset:49408
    buffer_load_dwordx4 v[76:79], v245, s[8:11], s67 offen offset:3072 sc1
    v_mfma_f32_16x16x32_bf16 v[168:171], v[96:99], v[40:43], v[168:171]
    v_mfma_f32_16x16x32_bf16 v[172:175], v[96:99], v[44:47], v[172:175]
    s_waitcnt lgkmcnt(4)
    ds_read_b128 v[96:99], v248 offset:50432
    v_mfma_f32_16x16x32_bf16 v[184:187], v[100:103], v[40:43], v[184:187]
    v_mfma_f32_16x16x32_bf16 v[188:191], v[100:103], v[44:47], v[188:191]
    s_waitcnt vmcnt(7) lgkmcnt(4)
    ds_read_b128 v[100:103], v248 offset:51456
    buffer_load_dwordx4 v[32:35], v246, s[8:11], s67 offen offset:0 sc1
    v_mfma_f32_16x16x32_bf16 v[144:147], v[80:83], v[48:51], v[144:147]
    v_mfma_f32_16x16x32_bf16 v[148:151], v[80:83], v[52:55], v[148:151]
    s_waitcnt lgkmcnt(4)
    ds_read_b128 v[80:83], v248 offset:55296
    v_mfma_f32_16x16x32_bf16 v[160:163], v[84:87], v[48:51], v[160:163]
    v_mfma_f32_16x16x32_bf16 v[164:167], v[84:87], v[52:55], v[164:167]
    s_waitcnt lgkmcnt(4)
    ds_read_b128 v[84:87], v248 offset:56320
    v_mfma_f32_16x16x32_bf16 v[176:179], v[88:91], v[48:51], v[176:179]
    v_mfma_f32_16x16x32_bf16 v[180:183], v[88:91], v[52:55], v[180:183]
    s_waitcnt lgkmcnt(4)
    ds_read_b128 v[88:91], v248 offset:57344
    buffer_load_dwordx4 v[36:39], v246, s[8:11], s67 offen offset:1024 sc1
    v_mfma_f32_16x16x32_bf16 v[152:155], v[92:95], v[48:51], v[152:155]
    v_mfma_f32_16x16x32_bf16 v[156:159], v[92:95], v[52:55], v[156:159]
    s_waitcnt lgkmcnt(4)
    ds_read_b128 v[92:95], v248 offset:55552
    v_mfma_f32_16x16x32_bf16 v[168:171], v[96:99], v[48:51], v[168:171]
    v_mfma_f32_16x16x32_bf16 v[172:175], v[96:99], v[52:55], v[172:175]
    s_waitcnt lgkmcnt(4)
    ds_read_b128 v[96:99], v248 offset:56576
    buffer_load_dwordx4 v[40:43], v246, s[8:11], s67 offen offset:2048 sc1
    v_mfma_f32_16x16x32_bf16 v[184:187], v[100:103], v[48:51], v[184:187]
    v_mfma_f32_16x16x32_bf16 v[188:191], v[100:103], v[52:55], v[188:191]
    s_waitcnt vmcnt(7) lgkmcnt(4)
    ds_read_b128 v[100:103], v248 offset:57600
    v_mfma_f32_16x16x32_bf16 v[144:147], v[80:83], v[56:59], v[144:147]
    v_mfma_f32_16x16x32_bf16 v[148:151], v[80:83], v[60:63], v[148:151]
    s_waitcnt lgkmcnt(4)
    ds_read_b128 v[80:83], v249 offset:0
    v_mfma_f32_16x16x32_bf16 v[160:163], v[84:87], v[56:59], v[160:163]
    v_mfma_f32_16x16x32_bf16 v[164:167], v[84:87], v[60:63], v[164:167]
    s_waitcnt lgkmcnt(4)
    ds_read_b128 v[84:87], v249 offset:1024
    buffer_load_dwordx4 v[44:47], v246, s[8:11], s67 offen offset:3072 sc1
    v_mfma_f32_16x16x32_bf16 v[176:179], v[88:91], v[56:59], v[176:179]
    buffer_load_dword v14, v9, s[4:7], s72 offen offset:1024 sc1
    v_mfma_f32_16x16x32_bf16 v[180:183], v[88:91], v[60:63], v[180:183]
    s_waitcnt lgkmcnt(4)
    ds_read_b128 v[88:91], v249 offset:2048
    v_mfma_f32_16x16x32_bf16 v[152:155], v[92:95], v[56:59], v[152:155]
    v_mfma_f32_16x16x32_bf16 v[156:159], v[92:95], v[60:63], v[156:159]
    s_waitcnt lgkmcnt(4)
    ds_read_b128 v[92:95], v249 offset:256
    buffer_load_dwordx4 v[48:51], v247, s[8:11], s67 offen offset:0 sc1
    v_mfma_f32_16x16x32_bf16 v[168:171], v[96:99], v[56:59], v[168:171]
    v_mfma_f32_16x16x32_bf16 v[172:175], v[96:99], v[60:63], v[172:175]
    s_waitcnt lgkmcnt(4)
    ds_read_b128 v[96:99], v249 offset:1280
    v_mfma_f32_16x16x32_bf16 v[184:187], v[100:103], v[56:59], v[184:187]
    v_mfma_f32_16x16x32_bf16 v[188:191], v[100:103], v[60:63], v[188:191]
    s_waitcnt vmcnt(8) lgkmcnt(4)
    ds_read_b128 v[100:103], v249 offset:2304
    buffer_load_dwordx4 v[52:55], v247, s[8:11], s67 offen offset:1024 sc1
    v_mfma_f32_16x16x32_bf16 v[144:147], v[80:83], v[64:67], v[144:147]
    v_mfma_f32_16x16x32_bf16 v[148:151], v[80:83], v[68:71], v[148:151]
    s_waitcnt lgkmcnt(4)
    ds_read_b128 v[80:83], v249 offset:6144
    v_mfma_f32_16x16x32_bf16 v[160:163], v[84:87], v[64:67], v[160:163]
    v_mfma_f32_16x16x32_bf16 v[164:167], v[84:87], v[68:71], v[164:167]
    s_waitcnt lgkmcnt(4)
    ds_read_b128 v[84:87], v249 offset:7168
    v_mfma_f32_16x16x32_bf16 v[176:179], v[88:91], v[64:67], v[176:179]
    v_mfma_f32_16x16x32_bf16 v[180:183], v[88:91], v[68:71], v[180:183]
    s_waitcnt lgkmcnt(4)
    ds_read_b128 v[88:91], v249 offset:8192
    buffer_load_dwordx4 v[56:59], v247, s[8:11], s67 offen offset:2048 sc1
    v_mfma_f32_16x16x32_bf16 v[152:155], v[92:95], v[64:67], v[152:155]
    v_mfma_f32_16x16x32_bf16 v[156:159], v[92:95], v[68:71], v[156:159]
    s_waitcnt lgkmcnt(4)
    ds_read_b128 v[92:95], v249 offset:6400
    v_mfma_f32_16x16x32_bf16 v[168:171], v[96:99], v[64:67], v[168:171]
    v_mfma_f32_16x16x32_bf16 v[172:175], v[96:99], v[68:71], v[172:175]
    s_waitcnt lgkmcnt(4)
    ds_read_b128 v[96:99], v249 offset:7424
    buffer_load_dwordx4 v[60:63], v247, s[8:11], s67 offen offset:3072 sc1
    v_mfma_f32_16x16x32_bf16 v[184:187], v[100:103], v[64:67], v[184:187]
    v_mfma_f32_16x16x32_bf16 v[188:191], v[100:103], v[68:71], v[188:191]
    s_waitcnt vmcnt(4) lgkmcnt(4)
    ds_read_b128 v[100:103], v249 offset:8448
    v_mfma_f32_16x16x32_bf16 v[144:147], v[80:83], v[72:75], v[144:147]
    v_cmp_gt_u32 vcc, s35, v14
    s_cbranch_vccnz SPIN_261
BACK_262:
    v_mfma_f32_16x16x32_bf16 v[148:151], v[80:83], v[76:79], v[148:151]
    s_waitcnt lgkmcnt(4)
    ds_read_b128 v[80:83], v249 offset:12288
    buffer_load_dwordx4 v[104:107], v16, s[4:7], s69 offen offset:0 sc1
    v_mfma_f32_16x16x32_bf16 v[160:163], v[84:87], v[72:75], v[160:163]
    v_mfma_f32_16x16x32_bf16 v[164:167], v[84:87], v[76:79], v[164:167]
    s_waitcnt lgkmcnt(4)
    ds_read_b128 v[84:87], v249 offset:13312
    v_mfma_f32_16x16x32_bf16 v[176:179], v[88:91], v[72:75], v[176:179]
    v_mfma_f32_16x16x32_bf16 v[180:183], v[88:91], v[76:79], v[180:183]
    s_waitcnt lgkmcnt(4)
    ds_read_b128 v[88:91], v249 offset:14336
    buffer_load_dwordx4 v[108:111], v16, s[4:7], s69 offen offset:1024 sc1
    v_mfma_f32_16x16x32_bf16 v[152:155], v[92:95], v[72:75], v[152:155]
    v_mfma_f32_16x16x32_bf16 v[156:159], v[92:95], v[76:79], v[156:159]
    s_waitcnt lgkmcnt(4)
    ds_read_b128 v[92:95], v249 offset:12544
    v_mfma_f32_16x16x32_bf16 v[168:171], v[96:99], v[72:75], v[168:171]
    v_mfma_f32_16x16x32_bf16 v[172:175], v[96:99], v[76:79], v[172:175]
    s_waitcnt lgkmcnt(4)
    ds_read_b128 v[96:99], v249 offset:13568
    v_mfma_f32_16x16x32_bf16 v[184:187], v[100:103], v[72:75], v[184:187]
    v_mfma_f32_16x16x32_bf16 v[188:191], v[100:103], v[76:79], v[188:191]
    s_waitcnt lgkmcnt(4)
    ds_read_b128 v[100:103], v249 offset:14592
    buffer_load_dwordx4 v[64:67], v240, s[8:11], s68 offen offset:0 sc1
    v_mfma_f32_16x16x32_bf16 v[144:147], v[80:83], v[32:35], v[144:147]
    v_mfma_f32_16x16x32_bf16 v[148:151], v[80:83], v[36:39], v[148:151]
    s_waitcnt lgkmcnt(4)
    ds_read_b128 v[80:83], v249 offset:18432
    v_mfma_f32_16x16x32_bf16 v[160:163], v[84:87], v[32:35], v[160:163]
    v_mfma_f32_16x16x32_bf16 v[164:167], v[84:87], v[36:39], v[164:167]
    s_waitcnt lgkmcnt(4)
    ds_read_b128 v[84:87], v249 offset:19456
    buffer_load_dwordx4 v[68:71], v240, s[8:11], s68 offen offset:1024 sc1
    v_mfma_f32_16x16x32_bf16 v[176:179], v[88:91], v[32:35], v[176:179]
    v_mfma_f32_16x16x32_bf16 v[180:183], v[88:91], v[36:39], v[180:183]
    s_waitcnt lgkmcnt(4)
    ds_read_b128 v[88:91], v249 offset:20480
    v_mfma_f32_16x16x32_bf16 v[152:155], v[92:95], v[32:35], v[152:155]
    v_mfma_f32_16x16x32_bf16 v[156:159], v[92:95], v[36:39], v[156:159]
    s_waitcnt lgkmcnt(4)
    ds_read_b128 v[92:95], v249 offset:18688
    v_mfma_f32_16x16x32_bf16 v[168:171], v[96:99], v[32:35], v[168:171]
    v_mfma_f32_16x16x32_bf16 v[172:175], v[96:99], v[36:39], v[172:175]
    s_waitcnt lgkmcnt(4)
    ds_read_b128 v[96:99], v249 offset:19712
    buffer_load_dwordx4 v[72:75], v240, s[8:11], s68 offen offset:2048 sc1
    v_mfma_f32_16x16x32_bf16 v[184:187], v[100:103], v[32:35], v[184:187]
    v_mfma_f32_16x16x32_bf16 v[188:191], v[100:103], v[36:39], v[188:191]
    s_waitcnt lgkmcnt(4)
    ds_read_b128 v[100:103], v249 offset:20736
    v_mfma_f32_16x16x32_bf16 v[144:147], v[80:83], v[40:43], v[144:147]
    v_mfma_f32_16x16x32_bf16 v[148:151], v[80:83], v[44:47], v[148:151]
    s_waitcnt lgkmcnt(4)
    ds_read_b128 v[80:83], v249 offset:24576
    buffer_load_dwordx4 v[76:79], v240, s[8:11], s68 offen offset:3072 sc1
    v_mfma_f32_16x16x32_bf16 v[160:163], v[84:87], v[40:43], v[160:163]
    v_mfma_f32_16x16x32_bf16 v[164:167], v[84:87], v[44:47], v[164:167]
    s_waitcnt lgkmcnt(4)
    ds_read_b128 v[84:87], v249 offset:25600
    v_mfma_f32_16x16x32_bf16 v[176:179], v[88:91], v[40:43], v[176:179]
    v_mfma_f32_16x16x32_bf16 v[180:183], v[88:91], v[44:47], v[180:183]
    s_waitcnt lgkmcnt(4)
    ds_read_b128 v[88:91], v249 offset:26624
    buffer_load_dwordx4 v[32:35], v241, s[8:11], s68 offen offset:0 sc1
    v_mfma_f32_16x16x32_bf16 v[152:155], v[92:95], v[40:43], v[152:155]
    v_mfma_f32_16x16x32_bf16 v[156:159], v[92:95], v[44:47], v[156:159]
    s_waitcnt lgkmcnt(4)
    ds_read_b128 v[92:95], v249 offset:24832
    v_mfma_f32_16x16x32_bf16 v[168:171], v[96:99], v[40:43], v[168:171]
    v_mfma_f32_16x16x32_bf16 v[172:175], v[96:99], v[44:47], v[172:175]
    s_waitcnt vmcnt(5) lgkmcnt(4)
    ds_read_b128 v[96:99], v249 offset:25856
    v_add_f32 v104, v104, v106
    v_mfma_f32_16x16x32_bf16 v[184:187], v[100:103], v[40:43], v[184:187]
    v_add_f32 v105, v105, v107
    v_add_f32 v108, v108, v110
    v_mfma_f32_16x16x32_bf16 v[188:191], v[100:103], v[44:47], v[188:191]
    s_waitcnt lgkmcnt(4)
    ds_read_b128 v[100:103], v249 offset:26880
    buffer_load_dwordx4 v[36:39], v241, s[8:11], s68 offen offset:1024 sc1
    v_mfma_f32_16x16x32_bf16 v[144:147], v[80:83], v[48:51], v[144:147]
    v_add_f32 v109, v109, v111
    v_add_f32 v104, v104, v108
    v_mfma_f32_16x16x32_bf16 v[148:151], v[80:83], v[52:55], v[148:151]
    s_waitcnt lgkmcnt(4)
    ds_read_b128 v[80:83], v249 offset:30720
    v_add_f32 v105, v105, v109
    v_mfma_f32_16x16x32_bf16 v[160:163], v[84:87], v[48:51], v[160:163]
    s_nop 0
    v_permlane32_swap_b32 v104, v105
    v_add_f32 v104, v104, v105
    v_mfma_f32_16x16x32_bf16 v[164:167], v[84:87], v[52:55], v[164:167]
    s_waitcnt lgkmcnt(4)
    ds_read_b128 v[84:87], v249 offset:31744
    buffer_load_dwordx4 v[40:43], v241, s[8:11], s68 offen offset:2048 sc1
    v_mfma_f32_16x16x32_bf16 v[176:179], v[88:91], v[48:51], v[176:179]
    v_mul_f32 v104, 0x3b000000, v104
    v_mov_b32 v105, v104
    v_mfma_f32_16x16x32_bf16 v[180:183], v[88:91], v[52:55], v[180:183]
    s_waitcnt lgkmcnt(4)
    ds_read_b128 v[88:91], v249 offset:32768
    v_permlane32_swap_b32 v104, v105
    v_mfma_f32_16x16x32_bf16 v[152:155], v[92:95], v[48:51], v[152:155]
    v_fma_f32 v105, -v104, v104, v105
    v_max_f32 v105, 0, v105
    v_mfma_f32_16x16x32_bf16 v[156:159], v[92:95], v[52:55], v[156:159]
    s_waitcnt lgkmcnt(4)
    ds_read_b128 v[92:95], v249 offset:30976
    v_add_f32 v105, 0x3727c5ac, v105
    v_mfma_f32_16x16x32_bf16 v[168:171], v[96:99], v[48:51], v[168:171]
    v_rsq_f32 v120, v105
    v_mfma_f32_16x16x32_bf16 v[172:175], v[96:99], v[52:55], v[172:175]
    s_waitcnt lgkmcnt(4)
    ds_read_b128 v[96:99], v249 offset:32000
    buffer_load_dwordx4 v[44:47], v241, s[8:11], s68 offen offset:3072 sc1
    v_mfma_f32_16x16x32_bf16 v[184:187], v[100:103], v[48:51], v[184:187]
    v_cvt_pk_bf16_f32 v106, -v104, -v104
    v_and_b32 v107, 0xffff0000, v106
    v_mfma_f32_16x16x32_bf16 v[188:191], v[100:103], v[52:55], v[188:191]
    s_waitcnt lgkmcnt(4)
    ds_read_b128 v[100:103], v249 offset:33024
    v_sub_f32 v107, -v104, v107
    v_mfma_f32_16x16x32_bf16 v[144:147], v[80:83], v[56:59], v[144:147]
    v_cvt_pk_bf16_f32 v107, v107, v107
    v_cndmask_b32 v124, v107, v106, s[24:25]
    v_mfma_f32_16x16x32_bf16 v[148:151], v[80:83], v[60:63], v[148:151]
    s_waitcnt lgkmcnt(4)
    ds_read_b128 v[80:83], v248 offset:0
    buffer_load_dwordx4 v[112:115], v16, s[4:7], s70 offen offset:0 sc1
    v_mfma_f32_16x16x32_bf16 v[160:163], v[84:87], v[56:59], v[160:163]
    v_mul_f32 v120, v120, v120
    v_mov_b32 v105, v124
    v_mfma_f32_16x16x32_bf16 v[164:167], v[84:87], v[60:63], v[164:167]
    s_waitcnt lgkmcnt(4)
    ds_read_b128 v[84:87], v248 offset:1024
    v_mov_b32 v107, 0
    v_mfma_f32_16x16x32_bf16 v[176:179], v[88:91], v[56:59], v[176:179]
    v_mov_b32 v121, v120
    v_mov_b32 v109, 0
    v_mfma_f32_16x16x32_bf16 v[180:183], v[88:91], v[60:63], v[180:183]
    s_waitcnt lgkmcnt(4)
    ds_read_b128 v[88:91], v248 offset:2048
    buffer_load_dwordx4 v[116:119], v16, s[4:7], s70 offen offset:1024 sc1
    v_mfma_f32_16x16x32_bf16 v[152:155], v[92:95], v[56:59], v[152:155]
    v_mov_b32 v111, v124
    v_permlane16_swap_b32 v105, v107
    v_mfma_f32_16x16x32_bf16 v[156:159], v[92:95], v[60:63], v[156:159]
    s_waitcnt lgkmcnt(4)
    ds_read_b128 v[92:95], v248 offset:256
    v_mov_b32 v104, 0
    v_mfma_f32_16x16x32_bf16 v[168:171], v[96:99], v[56:59], v[168:171]
    v_permlane16_swap_b32 v120, v121
    v_permlane16_swap_b32 v109, v111
    v_mfma_f32_16x16x32_bf16 v[172:175], v[96:99], v[60:63], v[172:175]
    s_waitcnt lgkmcnt(4)
    ds_read_b128 v[96:99], v248 offset:1280
    buffer_load_dwordx4 v[48:51], v242, s[8:11], s68 offen offset:0 sc1
    v_mfma_f32_16x16x32_bf16 v[184:187], v[100:103], v[56:59], v[184:187]
    v_mov_b32 v106, 0
    v_mov_b32 v108, 0
    v_mfma_f32_16x16x32_bf16 v[188:191], v[100:103], v[60:63], v[188:191]
    ds_read_b128 v[100:103], v248 offset:2304
    v_mov_b32 v110, 0
    v_mfma_f32_16x16x16_bf16 v[144:147], v[24:25], v[104:105], v[144:147]
    v_mfma_f32_16x16x16_bf16 v[148:151], v[24:25], v[106:107], v[148:151]
    buffer_load_dwordx4 v[52:55], v242, s[8:11], s68 offen offset:1024 sc1
    v_mfma_f32_16x16x16_bf16 v[152:155], v[24:25], v[108:109], v[152:155]
    v_mfma_f32_16x16x16_bf16 v[156:159], v[24:25], v[110:111], v[156:159]
    v_mfma_f32_16x16x16_bf16 v[160:163], v[26:27], v[104:105], v[160:163]
    v_mfma_f32_16x16x16_bf16 v[164:167], v[26:27], v[106:107], v[164:167]
    s_nop 4
    v_mul_f32 v144, v144, v152
    v_mul_f32 v145, v145, v153
    v_mfma_f32_16x16x16_bf16 v[168:171], v[26:27], v[108:109], v[168:171]
    v_mul_f32 v144, v144, v120
    v_mul_f32 v145, v145, v120
    v_mfma_f32_16x16x16_bf16 v[172:175], v[26:27], v[110:111], v[172:175]
    buffer_load_dwordx4 v[56:59], v242, s[8:11], s68 offen offset:2048 sc1
    v_cvt_pk_bf16_f32 v152, v144, v145
    v_mfma_f32_16x16x16_bf16 v[176:179], v[28:29], v[104:105], v[176:179]
    v_mul_f32 v146, v146, v154
    v_mul_f32 v147, v147, v155
    v_mfma_f32_16x16x16_bf16 v[180:183], v[28:29], v[106:107], v[180:183]
    v_mul_f32 v146, v146, v120
    v_mul_f32 v147, v147, v120
    v_mfma_f32_16x16x16_bf16 v[184:187], v[28:29], v[108:109], v[184:187]
    v_cvt_pk_bf16_f32 v153, v146, v147
    v_mul_f32 v148, v148, v156
    v_mfma_f32_16x16x16_bf16 v[188:191], v[28:29], v[110:111], v[188:191]
    s_waitcnt vmcnt(11) lgkmcnt(5)
    buffer_load_dwordx4 v[60:63], v242, s[8:11], s68 offen offset:3072 sc1
    v_mul_f32 v149, v149, v157
    v_mfma_f32_16x16x32_bf16 v[192:195], v[80:83], v[64:67], 0
    v_mul_f32 v148, v148, v121
    v_mul_f32 v149, v149, v121
    v_mfma_f32_16x16x32_bf16 v[196:199], v[80:83], v[68:71], 0
    s_waitcnt lgkmcnt(4)
    ds_read_b128 v[80:83], v248 offset:6144
    v_cvt_pk_bf16_f32 v154, v148, v149
    v_mfma_f32_16x16x32_bf16 v[208:211], v[84:87], v[64:67], 0
    v_mul_f32 v150, v150, v158
    v_mul_f32 v151, v151, v159
    v_mfma_f32_16x16x32_bf16 v[212:215], v[84:87], v[68:71], 0
    s_waitcnt lgkmcnt(4)
    ds_read_b128 v[84:87], v248 offset:7168
    v_mul_f32 v150, v150, v121
    v_mfma_f32_16x16x32_bf16 v[224:227], v[88:91], v[64:67], 0
    v_mul_f32 v151, v151, v121
    v_cvt_pk_bf16_f32 v155, v150, v151
    v_mfma_f32_16x16x32_bf16 v[228:231], v[88:91], v[68:71], 0
    s_waitcnt lgkmcnt(4)
    ds_read_b128 v[88:91], v248 offset:8192
    v_permlane32_swap_b32 v152, v154
    v_mfma_f32_16x16x32_bf16 v[200:203], v[92:95], v[64:67], 0
    v_permlane32_swap_b32 v153, v155
    v_mfma_f32_16x16x32_bf16 v[204:207], v[92:95], v[68:71], 0
    s_waitcnt lgkmcnt(4)
    ds_read_b128 v[92:95], v248 offset:6400
    buffer_store_dwordx4 v[152:155], v250, s[4:7], s73 offen offset:0
    v_mfma_f32_16x16x32_bf16 v[216:219], v[96:99], v[64:67], 0
    v_mul_f32 v160, v160, v168
    v_mul_f32 v161, v161, v169
    v_mfma_f32_16x16x32_bf16 v[220:223], v[96:99], v[68:71], 0
    s_waitcnt lgkmcnt(4)
    ds_read_b128 v[96:99], v248 offset:7424
    v_mul_f32 v160, v160, v120
    v_mfma_f32_16x16x32_bf16 v[232:235], v[100:103], v[64:67], 0
    v_mul_f32 v161, v161, v120
    v_cvt_pk_bf16_f32 v168, v160, v161
    v_mfma_f32_16x16x32_bf16 v[236:239], v[100:103], v[68:71], 0
    s_waitcnt vmcnt(11) lgkmcnt(4)
    ds_read_b128 v[100:103], v248 offset:8448
    buffer_load_dwordx4 v[64:67], v243, s[8:11], s68 offen offset:0 sc1
    v_mfma_f32_16x16x32_bf16 v[192:195], v[80:83], v[72:75], v[192:195]
    v_mul_f32 v162, v162, v170
    v_mul_f32 v163, v163, v171
    v_mfma_f32_16x16x32_bf16 v[196:199], v[80:83], v[76:79], v[196:199]
    s_waitcnt lgkmcnt(4)
    ds_read_b128 v[80:83], v248 offset:12288
    v_mul_f32 v162, v162, v120
    v_mfma_f32_16x16x32_bf16 v[208:211], v[84:87], v[72:75], v[208:211]
    v_mul_f32 v163, v163, v120
    v_cvt_pk_bf16_f32 v169, v162, v163
    v_mfma_f32_16x16x32_bf16 v[212:215], v[84:87], v[76:79], v[212:215]
    s_waitcnt lgkmcnt(4)
    ds_read_b128 v[84:87], v248 offset:13312
    buffer_load_dwordx4 v[68:71], v243, s[8:11], s68 offen offset:1024 sc1
    v_mfma_f32_16x16x32_bf16 v[224:227], v[88:91], v[72:75], v[224:227]
    v_mul_f32 v164, v164, v172
    v_mul_f32 v165, v165, v173
    v_mfma_f32_16x16x32_bf16 v[228:231], v[88:91], v[76:79], v[228:231]
    s_waitcnt lgkmcnt(4)
    ds_read_b128 v[88:91], v248 offset:14336
    v_mul_f32 v164, v164, v121
    v_mfma_f32_16x16x32_bf16 v[200:203], v[92:95], v[72:75], v[200:203]
    v_mul_f32 v165, v165, v121
    v_cvt_pk_bf16_f32 v170, v164, v165
    v_mfma_f32_16x16x32_bf16 v[204:207], v[92:95], v[76:79], v[204:207]
    s_waitcnt lgkmcnt(4)
    ds_read_b128 v[92:95], v248 offset:12544
    v_mul_f32 v166, v166, v174
    v_mfma_f32_16x16x32_bf16 v[216:219], v[96:99], v[72:75], v[216:219]
    v_mul_f32 v167, v167, v175
    v_mul_f32 v166, v166, v121
    v_mfma_f32_16x16x32_bf16 v[220:223], v[96:99], v[76:79], v[220:223]
    s_waitcnt lgkmcnt(4)
    ds_read_b128 v[96:99], v248 offset:13568
    v_mul_f32 v167, v167, v121
    v_mfma_f32_16x16x32_bf16 v[232:235], v[100:103], v[72:75], v[232:235]
    v_cvt_pk_bf16_f32 v171, v166, v167
    v_permlane32_swap_b32 v168, v170
    v_mfma_f32_16x16x32_bf16 v[236:239], v[100:103], v[76:79], v[236:239]
    s_waitcnt vmcnt(11) lgkmcnt(4)
    ds_read_b128 v[100:103], v248 offset:14592
    buffer_load_dwordx4 v[72:75], v243, s[8:11], s68 offen offset:2048 sc1
    v_mfma_f32_16x16x32_bf16 v[192:195], v[80:83], v[32:35], v[192:195]
    v_permlane32_swap_b32 v169, v171
    v_mfma_f32_16x16x32_bf16 v[196:199], v[80:83], v[36:39], v[196:199]
    s_waitcnt lgkmcnt(4)
    ds_read_b128 v[80:83], v248 offset:18432
    buffer_store_dwordx4 v[168:171], v251, s[4:7], s73 offen offset:512
    v_mfma_f32_16x16x32_bf16 v[208:211], v[84:87], v[32:35], v[208:211]
    v_mul_f32 v176, v176, v184
    v_mul_f32 v177, v177, v185
    v_mfma_f32_16x16x32_bf16 v[212:215], v[84:87], v[36:39], v[212:215]
    s_waitcnt lgkmcnt(4)
    ds_read_b128 v[84:87], v248 offset:19456
    buffer_load_dwordx4 v[76:79], v243, s[8:11], s68 offen offset:3072 sc1
    v_mfma_f32_16x16x32_bf16 v[224:227], v[88:91], v[32:35], v[224:227]
    v_mul_f32 v176, v176, v120
    v_mul_f32 v177, v177, v120
    v_mfma_f32_16x16x32_bf16 v[228:231], v[88:91], v[36:39], v[228:231]
    s_waitcnt lgkmcnt(4)
    ds_read_b128 v[88:91], v248 offset:20480
    v_cvt_pk_bf16_f32 v184, v176, v177
    v_mfma_f32_16x16x32_bf16 v[200:203], v[92:95], v[32:35], v[200:203]
    v_mul_f32 v178, v178, v186
    v_mul_f32 v179, v179, v187
    v_mfma_f32_16x16x32_bf16 v[204:207], v[92:95], v[36:39], v[204:207]
    s_waitcnt lgkmcnt(4)
    ds_read_b128 v[92:95], v248 offset:18688
    v_mul_f32 v178, v178, v120
    v_mfma_f32_16x16x32_bf16 v[216:219], v[96:99], v[32:35], v[216:219]
    v_mul_f32 v179, v179, v120
    v_cvt_pk_bf16_f32 v185, v178, v179
    v_mfma_f32_16x16x32_bf16 v[220:223], v[96:99], v[36:39], v[220:223]
    s_waitcnt lgkmcnt(4)
    ds_read_b128 v[96:99], v248 offset:19712
    v_mul_f32 v180, v180, v188
    v_mfma_f32_16x16x32_bf16 v[232:235], v[100:103], v[32:35], v[232:235]
    v_mul_f32 v181, v181, v189
    v_mul_f32 v180, v180, v121
    v_mfma_f32_16x16x32_bf16 v[236:239], v[100:103], v[36:39], v[236:239]
    s_waitcnt vmcnt(12) lgkmcnt(4)
    ds_read_b128 v[100:103], v248 offset:20736
    buffer_load_dwordx4 v[32:35], v244, s[8:11], s68 offen offset:0 sc1
    v_mfma_f32_16x16x32_bf16 v[192:195], v[80:83], v[40:43], v[192:195]
    v_mul_f32 v181, v181, v121
    v_cvt_pk_bf16_f32 v186, v180, v181
    v_mfma_f32_16x16x32_bf16 v[196:199], v[80:83], v[44:47], v[196:199]
    s_waitcnt lgkmcnt(4)
    ds_read_b128 v[80:83], v248 offset:24576
    v_mul_f32 v182, v182, v190
    v_mfma_f32_16x16x32_bf16 v[208:211], v[84:87], v[40:43], v[208:211]
    v_mul_f32 v183, v183, v191
    v_mul_f32 v182, v182, v121
    v_mfma_f32_16x16x32_bf16 v[212:215], v[84:87], v[44:47], v[212:215]
    s_waitcnt lgkmcnt(4)
    ds_read_b128 v[84:87], v248 offset:25600
    buffer_load_dwordx4 v[36:39], v244, s[8:11], s68 offen offset:1024 sc1
    v_mfma_f32_16x16x32_bf16 v[224:227], v[88:91], v[40:43], v[224:227]
    v_mul_f32 v183, v183, v121
    v_cvt_pk_bf16_f32 v187, v182, v183
    v_mfma_f32_16x16x32_bf16 v[228:231], v[88:91], v[44:47], v[228:231]
    s_waitcnt lgkmcnt(4)
    ds_read_b128 v[88:91], v248 offset:26624
    v_permlane32_swap_b32 v184, v186
    v_mfma_f32_16x16x32_bf16 v[200:203], v[92:95], v[40:43], v[200:203]
    v_permlane32_swap_b32 v185, v187
    v_mfma_f32_16x16x32_bf16 v[204:207], v[92:95], v[44:47], v[204:207]
    s_waitcnt lgkmcnt(4)
    ds_read_b128 v[92:95], v248 offset:24832
    buffer_store_dwordx4 v[184:187], v125, s[4:7], s73 offen offset:2048
    v_mfma_f32_16x16x32_bf16 v[216:219], v[96:99], v[40:43], v[216:219]
    s_waitcnt vmcnt(13)
    v_add_f32 v112, v112, v114
    v_add_f32 v113, v113, v115
    v_mfma_f32_16x16x32_bf16 v[220:223], v[96:99], v[44:47], v[220:223]
    s_waitcnt lgkmcnt(4)
    ds_read_b128 v[96:99], v248 offset:25856
    v_add_f32 v116, v116, v118
    v_mfma_f32_16x16x32_bf16 v[232:235], v[100:103], v[40:43], v[232:235]
    v_add_f32 v117, v117, v119
    v_add_f32 v112, v112, v116
    v_mfma_f32_16x16x32_bf16 v[236:239], v[100:103], v[44:47], v[236:239]
    s_waitcnt vmcnt(11) lgkmcnt(4)
    ds_read_b128 v[100:103], v248 offset:26880
    buffer_load_dwordx4 v[40:43], v244, s[8:11], s68 offen offset:2048 sc1
    v_mfma_f32_16x16x32_bf16 v[192:195], v[80:83], v[48:51], v[192:195]
    v_add_f32 v113, v113, v117
    s_nop 1
    v_permlane32_swap_b32 v112, v113
    v_mfma_f32_16x16x32_bf16 v[196:199], v[80:83], v[52:55], v[196:199]
    s_waitcnt lgkmcnt(4)
    ds_read_b128 v[80:83], v248 offset:30720
    v_add_f32 v112, v112, v113
    v_mfma_f32_16x16x32_bf16 v[208:211], v[84:87], v[48:51], v[208:211]
    v_mul_f32 v112, 0x3b000000, v112
    v_mov_b32 v113, v112
    v_mfma_f32_16x16x32_bf16 v[212:215], v[84:87], v[52:55], v[212:215]
    s_waitcnt lgkmcnt(4)
    ds_read_b128 v[84:87], v248 offset:31744
    buffer_load_dwordx4 v[44:47], v244, s[8:11], s68 offen offset:3072 sc1
    v_mfma_f32_16x16x32_bf16 v[224:227], v[88:91], v[48:51], v[224:227]
    v_permlane32_swap_b32 v112, v113
    v_fma_f32 v113, -v112, v112, v113
    v_mfma_f32_16x16x32_bf16 v[228:231], v[88:91], v[52:55], v[228:231]
    s_waitcnt lgkmcnt(4)
    ds_read_b128 v[88:91], v248 offset:32768
    v_max_f32 v113, 0, v113
    v_mfma_f32_16x16x32_bf16 v[200:203], v[92:95], v[48:51], v[200:203]
    v_add_f32 v113, 0x3727c5ac, v113
    v_mfma_f32_16x16x32_bf16 v[204:207], v[92:95], v[52:55], v[204:207]
    s_waitcnt lgkmcnt(4)
    ds_read_b128 v[92:95], v248 offset:30976
    v_mfma_f32_16x16x32_bf16 v[216:219], v[96:99], v[48:51], v[216:219]
    v_rsq_f32 v122, v113
    v_mfma_f32_16x16x32_bf16 v[220:223], v[96:99], v[52:55], v[220:223]
    s_waitcnt lgkmcnt(4)
    ds_read_b128 v[96:99], v248 offset:32000
    v_cvt_pk_bf16_f32 v114, -v112, -v112
    v_mfma_f32_16x16x32_bf16 v[232:235], v[100:103], v[48:51], v[232:235]
    v_and_b32 v115, 0xffff0000, v114
    v_sub_f32 v115, -v112, v115
    v_mfma_f32_16x16x32_bf16 v[236:239], v[100:103], v[52:55], v[236:239]
    s_waitcnt vmcnt(11) lgkmcnt(4)
    ds_read_b128 v[100:103], v248 offset:33024
    buffer_load_dwordx4 v[48:51], v245, s[8:11], s68 offen offset:0 sc1
    v_mfma_f32_16x16x32_bf16 v[192:195], v[80:83], v[56:59], v[192:195]
    v_cvt_pk_bf16_f32 v115, v115, v115
    v_cndmask_b32 v124, v115, v114, s[24:25]
    v_mfma_f32_16x16x32_bf16 v[196:199], v[80:83], v[60:63], v[196:199]
    s_waitcnt lgkmcnt(4)
    ds_read_b128 v[80:83], v248 offset:36864
    v_mul_f32 v122, v122, v122
    v_mfma_f32_16x16x32_bf16 v[208:211], v[84:87], v[56:59], v[208:211]
    v_mov_b32 v113, v124
    v_mov_b32 v115, 0
    v_mfma_f32_16x16x32_bf16 v[212:215], v[84:87], v[60:63], v[212:215]
    s_waitcnt lgkmcnt(4)
    ds_read_b128 v[84:87], v248 offset:37888
    buffer_load_dwordx4 v[52:55], v245, s[8:11], s68 offen offset:1024 sc1
    v_mfma_f32_16x16x32_bf16 v[224:227], v[88:91], v[56:59], v[224:227]
    v_mov_b32 v123, v122
    v_mov_b32 v117, 0
    v_mfma_f32_16x16x32_bf16 v[228:231], v[88:91], v[60:63], v[228:231]
    s_waitcnt lgkmcnt(4)
    ds_read_b128 v[88:91], v248 offset:38912
    v_mov_b32 v119, v124
    v_mfma_f32_16x16x32_bf16 v[200:203], v[92:95], v[56:59], v[200:203]
    v_permlane16_swap_b32 v113, v115
    v_mov_b32 v112, 0
    v_mfma_f32_16x16x32_bf16 v[204:207], v[92:95], v[60:63], v[204:207]
    s_waitcnt lgkmcnt(4)
    ds_read_b128 v[92:95], v248 offset:37120
    v_permlane16_swap_b32 v122, v123
    v_mfma_f32_16x16x32_bf16 v[216:219], v[96:99], v[56:59], v[216:219]
    v_permlane16_swap_b32 v117, v119
    v_mov_b32 v114, 0
    v_mfma_f32_16x16x32_bf16 v[220:223], v[96:99], v[60:63], v[220:223]
    s_waitcnt lgkmcnt(4)
    ds_read_b128 v[96:99], v248 offset:38144
    v_mov_b32 v116, 0
    v_mfma_f32_16x16x32_bf16 v[232:235], v[100:103], v[56:59], v[232:235]
    v_mov_b32 v118, 0
    v_mfma_f32_16x16x32_bf16 v[236:239], v[100:103], v[60:63], v[236:239]
    s_waitcnt vmcnt(10) lgkmcnt(4)
    ds_read_b128 v[100:103], v248 offset:39168
    buffer_load_dwordx4 v[56:59], v245, s[8:11], s68 offen offset:2048 sc1
    v_mfma_f32_16x16x32_bf16 v[192:195], v[80:83], v[64:67], v[192:195]
    v_mfma_f32_16x16x32_bf16 v[196:199], v[80:83], v[68:71], v[196:199]
    s_waitcnt vmcnt(5) lgkmcnt(4)
    ds_read_b128 v[80:83], v248 offset:43008
    v_mfma_f32_16x16x32_bf16 v[208:211], v[84:87], v[64:67], v[208:211]
    s_cbranch_vccnz SAFE_266
    buffer_store_dword v11, v10, s[4:7], s75 offen offset:2048
BACK_267:
    v_mfma_f32_16x16x32_bf16 v[212:215], v[84:87], v[68:71], v[212:215]
    s_waitcnt lgkmcnt(4)
    ds_read_b128 v[84:87], v248 offset:44032
    buffer_load_dwordx4 v[60:63], v245, s[8:11], s68 offen offset:3072 sc1
    v_mfma_f32_16x16x32_bf16 v[224:227], v[88:91], v[64:67], v[224:227]
    v_mfma_f32_16x16x32_bf16 v[228:231], v[88:91], v[68:71], v[228:231]
    s_waitcnt lgkmcnt(4)
    ds_read_b128 v[88:91], v248 offset:45056
    v_mfma_f32_16x16x32_bf16 v[200:203], v[92:95], v[64:67], v[200:203]
    v_mfma_f32_16x16x32_bf16 v[204:207], v[92:95], v[68:71], v[204:207]
    s_waitcnt lgkmcnt(4)
    ds_read_b128 v[92:95], v248 offset:43264
    v_mfma_f32_16x16x32_bf16 v[216:219], v[96:99], v[64:67], v[216:219]
    v_mfma_f32_16x16x32_bf16 v[220:223], v[96:99], v[68:71], v[220:223]
    s_waitcnt lgkmcnt(4)
    ds_read_b128 v[96:99], v248 offset:44288
    v_mfma_f32_16x16x32_bf16 v[232:235], v[100:103], v[64:67], v[232:235]
    v_mfma_f32_16x16x32_bf16 v[236:239], v[100:103], v[68:71], v[236:239]
    s_waitcnt lgkmcnt(4)
    ds_read_b128 v[100:103], v248 offset:45312
    buffer_load_dwordx4 v[64:67], v246, s[8:11], s68 offen offset:0 sc1
    v_mfma_f32_16x16x32_bf16 v[192:195], v[80:83], v[72:75], v[192:195]
    v_mfma_f32_16x16x32_bf16 v[196:199], v[80:83], v[76:79], v[196:199]
    s_waitcnt lgkmcnt(4)
    ds_read_b128 v[80:83], v248 offset:49152
    v_mfma_f32_16x16x32_bf16 v[208:211], v[84:87], v[72:75], v[208:211]
    v_mfma_f32_16x16x32_bf16 v[212:215], v[84:87], v[76:79], v[212:215]
    s_waitcnt lgkmcnt(4)
    ds_read_b128 v[84:87], v248 offset:50176
    buffer_load_dwordx4 v[68:71], v246, s[8:11], s68 offen offset:1024 sc1
    v_mfma_f32_16x16x32_bf16 v[224:227], v[88:91], v[72:75], v[224:227]
    v_mfma_f32_16x16x32_bf16 v[228:231], v[88:91], v[76:79], v[228:231]
    s_waitcnt lgkmcnt(4)
    ds_read_b128 v[88:91], v248 offset:51200
    v_mfma_f32_16x16x32_bf16 v[200:203], v[92:95], v[72:75], v[200:203]
    v_mfma_f32_16x16x32_bf16 v[204:207], v[92:95], v[76:79], v[204:207]
    s_waitcnt lgkmcnt(4)
    ds_read_b128 v[92:95], v248 offset:49408
    v_mfma_f32_16x16x32_bf16 v[216:219], v[96:99], v[72:75], v[216:219]
    v_mfma_f32_16x16x32_bf16 v[220:223], v[96:99], v[76:79], v[220:223]
    s_waitcnt lgkmcnt(4)
    ds_read_b128 v[96:99], v248 offset:50432
    v_mfma_f32_16x16x32_bf16 v[232:235], v[100:103], v[72:75], v[232:235]
    v_mfma_f32_16x16x32_bf16 v[236:239], v[100:103], v[76:79], v[236:239]
    s_waitcnt lgkmcnt(4)
    ds_read_b128 v[100:103], v248 offset:51456
    buffer_load_dwordx4 v[72:75], v246, s[8:11], s68 offen offset:2048 sc1
    v_mfma_f32_16x16x32_bf16 v[192:195], v[80:83], v[32:35], v[192:195]
    v_mfma_f32_16x16x32_bf16 v[196:199], v[80:83], v[36:39], v[196:199]
    s_waitcnt lgkmcnt(4)
    ds_read_b128 v[80:83], v248 offset:55296
    v_mfma_f32_16x16x32_bf16 v[208:211], v[84:87], v[32:35], v[208:211]
    v_mfma_f32_16x16x32_bf16 v[212:215], v[84:87], v[36:39], v[212:215]
    s_waitcnt lgkmcnt(4)
    ds_read_b128 v[84:87], v248 offset:56320
    buffer_load_dwordx4 v[76:79], v246, s[8:11], s68 offen offset:3072 sc1
    v_mfma_f32_16x16x32_bf16 v[224:227], v[88:91], v[32:35], v[224:227]
    v_mfma_f32_16x16x32_bf16 v[228:231], v[88:91], v[36:39], v[228:231]
    s_waitcnt lgkmcnt(4)
    ds_read_b128 v[88:91], v248 offset:57344
    v_mfma_f32_16x16x32_bf16 v[200:203], v[92:95], v[32:35], v[200:203]
    v_mfma_f32_16x16x32_bf16 v[204:207], v[92:95], v[36:39], v[204:207]
    s_waitcnt lgkmcnt(4)
    ds_read_b128 v[92:95], v248 offset:55552
    v_mfma_f32_16x16x32_bf16 v[216:219], v[96:99], v[32:35], v[216:219]
    v_mfma_f32_16x16x32_bf16 v[220:223], v[96:99], v[36:39], v[220:223]
    s_waitcnt lgkmcnt(4)
    ds_read_b128 v[96:99], v248 offset:56576
    v_mfma_f32_16x16x32_bf16 v[232:235], v[100:103], v[32:35], v[232:235]
    v_mfma_f32_16x16x32_bf16 v[236:239], v[100:103], v[36:39], v[236:239]
    s_waitcnt vmcnt(9) lgkmcnt(4)
    ds_read_b128 v[100:103], v248 offset:57600
    buffer_load_dwordx4 v[32:35], v247, s[8:11], s68 offen offset:0 sc1
    v_mfma_f32_16x16x32_bf16 v[192:195], v[80:83], v[40:43], v[192:195]
    v_mfma_f32_16x16x32_bf16 v[196:199], v[80:83], v[44:47], v[196:199]
    s_waitcnt lgkmcnt(4)
    ds_read_b128 v[80:83], v249 offset:0
    v_mfma_f32_16x16x32_bf16 v[208:211], v[84:87], v[40:43], v[208:211]
    v_mfma_f32_16x16x32_bf16 v[212:215], v[84:87], v[44:47], v[212:215]
    s_waitcnt lgkmcnt(4)
    ds_read_b128 v[84:87], v249 offset:1024
    buffer_load_dwordx4 v[36:39], v247, s[8:11], s68 offen offset:1024 sc1
    v_mfma_f32_16x16x32_bf16 v[224:227], v[88:91], v[40:43], v[224:227]
    v_mfma_f32_16x16x32_bf16 v[228:231], v[88:91], v[44:47], v[228:231]
    s_waitcnt lgkmcnt(4)
    ds_read_b128 v[88:91], v249 offset:2048
    v_mfma_f32_16x16x32_bf16 v[200:203], v[92:95], v[40:43], v[200:203]
    v_mfma_f32_16x16x32_bf16 v[204:207], v[92:95], v[44:47], v[204:207]
    s_waitcnt lgkmcnt(4)
    ds_read_b128 v[92:95], v249 offset:256
    v_mfma_f32_16x16x32_bf16 v[216:219], v[96:99], v[40:43], v[216:219]
    v_mfma_f32_16x16x32_bf16 v[220:223], v[96:99], v[44:47], v[220:223]
    s_waitcnt lgkmcnt(4)
    ds_read_b128 v[96:99], v249 offset:1280
    buffer_load_dword v14, v9, s[4:7], s79 offen offset:2048 sc1
    v_mfma_f32_16x16x32_bf16 v[232:235], v[100:103], v[40:43], v[232:235]
    v_mfma_f32_16x16x32_bf16 v[236:239], v[100:103], v[44:47], v[236:239]
    s_waitcnt vmcnt(10) lgkmcnt(4)
    ds_read_b128 v[100:103], v249 offset:2304
    buffer_load_dwordx4 v[40:43], v247, s[8:11], s68 offen offset:2048 sc1
    v_mfma_f32_16x16x32_bf16 v[192:195], v[80:83], v[48:51], v[192:195]
    v_mfma_f32_16x16x32_bf16 v[196:199], v[80:83], v[52:55], v[196:199]
    s_waitcnt lgkmcnt(4)
    ds_read_b128 v[80:83], v249 offset:6144
    v_mfma_f32_16x16x32_bf16 v[208:211], v[84:87], v[48:51], v[208:211]
    v_mfma_f32_16x16x32_bf16 v[212:215], v[84:87], v[52:55], v[212:215]
    s_waitcnt lgkmcnt(4)
    ds_read_b128 v[84:87], v249 offset:7168
    buffer_load_dwordx4 v[44:47], v247, s[8:11], s68 offen offset:3072 sc1
    v_mfma_f32_16x16x32_bf16 v[224:227], v[88:91], v[48:51], v[224:227]
    v_mfma_f32_16x16x32_bf16 v[228:231], v[88:91], v[52:55], v[228:231]
    s_waitcnt lgkmcnt(4)
    ds_read_b128 v[88:91], v249 offset:8192
    v_mfma_f32_16x16x32_bf16 v[200:203], v[92:95], v[48:51], v[200:203]
    v_mfma_f32_16x16x32_bf16 v[204:207], v[92:95], v[52:55], v[204:207]
    s_waitcnt lgkmcnt(4)
    ds_read_b128 v[92:95], v249 offset:6400
    v_mfma_f32_16x16x32_bf16 v[216:219], v[96:99], v[48:51], v[216:219]
    v_mfma_f32_16x16x32_bf16 v[220:223], v[96:99], v[52:55], v[220:223]
    s_waitcnt lgkmcnt(4)
    ds_read_b128 v[96:99], v249 offset:7424
    v_mfma_f32_16x16x32_bf16 v[232:235], v[100:103], v[48:51], v[232:235]
    v_mfma_f32_16x16x32_bf16 v[236:239], v[100:103], v[52:55], v[236:239]
    ds_read_b128 v[100:103], v249 offset:8448
    v_mfma_f32_16x16x16_bf16 v[192:195], v[24:25], v[112:113], v[192:195]
    v_mfma_f32_16x16x16_bf16 v[196:199], v[24:25], v[114:115], v[196:199]
    v_mfma_f32_16x16x16_bf16 v[200:203], v[24:25], v[116:117], v[200:203]
    v_mfma_f32_16x16x16_bf16 v[204:207], v[24:25], v[118:119], v[204:207]
    s_waitcnt vmcnt(2)
    v_cmp_gt_u32 vcc, s35, v14
    s_cbranch_vccnz SPIN_268
BACK_269:
    v_mfma_f32_16x16x16_bf16 v[208:211], v[26:27], v[112:113], v[208:211]
    v_mfma_f32_16x16x16_bf16 v[212:215], v[26:27], v[114:115], v[212:215]
    buffer_load_dwordx4 v[128:131], v16, s[4:7], s77 offen offset:0 sc1
    v_mfma_f32_16x16x16_bf16 v[216:219], v[26:27], v[116:117], v[216:219]
    v_mfma_f32_16x16x16_bf16 v[220:223], v[26:27], v[118:119], v[220:223]
    v_mfma_f32_16x16x16_bf16 v[224:227], v[28:29], v[112:113], v[224:227]
    v_mfma_f32_16x16x16_bf16 v[228:231], v[28:29], v[114:115], v[228:231]
    buffer_load_dwordx4 v[132:135], v16, s[4:7], s77 offen offset:2048 sc1
    v_mfma_f32_16x16x16_bf16 v[232:235], v[28:29], v[116:117], v[232:235]
    v_mfma_f32_16x16x16_bf16 v[236:239], v[28:29], v[118:119], v[236:239]
    s_waitcnt lgkmcnt(5)
    v_mfma_f32_16x16x32_bf16 v[192:195], v[80:83], v[56:59], v[192:195]
    v_mfma_f32_16x16x32_bf16 v[196:199], v[80:83], v[60:63], v[196:199]
    s_waitcnt lgkmcnt(4)
    ds_read_b128 v[80:83], v249 offset:12288
    buffer_load_dwordx4 v[136:139], v17, s[4:7], s77 offen offset:0 sc1
    v_mfma_f32_16x16x32_bf16 v[208:211], v[84:87], v[56:59], v[208:211]
    v_mfma_f32_16x16x32_bf16 v[212:215], v[84:87], v[60:63], v[212:215]
    s_waitcnt lgkmcnt(4)
    ds_read_b128 v[84:87], v249 offset:12544
    v_mfma_f32_16x16x32_bf16 v[224:227], v[88:91], v[56:59], v[224:227]
    v_mfma_f32_16x16x32_bf16 v[228:231], v[88:91], v[60:63], v[228:231]
    s_waitcnt lgkmcnt(4)
    ds_read_b128 v[88:91], v249 offset:18432
    buffer_load_dwordx4 v[140:143], v17, s[4:7], s77 offen offset:2048 sc1
    v_mfma_f32_16x16x32_bf16 v[200:203], v[92:95], v[56:59], v[200:203]
    v_mfma_f32_16x16x32_bf16 v[204:207], v[92:95], v[60:63], v[204:207]
    s_waitcnt lgkmcnt(4)
    ds_read_b128 v[92:95], v249 offset:18688
    v_mfma_f32_16x16x32_bf16 v[216:219], v[96:99], v[56:59], v[216:219]
    v_mfma_f32_16x16x32_bf16 v[220:223], v[96:99], v[60:63], v[220:223]
    s_waitcnt lgkmcnt(4)
    ds_read_b128 v[96:99], v249 offset:24576
    buffer_load_dwordx4 v[144:147], v18, s[4:7], s77 offen offset:0 sc1
    v_mfma_f32_16x16x32_bf16 v[232:235], v[100:103], v[56:59], v[232:235]
    v_mfma_f32_16x16x32_bf16 v[236:239], v[100:103], v[60:63], v[236:239]
    s_waitcnt lgkmcnt(4)
    ds_read_b128 v[100:103], v249 offset:24832
    v_mfma_f32_16x16x32_bf16 v[192:195], v[80:83], v[64:67], v[192:195]
    v_mfma_f32_16x16x32_bf16 v[196:199], v[80:83], v[68:71], v[196:199]
    s_waitcnt lgkmcnt(4)
    ds_read_b128 v[80:83], v249 offset:30720
    buffer_load_dwordx4 v[148:151], v18, s[4:7], s77 offen offset:2048 sc1
    v_mfma_f32_16x16x32_bf16 v[200:203], v[84:87], v[64:67], v[200:203]
    v_mfma_f32_16x16x32_bf16 v[204:207], v[84:87], v[68:71], v[204:207]
    s_waitcnt lgkmcnt(4)
    ds_read_b128 v[84:87], v249 offset:30976
    v_mfma_f32_16x16x32_bf16 v[192:195], v[88:91], v[72:75], v[192:195]
    v_mfma_f32_16x16x32_bf16 v[196:199], v[88:91], v[76:79], v[196:199]
    s_waitcnt lgkmcnt(4)
    ds_read_b128 v[88:91], v249 offset:13312
    buffer_load_dwordx4 v[152:155], v19, s[4:7], s77 offen offset:0 sc1
    v_mfma_f32_16x16x32_bf16 v[200:203], v[92:95], v[72:75], v[200:203]
    v_mfma_f32_16x16x32_bf16 v[204:207], v[92:95], v[76:79], v[204:207]
    s_waitcnt lgkmcnt(4)
    ds_read_b128 v[92:95], v249 offset:13568
    v_mfma_f32_16x16x32_bf16 v[192:195], v[96:99], v[32:35], v[192:195]
    v_mfma_f32_16x16x32_bf16 v[196:199], v[96:99], v[36:39], v[196:199]
    s_waitcnt lgkmcnt(4)
    ds_read_b128 v[96:99], v249 offset:19456
    buffer_load_dwordx4 v[156:159], v19, s[4:7], s77 offen offset:2048 sc1
    v_mfma_f32_16x16x32_bf16 v[200:203], v[100:103], v[32:35], v[200:203]
    v_mfma_f32_16x16x32_bf16 v[204:207], v[100:103], v[36:39], v[204:207]
    s_waitcnt vmcnt(8) lgkmcnt(4)
    ds_read_b128 v[100:103], v249 offset:19712
    v_mfma_f32_16x16x32_bf16 v[192:195], v[80:83], v[40:43], v[192:195]
    v_mfma_f32_16x16x32_bf16 v[196:199], v[80:83], v[44:47], v[196:199]
    s_waitcnt lgkmcnt(4)
    ds_read_b128 v[80:83], v249 offset:25600
    buffer_load_dwordx4 v[160:163], v20, s[4:7], s77 offen offset:0 sc1
    v_mfma_f32_16x16x32_bf16 v[200:203], v[84:87], v[40:43], v[200:203]
    v_mfma_f32_16x16x32_bf16 v[204:207], v[84:87], v[44:47], v[204:207]
    s_waitcnt lgkmcnt(4)
    ds_read_b128 v[84:87], v249 offset:25856
    v_mfma_f32_16x16x32_bf16 v[208:211], v[88:91], v[64:67], v[208:211]
    v_mfma_f32_16x16x32_bf16 v[212:215], v[88:91], v[68:71], v[212:215]
    s_waitcnt lgkmcnt(4)
    ds_read_b128 v[88:91], v249 offset:31744
    buffer_load_dwordx4 v[164:167], v20, s[4:7], s77 offen offset:2048 sc1
    v_mfma_f32_16x16x32_bf16 v[216:219], v[92:95], v[64:67], v[216:219]
    v_mul_f32 v192, v192, v200
    v_mul_f32 v193, v193, v201
    v_mfma_f32_16x16x32_bf16 v[220:223], v[92:95], v[68:71], v[220:223]
    s_waitcnt lgkmcnt(4)
    ds_read_b128 v[92:95], v249 offset:32000
    v_mul_f32 v192, v192, v122
    v_mfma_f32_16x16x32_bf16 v[208:211], v[96:99], v[72:75], v[208:211]
    v_mul_f32 v193, v193, v122
    v_cvt_pk_bf16_f32 v200, v192, v193
    v_mfma_f32_16x16x32_bf16 v[212:215], v[96:99], v[76:79], v[212:215]
    s_waitcnt lgkmcnt(4)
    ds_read_b128 v[96:99], v249 offset:14336
    buffer_load_dwordx4 v[168:171], v21, s[4:7], s77 offen offset:0 sc1
    v_mfma_f32_16x16x32_bf16 v[216:219], v[100:103], v[72:75], v[216:219]
    v_mul_f32 v194, v194, v202
    v_mul_f32 v195, v195, v203
    v_mfma_f32_16x16x32_bf16 v[220:223], v[100:103], v[76:79], v[220:223]
    s_waitcnt lgkmcnt(4)
    ds_read_b128 v[100:103], v249 offset:14592
    v_mul_f32 v194, v194, v122
    v_mfma_f32_16x16x32_bf16 v[208:211], v[80:83], v[32:35], v[208:211]
    v_mul_f32 v195, v195, v122
    v_cvt_pk_bf16_f32 v201, v194, v195
    v_mfma_f32_16x16x32_bf16 v[212:215], v[80:83], v[36:39], v[212:215]
    s_waitcnt lgkmcnt(4)
    ds_read_b128 v[80:83], v249 offset:20480
    buffer_load_dwordx4 v[172:175], v16, s[4:7], s77 offen offset:1024 sc1
    v_mfma_f32_16x16x32_bf16 v[216:219], v[84:87], v[32:35], v[216:219]
    v_mul_f32 v196, v196, v204
    v_mul_f32 v197, v197, v205
    v_mfma_f32_16x16x32_bf16 v[220:223], v[84:87], v[36:39], v[220:223]
    s_waitcnt lgkmcnt(4)
    ds_read_b128 v[84:87], v249 offset:20736
    v_mul_f32 v196, v196, v123
    v_mfma_f32_16x16x32_bf16 v[208:211], v[88:91], v[40:43], v[208:211]
    v_mul_f32 v197, v197, v123
    v_cvt_pk_bf16_f32 v202, v196, v197
    v_mfma_f32_16x16x32_bf16 v[212:215], v[88:91], v[44:47], v[212:215]
    s_waitcnt lgkmcnt(4)
    ds_read_b128 v[88:91], v249 offset:26624
    buffer_load_dwordx4 v[176:179], v16, s[4:7], s77 offen offset:3072 sc1
    v_mfma_f32_16x16x32_bf16 v[216:219], v[92:95], v[40:43], v[216:219]
    v_mul_f32 v198, v198, v206
    v_mul_f32 v199, v199, v207
    v_mfma_f32_16x16x32_bf16 v[220:223], v[92:95], v[44:47], v[220:223]
    s_waitcnt lgkmcnt(4)
    ds_read_b128 v[92:95], v249 offset:26880
    v_mul_f32 v198, v198, v123
    v_mfma_f32_16x16x32_bf16 v[224:227], v[96:99], v[64:67], v[224:227]
    v_mul_f32 v199, v199, v123
    v_cvt_pk_bf16_f32 v203, v198, v199
    v_mfma_f32_16x16x32_bf16 v[228:231], v[96:99], v[68:71], v[228:231]
    s_waitcnt lgkmcnt(4)
    ds_read_b128 v[96:99], v249 offset:32768
    buffer_load_dwordx4 v[180:183], v17, s[4:7], s77 offen offset:1024 sc1
    v_mfma_f32_16x16x32_bf16 v[232:235], v[100:103], v[64:67], v[232:235]
    v_permlane32_swap_b32 v200, v202
    v_permlane32_swap_b32 v201, v203
    v_mfma_f32_16x16x32_bf16 v[236:239], v[100:103], v[68:71], v[236:239]
    s_waitcnt lgkmcnt(4)
    ds_read_b128 v[100:103], v249 offset:33024
    buffer_store_dwordx4 v[200:203], v250, s[4:7], s74 offen offset:0
    v_mfma_f32_16x16x32_bf16 v[224:227], v[80:83], v[72:75], v[224:227]
    v_mul_f32 v208, v208, v216
    v_mul_f32 v209, v209, v217
    v_mfma_f32_16x16x32_bf16 v[228:231], v[80:83], v[76:79], v[228:231]
    s_waitcnt lgkmcnt(4)
    buffer_load_dwordx4 v[184:187], v17, s[4:7], s77 offen offset:3072 sc1
    v_mul_f32 v208, v208, v122
    v_mfma_f32_16x16x32_bf16 v[232:235], v[84:87], v[72:75], v[232:235]
    v_mul_f32 v209, v209, v122
    v_cvt_pk_bf16_f32 v216, v208, v209
    v_mfma_f32_16x16x32_bf16 v[236:239], v[84:87], v[76:79], v[236:239]
    s_waitcnt lgkmcnt(3)
    v_mul_f32 v210, v210, v218
    v_mul_f32 v211, v211, v219
    v_mfma_f32_16x16x32_bf16 v[224:227], v[88:91], v[32:35], v[224:227]
    v_mul_f32 v210, v210, v122
    v_mul_f32 v211, v211, v122
    v_mfma_f32_16x16x32_bf16 v[228:231], v[88:91], v[36:39], v[228:231]
    s_waitcnt lgkmcnt(2)
    buffer_load_dwordx4 v[188:191], v18, s[4:7], s77 offen offset:1024 sc1
    v_cvt_pk_bf16_f32 v217, v210, v211
    v_mfma_f32_16x16x32_bf16 v[232:235], v[92:95], v[32:35], v[232:235]
    v_mul_f32 v212, v212, v220
    v_mul_f32 v213, v213, v221
    v_mfma_f32_16x16x32_bf16 v[236:239], v[92:95], v[36:39], v[236:239]
    s_waitcnt lgkmcnt(1)
    v_mul_f32 v212, v212, v123
    v_mul_f32 v213, v213, v123
    v_mfma_f32_16x16x32_bf16 v[224:227], v[96:99], v[40:43], v[224:227]
    v_cvt_pk_bf16_f32 v218, v212, v213
    v_mul_f32 v214, v214, v222
    v_mfma_f32_16x16x32_bf16 v[228:231], v[96:99], v[44:47], v[228:231]
    s_waitcnt lgkmcnt(0)
    v_mul_f32 v215, v215, v223
    v_mul_f32 v214, v214, v123
    v_mfma_f32_16x16x32_bf16 v[232:235], v[100:103], v[40:43], v[232:235]
    v_mul_f32 v215, v215, v123
    v_cvt_pk_bf16_f32 v219, v214, v215
    v_mfma_f32_16x16x32_bf16 v[236:239], v[100:103], v[44:47], v[236:239]
    v_permlane32_swap_b32 v216, v218
    v_permlane32_swap_b32 v217, v219
    s_waitcnt vmcnt(16)
    v_mfma_f32_16x16x32_bf16 v[48:51], a[0:3], v[128:131], 0
    buffer_store_dwordx4 v[216:219], v251, s[4:7], s74 offen offset:512
    v_mfma_f32_16x16x32_bf16 v[56:59], a[4:7], v[128:131], 0
    v_mul_f32 v224, v224, v232
    v_mul_f32 v225, v225, v233
    v_mfma_f32_16x16x32_bf16 v[64:67], a[8:11], v[128:131], 0
    v_mul_f32 v224, v224, v122
    v_mul_f32 v225, v225, v122
    v_mfma_f32_16x16x32_bf16 v[72:75], a[12:15], v[128:131], 0
    s_waitcnt vmcnt(16)
    buffer_load_dwordx4 v[128:131], v18, s[4:7], s77 offen offset:3072 sc1
    v_cvt_pk_bf16_f32 v232, v224, v225
    v_mfma_f32_16x16x32_bf16 v[48:51], a[16:19], v[132:135], v[48:51]
    v_mul_f32 v226, v226, v234
    v_mul_f32 v227, v227, v235
    v_mfma_f32_16x16x32_bf16 v[56:59], a[20:23], v[132:135], v[56:59]
    v_mul_f32 v226, v226, v122
    v_mul_f32 v227, v227, v122
    v_mfma_f32_16x16x32_bf16 v[64:67], a[24:27], v[132:135], v[64:67]
    v_cvt_pk_bf16_f32 v233, v226, v227
    v_mul_f32 v228, v228, v236
    v_mfma_f32_16x16x32_bf16 v[72:75], a[28:31], v[132:135], v[72:75]
    s_waitcnt vmcnt(16)
    buffer_load_dwordx4 v[132:135], v19, s[4:7], s77 offen offset:1024 sc1
    v_mul_f32 v229, v229, v237
    v_mfma_f32_16x16x32_bf16 v[48:51], a[32:35], v[136:139], v[48:51]
    v_mul_f32 v228, v228, v123
    v_mul_f32 v229, v229, v123
    v_mfma_f32_16x16x32_bf16 v[56:59], a[36:39], v[136:139], v[56:59]
    v_cvt_pk_bf16_f32 v234, v228, v229
    v_mul_f32 v230, v230, v238
    v_mfma_f32_16x16x32_bf16 v[64:67], a[40:43], v[136:139], v[64:67]
    v_mul_f32 v231, v231, v239
    v_mul_f32 v230, v230, v123
    v_mfma_f32_16x16x32_bf16 v[72:75], a[44:47], v[136:139], v[72:75]
    s_waitcnt vmcnt(16)
    buffer_load_dwordx4 v[136:139], v19, s[4:7], s77 offen offset:3072 sc1
    v_mul_f32 v231, v231, v123
    v_mfma_f32_16x16x32_bf16 v[48:51], a[48:51], v[140:143], v[48:51]
    v_cvt_pk_bf16_f32 v235, v230, v231
    v_permlane32_swap_b32 v232, v234
    v_mfma_f32_16x16x32_bf16 v[56:59], a[52:55], v[140:143], v[56:59]
    v_permlane32_swap_b32 v233, v235
    v_mfma_f32_16x16x32_bf16 v[64:67], a[56:59], v[140:143], v[64:67]
    buffer_store_dwordx4 v[232:235], v125, s[4:7], s74 offen offset:2048
    v_mfma_f32_16x16x32_bf16 v[72:75], a[60:63], v[140:143], v[72:75]
    s_waitcnt vmcnt(17)
    buffer_load_dwordx4 v[140:143], v20, s[4:7], s77 offen offset:1024 sc1
    v_mfma_f32_16x16x32_bf16 v[48:51], a[64:67], v[144:147], v[48:51]
    v_mfma_f32_16x16x32_bf16 v[56:59], a[68:71], v[144:147], v[56:59]
    v_mfma_f32_16x16x32_bf16 v[64:67], a[72:75], v[144:147], v[64:67]
    v_mfma_f32_16x16x32_bf16 v[72:75], a[76:79], v[144:147], v[72:75]
    s_waitcnt vmcnt(17)
    buffer_load_dwordx4 v[144:147], v20, s[4:7], s77 offen offset:3072 sc1
    v_mfma_f32_16x16x32_bf16 v[48:51], a[80:83], v[148:151], v[48:51]
    v_mfma_f32_16x16x32_bf16 v[56:59], a[84:87], v[148:151], v[56:59]
    v_mfma_f32_16x16x32_bf16 v[64:67], a[88:91], v[148:151], v[64:67]
    v_mfma_f32_16x16x32_bf16 v[72:75], a[92:95], v[148:151], v[72:75]
    s_waitcnt vmcnt(17)
    buffer_load_dwordx4 v[148:151], v21, s[4:7], s77 offen offset:1024 sc1
    v_mfma_f32_16x16x32_bf16 v[48:51], a[96:99], v[152:155], v[48:51]
    v_mfma_f32_16x16x32_bf16 v[56:59], a[100:103], v[152:155], v[56:59]
    v_mfma_f32_16x16x32_bf16 v[64:67], a[104:107], v[152:155], v[64:67]
    v_mfma_f32_16x16x32_bf16 v[72:75], a[108:111], v[152:155], v[72:75]
    s_waitcnt vmcnt(17)
    v_mfma_f32_16x16x32_bf16 v[48:51], a[112:115], v[156:159], v[48:51]
    v_mfma_f32_16x16x32_bf16 v[56:59], a[116:119], v[156:159], v[56:59]
    v_mfma_f32_16x16x32_bf16 v[64:67], a[120:123], v[156:159], v[64:67]
    v_mfma_f32_16x16x32_bf16 v[72:75], a[124:127], v[156:159], v[72:75]
    s_waitcnt vmcnt(16)
    v_mfma_f32_16x16x32_bf16 v[48:51], a[128:131], v[160:163], v[48:51]
    v_mfma_f32_16x16x32_bf16 v[56:59], a[132:135], v[160:163], v[56:59]
    s_waitcnt vmcnt(3)
    s_cbranch_vccnz SAFE_271
    buffer_store_dword v11, v10, s[4:7], s76 offen offset:2048
BACK_272:
    v_mfma_f32_16x16x32_bf16 v[64:67], a[136:139], v[160:163], v[64:67]
    v_mfma_f32_16x16x32_bf16 v[72:75], a[140:143], v[160:163], v[72:75]
    v_mfma_f32_16x16x32_bf16 v[48:51], a[144:147], v[164:167], v[48:51]
    v_mfma_f32_16x16x32_bf16 v[56:59], a[148:151], v[164:167], v[56:59]
    v_mfma_f32_16x16x32_bf16 v[64:67], a[152:155], v[164:167], v[64:67]
    v_mfma_f32_16x16x32_bf16 v[72:75], a[156:159], v[164:167], v[72:75]
    v_mfma_f32_16x16x32_bf16 v[48:51], a[160:163], v[168:171], v[48:51]
    v_mfma_f32_16x16x32_bf16 v[56:59], a[164:167], v[168:171], v[56:59]
    v_mfma_f32_16x16x32_bf16 v[64:67], a[168:171], v[168:171], v[64:67]
    v_mfma_f32_16x16x32_bf16 v[72:75], a[172:175], v[168:171], v[72:75]
    v_mfma_f32_16x16x32_bf16 v[52:55], a[0:3], v[172:175], 0
    v_mfma_f32_16x16x32_bf16 v[60:63], a[4:7], v[172:175], 0
    v_mfma_f32_16x16x32_bf16 v[68:71], a[8:11], v[172:175], 0
    v_mfma_f32_16x16x32_bf16 v[76:79], a[12:15], v[172:175], 0
    v_mfma_f32_16x16x32_bf16 v[52:55], a[16:19], v[176:179], v[52:55]
    v_mfma_f32_16x16x32_bf16 v[60:63], a[20:23], v[176:179], v[60:63]
    ds_write_b128 v5, v[48:51] offset:0
    v_mfma_f32_16x16x32_bf16 v[68:71], a[24:27], v[176:179], v[68:71]
    v_mfma_f32_16x16x32_bf16 v[76:79], a[28:31], v[176:179], v[76:79]
    v_mfma_f32_16x16x32_bf16 v[52:55], a[32:35], v[180:183], v[52:55]
    v_mfma_f32_16x16x32_bf16 v[60:63], a[36:39], v[180:183], v[60:63]
    ds_write_b128 v5, v[56:59] offset:2048
    v_mfma_f32_16x16x32_bf16 v[68:71], a[40:43], v[180:183], v[68:71]
    v_mfma_f32_16x16x32_bf16 v[76:79], a[44:47], v[180:183], v[76:79]
    v_mfma_f32_16x16x32_bf16 v[52:55], a[48:51], v[184:187], v[52:55]
    v_mfma_f32_16x16x32_bf16 v[60:63], a[52:55], v[184:187], v[60:63]
    buffer_load_dword v14, v9, s[4:7], s80 offen offset:2048 sc1
    ds_write_b128 v5, v[64:67] offset:4096
    v_mfma_f32_16x16x32_bf16 v[68:71], a[56:59], v[184:187], v[68:71]
    v_mfma_f32_16x16x32_bf16 v[76:79], a[60:63], v[184:187], v[76:79]
    v_mfma_f32_16x16x32_bf16 v[52:55], a[64:67], v[188:191], v[52:55]
    v_mfma_f32_16x16x32_bf16 v[60:63], a[68:71], v[188:191], v[60:63]
    ds_write_b128 v5, v[72:75] offset:6144
    v_mfma_f32_16x16x32_bf16 v[68:71], a[72:75], v[188:191], v[68:71]
    v_mfma_f32_16x16x32_bf16 v[76:79], a[76:79], v[188:191], v[76:79]
    v_mfma_f32_16x16x32_bf16 v[52:55], a[80:83], v[128:131], v[52:55]
    v_mfma_f32_16x16x32_bf16 v[60:63], a[84:87], v[128:131], v[60:63]
    v_mfma_f32_16x16x32_bf16 v[68:71], a[88:91], v[128:131], v[68:71]
    v_mfma_f32_16x16x32_bf16 v[76:79], a[92:95], v[128:131], v[76:79]
    v_mfma_f32_16x16x32_bf16 v[52:55], a[96:99], v[132:135], v[52:55]
    v_mfma_f32_16x16x32_bf16 v[60:63], a[100:103], v[132:135], v[60:63]
    v_mfma_f32_16x16x32_bf16 v[68:71], a[104:107], v[132:135], v[68:71]
    v_mfma_f32_16x16x32_bf16 v[76:79], a[108:111], v[132:135], v[76:79]
    s_branch PJ_276
.p2align 12
PJ_276:
    v_mfma_f32_16x16x32_bf16 v[52:55], a[112:115], v[136:139], v[52:55]
    v_mfma_f32_16x16x32_bf16 v[60:63], a[116:119], v[136:139], v[60:63]
    s_waitcnt vmcnt(0)
    v_cmp_gt_u32 vcc, s35, v14
    s_cbranch_vccnz SPIN_273
BACK_274:
    v_mfma_f32_16x16x32_bf16 v[68:71], a[120:123], v[136:139], v[68:71]
    buffer_load_dwordx4 v[152:155], v16, s[4:7], s78 offen offset:0 sc1
    v_mfma_f32_16x16x32_bf16 v[76:79], a[124:127], v[136:139], v[76:79]
    buffer_load_dwordx4 v[156:159], v16, s[4:7], s78 offen offset:2048 sc1
    v_mfma_f32_16x16x32_bf16 v[52:55], a[128:131], v[140:143], v[52:55]
    buffer_load_dwordx4 v[160:163], v17, s[4:7], s78 offen offset:0 sc1
    v_mfma_f32_16x16x32_bf16 v[60:63], a[132:135], v[140:143], v[60:63]
    buffer_load_dwordx4 v[164:167], v17, s[4:7], s78 offen offset:2048 sc1
    v_mfma_f32_16x16x32_bf16 v[68:71], a[136:139], v[140:143], v[68:71]
    buffer_load_dwordx4 v[168:171], v18, s[4:7], s78 offen offset:0 sc1
    v_mfma_f32_16x16x32_bf16 v[76:79], a[140:143], v[140:143], v[76:79]
    buffer_load_dwordx4 v[172:175], v18, s[4:7], s78 offen offset:2048 sc1
    v_mfma_f32_16x16x32_bf16 v[52:55], a[144:147], v[144:147], v[52:55]
    buffer_load_dwordx4 v[176:179], v19, s[4:7], s78 offen offset:0 sc1
    v_mfma_f32_16x16x32_bf16 v[60:63], a[148:151], v[144:147], v[60:63]
    buffer_load_dwordx4 v[180:183], v19, s[4:7], s78 offen offset:2048 sc1
    v_mfma_f32_16x16x32_bf16 v[68:71], a[152:155], v[144:147], v[68:71]
    buffer_load_dwordx4 v[184:187], v20, s[4:7], s78 offen offset:0 sc1
    v_mfma_f32_16x16x32_bf16 v[76:79], a[156:159], v[144:147], v[76:79]
    buffer_load_dwordx4 v[188:191], v20, s[4:7], s78 offen offset:2048 sc1
    v_mfma_f32_16x16x32_bf16 v[52:55], a[160:163], v[148:151], v[52:55]
    v_mfma_f32_16x16x32_bf16 v[60:63], a[164:167], v[148:151], v[60:63]
    v_mfma_f32_16x16x32_bf16 v[68:71], a[168:171], v[148:151], v[68:71]
    v_mfma_f32_16x16x32_bf16 v[76:79], a[172:175], v[148:151], v[76:79]
C1_done:
    s_waitcnt vmcnt(9)
    v_mfma_f32_16x16x32_bf16 v[80:83], a[0:3], v[152:155], 0
    v_mfma_f32_16x16x32_bf16 v[88:91], a[4:7], v[152:155], 0
    buffer_load_dwordx4 v[128:131], v21, s[4:7], s78 offen offset:0 sc1
    v_and_b32 v0, 7, v13
    v_mfma_f32_16x16x32_bf16 v[96:99], a[8:11], v[152:155], 0
    s_lshl_b32 s30, s14, 3
    v_add_u32 v0, s30, v0
    v_bfe_u32 v1, v13, 3, 1
    v_mfma_f32_16x16x32_bf16 v[104:107], a[12:15], v[152:155], 0
    s_waitcnt vmcnt(9)
    ds_write_b128 v5, v[52:55] offset:1024
    v_lshrrev_b32 v2, 4, v13
    v_mfma_f32_16x16x32_bf16 v[80:83], a[16:19], v[156:159], v[80:83]
    v_lshlrev_b32 v8, 10, v0
    v_lshl_add_u32 v8, v2, 5, v8
    v_mfma_f32_16x16x32_bf16 v[88:91], a[20:23], v[156:159], v[88:91]
    buffer_load_dwordx4 v[132:135], v16, s[4:7], s78 offen offset:1024 sc1
    v_lshl_add_u32 v8, v1, 4, v8
    v_mfma_f32_16x16x32_bf16 v[96:99], a[24:27], v[156:159], v[96:99]
    v_accvgpr_read_b32 v224, a240
    v_accvgpr_read_b32 v225, a241
    v_mfma_f32_16x16x32_bf16 v[104:107], a[28:31], v[156:159], v[104:107]
    s_waitcnt vmcnt(9)
    ds_write_b128 v5, v[60:63] offset:3072
    v_accvgpr_read_b32 v226, a242
    v_mfma_f32_16x16x32_bf16 v[80:83], a[32:35], v[160:163], v[80:83]
    v_accvgpr_read_b32 v227, a243
    v_accvgpr_read_b32 v228, a244
    v_mfma_f32_16x16x32_bf16 v[88:91], a[36:39], v[160:163], v[88:91]
    buffer_load_dwordx4 v[136:139], v16, s[4:7], s78 offen offset:3072 sc1
    v_accvgpr_read_b32 v229, a245
    v_mfma_f32_16x16x32_bf16 v[96:99], a[40:43], v[160:163], v[96:99]
    v_accvgpr_read_b32 v230, a246
    v_accvgpr_read_b32 v231, a247
    v_mfma_f32_16x16x32_bf16 v[104:107], a[44:47], v[160:163], v[104:107]
    s_waitcnt vmcnt(9)
    ds_write_b128 v5, v[68:71] offset:5120
    v_accvgpr_read_b32 v232, a248
    v_mfma_f32_16x16x32_bf16 v[80:83], a[48:51], v[164:167], v[80:83]
    v_accvgpr_read_b32 v233, a249
    v_accvgpr_read_b32 v234, a250
    v_mfma_f32_16x16x32_bf16 v[88:91], a[52:55], v[164:167], v[88:91]
    buffer_load_dwordx4 v[140:143], v17, s[4:7], s78 offen offset:1024 sc1
    v_accvgpr_read_b32 v235, a251
    v_mfma_f32_16x16x32_bf16 v[96:99], a[56:59], v[164:167], v[96:99]
    v_accvgpr_read_b32 v236, a252
    v_accvgpr_read_b32 v237, a253
    v_mfma_f32_16x16x32_bf16 v[104:107], a[60:63], v[164:167], v[104:107]
    s_waitcnt vmcnt(9)
    ds_write_b128 v5, v[76:79] offset:7168
    v_accvgpr_read_b32 v238, a254
    v_mfma_f32_16x16x32_bf16 v[80:83], a[64:67], v[168:171], v[80:83]
    v_accvgpr_read_b32 v239, a255
    v_mfma_f32_16x16x32_bf16 v[88:91], a[68:71], v[168:171], v[88:91]
    buffer_load_dwordx4 v[144:147], v17, s[4:7], s78 offen offset:3072 sc1
    v_mfma_f32_16x16x32_bf16 v[96:99], a[72:75], v[168:171], v[96:99]
    v_mfma_f32_16x16x32_bf16 v[104:107], a[76:79], v[168:171], v[104:107]
    s_waitcnt vmcnt(9) lgkmcnt(0)
    s_barrier
    v_mfma_f32_16x16x32_bf16 v[80:83], a[80:83], v[172:175], v[80:83]
    v_mfma_f32_16x16x32_bf16 v[88:91], a[84:87], v[172:175], v[88:91]
    buffer_load_dwordx4 v[148:151], v18, s[4:7], s78 offen offset:1024 sc1
    ds_read_b128 v[192:195], v6 offset:0
    v_mfma_f32_16x16x32_bf16 v[96:99], a[88:91], v[172:175], v[96:99]
    ds_read_b128 v[196:199], v6 offset:512
    v_mfma_f32_16x16x32_bf16 v[104:107], a[92:95], v[172:175], v[104:107]
    s_waitcnt vmcnt(9)
    ds_read_b128 v[200:203], v6 offset:8192
    ds_read_b128 v[204:207], v6 offset:8704
    v_mfma_f32_16x16x32_bf16 v[80:83], a[96:99], v[176:179], v[80:83]
    v_mfma_f32_16x16x32_bf16 v[88:91], a[100:103], v[176:179], v[88:91]
    buffer_load_dwordx4 v[152:155], v18, s[4:7], s78 offen offset:3072 sc1
    ds_read_b128 v[208:211], v6 offset:16384
    v_mfma_f32_16x16x32_bf16 v[96:99], a[104:107], v[176:179], v[96:99]
    ds_read_b128 v[212:215], v6 offset:16896
    v_mfma_f32_16x16x32_bf16 v[104:107], a[108:111], v[176:179], v[104:107]
    s_waitcnt vmcnt(9)
    ds_read_b128 v[216:219], v6 offset:24576
    ds_read_b128 v[220:223], v6 offset:25088
    v_mfma_f32_16x16x32_bf16 v[80:83], a[112:115], v[180:183], v[80:83]
    v_mfma_f32_16x16x32_bf16 v[88:91], a[116:119], v[180:183], v[88:91]
    s_waitcnt lgkmcnt(4)
    buffer_load_dwordx4 v[156:159], v19, s[4:7], s78 offen offset:1024 sc1
    v_add_f32 v224, v224, v192
    v_mfma_f32_16x16x32_bf16 v[96:99], a[120:123], v[180:183], v[96:99]
    v_add_f32 v225, v225, v193
    v_add_f32 v226, v226, v194
    v_mfma_f32_16x16x32_bf16 v[104:107], a[124:127], v[180:183], v[104:107]
    s_waitcnt vmcnt(9)
    v_add_f32 v227, v227, v195
    v_add_f32 v228, v228, v196
    v_mfma_f32_16x16x32_bf16 v[80:83], a[128:131], v[184:187], v[80:83]
    v_add_f32 v229, v229, v197
    v_add_f32 v230, v230, v198
    v_mfma_f32_16x16x32_bf16 v[88:91], a[132:135], v[184:187], v[88:91]
    buffer_load_dwordx4 v[160:163], v19, s[4:7], s78 offen offset:3072 sc1
    v_add_f32 v231, v231, v199
    v_mfma_f32_16x16x32_bf16 v[96:99], a[136:139], v[184:187], v[96:99]
    v_add_f32 v224, v224, v200
    v_add_f32 v225, v225, v201
    v_mfma_f32_16x16x32_bf16 v[104:107], a[140:143], v[184:187], v[104:107]
    s_waitcnt vmcnt(9)
    v_add_f32 v226, v226, v202
    v_add_f32 v227, v227, v203
    v_mfma_f32_16x16x32_bf16 v[80:83], a[144:147], v[188:191], v[80:83]
    v_add_f32 v228, v228, v204
    v_add_f32 v229, v229, v205
    v_mfma_f32_16x16x32_bf16 v[88:91], a[148:151], v[188:191], v[88:91]
    buffer_load_dwordx4 v[164:167], v20, s[4:7], s78 offen offset:1024 sc1
    v_add_f32 v230, v230, v206
    v_mfma_f32_16x16x32_bf16 v[96:99], a[152:155], v[188:191], v[96:99]
    v_add_f32 v231, v231, v207
    v_mfma_f32_16x16x32_bf16 v[104:107], a[156:159], v[188:191], v[104:107]
    s_waitcnt vmcnt(9) lgkmcnt(0)
    v_add_f32 v224, v224, v208
    v_add_f32 v225, v225, v209
    v_mfma_f32_16x16x32_bf16 v[80:83], a[160:163], v[128:131], v[80:83]
    v_add_f32 v226, v226, v210
    v_add_f32 v227, v227, v211
    v_mfma_f32_16x16x32_bf16 v[88:91], a[164:167], v[128:131], v[88:91]
    buffer_load_dwordx4 v[168:171], v20, s[4:7], s78 offen offset:3072 sc1
    v_add_f32 v228, v228, v212
    v_mfma_f32_16x16x32_bf16 v[96:99], a[168:171], v[128:131], v[96:99]
    v_add_f32 v229, v229, v213
    v_add_f32 v230, v230, v214
    v_mfma_f32_16x16x32_bf16 v[104:107], a[172:175], v[128:131], v[104:107]
    s_waitcnt vmcnt(9)
    v_add_f32 v231, v231, v215
    v_add_f32 v224, v224, v216
    v_mfma_f32_16x16x32_bf16 v[84:87], a[0:3], v[132:135], 0
    v_add_f32 v225, v225, v217
    v_add_f32 v226, v226, v218
    v_mfma_f32_16x16x32_bf16 v[92:95], a[4:7], v[132:135], 0
    buffer_load_dwordx4 v[172:175], v21, s[4:7], s78 offen offset:1024 sc1
    v_add_f32 v227, v227, v219
    v_mfma_f32_16x16x32_bf16 v[100:103], a[8:11], v[132:135], 0
    v_add_f32 v228, v228, v220
    v_add_f32 v229, v229, v221
    v_mfma_f32_16x16x32_bf16 v[108:111], a[12:15], v[132:135], 0
    s_waitcnt vmcnt(9)
    v_add_f32 v230, v230, v222
    v_add_f32 v231, v231, v223
    v_mfma_f32_16x16x32_bf16 v[84:87], a[16:19], v[136:139], v[84:87]
    v_cvt_pk_bf16_f32 v192, v224, v225
    v_cvt_pk_bf16_f32 v193, v226, v227
    v_mfma_f32_16x16x32_bf16 v[92:95], a[20:23], v[136:139], v[92:95]
    v_cvt_pk_bf16_f32 v194, v228, v229
    v_cvt_pk_bf16_f32 v195, v230, v231
    v_mfma_f32_16x16x32_bf16 v[100:103], a[24:27], v[136:139], v[100:103]
    v_mov_b32 v196, v192
    v_mov_b32 v197, v193
    v_mfma_f32_16x16x32_bf16 v[108:111], a[28:31], v[136:139], v[108:111]
    s_waitcnt vmcnt(8)
    v_mov_b32_dpp v192, v194 row_ror:8 row_mask:0xf bank_mask:0xc
    v_mov_b32_dpp v193, v195 row_ror:8 row_mask:0xf bank_mask:0xc
    v_mfma_f32_16x16x32_bf16 v[84:87], a[32:35], v[140:143], v[84:87]
    v_mov_b32_dpp v194, v196 row_ror:8 row_mask:0xf bank_mask:0x3
    v_mov_b32_dpp v195, v197 row_ror:8 row_mask:0xf bank_mask:0x3
    v_mfma_f32_16x16x32_bf16 v[92:95], a[36:39], v[140:143], v[92:95]
    buffer_store_dwordx4 v[192:195], v8, s[8:11], s85 offen
    v_mfma_f32_16x16x32_bf16 v[100:103], a[40:43], v[140:143], v[100:103]
    v_mfma_f32_16x16x32_bf16 v[108:111], a[44:47], v[140:143], v[108:111]
    s_waitcnt vmcnt(8)
    v_mfma_f32_16x16x32_bf16 v[84:87], a[48:51], v[144:147], v[84:87]
    v_mfma_f32_16x16x32_bf16 v[92:95], a[52:55], v[144:147], v[92:95]
    v_mfma_f32_16x16x32_bf16 v[100:103], a[56:59], v[144:147], v[100:103]
    v_mfma_f32_16x16x32_bf16 v[108:111], a[60:63], v[144:147], v[108:111]
    s_waitcnt vmcnt(7)
    v_mfma_f32_16x16x32_bf16 v[84:87], a[64:67], v[148:151], v[84:87]
    v_mfma_f32_16x16x32_bf16 v[92:95], a[68:71], v[148:151], v[92:95]
    ds_write_b128 v5, v[80:83] offset:32768
    v_mfma_f32_16x16x32_bf16 v[100:103], a[72:75], v[148:151], v[100:103]
    v_mfma_f32_16x16x32_bf16 v[108:111], a[76:79], v[148:151], v[108:111]
    s_waitcnt vmcnt(6)
    v_mfma_f32_16x16x32_bf16 v[84:87], a[80:83], v[152:155], v[84:87]
    v_mfma_f32_16x16x32_bf16 v[92:95], a[84:87], v[152:155], v[92:95]
    v_mfma_f32_16x16x32_bf16 v[100:103], a[88:91], v[152:155], v[100:103]
    v_mfma_f32_16x16x32_bf16 v[108:111], a[92:95], v[152:155], v[108:111]
    s_waitcnt vmcnt(5)
    ds_write_b128 v5, v[88:91] offset:34816
    v_mfma_f32_16x16x32_bf16 v[84:87], a[96:99], v[156:159], v[84:87]
    v_mfma_f32_16x16x32_bf16 v[92:95], a[100:103], v[156:159], v[92:95]
    v_mfma_f32_16x16x32_bf16 v[100:103], a[104:107], v[156:159], v[100:103]
    v_mfma_f32_16x16x32_bf16 v[108:111], a[108:111], v[156:159], v[108:111]
    s_waitcnt vmcnt(4)
    v_mfma_f32_16x16x32_bf16 v[84:87], a[112:115], v[160:163], v[84:87]
    v_mfma_f32_16x16x32_bf16 v[92:95], a[116:119], v[160:163], v[92:95]
    ds_write_b128 v5, v[96:99] offset:36864
    v_mfma_f32_16x16x32_bf16 v[100:103], a[120:123], v[160:163], v[100:103]
    v_mfma_f32_16x16x32_bf16 v[108:111], a[124:127], v[160:163], v[108:111]
    s_waitcnt vmcnt(3)
    v_mfma_f32_16x16x32_bf16 v[84:87], a[128:131], v[164:167], v[84:87]
    v_mfma_f32_16x16x32_bf16 v[92:95], a[132:135], v[164:167], v[92:95]
    v_mfma_f32_16x16x32_bf16 v[100:103], a[136:139], v[164:167], v[100:103]
    v_mfma_f32_16x16x32_bf16 v[108:111], a[140:143], v[164:167], v[108:111]
    s_waitcnt vmcnt(2)
    ds_write_b128 v5, v[104:107] offset:38912
    v_mfma_f32_16x16x32_bf16 v[84:87], a[144:147], v[168:171], v[84:87]
    v_mfma_f32_16x16x32_bf16 v[92:95], a[148:151], v[168:171], v[92:95]
    v_mfma_f32_16x16x32_bf16 v[100:103], a[152:155], v[168:171], v[100:103]
    v_mfma_f32_16x16x32_bf16 v[108:111], a[156:159], v[168:171], v[108:111]
    s_waitcnt vmcnt(1)
    v_mfma_f32_16x16x32_bf16 v[84:87], a[160:163], v[172:175], v[84:87]
    v_mfma_f32_16x16x32_bf16 v[92:95], a[164:167], v[172:175], v[92:95]
    v_mfma_f32_16x16x32_bf16 v[100:103], a[168:171], v[172:175], v[100:103]
    v_mfma_f32_16x16x32_bf16 v[108:111], a[172:175], v[172:175], v[108:111]
    s_lshl2_add_u32 s30, s13, s14
    s_cmp_lg_u32 s30, 127
    s_cbranch_scc1 EWB_297
    buffer_wbl2 sc1
EWB_297:
    s_nop 1
    ds_write_b128 v5, v[84:87] offset:33792
    ds_write_b128 v5, v[92:95] offset:35840
    ds_write_b128 v5, v[100:103] offset:37888
    ds_write_b128 v5, v[108:111] offset:39936
    s_waitcnt lgkmcnt(0)
    s_barrier
    ds_read_b128 v[192:195], v6 offset:32768
    ds_read_b128 v[196:199], v6 offset:33280
    ds_read_b128 v[200:203], v6 offset:40960
    ds_read_b128 v[204:207], v6 offset:41472
    ds_read_b128 v[208:211], v6 offset:49152
    ds_read_b128 v[212:215], v6 offset:49664
    ds_read_b128 v[216:219], v6 offset:57344
    ds_read_b128 v[220:223], v6 offset:57856
    s_waitcnt lgkmcnt(6)
    v_pk_add_f32 v[232:233], v[232:233], v[192:193]
    v_pk_add_f32 v[234:235], v[234:235], v[194:195]
    v_pk_add_f32 v[236:237], v[236:237], v[196:197]
    v_pk_add_f32 v[238:239], v[238:239], v[198:199]
    s_waitcnt lgkmcnt(4)
    v_pk_add_f32 v[232:233], v[232:233], v[200:201]
    v_pk_add_f32 v[234:235], v[234:235], v[202:203]
    v_pk_add_f32 v[236:237], v[236:237], v[204:205]
    v_pk_add_f32 v[238:239], v[238:239], v[206:207]
    s_waitcnt lgkmcnt(2)
    v_pk_add_f32 v[232:233], v[232:233], v[208:209]
    v_pk_add_f32 v[234:235], v[234:235], v[210:211]
    v_pk_add_f32 v[236:237], v[236:237], v[212:213]
    v_pk_add_f32 v[238:239], v[238:239], v[214:215]
    s_waitcnt lgkmcnt(0)
    v_pk_add_f32 v[232:233], v[232:233], v[216:217]
    v_pk_add_f32 v[234:235], v[234:235], v[218:219]
    v_pk_add_f32 v[236:237], v[236:237], v[220:221]
    v_pk_add_f32 v[238:239], v[238:239], v[222:223]
    v_cvt_pk_bf16_f32 v192, v232, v233
    v_cvt_pk_bf16_f32 v193, v234, v235
    v_cvt_pk_bf16_f32 v194, v236, v237
    v_cvt_pk_bf16_f32 v195, v238, v239
    v_mov_b32 v196, v192
    v_mov_b32 v197, v193
    v_mov_b32_dpp v192, v194 row_ror:8 row_mask:0xf bank_mask:0xc
    v_mov_b32_dpp v193, v195 row_ror:8 row_mask:0xf bank_mask:0xc
    v_mov_b32_dpp v194, v196 row_ror:8 row_mask:0xf bank_mask:0x3
    v_mov_b32_dpp v195, v197 row_ror:8 row_mask:0xf bank_mask:0x3
    buffer_store_dwordx4 v[192:195], v8, s[8:11], s86 offen
M_fin:
M_end:
    s_endpgm
M_hot:
ATTG00_0:
    v_mfma_f32_32x32x16_bf16 v[96:111], v[136:139], v[148:151], 0
    s_waitcnt lgkmcnt(0)
    buffer_load_dwordx4 a[152:155], v17, s[4:7], s1 offen offset:2048 sc1
    buffer_load_dwordx4 a[156:159], v17, s[4:7], s1 offen offset:3072 sc1
    buffer_load_dwordx4 a[160:163], v18, s[4:7], s1 offen offset:0 sc1
    buffer_load_dwordx4 a[164:167], v18, s[4:7], s1 offen offset:1024 sc1
    buffer_load_dwordx4 a[168:171], v18, s[4:7], s1 offen offset:2048 sc1
    buffer_load_dwordx4 a[172:175], v18, s[4:7], s1 offen offset:3072 sc1
    buffer_load_dwordx4 a[176:179], v16, s[4:7], s83 offen offset:0 sc1
    buffer_load_dwordx4 a[180:183], v16, s[4:7], s83 offen offset:1024 sc1
    buffer_load_dwordx4 a[184:187], v16, s[4:7], s83 offen offset:2048 sc1
    buffer_load_dwordx4 a[188:191], v16, s[4:7], s83 offen offset:3072 sc1
    buffer_load_dwordx4 a[192:195], v17, s[4:7], s83 offen offset:0 sc1
    buffer_load_dwordx4 a[196:199], v17, s[4:7], s83 offen offset:1024 sc1
    buffer_load_dwordx4 a[200:203], v17, s[4:7], s83 offen offset:2048 sc1
    buffer_load_dwordx4 a[204:207], v17, s[4:7], s83 offen offset:3072 sc1
    buffer_load_dwordx4 a[208:211], v18, s[4:7], s83 offen offset:0 sc1
    buffer_load_dwordx4 a[212:215], v18, s[4:7], s83 offen offset:1024 sc1
    buffer_load_dwordx4 a[216:219], v18, s[4:7], s83 offen offset:2048 sc1
    buffer_load_dwordx4 a[220:223], v18, s[4:7], s83 offen offset:3072 sc1
    buffer_load_dwordx4 a[224:227], v19, s[4:7], s83 offen offset:0 sc1
    buffer_load_dwordx4 a[228:231], v19, s[4:7], s83 offen offset:1024 sc1
    global_load_dword v246, v246, s[90:91]
    buffer_load_dwordx4 a[232:235], v19, s[4:7], s83 offen offset:2048 sc1
    buffer_load_dwordx4 a[236:239], v19, s[4:7], s83 offen offset:3072 sc1
    v_exp_f32 v112, v112
    v_exp_f32 v113, v113
    v_exp_f32 v114, v114
    v_exp_f32 v115, v115
    v_mfma_f32_32x32x16_bf16 v[208:223], v[68:71], v[132:135], v[208:223]
    s_mov_b64 exec, s[20:21]
    ds_read_b128 v[64:67], v251 offset:53248
    ds_read_b128 v[68:71], v251 offset:54272
    s_mov_b64 exec, -1
    v_cvt_pk_bf16_f32 v128, v112, v113
    v_exp_f32 v116, v116
    v_exp_f32 v117, v117
    v_cvt_pk_bf16_f32 v129, v114, v115
    v_exp_f32 v118, v118
    v_exp_f32 v119, v119
    v_exp_f32 v120, v120
    v_cvt_pk_bf16_f32 v130, v116, v117
    v_cvt_pk_bf16_f32 v131, v118, v119
    v_exp_f32 v121, v121
    v_exp_f32 v122, v122
    v_mfma_f32_32x32x16_bf16 v[208:223], v[72:75], v[128:131], v[208:223]
    v_exp_f32 v123, v123
    v_cvt_pk_bf16_f32 v132, v120, v121
    v_exp_f32 v124, v124
    v_exp_f32 v125, v125
    v_cvt_pk_bf16_f32 v133, v122, v123
    v_exp_f32 v126, v126
    v_exp_f32 v127, v127
    v_cvt_pk_bf16_f32 v134, v124, v125
    v_cvt_pk_bf16_f32 v135, v126, v127
    v_exp_f32 v96, v96
    v_exp_f32 v97, v97
    v_exp_f32 v98, v98
    v_exp_f32 v99, v99
    v_mfma_f32_32x32x16_bf16 v[208:223], v[76:79], v[132:135], v[208:223]
    v_cvt_pk_bf16_f32 v128, v96, v97
    v_exp_f32 v100, v100
    v_exp_f32 v101, v101
    v_cvt_pk_bf16_f32 v129, v98, v99
    v_exp_f32 v102, v102
    v_exp_f32 v103, v103
    v_exp_f32 v104, v104
    v_cvt_pk_bf16_f32 v130, v100, v101
    v_cvt_pk_bf16_f32 v131, v102, v103
    v_exp_f32 v105, v105
    v_exp_f32 v106, v106
    s_waitcnt lgkmcnt(0)
    v_mfma_f32_32x32x16_bf16 v[208:223], v[64:67], v[128:131], v[208:223]
    v_exp_f32 v107, v107
    v_cvt_pk_bf16_f32 v132, v104, v105
    v_exp_f32 v108, v108
    v_exp_f32 v109, v109
    v_cvt_pk_bf16_f32 v133, v106, v107
    v_exp_f32 v110, v110
    v_exp_f32 v111, v111
    v_cvt_pk_bf16_f32 v134, v108, v109
    v_cvt_pk_bf16_f32 v135, v110, v111
    s_nop 1
    v_mfma_f32_32x32x16_bf16 v[208:223], v[68:71], v[132:135], v[208:223]
    s_nop 11
    v_subrev_u32 v217, 0x2b800000, v216
    v_cmp_lt_u32 s[26:27], s87, v217
    s_nop 0
    s_cmp_lg_u64 s[26:27], 0
    s_cbranch_scc1 SLOW_20
BACK_21:
    v_rcp_f32 v217, v216
    s_nop 0
    v_mul_f32 v208, v208, v217
    v_mul_f32 v209, v209, v217
    v_cvt_pk_bf16_f32 v220, v208, v209
    v_mul_f32 v210, v210, v217
    v_mul_f32 v211, v211, v217
    v_cvt_pk_bf16_f32 v221, v210, v211
    v_mul_f32 v212, v212, v217
    v_mul_f32 v213, v213, v217
    v_cvt_pk_bf16_f32 v222, v212, v213
    v_mul_f32 v214, v214, v217
    v_mul_f32 v215, v215, v217
    v_cvt_pk_bf16_f32 v223, v214, v215
    buffer_store_dwordx4 v[220:223], v0, s[4:7], s54 offen
    s_waitcnt vmcnt(0)
    s_cbranch_vccnz SAFE_22
    buffer_store_dword v11, v10, s[4:7], s56 offen offset:0
BACK_23:
    buffer_load_dword v14, v15, s[4:7], s59 offen offset:0 sc1
    s_branch ATT0_done
ATTG00_1:
    v_mfma_f32_32x32x16_bf16 v[96:111], v[136:139], v[148:151], 0
    s_waitcnt lgkmcnt(0)
    buffer_load_dwordx4 a[152:155], v17, s[4:7], s1 offen offset:2048 sc1
    buffer_load_dwordx4 a[156:159], v17, s[4:7], s1 offen offset:3072 sc1
    buffer_load_dwordx4 a[160:163], v18, s[4:7], s1 offen offset:0 sc1
    buffer_load_dwordx4 a[164:167], v18, s[4:7], s1 offen offset:1024 sc1
    buffer_load_dwordx4 a[168:171], v18, s[4:7], s1 offen offset:2048 sc1
    buffer_load_dwordx4 a[172:175], v18, s[4:7], s1 offen offset:3072 sc1
    buffer_load_dwordx4 a[176:179], v16, s[4:7], s83 offen offset:0 sc1
    buffer_load_dwordx4 a[180:183], v16, s[4:7], s83 offen offset:1024 sc1
    buffer_load_dwordx4 a[184:187], v16, s[4:7], s83 offen offset:2048 sc1
    buffer_load_dwordx4 a[188:191], v16, s[4:7], s83 offen offset:3072 sc1
    buffer_load_dwordx4 a[192:195], v17, s[4:7], s83 offen offset:0 sc1
    buffer_load_dwordx4 a[196:199], v17, s[4:7], s83 offen offset:1024 sc1
    buffer_load_dwordx4 a[200:203], v17, s[4:7], s83 offen offset:2048 sc1
    buffer_load_dwordx4 a[204:207], v17, s[4:7], s83 offen offset:3072 sc1
    buffer_load_dwordx4 a[208:211], v18, s[4:7], s83 offen offset:0 sc1
    buffer_load_dwordx4 a[212:215], v18, s[4:7], s83 offen offset:1024 sc1
    buffer_load_dwordx4 a[216:219], v18, s[4:7], s83 offen offset:2048 sc1
    buffer_load_dwordx4 a[220:223], v18, s[4:7], s83 offen offset:3072 sc1
    buffer_load_dwordx4 a[224:227], v19, s[4:7], s83 offen offset:0 sc1
    buffer_load_dwordx4 a[228:231], v19, s[4:7], s83 offen offset:1024 sc1
    global_load_dword v246, v246, s[90:91]
    buffer_load_dwordx4 a[232:235], v19, s[4:7], s83 offen offset:2048 sc1
    buffer_load_dwordx4 a[236:239], v19, s[4:7], s83 offen offset:3072 sc1
    v_exp_f32 v112, v112
    v_exp_f32 v113, v113
    v_exp_f32 v114, v114
    v_exp_f32 v115, v115
    v_mfma_f32_32x32x16_bf16 v[208:223], v[68:71], v[132:135], v[208:223]
    s_mov_b64 exec, s[20:21]
    ds_read_b128 v[64:67], v251 offset:53248
    ds_read_b128 v[68:71], v251 offset:54272
    s_mov_b64 exec, -1
    v_cvt_pk_bf16_f32 v128, v112, v113
    v_exp_f32 v116, v116
    v_exp_f32 v117, v117
    v_cvt_pk_bf16_f32 v129, v114, v115
    v_exp_f32 v118, v118
    v_exp_f32 v119, v119
    v_exp_f32 v120, v120
    v_cvt_pk_bf16_f32 v130, v116, v117
    v_cvt_pk_bf16_f32 v131, v118, v119
    v_exp_f32 v121, v121
    v_exp_f32 v122, v122
    v_mfma_f32_32x32x16_bf16 v[208:223], v[72:75], v[128:131], v[208:223]
    v_exp_f32 v123, v123
    v_cvt_pk_bf16_f32 v132, v120, v121
    v_exp_f32 v124, v124
    v_exp_f32 v125, v125
    v_cvt_pk_bf16_f32 v133, v122, v123
    v_exp_f32 v126, v126
    v_exp_f32 v127, v127
    v_cvt_pk_bf16_f32 v134, v124, v125
    v_cvt_pk_bf16_f32 v135, v126, v127
    v_exp_f32 v96, v96
    v_exp_f32 v97, v97
    v_exp_f32 v98, v98
    v_exp_f32 v99, v99
    v_mfma_f32_32x32x16_bf16 v[208:223], v[76:79], v[132:135], v[208:223]
    v_cvt_pk_bf16_f32 v128, v96, v97
    v_exp_f32 v100, v100
    v_exp_f32 v101, v101
    v_cvt_pk_bf16_f32 v129, v98, v99
    v_exp_f32 v102, v102
    v_exp_f32 v103, v103
    v_exp_f32 v104, v104
    v_cvt_pk_bf16_f32 v130, v100, v101
    v_cvt_pk_bf16_f32 v131, v102, v103
    v_exp_f32 v105, v105
    v_exp_f32 v106, v106
    s_waitcnt lgkmcnt(0)
    v_mfma_f32_32x32x16_bf16 v[208:223], v[64:67], v[128:131], v[208:223]
    v_exp_f32 v107, v107
    v_cvt_pk_bf16_f32 v132, v104, v105
    v_exp_f32 v108, v108
    v_exp_f32 v109, v109
    v_cvt_pk_bf16_f32 v133, v106, v107
    v_exp_f32 v110, v110
    v_exp_f32 v111, v111
    v_cvt_pk_bf16_f32 v134, v108, v109
    v_cvt_pk_bf16_f32 v135, v110, v111
    s_nop 1
    v_mfma_f32_32x32x16_bf16 v[208:223], v[68:71], v[132:135], v[208:223]
    s_nop 11
    v_subrev_u32 v217, 0x2b800000, v216
    v_cmp_lt_u32 s[26:27], s87, v217
    s_nop 0
    s_cmp_lg_u64 s[26:27], 0
    s_cbranch_scc1 SLOW_42
BACK_43:
    v_rcp_f32 v217, v216
    s_nop 0
    v_mul_f32 v208, v208, v217
    v_mul_f32 v209, v209, v217
    v_cvt_pk_bf16_f32 v220, v208, v209
    v_mul_f32 v210, v210, v217
    v_mul_f32 v211, v211, v217
    v_cvt_pk_bf16_f32 v221, v210, v211
    v_mul_f32 v212, v212, v217
    v_mul_f32 v213, v213, v217
    v_cvt_pk_bf16_f32 v222, v212, v213
    v_mul_f32 v214, v214, v217
    v_mul_f32 v215, v215, v217
    v_cvt_pk_bf16_f32 v223, v214, v215
    buffer_store_dwordx4 v[220:223], v0, s[4:7], s54 offen
    s_waitcnt vmcnt(0)
    s_cbranch_vccnz SAFE_44
    buffer_store_dword v11, v10, s[4:7], s56 offen offset:0
BACK_45:
    buffer_load_dword v14, v15, s[4:7], s59 offen offset:0 sc1
    s_branch ATT0_done
ATTG00_2:
    v_mfma_f32_32x32x16_bf16 v[96:111], v[136:139], v[144:147], 0
    s_waitcnt lgkmcnt(0)
    buffer_load_dwordx4 a[152:155], v17, s[4:7], s1 offen offset:2048 sc1
    buffer_load_dwordx4 a[156:159], v17, s[4:7], s1 offen offset:3072 sc1
    buffer_load_dwordx4 a[160:163], v18, s[4:7], s1 offen offset:0 sc1
    buffer_load_dwordx4 a[164:167], v18, s[4:7], s1 offen offset:1024 sc1
    buffer_load_dwordx4 a[168:171], v18, s[4:7], s1 offen offset:2048 sc1
    buffer_load_dwordx4 a[172:175], v18, s[4:7], s1 offen offset:3072 sc1
    buffer_load_dwordx4 a[176:179], v16, s[4:7], s83 offen offset:0 sc1
    buffer_load_dwordx4 a[180:183], v16, s[4:7], s83 offen offset:1024 sc1
    buffer_load_dwordx4 a[184:187], v16, s[4:7], s83 offen offset:2048 sc1
    buffer_load_dwordx4 a[188:191], v16, s[4:7], s83 offen offset:3072 sc1
    buffer_load_dwordx4 a[192:195], v17, s[4:7], s83 offen offset:0 sc1
    buffer_load_dwordx4 a[196:199], v17, s[4:7], s83 offen offset:1024 sc1
    buffer_load_dwordx4 a[200:203], v17, s[4:7], s83 offen offset:2048 sc1
    buffer_load_dwordx4 a[204:207], v17, s[4:7], s83 offen offset:3072 sc1
    buffer_load_dwordx4 a[208:211], v18, s[4:7], s83 offen offset:0 sc1
    buffer_load_dwordx4 a[212:215], v18, s[4:7], s83 offen offset:1024 sc1
    buffer_load_dwordx4 a[216:219], v18, s[4:7], s83 offen offset:2048 sc1
    buffer_load_dwordx4 a[220:223], v18, s[4:7], s83 offen offset:3072 sc1
    buffer_load_dwordx4 a[224:227], v19, s[4:7], s83 offen offset:0 sc1
    buffer_load_dwordx4 a[228:231], v19, s[4:7], s83 offen offset:1024 sc1
    global_load_dword v246, v246, s[90:91]
    buffer_load_dwordx4 a[232:235], v19, s[4:7], s83 offen offset:2048 sc1
    buffer_load_dwordx4 a[236:239], v19, s[4:7], s83 offen offset:3072 sc1
    v_exp_f32 v112, v112
    v_exp_f32 v113, v113
    v_exp_f32 v114, v114
    v_exp_f32 v115, v115
    v_mfma_f32_32x32x16_bf16 v[208:223], v[68:71], v[132:135], v[208:223]
    s_mov_b64 exec, s[20:21]
    ds_read_b128 v[64:67], v250 offset:36864
    ds_read_b128 v[68:71], v250 offset:37888
    s_mov_b64 exec, -1
    v_cvt_pk_bf16_f32 v128, v112, v113
    v_exp_f32 v116, v116
    v_exp_f32 v117, v117
    v_cvt_pk_bf16_f32 v129, v114, v115
    v_exp_f32 v118, v118
    v_exp_f32 v119, v119
    v_exp_f32 v120, v120
    v_cvt_pk_bf16_f32 v130, v116, v117
    v_cvt_pk_bf16_f32 v131, v118, v119
    v_exp_f32 v121, v121
    v_exp_f32 v122, v122
    v_mfma_f32_32x32x16_bf16 v[192:207], v[72:75], v[128:131], v[192:207]
    v_exp_f32 v123, v123
    v_cvt_pk_bf16_f32 v132, v120, v121
    v_exp_f32 v124, v124
    v_exp_f32 v125, v125
    v_cvt_pk_bf16_f32 v133, v122, v123
    v_exp_f32 v126, v126
    v_exp_f32 v127, v127
    v_cvt_pk_bf16_f32 v134, v124, v125
    v_cvt_pk_bf16_f32 v135, v126, v127
    v_exp_f32 v96, v96
    v_exp_f32 v97, v97
    v_exp_f32 v98, v98
    v_exp_f32 v99, v99
    v_mfma_f32_32x32x16_bf16 v[192:207], v[76:79], v[132:135], v[192:207]
    v_cvt_pk_bf16_f32 v128, v96, v97
    v_exp_f32 v100, v100
    v_exp_f32 v101, v101
    v_cvt_pk_bf16_f32 v129, v98, v99
    v_exp_f32 v102, v102
    v_exp_f32 v103, v103
    v_exp_f32 v104, v104
    v_cvt_pk_bf16_f32 v130, v100, v101
    v_cvt_pk_bf16_f32 v131, v102, v103
    v_exp_f32 v105, v105
    v_exp_f32 v106, v106
    s_waitcnt lgkmcnt(0)
    v_mfma_f32_32x32x16_bf16 v[192:207], v[64:67], v[128:131], v[192:207]
    v_exp_f32 v107, v107
    v_cvt_pk_bf16_f32 v132, v104, v105
    v_exp_f32 v108, v108
    v_exp_f32 v109, v109
    v_cvt_pk_bf16_f32 v133, v106, v107
    v_exp_f32 v110, v110
    v_exp_f32 v111, v111
    v_cvt_pk_bf16_f32 v134, v108, v109
    v_cvt_pk_bf16_f32 v135, v110, v111
    s_nop 1
    v_mfma_f32_32x32x16_bf16 v[192:207], v[68:71], v[132:135], v[192:207]
    v_subrev_u32 v217, 0x2b800000, v216
    v_cmp_lt_u32 s[26:27], s87, v217
    s_nop 0
    s_cmp_lg_u64 s[26:27], 0
    s_cbranch_scc1 SLOW_64
BACK_65:
    v_rcp_f32 v217, v216
    s_nop 0
    v_mul_f32 v208, v208, v217
    v_mul_f32 v209, v209, v217
    v_cvt_pk_bf16_f32 v220, v208, v209
    v_mul_f32 v210, v210, v217
    v_mul_f32 v211, v211, v217
    v_cvt_pk_bf16_f32 v221, v210, v211
    v_mul_f32 v212, v212, v217
    v_mul_f32 v213, v213, v217
    v_cvt_pk_bf16_f32 v222, v212, v213
    v_mul_f32 v214, v214, v217
    v_mul_f32 v215, v215, v217
    v_cvt_pk_bf16_f32 v223, v214, v215
    buffer_store_dwordx4 v[220:223], v0, s[4:7], s54 offen
    s_waitcnt vmcnt(0)
    s_cbranch_vccnz SAFE_66
    buffer_store_dword v11, v10, s[4:7], s56 offen offset:0
BACK_67:
    buffer_load_dword v14, v15, s[4:7], s59 offen offset:0 sc1
    s_branch ATT0_done
ATTG00_3:
    v_mfma_f32_32x32x16_bf16 v[96:111], v[136:139], v[144:147], 0
    s_waitcnt lgkmcnt(0)
    buffer_load_dwordx4 a[152:155], v17, s[4:7], s1 offen offset:2048 sc1
    buffer_load_dwordx4 a[156:159], v17, s[4:7], s1 offen offset:3072 sc1
    buffer_load_dwordx4 a[160:163], v18, s[4:7], s1 offen offset:0 sc1
    buffer_load_dwordx4 a[164:167], v18, s[4:7], s1 offen offset:1024 sc1
    buffer_load_dwordx4 a[168:171], v18, s[4:7], s1 offen offset:2048 sc1
    buffer_load_dwordx4 a[172:175], v18, s[4:7], s1 offen offset:3072 sc1
    buffer_load_dwordx4 a[176:179], v16, s[4:7], s83 offen offset:0 sc1
    buffer_load_dwordx4 a[180:183], v16, s[4:7], s83 offen offset:1024 sc1
    buffer_load_dwordx4 a[184:187], v16, s[4:7], s83 offen offset:2048 sc1
    buffer_load_dwordx4 a[188:191], v16, s[4:7], s83 offen offset:3072 sc1
    buffer_load_dwordx4 a[192:195], v17, s[4:7], s83 offen offset:0 sc1
    buffer_load_dwordx4 a[196:199], v17, s[4:7], s83 offen offset:1024 sc1
    buffer_load_dwordx4 a[200:203], v17, s[4:7], s83 offen offset:2048 sc1
    buffer_load_dwordx4 a[204:207], v17, s[4:7], s83 offen offset:3072 sc1
    buffer_load_dwordx4 a[208:211], v18, s[4:7], s83 offen offset:0 sc1
    buffer_load_dwordx4 a[212:215], v18, s[4:7], s83 offen offset:1024 sc1
    buffer_load_dwordx4 a[216:219], v18, s[4:7], s83 offen offset:2048 sc1
    buffer_load_dwordx4 a[220:223], v18, s[4:7], s83 offen offset:3072 sc1
    buffer_load_dwordx4 a[224:227], v19, s[4:7], s83 offen offset:0 sc1
    buffer_load_dwordx4 a[228:231], v19, s[4:7], s83 offen offset:1024 sc1
    global_load_dword v246, v246, s[90:91]
    buffer_load_dwordx4 a[232:235], v19, s[4:7], s83 offen offset:2048 sc1
    buffer_load_dwordx4 a[236:239], v19, s[4:7], s83 offen offset:3072 sc1
    v_exp_f32 v112, v112
    v_exp_f32 v113, v113
    v_exp_f32 v114, v114
    v_exp_f32 v115, v115
    v_mfma_f32_32x32x16_bf16 v[208:223], v[68:71], v[132:135], v[208:223]
    s_mov_b64 exec, s[20:21]
    ds_read_b128 v[64:67], v250 offset:36864
    ds_read_b128 v[68:71], v250 offset:37888
    s_mov_b64 exec, -1
    v_cvt_pk_bf16_f32 v128, v112, v113
    v_exp_f32 v116, v116
    v_exp_f32 v117, v117
    v_cvt_pk_bf16_f32 v129, v114, v115
    v_exp_f32 v118, v118
    v_exp_f32 v119, v119
    v_exp_f32 v120, v120
    v_cvt_pk_bf16_f32 v130, v116, v117
    v_cvt_pk_bf16_f32 v131, v118, v119
    v_exp_f32 v121, v121
    v_exp_f32 v122, v122
    v_mfma_f32_32x32x16_bf16 v[192:207], v[72:75], v[128:131], v[192:207]
    v_exp_f32 v123, v123
    v_cvt_pk_bf16_f32 v132, v120, v121
    v_exp_f32 v124, v124
    v_exp_f32 v125, v125
    v_cvt_pk_bf16_f32 v133, v122, v123
    v_exp_f32 v126, v126
    v_exp_f32 v127, v127
    v_cvt_pk_bf16_f32 v134, v124, v125
    v_cvt_pk_bf16_f32 v135, v126, v127
    v_exp_f32 v96, v96
    v_exp_f32 v97, v97
    v_exp_f32 v98, v98
    v_exp_f32 v99, v99
    v_mfma_f32_32x32x16_bf16 v[192:207], v[76:79], v[132:135], v[192:207]
    v_cvt_pk_bf16_f32 v128, v96, v97
    v_exp_f32 v100, v100
    v_exp_f32 v101, v101
    v_cvt_pk_bf16_f32 v129, v98, v99
    v_exp_f32 v102, v102
    v_exp_f32 v103, v103
    v_exp_f32 v104, v104
    v_cvt_pk_bf16_f32 v130, v100, v101
    v_cvt_pk_bf16_f32 v131, v102, v103
    v_exp_f32 v105, v105
    v_exp_f32 v106, v106
    s_waitcnt lgkmcnt(0)
    v_mfma_f32_32x32x16_bf16 v[192:207], v[64:67], v[128:131], v[192:207]
    v_exp_f32 v107, v107
    v_cvt_pk_bf16_f32 v132, v104, v105
    v_exp_f32 v108, v108
    v_exp_f32 v109, v109
    v_cvt_pk_bf16_f32 v133, v106, v107
    v_exp_f32 v110, v110
    v_exp_f32 v111, v111
    v_cvt_pk_bf16_f32 v134, v108, v109
    v_cvt_pk_bf16_f32 v135, v110, v111
    s_nop 1
    v_mfma_f32_32x32x16_bf16 v[192:207], v[68:71], v[132:135], v[192:207]
    v_subrev_u32 v217, 0x2b800000, v216
    v_cmp_lt_u32 s[26:27], s87, v217
    s_nop 0
    s_cmp_lg_u64 s[26:27], 0
    s_cbranch_scc1 SLOW_86
BACK_87:
    v_rcp_f32 v217, v216
    s_nop 0
    v_mul_f32 v208, v208, v217
    v_mul_f32 v209, v209, v217
    v_cvt_pk_bf16_f32 v220, v208, v209
    v_mul_f32 v210, v210, v217
    v_mul_f32 v211, v211, v217
    v_cvt_pk_bf16_f32 v221, v210, v211
    v_mul_f32 v212, v212, v217
    v_mul_f32 v213, v213, v217
    v_cvt_pk_bf16_f32 v222, v212, v213
    v_mul_f32 v214, v214, v217
    v_mul_f32 v215, v215, v217
    v_cvt_pk_bf16_f32 v223, v214, v215
    buffer_store_dwordx4 v[220:223], v0, s[4:7], s54 offen
    s_waitcnt vmcnt(0)
    s_cbranch_vccnz SAFE_88
    buffer_store_dword v11, v10, s[4:7], s56 offen offset:0
BACK_89:
    buffer_load_dword v14, v15, s[4:7], s59 offen offset:0 sc1
    s_branch ATT0_done
C0_2:
    s_nop 7
    v_accvgpr_read_b32 v224, a248
    v_accvgpr_read_b32 v225, a249
    v_accvgpr_read_b32 v226, a250
    v_accvgpr_read_b32 v227, a251
    v_accvgpr_read_b32 v228, a252
    v_accvgpr_read_b32 v229, a253
    v_accvgpr_read_b32 v230, a254
    v_accvgpr_read_b32 v231, a255
    ds_write_b128 v5, v[132:135] offset:33792
    ds_write_b128 v5, v[140:143] offset:35840
    ds_write_b128 v5, v[148:151] offset:37888
    ds_write_b128 v5, v[156:159] offset:39936
    s_waitcnt vmcnt(0)
    v_cmp_gt_u32 vcc, s34, v14
    s_cbranch_vccz BACK_126
SPIN_125:
    buffer_load_dword v14, v9, s[4:7], s71 offen offset:1024 sc1
    s_sub_u32 s16, s16, 1
    s_cbranch_scc1 M_end
    s_waitcnt vmcnt(0)
    v_cmp_gt_u32 vcc, 1, v14
    s_cbranch_vccnz SPIN_125
    s_cmp_lg_u32 s15, 0
    s_cbranch_scc1 SPIN2_127
BACK_126:
    buffer_load_dwordx4 v[32:35], v240, s[8:11], s67 offen offset:0 sc1
    buffer_load_dwordx4 v[36:39], v240, s[8:11], s67 offen offset:1024 sc1
    buffer_load_dwordx4 v[40:43], v240, s[8:11], s67 offen offset:2048 sc1
    buffer_load_dwordx4 v[44:47], v240, s[8:11], s67 offen offset:3072 sc1
    ds_read_b128 v[80:83], v248 offset:0
    ds_read_b128 v[84:87], v248 offset:1024
    ds_read_b128 v[88:91], v248 offset:256
    ds_read_b128 v[92:95], v248 offset:1280
    ds_read_b128 v[96:99], v248 offset:6144
    ds_read_b128 v[100:103], v248 offset:7168
    s_waitcnt lgkmcnt(6)
    s_barrier
    s_waitcnt vmcnt(2) lgkmcnt(5)
    v_mfma_f32_16x16x32_bf16 v[144:147], v[80:83], v[32:35], 0
    v_mfma_f32_16x16x32_bf16 v[148:151], v[80:83], v[36:39], 0
    s_waitcnt lgkmcnt(4)
    ds_read_b128 v[80:83], v248 offset:6400
    buffer_load_dwordx4 v[48:51], v241, s[8:11], s67 offen offset:0 sc1
    v_mfma_f32_16x16x32_bf16 v[160:163], v[84:87], v[32:35], 0
    ds_read_b128 v[192:195], v6 offset:32768
    ds_read_b128 v[196:199], v6 offset:33280
    v_mfma_f32_16x16x32_bf16 v[164:167], v[84:87], v[36:39], 0
    s_waitcnt lgkmcnt(6)
    ds_read_b128 v[84:87], v248 offset:7424
    buffer_load_dwordx4 v[52:55], v241, s[8:11], s67 offen offset:1024 sc1
    v_mfma_f32_16x16x32_bf16 v[152:155], v[88:91], v[32:35], 0
    ds_read_b128 v[200:203], v6 offset:40960
    ds_read_b128 v[204:207], v6 offset:41472
    v_mfma_f32_16x16x32_bf16 v[156:159], v[88:91], v[36:39], 0
    s_waitcnt lgkmcnt(8)
    ds_read_b128 v[88:91], v248 offset:12288
    ds_read_b128 v[208:211], v6 offset:49152
    v_mfma_f32_16x16x32_bf16 v[168:171], v[92:95], v[32:35], 0
    ds_read_b128 v[212:215], v6 offset:49664
    v_mfma_f32_16x16x32_bf16 v[172:175], v[92:95], v[36:39], 0
    s_waitcnt vmcnt(2) lgkmcnt(10)
    ds_read_b128 v[92:95], v248 offset:13312
    buffer_load_dwordx4 v[56:59], v241, s[8:11], s67 offen offset:2048 sc1
    v_mfma_f32_16x16x32_bf16 v[144:147], v[96:99], v[40:43], v[144:147]
    ds_read_b128 v[216:219], v6 offset:57344
    ds_read_b128 v[220:223], v6 offset:57856
    v_mfma_f32_16x16x32_bf16 v[148:151], v[96:99], v[44:47], v[148:151]
    s_waitcnt lgkmcnt(12)
    ds_read_b128 v[96:99], v248 offset:12544
    v_mfma_f32_16x16x32_bf16 v[160:163], v[100:103], v[40:43], v[160:163]
    v_mfma_f32_16x16x32_bf16 v[164:167], v[100:103], v[44:47], v[164:167]
    s_waitcnt lgkmcnt(7)
    ds_read_b128 v[100:103], v248 offset:13568
    buffer_load_dwordx4 v[60:63], v241, s[8:11], s67 offen offset:3072 sc1
    v_mfma_f32_16x16x32_bf16 v[152:155], v[80:83], v[40:43], v[152:155]
    v_add_f32 v224, v224, v192
    v_add_f32 v225, v225, v193
    v_mfma_f32_16x16x32_bf16 v[156:159], v[80:83], v[44:47], v[156:159]
    ds_read_b128 v[80:83], v248 offset:18432
    buffer_load_dwordx4 v[64:67], v242, s[8:11], s67 offen offset:0 sc1
    v_mfma_f32_16x16x32_bf16 v[168:171], v[84:87], v[40:43], v[168:171]
    v_add_f32 v226, v226, v194
    v_add_f32 v227, v227, v195
    v_mfma_f32_16x16x32_bf16 v[172:175], v[84:87], v[44:47], v[172:175]
    s_waitcnt vmcnt(3) lgkmcnt(8)
    ds_read_b128 v[84:87], v248 offset:19456
    v_add_f32 v228, v228, v196
    v_mfma_f32_16x16x32_bf16 v[144:147], v[88:91], v[48:51], v[144:147]
    v_add_f32 v229, v229, v197
    v_add_f32 v230, v230, v198
    v_mfma_f32_16x16x32_bf16 v[148:151], v[88:91], v[52:55], v[148:151]
    s_waitcnt lgkmcnt(6)
    ds_read_b128 v[88:91], v248 offset:18688
    buffer_load_dwordx4 v[68:71], v242, s[8:11], s67 offen offset:1024 sc1
    v_mfma_f32_16x16x32_bf16 v[160:163], v[92:95], v[48:51], v[160:163]
    v_add_f32 v231, v231, v199
    v_add_f32 v224, v224, v200
    v_mfma_f32_16x16x32_bf16 v[164:167], v[92:95], v[52:55], v[164:167]
    s_waitcnt lgkmcnt(4)
    ds_read_b128 v[92:95], v248 offset:19712
    v_add_f32 v225, v225, v201
    v_mfma_f32_16x16x32_bf16 v[152:155], v[96:99], v[48:51], v[152:155]
    v_add_f32 v226, v226, v202
    v_add_f32 v227, v227, v203
    v_mfma_f32_16x16x32_bf16 v[156:159], v[96:99], v[52:55], v[156:159]
    s_waitcnt lgkmcnt(4)
    ds_read_b128 v[96:99], v248 offset:24576
    buffer_load_dwordx4 v[72:75], v242, s[8:11], s67 offen offset:2048 sc1
    v_mfma_f32_16x16x32_bf16 v[168:171], v[100:103], v[48:51], v[168:171]
    v_add_f32 v228, v228, v204
    v_add_f32 v229, v229, v205
    v_mfma_f32_16x16x32_bf16 v[172:175], v[100:103], v[52:55], v[172:175]
    s_waitcnt vmcnt(3) lgkmcnt(4)
    ds_read_b128 v[100:103], v248 offset:25600
    buffer_load_dwordx4 v[76:79], v242, s[8:11], s67 offen offset:3072 sc1
    v_mfma_f32_16x16x32_bf16 v[144:147], v[80:83], v[56:59], v[144:147]
    v_add_f32 v230, v230, v206
    v_add_f32 v231, v231, v207
    v_mfma_f32_16x16x32_bf16 v[148:151], v[80:83], v[60:63], v[148:151]
    s_waitcnt lgkmcnt(4)
    ds_read_b128 v[80:83], v248 offset:24832
    v_add_f32 v224, v224, v208
    v_mfma_f32_16x16x32_bf16 v[160:163], v[84:87], v[56:59], v[160:163]
    v_add_f32 v225, v225, v209
    v_add_f32 v226, v226, v210
    v_mfma_f32_16x16x32_bf16 v[164:167], v[84:87], v[60:63], v[164:167]
    s_waitcnt lgkmcnt(4)
    ds_read_b128 v[84:87], v248 offset:25856
    buffer_load_dwordx4 v[32:35], v243, s[8:11], s67 offen offset:0 sc1
    v_mfma_f32_16x16x32_bf16 v[152:155], v[88:91], v[56:59], v[152:155]
    v_add_f32 v227, v227, v211
    v_add_f32 v228, v228, v212
    v_mfma_f32_16x16x32_bf16 v[156:159], v[88:91], v[60:63], v[156:159]
    s_waitcnt lgkmcnt(4)
    ds_read_b128 v[88:91], v248 offset:30720
    v_add_f32 v229, v229, v213
    v_mfma_f32_16x16x32_bf16 v[168:171], v[92:95], v[56:59], v[168:171]
    v_add_f32 v230, v230, v214
    v_add_f32 v231, v231, v215
    v_mfma_f32_16x16x32_bf16 v[172:175], v[92:95], v[60:63], v[172:175]
    s_waitcnt vmcnt(3) lgkmcnt(4)
    ds_read_b128 v[92:95], v248 offset:31744
    buffer_load_dwordx4 v[36:39], v243, s[8:11], s67 offen offset:1024 sc1
    v_mfma_f32_16x16x32_bf16 v[144:147], v[96:99], v[64:67], v[144:147]
    v_add_f32 v224, v224, v216
    v_add_f32 v225, v225, v217
    v_mfma_f32_16x16x32_bf16 v[148:151], v[96:99], v[68:71], v[148:151]
    s_waitcnt lgkmcnt(4)
    ds_read_b128 v[96:99], v248 offset:30976
    buffer_load_dwordx4 v[40:43], v243, s[8:11], s67 offen offset:2048 sc1
    v_mfma_f32_16x16x32_bf16 v[160:163], v[100:103], v[64:67], v[160:163]
    v_add_f32 v226, v226, v218
    v_add_f32 v227, v227, v219
    v_mfma_f32_16x16x32_bf16 v[164:167], v[100:103], v[68:71], v[164:167]
    s_waitcnt lgkmcnt(4)
    ds_read_b128 v[100:103], v248 offset:32000
    v_add_f32 v228, v228, v220
    v_mfma_f32_16x16x32_bf16 v[152:155], v[80:83], v[64:67], v[152:155]
    v_add_f32 v229, v229, v221
    v_add_f32 v230, v230, v222
    v_mfma_f32_16x16x32_bf16 v[156:159], v[80:83], v[68:71], v[156:159]
    s_waitcnt lgkmcnt(4)
    ds_read_b128 v[80:83], v248 offset:36864
    buffer_load_dwordx4 v[44:47], v243, s[8:11], s67 offen offset:3072 sc1
    v_mfma_f32_16x16x32_bf16 v[168:171], v[84:87], v[64:67], v[168:171]
    v_add_f32 v231, v231, v223
    v_cvt_pk_bf16_f32 v192, v224, v225
    v_mfma_f32_16x16x32_bf16 v[172:175], v[84:87], v[68:71], v[172:175]
    s_waitcnt vmcnt(4) lgkmcnt(4)
    ds_read_b128 v[84:87], v248 offset:37888
    v_cvt_pk_bf16_f32 v193, v226, v227
    v_mfma_f32_16x16x32_bf16 v[144:147], v[88:91], v[72:75], v[144:147]
    v_cvt_pk_bf16_f32 v194, v228, v229
    v_cvt_pk_bf16_f32 v195, v230, v231
    v_mfma_f32_16x16x32_bf16 v[148:151], v[88:91], v[76:79], v[148:151]
    s_waitcnt lgkmcnt(4)
    ds_read_b128 v[88:91], v248 offset:37120
    buffer_load_dwordx4 v[48:51], v244, s[8:11], s67 offen offset:0 sc1
    v_mfma_f32_16x16x32_bf16 v[160:163], v[92:95], v[72:75], v[160:163]
    buffer_store_dwordx4 v[192:195], v7, s[8:11], s62 offen
    v_dot2_f32_bf16 v196, v192, s36, 0
    v_dot2_f32_bf16 v197, v192, v192, 0
    v_dot2_f32_bf16 v196, v193, s36, v196
    v_dot2_f32_bf16 v197, v193, v193, v197
    v_dot2_f32_bf16 v196, v194, s36, v196
    v_dot2_f32_bf16 v197, v194, v194, v197
    v_dot2_f32_bf16 v196, v195, s36, v196
    v_dot2_f32_bf16 v197, v195, v195, v197
    v_mfma_f32_16x16x32_bf16 v[164:167], v[92:95], v[76:79], v[164:167]
    s_waitcnt lgkmcnt(4)
    ds_read_b128 v[92:95], v248 offset:38144
    v_accvgpr_write_b32 a248, v224
    v_mfma_f32_16x16x32_bf16 v[152:155], v[96:99], v[72:75], v[152:155]
    v_accvgpr_write_b32 a249, v225
    v_accvgpr_write_b32 a250, v226
    v_mfma_f32_16x16x32_bf16 v[156:159], v[96:99], v[76:79], v[156:159]
    s_waitcnt lgkmcnt(4)
    ds_read_b128 v[96:99], v248 offset:43008
    buffer_load_dwordx4 v[52:55], v244, s[8:11], s67 offen offset:1024 sc1
    v_mfma_f32_16x16x32_bf16 v[168:171], v[100:103], v[72:75], v[168:171]
    v_permlane16_swap_b32 v196, v197
    v_add_f32 v196, v196, v197
    v_mfma_f32_16x16x32_bf16 v[172:175], v[100:103], v[76:79], v[172:175]
    s_waitcnt vmcnt(5) lgkmcnt(4)
    ds_read_b128 v[100:103], v248 offset:44032
    buffer_load_dwordx4 v[56:59], v244, s[8:11], s67 offen offset:2048 sc1
    v_mfma_f32_16x16x32_bf16 v[144:147], v[80:83], v[32:35], v[144:147]
    v_mov_b32 v197, v196
    v_accvgpr_write_b32 a251, v227
    v_mfma_f32_16x16x32_bf16 v[148:151], v[80:83], v[36:39], v[148:151]
    s_waitcnt lgkmcnt(4)
    ds_read_b128 v[80:83], v248 offset:43264
    v_accvgpr_write_b32 a252, v228
    v_mfma_f32_16x16x32_bf16 v[160:163], v[84:87], v[32:35], v[160:163]
    v_permlane32_swap_b32 v196, v197
    v_add_f32 v196, v196, v197
    v_mfma_f32_16x16x32_bf16 v[164:167], v[84:87], v[36:39], v[164:167]
    s_waitcnt lgkmcnt(4)
    ds_read_b128 v[84:87], v248 offset:44288
    buffer_load_dwordx4 v[60:63], v244, s[8:11], s67 offen offset:3072 sc1
    v_mfma_f32_16x16x32_bf16 v[152:155], v[88:91], v[32:35], v[152:155]
    v_accvgpr_write_b32 a253, v229
    v_accvgpr_write_b32 a254, v230
    v_mfma_f32_16x16x32_bf16 v[156:159], v[88:91], v[36:39], v[156:159]
    s_waitcnt lgkmcnt(4)
    ds_read_b128 v[88:91], v248 offset:49152
    v_add_f32_dpp v196, v196, v196 row_ror:8 row_mask:0xf bank_mask:0xf
    v_mfma_f32_16x16x32_bf16 v[168:171], v[92:95], v[32:35], v[168:171]
    s_cbranch_vccnz SAFE_128
    buffer_store_dword v196, v8, s[4:7], s64 offen
BACK_129:
    v_mfma_f32_16x16x32_bf16 v[172:175], v[92:95], v[36:39], v[172:175]
    s_waitcnt vmcnt(6) lgkmcnt(4)
    ds_read_b128 v[92:95], v248 offset:50176
    buffer_load_dwordx4 v[64:67], v245, s[8:11], s67 offen offset:0 sc1
    v_mfma_f32_16x16x32_bf16 v[144:147], v[96:99], v[40:43], v[144:147]
    v_accvgpr_write_b32 a255, v231
    v_mfma_f32_16x16x32_bf16 v[148:151], v[96:99], v[44:47], v[148:151]
    s_waitcnt lgkmcnt(4)
    ds_read_b128 v[96:99], v248 offset:49408
    buffer_load_dwordx4 v[68:71], v245, s[8:11], s67 offen offset:1024 sc1
    v_mfma_f32_16x16x32_bf16 v[160:163], v[100:103], v[40:43], v[160:163]
    s_lshl_b32 s3, s14, 8
    s_add_u32 s3, s3, 98304
    v_lshl_add_u32 v252, v13, 2, s3
    v_mfma_f32_16x16x32_bf16 v[164:167], v[100:103], v[44:47], v[164:167]
    s_waitcnt lgkmcnt(4)
    ds_read_b128 v[100:103], v248 offset:50432
    v_lshl_add_u32 v254, v3, 9, v9
    v_mfma_f32_16x16x32_bf16 v[152:155], v[80:83], v[40:43], v[152:155]
    v_add_u32 v254, 98304, v254
    v_mfma_f32_16x16x32_bf16 v[156:159], v[80:83], v[44:47], v[156:159]
    s_waitcnt lgkmcnt(4)
    ds_read_b128 v[80:83], v248 offset:55296
    buffer_load_dwordx4 v[72:75], v245, s[8:11], s67 offen offset:2048 sc1
    v_mfma_f32_16x16x32_bf16 v[168:171], v[84:87], v[40:43], v[168:171]
    ds_write_b32 v252, v12 offset:0
    ds_write_b32 v252, v253 offset:1024
    v_mfma_f32_16x16x32_bf16 v[172:175], v[84:87], v[44:47], v[172:175]
    s_waitcnt vmcnt(6) lgkmcnt(6)
    ds_read_b128 v[84:87], v248 offset:56320
    v_mfma_f32_16x16x32_bf16 v[144:147], v[88:91], v[48:51], v[144:147]
    v_mfma_f32_16x16x32_bf16 v[148:151], v[88:91], v[52:55], v[148:151]
    s_waitcnt lgkmcnt(6)
    ds_read_b128 v[88:91], v248 offset:55552
    buffer_load_dwordx4 v[76:79], v245, s[8:11], s67 offen offset:3072 sc1
    v_mfma_f32_16x16x32_bf16 v[160:163], v[92:95], v[48:51], v[160:163]
    v_mfma_f32_16x16x32_bf16 v[164:167], v[92:95], v[52:55], v[164:167]
    s_waitcnt lgkmcnt(6)
    ds_read_b128 v[92:95], v248 offset:56576
    buffer_load_dwordx4 v[32:35], v246, s[8:11], s67 offen offset:0 sc1
    v_mfma_f32_16x16x32_bf16 v[152:155], v[96:99], v[48:51], v[152:155]
    v_mfma_f32_16x16x32_bf16 v[156:159], v[96:99], v[52:55], v[156:159]
    s_waitcnt lgkmcnt(3)
    ds_read_b128 v[96:99], v249 offset:0
    s_barrier
    v_mfma_f32_16x16x32_bf16 v[168:171], v[100:103], v[48:51], v[168:171]
    s_waitcnt vmcnt(5)
    s_cbranch_vccnz SAFE_133
    buffer_store_dword v11, v10, s[4:7], s66 offen offset:1024
BACK_134:
    v_mfma_f32_16x16x32_bf16 v[172:175], v[100:103], v[52:55], v[172:175]
    ds_read_b128 v[100:103], v249 offset:1024
    buffer_load_dwordx4 v[36:39], v246, s[8:11], s67 offen offset:1024 sc1
    v_mfma_f32_16x16x32_bf16 v[144:147], v[80:83], v[56:59], v[144:147]
    ds_read_b32 v200, v254 offset:0
    v_mfma_f32_16x16x32_bf16 v[148:151], v[80:83], v[60:63], v[148:151]
    s_waitcnt lgkmcnt(5)
    ds_read_b128 v[80:83], v249 offset:256
    v_mfma_f32_16x16x32_bf16 v[160:163], v[84:87], v[56:59], v[160:163]
    ds_read_b32 v201, v254 offset:128
    v_mfma_f32_16x16x32_bf16 v[164:167], v[84:87], v[60:63], v[164:167]
    s_waitcnt lgkmcnt(6)
    ds_read_b128 v[84:87], v249 offset:1280
    buffer_load_dwordx4 v[40:43], v246, s[8:11], s67 offen offset:2048 sc1
    v_mfma_f32_16x16x32_bf16 v[152:155], v[88:91], v[56:59], v[152:155]
    ds_read_b32 v202, v254 offset:256
    v_mfma_f32_16x16x32_bf16 v[156:159], v[88:91], v[60:63], v[156:159]
    s_waitcnt lgkmcnt(7)
    ds_read_b128 v[88:91], v249 offset:6144
    v_mfma_f32_16x16x32_bf16 v[168:171], v[92:95], v[56:59], v[168:171]
    ds_read_b32 v203, v254 offset:384
    v_mfma_f32_16x16x32_bf16 v[172:175], v[92:95], v[60:63], v[172:175]
    s_waitcnt vmcnt(6) lgkmcnt(8)
    ds_read_b128 v[92:95], v249 offset:7168
    buffer_load_dwordx4 v[44:47], v246, s[8:11], s67 offen offset:3072 sc1
    v_mfma_f32_16x16x32_bf16 v[144:147], v[96:99], v[64:67], v[144:147]
    ds_read_b32 v204, v254 offset:1024
    v_mfma_f32_16x16x32_bf16 v[148:151], v[96:99], v[68:71], v[148:151]
    s_waitcnt lgkmcnt(9)
    ds_read_b128 v[96:99], v249 offset:6400
    buffer_load_dwordx4 v[48:51], v247, s[8:11], s67 offen offset:0 sc1
    v_mfma_f32_16x16x32_bf16 v[160:163], v[100:103], v[64:67], v[160:163]
    buffer_load_dword v14, v9, s[4:7], s72 offen offset:1024 sc1
    v_mfma_f32_16x16x32_bf16 v[164:167], v[100:103], v[68:71], v[164:167]
    s_waitcnt lgkmcnt(8)
    ds_read_b128 v[100:103], v249 offset:7424
    v_mfma_f32_16x16x32_bf16 v[152:155], v[80:83], v[64:67], v[152:155]
    ds_read_b32 v205, v254 offset:1152
    v_mfma_f32_16x16x32_bf16 v[156:159], v[80:83], v[68:71], v[156:159]
    s_waitcnt lgkmcnt(8)
    ds_read_b128 v[80:83], v249 offset:12288
    buffer_load_dwordx4 v[52:55], v247, s[8:11], s67 offen offset:1024 sc1
    v_mfma_f32_16x16x32_bf16 v[168:171], v[84:87], v[64:67], v[168:171]
    ds_read_b32 v206, v254 offset:1280
    v_mfma_f32_16x16x32_bf16 v[172:175], v[84:87], v[68:71], v[172:175]
    s_waitcnt vmcnt(8) lgkmcnt(8)
    ds_read_b128 v[84:87], v249 offset:13312
    v_mfma_f32_16x16x32_bf16 v[144:147], v[88:91], v[72:75], v[144:147]
    ds_read_b32 v207, v254 offset:1408
    v_mfma_f32_16x16x32_bf16 v[148:151], v[88:91], v[76:79], v[148:151]
    s_waitcnt lgkmcnt(0)
    ds_read_b128 v[88:91], v249 offset:12544
    buffer_load_dwordx4 v[56:59], v247, s[8:11], s67 offen offset:2048 sc1
    v_mfma_f32_16x16x32_bf16 v[160:163], v[92:95], v[72:75], v[160:163]
    v_add_f32 v200, v200, v201
    v_add_f32 v202, v202, v203
    v_mfma_f32_16x16x32_bf16 v[164:167], v[92:95], v[76:79], v[164:167]
    ds_read_b128 v[92:95], v249 offset:13568
    buffer_load_dwordx4 v[60:63], v247, s[8:11], s67 offen offset:3072 sc1
    v_mfma_f32_16x16x32_bf16 v[152:155], v[96:99], v[72:75], v[152:155]
    v_add_f32 v200, v200, v202
    v_mov_b32 v201, v200
    v_mfma_f32_16x16x32_bf16 v[156:159], v[96:99], v[76:79], v[156:159]
    s_waitcnt vmcnt(3)
    ds_read_b128 v[96:99], v249 offset:18432
    v_add_f32 v204, v204, v205
    v_mfma_f32_16x16x32_bf16 v[168:171], v[100:103], v[72:75], v[168:171]
    v_cmp_gt_u32 vcc, s34, v14
    s_cbranch_vccnz SPIN_130
BACK_131:
    v_mfma_f32_16x16x32_bf16 v[172:175], v[100:103], v[76:79], v[172:175]
    ds_read_b128 v[100:103], v249 offset:19456
    buffer_load_dwordx4 v[104:107], v16, s[4:7], s69 offen offset:0 sc1
    v_mfma_f32_16x16x32_bf16 v[144:147], v[80:83], v[32:35], v[144:147]
    buffer_load_dwordx4 v[108:111], v16, s[4:7], s69 offen offset:1024 sc1
    buffer_load_dwordx4 v[112:115], v16, s[4:7], s70 offen offset:0 sc1
    v_mfma_f32_16x16x32_bf16 v[148:151], v[80:83], v[36:39], v[148:151]
    ds_read_b128 v[80:83], v249 offset:18688
    buffer_load_dwordx4 v[116:119], v16, s[4:7], s70 offen offset:1024 sc1
    v_mfma_f32_16x16x32_bf16 v[160:163], v[84:87], v[32:35], v[160:163]
    buffer_load_dwordx4 v[64:67], v240, s[8:11], s68 offen offset:0 sc1
    v_add_f32 v206, v206, v207
    v_mfma_f32_16x16x32_bf16 v[164:167], v[84:87], v[36:39], v[164:167]
    s_waitcnt lgkmcnt(4)
    ds_read_b128 v[84:87], v249 offset:19712
    buffer_load_dwordx4 v[68:71], v240, s[8:11], s68 offen offset:1024 sc1
    v_mfma_f32_16x16x32_bf16 v[152:155], v[88:91], v[32:35], v[152:155]
    v_add_f32 v204, v204, v206
    v_mov_b32 v205, v204
    v_mfma_f32_16x16x32_bf16 v[156:159], v[88:91], v[36:39], v[156:159]
    s_waitcnt lgkmcnt(4)
    ds_read_b128 v[88:91], v249 offset:24576
    v_permlane32_swap_b32 v200, v201
    v_mfma_f32_16x16x32_bf16 v[168:171], v[92:95], v[32:35], v[168:171]
    v_add_f32 v200, v200, v201
    v_cvt_pk_bf16_f32 v201, v200, v200
    v_mfma_f32_16x16x32_bf16 v[172:175], v[92:95], v[36:39], v[172:175]
    s_waitcnt lgkmcnt(4)
    ds_read_b128 v[92:95], v249 offset:25600
    buffer_load_dwordx4 v[72:75], v240, s[8:11], s68 offen offset:2048 sc1
    v_mfma_f32_16x16x32_bf16 v[144:147], v[96:99], v[40:43], v[144:147]
    v_and_b32 v201, 0xffff0000, v201
    v_sub_f32 v200, v200, v201
    v_mfma_f32_16x16x32_bf16 v[148:151], v[96:99], v[44:47], v[148:151]
    s_waitcnt lgkmcnt(4)
    ds_read_b128 v[96:99], v249 offset:24832
    buffer_load_dwordx4 v[76:79], v240, s[8:11], s68 offen offset:3072 sc1
    v_mfma_f32_16x16x32_bf16 v[160:163], v[100:103], v[40:43], v[160:163]
    v_cvt_pk_bf16_f32 v25, v201, v200
    v_permlane32_swap_b32 v204, v205
    v_mfma_f32_16x16x32_bf16 v[164:167], v[100:103], v[44:47], v[164:167]
    s_waitcnt lgkmcnt(4)
    ds_read_b128 v[100:103], v249 offset:25856
    v_add_f32 v204, v204, v205
    v_mfma_f32_16x16x32_bf16 v[152:155], v[80:83], v[40:43], v[152:155]
    v_cvt_pk_bf16_f32 v205, v204, v204
    v_and_b32 v205, 0xffff0000, v205
    v_mfma_f32_16x16x32_bf16 v[156:159], v[80:83], v[44:47], v[156:159]
    s_waitcnt lgkmcnt(4)
    ds_read_b128 v[80:83], v249 offset:30720
    buffer_load_dwordx4 v[32:35], v241, s[8:11], s68 offen offset:0 sc1
    v_mfma_f32_16x16x32_bf16 v[168:171], v[84:87], v[40:43], v[168:171]
    v_sub_f32 v204, v204, v205
    v_cvt_pk_bf16_f32 v27, v205, v204
    v_mfma_f32_16x16x32_bf16 v[172:175], v[84:87], v[44:47], v[172:175]
    s_waitcnt vmcnt(11) lgkmcnt(4)
    ds_read_b128 v[84:87], v249 offset:31744
    v_mfma_f32_16x16x32_bf16 v[144:147], v[88:91], v[48:51], v[144:147]
    v_mfma_f32_16x16x32_bf16 v[148:151], v[88:91], v[52:55], v[148:151]
    s_waitcnt lgkmcnt(4)
    ds_read_b128 v[88:91], v249 offset:30976
    buffer_load_dwordx4 v[36:39], v241, s[8:11], s68 offen offset:1024 sc1
    v_mfma_f32_16x16x32_bf16 v[160:163], v[92:95], v[48:51], v[160:163]
    v_mfma_f32_16x16x32_bf16 v[164:167], v[92:95], v[52:55], v[164:167]
    s_waitcnt lgkmcnt(4)
    ds_read_b128 v[92:95], v249 offset:32000
    buffer_load_dwordx4 v[40:43], v241, s[8:11], s68 offen offset:2048 sc1
    v_mfma_f32_16x16x32_bf16 v[152:155], v[96:99], v[48:51], v[152:155]
    v_mfma_f32_16x16x32_bf16 v[156:159], v[96:99], v[52:55], v[156:159]
    s_waitcnt lgkmcnt(4)
    ds_read_b128 v[96:99], v248 offset:0
    v_mfma_f32_16x16x32_bf16 v[168:171], v[100:103], v[48:51], v[168:171]
    v_mfma_f32_16x16x32_bf16 v[172:175], v[100:103], v[52:55], v[172:175]
    s_waitcnt vmcnt(9) lgkmcnt(4)
    ds_read_b128 v[100:103], v248 offset:1024
    buffer_load_dwordx4 v[44:47], v241, s[8:11], s68 offen offset:3072 sc1
    v_mfma_f32_16x16x32_bf16 v[144:147], v[80:83], v[56:59], v[144:147]
    v_add_f32 v104, v104, v106
    v_add_f32 v105, v105, v107
    v_mfma_f32_16x16x32_bf16 v[148:151], v[80:83], v[60:63], v[148:151]
    s_waitcnt lgkmcnt(4)
    ds_read_b128 v[80:83], v248 offset:256
    v_add_f32 v108, v108, v110
    v_mfma_f32_16x16x32_bf16 v[160:163], v[84:87], v[56:59], v[160:163]
    v_add_f32 v109, v109, v111
    v_add_f32 v104, v104, v108
    v_mfma_f32_16x16x32_bf16 v[164:167], v[84:87], v[60:63], v[164:167]
    s_waitcnt lgkmcnt(4)
    ds_read_b128 v[84:87], v248 offset:1280
    buffer_load_dwordx4 v[48:51], v242, s[8:11], s68 offen offset:0 sc1
    v_mfma_f32_16x16x32_bf16 v[152:155], v[88:91], v[56:59], v[152:155]
    v_add_f32 v105, v105, v109
    s_nop 1
    v_permlane32_swap_b32 v104, v105
    v_mfma_f32_16x16x32_bf16 v[156:159], v[88:91], v[60:63], v[156:159]
    s_waitcnt lgkmcnt(4)
    ds_read_b128 v[88:91], v248 offset:6144
    buffer_load_dwordx4 v[52:55], v242, s[8:11], s68 offen offset:1024 sc1
    v_mfma_f32_16x16x32_bf16 v[168:171], v[92:95], v[56:59], v[168:171]
    v_add_f32 v104, v104, v105
    v_mul_f32 v104, 0x3b000000, v104
    v_mfma_f32_16x16x32_bf16 v[172:175], v[92:95], v[60:63], v[172:175]
    ds_read_b128 v[92:95], v248 offset:7168
    v_mov_b32 v105, v104
    s_nop 1
    v_permlane32_swap_b32 v104, v105
    v_fma_f32 v105, -v104, v104, v105
    v_max_f32 v105, 0, v105
    v_add_f32 v105, 0x3727c5ac, v105
    v_rsq_f32 v120, v105
    v_cvt_pk_bf16_f32 v106, -v104, -v104
    v_and_b32 v107, 0xffff0000, v106
    v_sub_f32 v107, -v104, v107
    v_cvt_pk_bf16_f32 v107, v107, v107
    v_cndmask_b32 v124, v107, v106, s[24:25]
    v_mul_f32 v120, v120, v120
    v_mov_b32 v105, v124
    v_mov_b32 v107, 0
    v_mov_b32 v121, v120
    v_mov_b32 v109, 0
    v_mov_b32 v111, v124
    v_permlane16_swap_b32 v105, v107
    v_mov_b32 v104, 0
    v_permlane16_swap_b32 v120, v121
    v_permlane16_swap_b32 v109, v111
    v_mov_b32 v106, 0
    v_mov_b32 v108, 0
    v_mov_b32 v110, 0
    v_mfma_f32_16x16x16_bf16 v[144:147], v[24:25], v[104:105], v[144:147]
    v_mfma_f32_16x16x16_bf16 v[148:151], v[24:25], v[106:107], v[148:151]
    buffer_load_dwordx4 v[56:59], v242, s[8:11], s68 offen offset:2048 sc1
    v_mfma_f32_16x16x16_bf16 v[152:155], v[24:25], v[108:109], v[152:155]
    v_mfma_f32_16x16x16_bf16 v[156:159], v[24:25], v[110:111], v[156:159]
    v_mfma_f32_16x16x16_bf16 v[160:163], v[26:27], v[104:105], v[160:163]
    v_mfma_f32_16x16x16_bf16 v[164:167], v[26:27], v[106:107], v[164:167]
    buffer_load_dwordx4 v[60:63], v242, s[8:11], s68 offen offset:3072 sc1
    s_nop 3
    v_mul_f32 v144, v144, v152
    v_mfma_f32_16x16x16_bf16 v[168:171], v[26:27], v[108:109], v[168:171]
    v_mul_f32 v145, v145, v153
    v_mul_f32 v144, v144, v120
    v_mfma_f32_16x16x16_bf16 v[172:175], v[26:27], v[110:111], v[172:175]
    s_waitcnt vmcnt(10) lgkmcnt(5)
    v_mul_f32 v145, v145, v120
    v_cvt_pk_bf16_f32 v152, v144, v145
    v_mfma_f32_16x16x32_bf16 v[192:195], v[96:99], v[64:67], 0
    v_mul_f32 v146, v146, v154
    v_mul_f32 v147, v147, v155
    v_mfma_f32_16x16x32_bf16 v[196:199], v[96:99], v[68:71], 0
    s_waitcnt lgkmcnt(4)
    ds_read_b128 v[96:99], v248 offset:6400
    v_mul_f32 v146, v146, v120
    v_mfma_f32_16x16x32_bf16 v[208:211], v[100:103], v[64:67], 0
    v_mul_f32 v147, v147, v120
    v_cvt_pk_bf16_f32 v153, v146, v147
    v_mfma_f32_16x16x32_bf16 v[212:215], v[100:103], v[68:71], 0
    s_waitcnt lgkmcnt(4)
    ds_read_b128 v[100:103], v248 offset:7424
    v_mul_f32 v148, v148, v156
    v_mfma_f32_16x16x32_bf16 v[200:203], v[80:83], v[64:67], 0
    v_mul_f32 v149, v149, v157
    v_mul_f32 v148, v148, v121
    v_mfma_f32_16x16x32_bf16 v[204:207], v[80:83], v[68:71], 0
    s_waitcnt lgkmcnt(4)
    ds_read_b128 v[80:83], v248 offset:12288
    v_mul_f32 v149, v149, v121
    v_mfma_f32_16x16x32_bf16 v[216:219], v[84:87], v[64:67], 0
    v_cvt_pk_bf16_f32 v154, v148, v149
    v_mul_f32 v150, v150, v158
    v_mfma_f32_16x16x32_bf16 v[220:223], v[84:87], v[68:71], 0
    s_waitcnt vmcnt(8) lgkmcnt(4)
    ds_read_b128 v[84:87], v248 offset:13312
    buffer_load_dwordx4 v[64:67], v243, s[8:11], s68 offen offset:0 sc1
    v_mfma_f32_16x16x32_bf16 v[192:195], v[88:91], v[72:75], v[192:195]
    v_mul_f32 v151, v151, v159
    v_mul_f32 v150, v150, v121
    v_mfma_f32_16x16x32_bf16 v[196:199], v[88:91], v[76:79], v[196:199]
    s_waitcnt lgkmcnt(4)
    ds_read_b128 v[88:91], v248 offset:12544
    buffer_load_dwordx4 v[68:71], v243, s[8:11], s68 offen offset:1024 sc1
    v_mfma_f32_16x16x32_bf16 v[208:211], v[92:95], v[72:75], v[208:211]
    v_mul_f32 v151, v151, v121
    v_cvt_pk_bf16_f32 v155, v150, v151
    v_mfma_f32_16x16x32_bf16 v[212:215], v[92:95], v[76:79], v[212:215]
    s_waitcnt lgkmcnt(4)
    ds_read_b128 v[92:95], v248 offset:13568
    v_permlane32_swap_b32 v152, v154
    v_mfma_f32_16x16x32_bf16 v[200:203], v[96:99], v[72:75], v[200:203]
    v_permlane32_swap_b32 v153, v155
    v_mfma_f32_16x16x32_bf16 v[204:207], v[96:99], v[76:79], v[204:207]
    s_waitcnt lgkmcnt(4)
    ds_read_b128 v[96:99], v248 offset:18432
    buffer_store_dwordx4 v[152:155], v250, s[4:7], s73 offen offset:0
    v_mfma_f32_16x16x32_bf16 v[216:219], v[100:103], v[72:75], v[216:219]
    v_mul_f32 v160, v160, v168
    v_mul_f32 v161, v161, v169
    v_mfma_f32_16x16x32_bf16 v[220:223], v[100:103], v[76:79], v[220:223]
    s_waitcnt vmcnt(9) lgkmcnt(4)
    ds_read_b128 v[100:103], v248 offset:19456
    buffer_load_dwordx4 v[72:75], v243, s[8:11], s68 offen offset:2048 sc1
    v_mfma_f32_16x16x32_bf16 v[192:195], v[80:83], v[32:35], v[192:195]
    v_mul_f32 v160, v160, v120
    v_mul_f32 v161, v161, v120
    v_mfma_f32_16x16x32_bf16 v[196:199], v[80:83], v[36:39], v[196:199]
    s_waitcnt lgkmcnt(4)
    ds_read_b128 v[80:83], v248 offset:18688
    buffer_load_dwordx4 v[76:79], v243, s[8:11], s68 offen offset:3072 sc1
    v_mfma_f32_16x16x32_bf16 v[208:211], v[84:87], v[32:35], v[208:211]
    v_cvt_pk_bf16_f32 v168, v160, v161
    v_mul_f32 v162, v162, v170
    v_mfma_f32_16x16x32_bf16 v[212:215], v[84:87], v[36:39], v[212:215]
    s_waitcnt lgkmcnt(4)
    ds_read_b128 v[84:87], v248 offset:19712
    v_mul_f32 v163, v163, v171
    v_mfma_f32_16x16x32_bf16 v[200:203], v[88:91], v[32:35], v[200:203]
    v_mul_f32 v162, v162, v120
    v_mul_f32 v163, v163, v120
    v_mfma_f32_16x16x32_bf16 v[204:207], v[88:91], v[36:39], v[204:207]
    s_waitcnt lgkmcnt(4)
    ds_read_b128 v[88:91], v248 offset:24576
    v_cvt_pk_bf16_f32 v169, v162, v163
    v_mfma_f32_16x16x32_bf16 v[216:219], v[92:95], v[32:35], v[216:219]
    v_mul_f32 v164, v164, v172
    v_mul_f32 v165, v165, v173
    v_mfma_f32_16x16x32_bf16 v[220:223], v[92:95], v[36:39], v[220:223]
    s_waitcnt vmcnt(9) lgkmcnt(4)
    ds_read_b128 v[92:95], v248 offset:25600
    buffer_load_dwordx4 v[32:35], v244, s[8:11], s68 offen offset:0 sc1
    v_mfma_f32_16x16x32_bf16 v[192:195], v[96:99], v[40:43], v[192:195]
    v_mul_f32 v164, v164, v121
    v_mul_f32 v165, v165, v121
    v_mfma_f32_16x16x32_bf16 v[196:199], v[96:99], v[44:47], v[196:199]
    s_waitcnt lgkmcnt(4)
    ds_read_b128 v[96:99], v248 offset:24832
    buffer_load_dwordx4 v[36:39], v244, s[8:11], s68 offen offset:1024 sc1
    v_mfma_f32_16x16x32_bf16 v[208:211], v[100:103], v[40:43], v[208:211]
    v_cvt_pk_bf16_f32 v170, v164, v165
    v_mul_f32 v166, v166, v174
    v_mfma_f32_16x16x32_bf16 v[212:215], v[100:103], v[44:47], v[212:215]
    s_waitcnt lgkmcnt(4)
    ds_read_b128 v[100:103], v248 offset:25856
    v_mul_f32 v167, v167, v175
    v_mfma_f32_16x16x32_bf16 v[200:203], v[80:83], v[40:43], v[200:203]
    v_mul_f32 v166, v166, v121
    v_mul_f32 v167, v167, v121
    v_mfma_f32_16x16x32_bf16 v[204:207], v[80:83], v[44:47], v[204:207]
    s_waitcnt lgkmcnt(4)
    ds_read_b128 v[80:83], v248 offset:30720
    v_cvt_pk_bf16_f32 v171, v166, v167
    v_mfma_f32_16x16x32_bf16 v[216:219], v[84:87], v[40:43], v[216:219]
    v_permlane32_swap_b32 v168, v170
    v_permlane32_swap_b32 v169, v171
    v_mfma_f32_16x16x32_bf16 v[220:223], v[84:87], v[44:47], v[220:223]
    s_waitcnt vmcnt(9) lgkmcnt(4)
    ds_read_b128 v[84:87], v248 offset:31744
    buffer_load_dwordx4 v[40:43], v244, s[8:11], s68 offen offset:2048 sc1
    v_mfma_f32_16x16x32_bf16 v[192:195], v[88:91], v[48:51], v[192:195]
    buffer_store_dwordx4 v[168:171], v251, s[4:7], s73 offen offset:512
    s_barrier
    v_mfma_f32_16x16x32_bf16 v[196:199], v[88:91], v[52:55], v[196:199]
    s_waitcnt lgkmcnt(4)
    ds_read_b128 v[88:91], v248 offset:30976
    buffer_load_dwordx4 v[44:47], v244, s[8:11], s68 offen offset:3072 sc1
    v_mfma_f32_16x16x32_bf16 v[208:211], v[92:95], v[48:51], v[208:211]
    v_add_f32 v112, v112, v114
    v_add_f32 v113, v113, v115
    v_mfma_f32_16x16x32_bf16 v[212:215], v[92:95], v[52:55], v[212:215]
    s_waitcnt lgkmcnt(4)
    ds_read_b128 v[92:95], v248 offset:32000
    v_add_f32 v116, v116, v118
    v_mfma_f32_16x16x32_bf16 v[200:203], v[96:99], v[48:51], v[200:203]
    v_add_f32 v117, v117, v119
    v_add_f32 v112, v112, v116
    v_mfma_f32_16x16x32_bf16 v[204:207], v[96:99], v[52:55], v[204:207]
    s_waitcnt lgkmcnt(4)
    ds_read_b128 v[96:99], v248 offset:36864
    v_add_f32 v113, v113, v117
    v_mfma_f32_16x16x32_bf16 v[216:219], v[100:103], v[48:51], v[216:219]
    s_nop 0
    v_permlane32_swap_b32 v112, v113
    v_add_f32 v112, v112, v113
    v_mfma_f32_16x16x32_bf16 v[220:223], v[100:103], v[52:55], v[220:223]
    s_waitcnt vmcnt(10) lgkmcnt(4)
    ds_read_b128 v[100:103], v248 offset:37888
    buffer_load_dwordx4 v[48:51], v245, s[8:11], s68 offen offset:0 sc1
    v_mfma_f32_16x16x32_bf16 v[192:195], v[80:83], v[56:59], v[192:195]
    v_mul_f32 v112, 0x3b000000, v112
    v_mov_b32 v113, v112
    v_mfma_f32_16x16x32_bf16 v[196:199], v[80:83], v[60:63], v[196:199]
    s_waitcnt lgkmcnt(4)
    ds_read_b128 v[80:83], v248 offset:37120
    buffer_load_dwordx4 v[52:55], v245, s[8:11], s68 offen offset:1024 sc1
    v_mfma_f32_16x16x32_bf16 v[208:211], v[84:87], v[56:59], v[208:211]
    v_permlane32_swap_b32 v112, v113
    v_fma_f32 v113, -v112, v112, v113
    v_mfma_f32_16x16x32_bf16 v[212:215], v[84:87], v[60:63], v[212:215]
    s_waitcnt lgkmcnt(4)
    ds_read_b128 v[84:87], v248 offset:38144
    v_max_f32 v113, 0, v113
    v_mfma_f32_16x16x32_bf16 v[200:203], v[88:91], v[56:59], v[200:203]
    v_add_f32 v113, 0x3727c5ac, v113
    v_mfma_f32_16x16x32_bf16 v[204:207], v[88:91], v[60:63], v[204:207]
    s_waitcnt lgkmcnt(4)
    ds_read_b128 v[88:91], v248 offset:43008
    v_mfma_f32_16x16x32_bf16 v[216:219], v[92:95], v[56:59], v[216:219]
    v_rsq_f32 v122, v113
    v_mfma_f32_16x16x32_bf16 v[220:223], v[92:95], v[60:63], v[220:223]
    s_waitcnt vmcnt(10) lgkmcnt(4)
    ds_read_b128 v[92:95], v248 offset:44032
    buffer_load_dwordx4 v[56:59], v245, s[8:11], s68 offen offset:2048 sc1
    v_mfma_f32_16x16x32_bf16 v[192:195], v[96:99], v[64:67], v[192:195]
    v_cvt_pk_bf16_f32 v114, -v112, -v112
    v_and_b32 v115, 0xffff0000, v114
    v_mfma_f32_16x16x32_bf16 v[196:199], v[96:99], v[68:71], v[196:199]
    s_waitcnt lgkmcnt(4)
    ds_read_b128 v[96:99], v248 offset:43264
    buffer_load_dwordx4 v[60:63], v245, s[8:11], s68 offen offset:3072 sc1
    v_mfma_f32_16x16x32_bf16 v[208:211], v[100:103], v[64:67], v[208:211]
    v_sub_f32 v115, -v112, v115
    v_cvt_pk_bf16_f32 v115, v115, v115
    v_mfma_f32_16x16x32_bf16 v[212:215], v[100:103], v[68:71], v[212:215]
    s_waitcnt lgkmcnt(4)
    ds_read_b128 v[100:103], v248 offset:44288
    v_cndmask_b32 v124, v115, v114, s[24:25]
    v_mfma_f32_16x16x32_bf16 v[200:203], v[80:83], v[64:67], v[200:203]
    v_mul_f32 v122, v122, v122
    v_mov_b32 v113, v124
    v_mfma_f32_16x16x32_bf16 v[204:207], v[80:83], v[68:71], v[204:207]
    s_waitcnt lgkmcnt(4)
    ds_read_b128 v[80:83], v248 offset:49152
    v_mov_b32 v115, 0
    v_mfma_f32_16x16x32_bf16 v[216:219], v[84:87], v[64:67], v[216:219]
    v_mov_b32 v123, v122
    v_mov_b32 v117, 0
    v_mfma_f32_16x16x32_bf16 v[220:223], v[84:87], v[68:71], v[220:223]
    s_waitcnt vmcnt(9) lgkmcnt(4)
    ds_read_b128 v[84:87], v248 offset:50176
    buffer_load_dwordx4 v[64:67], v246, s[8:11], s68 offen offset:0 sc1
    v_mfma_f32_16x16x32_bf16 v[192:195], v[88:91], v[72:75], v[192:195]
    v_mov_b32 v119, v124
    v_permlane16_swap_b32 v113, v115
    v_mfma_f32_16x16x32_bf16 v[196:199], v[88:91], v[76:79], v[196:199]
    s_waitcnt lgkmcnt(4)
    ds_read_b128 v[88:91], v248 offset:49408
    buffer_load_dwordx4 v[68:71], v246, s[8:11], s68 offen offset:1024 sc1
    v_mfma_f32_16x16x32_bf16 v[208:211], v[92:95], v[72:75], v[208:211]
    v_mov_b32 v112, 0
    v_permlane16_swap_b32 v122, v123
    v_mfma_f32_16x16x32_bf16 v[212:215], v[92:95], v[76:79], v[212:215]
    s_waitcnt lgkmcnt(4)
    ds_read_b128 v[92:95], v248 offset:50432
    v_permlane16_swap_b32 v117, v119
    v_mfma_f32_16x16x32_bf16 v[200:203], v[96:99], v[72:75], v[200:203]
    v_mov_b32 v114, 0
    v_mov_b32 v116, 0
    v_mfma_f32_16x16x32_bf16 v[204:207], v[96:99], v[76:79], v[204:207]
    s_waitcnt lgkmcnt(4)
    ds_read_b128 v[96:99], v248 offset:55296
    v_mov_b32 v118, 0
    v_mfma_f32_16x16x32_bf16 v[216:219], v[100:103], v[72:75], v[216:219]
    s_waitcnt vmcnt(7)
    s_cbranch_vccnz SAFE_135
    buffer_store_dword v11, v10, s[4:7], s75 offen offset:2048
BACK_136:
    v_mfma_f32_16x16x32_bf16 v[220:223], v[100:103], v[76:79], v[220:223]
    s_waitcnt lgkmcnt(4)
    ds_read_b128 v[100:103], v248 offset:56320
    buffer_load_dwordx4 v[72:75], v246, s[8:11], s68 offen offset:2048 sc1
    v_mfma_f32_16x16x32_bf16 v[192:195], v[80:83], v[32:35], v[192:195]
    v_mfma_f32_16x16x32_bf16 v[196:199], v[80:83], v[36:39], v[196:199]
    s_waitcnt lgkmcnt(4)
    ds_read_b128 v[80:83], v248 offset:55552
    buffer_load_dwordx4 v[76:79], v246, s[8:11], s68 offen offset:3072 sc1
    v_mfma_f32_16x16x32_bf16 v[208:211], v[84:87], v[32:35], v[208:211]
    buffer_load_dword v14, v9, s[4:7], s79 offen offset:2048 sc1
    v_mfma_f32_16x16x32_bf16 v[212:215], v[84:87], v[36:39], v[212:215]
    s_waitcnt vmcnt(0) lgkmcnt(4)
    ds_read_b128 v[84:87], v248 offset:56576
    v_mfma_f32_16x16x32_bf16 v[200:203], v[88:91], v[32:35], v[200:203]
    v_cmp_gt_u32 vcc, s34, v14
    s_cbranch_vccnz SPIN_137
BACK_138:
    v_mfma_f32_16x16x32_bf16 v[204:207], v[88:91], v[36:39], v[204:207]
    s_waitcnt lgkmcnt(4)
    ds_read_b128 v[88:91], v249 offset:0
    buffer_load_dwordx4 v[128:131], v16, s[4:7], s77 offen offset:0 sc1
    v_mfma_f32_16x16x32_bf16 v[216:219], v[92:95], v[32:35], v[216:219]
    v_mfma_f32_16x16x32_bf16 v[220:223], v[92:95], v[36:39], v[220:223]
    s_waitcnt lgkmcnt(4)
    ds_read_b128 v[92:95], v249 offset:1024
    buffer_load_dwordx4 v[32:35], v247, s[8:11], s68 offen offset:0 sc1
    v_mfma_f32_16x16x32_bf16 v[192:195], v[96:99], v[40:43], v[192:195]
    v_mfma_f32_16x16x32_bf16 v[196:199], v[96:99], v[44:47], v[196:199]
    s_waitcnt lgkmcnt(4)
    ds_read_b128 v[96:99], v249 offset:256
    buffer_load_dwordx4 v[36:39], v247, s[8:11], s68 offen offset:1024 sc1
    v_mfma_f32_16x16x32_bf16 v[208:211], v[100:103], v[40:43], v[208:211]
    buffer_load_dwordx4 v[132:135], v16, s[4:7], s77 offen offset:2048 sc1
    v_mfma_f32_16x16x32_bf16 v[212:215], v[100:103], v[44:47], v[212:215]
    s_waitcnt lgkmcnt(4)
    ds_read_b128 v[100:103], v249 offset:1280
    v_mfma_f32_16x16x32_bf16 v[200:203], v[80:83], v[40:43], v[200:203]
    v_mfma_f32_16x16x32_bf16 v[204:207], v[80:83], v[44:47], v[204:207]
    s_waitcnt lgkmcnt(4)
    ds_read_b128 v[80:83], v249 offset:6144
    buffer_load_dwordx4 v[136:139], v17, s[4:7], s77 offen offset:0 sc1
    v_mfma_f32_16x16x32_bf16 v[216:219], v[84:87], v[40:43], v[216:219]
    v_mfma_f32_16x16x32_bf16 v[220:223], v[84:87], v[44:47], v[220:223]
    s_waitcnt lgkmcnt(4)
    ds_read_b128 v[84:87], v249 offset:7168
    buffer_load_dwordx4 v[40:43], v247, s[8:11], s68 offen offset:2048 sc1
    v_mfma_f32_16x16x32_bf16 v[192:195], v[88:91], v[48:51], v[192:195]
    v_mfma_f32_16x16x32_bf16 v[196:199], v[88:91], v[52:55], v[196:199]
    s_waitcnt lgkmcnt(4)
    ds_read_b128 v[88:91], v249 offset:6400
    buffer_load_dwordx4 v[44:47], v247, s[8:11], s68 offen offset:3072 sc1
    v_mfma_f32_16x16x32_bf16 v[208:211], v[92:95], v[48:51], v[208:211]
    buffer_load_dwordx4 v[140:143], v17, s[4:7], s77 offen offset:2048 sc1
    v_mfma_f32_16x16x32_bf16 v[212:215], v[92:95], v[52:55], v[212:215]
    s_waitcnt lgkmcnt(4)
    ds_read_b128 v[92:95], v249 offset:7424
    v_mfma_f32_16x16x32_bf16 v[200:203], v[96:99], v[48:51], v[200:203]
    v_mfma_f32_16x16x32_bf16 v[204:207], v[96:99], v[52:55], v[204:207]
    s_waitcnt lgkmcnt(4)
    ds_read_b128 v[96:99], v249 offset:12288
    buffer_load_dwordx4 v[144:147], v18, s[4:7], s77 offen offset:0 sc1
    v_mfma_f32_16x16x32_bf16 v[216:219], v[100:103], v[48:51], v[216:219]
    v_mfma_f32_16x16x32_bf16 v[220:223], v[100:103], v[52:55], v[220:223]
    ds_read_b128 v[100:103], v249 offset:12544
    v_mfma_f32_16x16x16_bf16 v[192:195], v[24:25], v[112:113], v[192:195]
    v_mfma_f32_16x16x16_bf16 v[196:199], v[24:25], v[114:115], v[196:199]
    buffer_load_dwordx4 v[148:151], v18, s[4:7], s77 offen offset:2048 sc1
    v_mfma_f32_16x16x16_bf16 v[200:203], v[24:25], v[116:117], v[200:203]
    v_mfma_f32_16x16x16_bf16 v[204:207], v[24:25], v[118:119], v[204:207]
    v_mfma_f32_16x16x16_bf16 v[208:211], v[26:27], v[112:113], v[208:211]
    v_mfma_f32_16x16x16_bf16 v[212:215], v[26:27], v[114:115], v[212:215]
    buffer_load_dwordx4 v[152:155], v19, s[4:7], s77 offen offset:0 sc1
    v_mfma_f32_16x16x16_bf16 v[216:219], v[26:27], v[116:117], v[216:219]
    v_mfma_f32_16x16x16_bf16 v[220:223], v[26:27], v[118:119], v[220:223]
    s_waitcnt lgkmcnt(5)
    v_mfma_f32_16x16x32_bf16 v[192:195], v[80:83], v[56:59], v[192:195]
    v_mfma_f32_16x16x32_bf16 v[196:199], v[80:83], v[60:63], v[196:199]
    s_waitcnt lgkmcnt(4)
    ds_read_b128 v[80:83], v249 offset:18432
    buffer_load_dwordx4 v[156:159], v19, s[4:7], s77 offen offset:2048 sc1
    v_mfma_f32_16x16x32_bf16 v[208:211], v[84:87], v[56:59], v[208:211]
    v_mfma_f32_16x16x32_bf16 v[212:215], v[84:87], v[60:63], v[212:215]
    s_waitcnt lgkmcnt(4)
    ds_read_b128 v[84:87], v249 offset:18688
    v_mfma_f32_16x16x32_bf16 v[200:203], v[88:91], v[56:59], v[200:203]
    v_mfma_f32_16x16x32_bf16 v[204:207], v[88:91], v[60:63], v[204:207]
    s_waitcnt lgkmcnt(4)
    ds_read_b128 v[88:91], v249 offset:24576
    buffer_load_dwordx4 v[160:163], v20, s[4:7], s77 offen offset:0 sc1
    v_mfma_f32_16x16x32_bf16 v[216:219], v[92:95], v[56:59], v[216:219]
    v_mfma_f32_16x16x32_bf16 v[220:223], v[92:95], v[60:63], v[220:223]
    s_waitcnt lgkmcnt(4)
    ds_read_b128 v[92:95], v249 offset:24832
    v_mfma_f32_16x16x32_bf16 v[192:195], v[96:99], v[64:67], v[192:195]
    v_mfma_f32_16x16x32_bf16 v[196:199], v[96:99], v[68:71], v[196:199]
    s_waitcnt lgkmcnt(4)
    ds_read_b128 v[96:99], v249 offset:30720
    buffer_load_dwordx4 v[164:167], v20, s[4:7], s77 offen offset:2048 sc1
    v_mfma_f32_16x16x32_bf16 v[200:203], v[100:103], v[64:67], v[200:203]
    v_mfma_f32_16x16x32_bf16 v[204:207], v[100:103], v[68:71], v[204:207]
    s_waitcnt lgkmcnt(4)
    ds_read_b128 v[100:103], v249 offset:30976
    v_mfma_f32_16x16x32_bf16 v[192:195], v[80:83], v[72:75], v[192:195]
    v_mfma_f32_16x16x32_bf16 v[196:199], v[80:83], v[76:79], v[196:199]
    s_waitcnt lgkmcnt(4)
    ds_read_b128 v[80:83], v249 offset:13312
    buffer_load_dwordx4 v[168:171], v21, s[4:7], s77 offen offset:0 sc1
    v_mfma_f32_16x16x32_bf16 v[200:203], v[84:87], v[72:75], v[200:203]
    v_mfma_f32_16x16x32_bf16 v[204:207], v[84:87], v[76:79], v[204:207]
    s_waitcnt vmcnt(12) lgkmcnt(4)
    ds_read_b128 v[84:87], v249 offset:13568
    v_mfma_f32_16x16x32_bf16 v[192:195], v[88:91], v[32:35], v[192:195]
    v_mfma_f32_16x16x32_bf16 v[196:199], v[88:91], v[36:39], v[196:199]
    s_waitcnt lgkmcnt(4)
    ds_read_b128 v[88:91], v249 offset:19456
    buffer_load_dwordx4 v[172:175], v16, s[4:7], s77 offen offset:1024 sc1
    v_mfma_f32_16x16x32_bf16 v[200:203], v[92:95], v[32:35], v[200:203]
    v_mfma_f32_16x16x32_bf16 v[204:207], v[92:95], v[36:39], v[204:207]
    s_waitcnt vmcnt(9) lgkmcnt(4)
    ds_read_b128 v[92:95], v249 offset:19712
    v_mfma_f32_16x16x32_bf16 v[192:195], v[96:99], v[40:43], v[192:195]
    v_mfma_f32_16x16x32_bf16 v[196:199], v[96:99], v[44:47], v[196:199]
    s_waitcnt lgkmcnt(4)
    ds_read_b128 v[96:99], v249 offset:25600
    buffer_load_dwordx4 v[176:179], v16, s[4:7], s77 offen offset:3072 sc1
    v_mfma_f32_16x16x32_bf16 v[200:203], v[100:103], v[40:43], v[200:203]
    v_mfma_f32_16x16x32_bf16 v[204:207], v[100:103], v[44:47], v[204:207]
    s_waitcnt lgkmcnt(4)
    ds_read_b128 v[100:103], v249 offset:25856
    v_mfma_f32_16x16x32_bf16 v[208:211], v[80:83], v[64:67], v[208:211]
    v_mfma_f32_16x16x32_bf16 v[212:215], v[80:83], v[68:71], v[212:215]
    s_waitcnt lgkmcnt(4)
    ds_read_b128 v[80:83], v249 offset:31744
    buffer_load_dwordx4 v[180:183], v17, s[4:7], s77 offen offset:1024 sc1
    v_mfma_f32_16x16x32_bf16 v[216:219], v[84:87], v[64:67], v[216:219]
    v_mul_f32 v192, v192, v200
    v_mul_f32 v193, v193, v201
    v_mfma_f32_16x16x32_bf16 v[220:223], v[84:87], v[68:71], v[220:223]
    s_waitcnt lgkmcnt(4)
    ds_read_b128 v[84:87], v249 offset:32000
    v_mul_f32 v192, v192, v122
    v_mfma_f32_16x16x32_bf16 v[208:211], v[88:91], v[72:75], v[208:211]
    v_mul_f32 v193, v193, v122
    v_cvt_pk_bf16_f32 v200, v192, v193
    v_mfma_f32_16x16x32_bf16 v[212:215], v[88:91], v[76:79], v[212:215]
    s_waitcnt lgkmcnt(4)
    buffer_load_dwordx4 v[184:187], v17, s[4:7], s77 offen offset:3072 sc1
    v_mul_f32 v194, v194, v202
    v_mfma_f32_16x16x32_bf16 v[216:219], v[92:95], v[72:75], v[216:219]
    v_mul_f32 v195, v195, v203
    v_mul_f32 v194, v194, v122
    v_mfma_f32_16x16x32_bf16 v[220:223], v[92:95], v[76:79], v[220:223]
    s_waitcnt lgkmcnt(3)
    v_mul_f32 v195, v195, v122
    v_cvt_pk_bf16_f32 v201, v194, v195
    v_mfma_f32_16x16x32_bf16 v[208:211], v[96:99], v[32:35], v[208:211]
    v_mul_f32 v196, v196, v204
    v_mul_f32 v197, v197, v205
    v_mfma_f32_16x16x32_bf16 v[212:215], v[96:99], v[36:39], v[212:215]
    s_waitcnt lgkmcnt(2)
    buffer_load_dwordx4 v[188:191], v18, s[4:7], s77 offen offset:1024 sc1
    v_mul_f32 v196, v196, v123
    v_mfma_f32_16x16x32_bf16 v[216:219], v[100:103], v[32:35], v[216:219]
    v_mul_f32 v197, v197, v123
    v_cvt_pk_bf16_f32 v202, v196, v197
    v_mfma_f32_16x16x32_bf16 v[220:223], v[100:103], v[36:39], v[220:223]
    s_waitcnt lgkmcnt(1)
    v_mul_f32 v198, v198, v206
    v_mul_f32 v199, v199, v207
    v_mfma_f32_16x16x32_bf16 v[208:211], v[80:83], v[40:43], v[208:211]
    v_mul_f32 v198, v198, v123
    v_mul_f32 v199, v199, v123
    v_mfma_f32_16x16x32_bf16 v[212:215], v[80:83], v[44:47], v[212:215]
    s_waitcnt lgkmcnt(0)
    v_cvt_pk_bf16_f32 v203, v198, v199
    v_permlane32_swap_b32 v200, v202
    v_mfma_f32_16x16x32_bf16 v[216:219], v[84:87], v[40:43], v[216:219]
    v_permlane32_swap_b32 v201, v203
    v_mfma_f32_16x16x32_bf16 v[220:223], v[84:87], v[44:47], v[220:223]
    buffer_store_dwordx4 v[200:203], v250, s[4:7], s74 offen offset:0
    v_mfma_f32_16x16x32_bf16 v[48:51], a[0:3], v[128:131], 0
    v_mfma_f32_16x16x32_bf16 v[56:59], a[4:7], v[128:131], 0
    s_nop 2
    v_mul_f32 v208, v208, v216
    v_mul_f32 v209, v209, v217
    v_mfma_f32_16x16x32_bf16 v[64:67], a[8:11], v[128:131], 0
    v_mul_f32 v208, v208, v122
    v_mul_f32 v209, v209, v122
    v_mfma_f32_16x16x32_bf16 v[72:75], a[12:15], v[128:131], 0
    buffer_load_dwordx4 v[128:131], v18, s[4:7], s77 offen offset:3072 sc1
    v_cvt_pk_bf16_f32 v216, v208, v209
    v_mfma_f32_16x16x32_bf16 v[48:51], a[16:19], v[132:135], v[48:51]
    v_mul_f32 v210, v210, v218
    v_mul_f32 v211, v211, v219
    v_mfma_f32_16x16x32_bf16 v[56:59], a[20:23], v[132:135], v[56:59]
    v_mul_f32 v210, v210, v122
    v_mul_f32 v211, v211, v122
    v_mfma_f32_16x16x32_bf16 v[64:67], a[24:27], v[132:135], v[64:67]
    v_cvt_pk_bf16_f32 v217, v210, v211
    v_mul_f32 v212, v212, v220
    v_mfma_f32_16x16x32_bf16 v[72:75], a[28:31], v[132:135], v[72:75]
    buffer_load_dwordx4 v[132:135], v19, s[4:7], s77 offen offset:1024 sc1
    v_mul_f32 v213, v213, v221
    v_mfma_f32_16x16x32_bf16 v[48:51], a[32:35], v[136:139], v[48:51]
    v_mul_f32 v212, v212, v123
    v_mul_f32 v213, v213, v123
    v_mfma_f32_16x16x32_bf16 v[56:59], a[36:39], v[136:139], v[56:59]
    v_cvt_pk_bf16_f32 v218, v212, v213
    v_mul_f32 v214, v214, v222
    v_mfma_f32_16x16x32_bf16 v[64:67], a[40:43], v[136:139], v[64:67]
    v_mul_f32 v215, v215, v223
    v_mul_f32 v214, v214, v123
    v_mfma_f32_16x16x32_bf16 v[72:75], a[44:47], v[136:139], v[72:75]
    s_waitcnt vmcnt(15)
    buffer_load_dwordx4 v[136:139], v19, s[4:7], s77 offen offset:3072 sc1
    v_mul_f32 v215, v215, v123
    v_mfma_f32_16x16x32_bf16 v[48:51], a[48:51], v[140:143], v[48:51]
    v_cvt_pk_bf16_f32 v219, v214, v215
    v_permlane32_swap_b32 v216, v218
    v_mfma_f32_16x16x32_bf16 v[56:59], a[52:55], v[140:143], v[56:59]
    v_permlane32_swap_b32 v217, v219
    v_mfma_f32_16x16x32_bf16 v[64:67], a[56:59], v[140:143], v[64:67]
    buffer_store_dwordx4 v[216:219], v251, s[4:7], s74 offen offset:512
    v_mfma_f32_16x16x32_bf16 v[72:75], a[60:63], v[140:143], v[72:75]
    s_waitcnt vmcnt(16)
    buffer_load_dwordx4 v[140:143], v20, s[4:7], s77 offen offset:1024 sc1
    v_mfma_f32_16x16x32_bf16 v[48:51], a[64:67], v[144:147], v[48:51]
    v_mfma_f32_16x16x32_bf16 v[56:59], a[68:71], v[144:147], v[56:59]
    v_mfma_f32_16x16x32_bf16 v[64:67], a[72:75], v[144:147], v[64:67]
    v_mfma_f32_16x16x32_bf16 v[72:75], a[76:79], v[144:147], v[72:75]
    s_waitcnt vmcnt(16)
    buffer_load_dwordx4 v[144:147], v20, s[4:7], s77 offen offset:3072 sc1
    v_mfma_f32_16x16x32_bf16 v[48:51], a[80:83], v[148:151], v[48:51]
    v_mfma_f32_16x16x32_bf16 v[56:59], a[84:87], v[148:151], v[56:59]
    v_mfma_f32_16x16x32_bf16 v[64:67], a[88:91], v[148:151], v[64:67]
    v_mfma_f32_16x16x32_bf16 v[72:75], a[92:95], v[148:151], v[72:75]
    s_waitcnt vmcnt(16)
    buffer_load_dwordx4 v[148:151], v21, s[4:7], s77 offen offset:1024 sc1
    v_mfma_f32_16x16x32_bf16 v[48:51], a[96:99], v[152:155], v[48:51]
    v_mfma_f32_16x16x32_bf16 v[56:59], a[100:103], v[152:155], v[56:59]
    v_mfma_f32_16x16x32_bf16 v[64:67], a[104:107], v[152:155], v[64:67]
    v_mfma_f32_16x16x32_bf16 v[72:75], a[108:111], v[152:155], v[72:75]
    s_waitcnt vmcnt(16)
    v_mfma_f32_16x16x32_bf16 v[48:51], a[112:115], v[156:159], v[48:51]
    v_mfma_f32_16x16x32_bf16 v[56:59], a[116:119], v[156:159], v[56:59]
    v_mfma_f32_16x16x32_bf16 v[64:67], a[120:123], v[156:159], v[64:67]
    v_mfma_f32_16x16x32_bf16 v[72:75], a[124:127], v[156:159], v[72:75]
    s_waitcnt vmcnt(15)
    v_mfma_f32_16x16x32_bf16 v[48:51], a[128:131], v[160:163], v[48:51]
    v_mfma_f32_16x16x32_bf16 v[56:59], a[132:135], v[160:163], v[56:59]
    s_waitcnt vmcnt(3)
    s_cbranch_vccnz SAFE_140
    buffer_store_dword v11, v10, s[4:7], s76 offen offset:2048
BACK_141:
    v_mfma_f32_16x16x32_bf16 v[64:67], a[136:139], v[160:163], v[64:67]
    v_mfma_f32_16x16x32_bf16 v[72:75], a[140:143], v[160:163], v[72:75]
    v_mfma_f32_16x16x32_bf16 v[48:51], a[144:147], v[164:167], v[48:51]
    v_mfma_f32_16x16x32_bf16 v[56:59], a[148:151], v[164:167], v[56:59]
    v_mfma_f32_16x16x32_bf16 v[64:67], a[152:155], v[164:167], v[64:67]
    v_mfma_f32_16x16x32_bf16 v[72:75], a[156:159], v[164:167], v[72:75]
    v_mfma_f32_16x16x32_bf16 v[48:51], a[160:163], v[168:171], v[48:51]
    v_mfma_f32_16x16x32_bf16 v[56:59], a[164:167], v[168:171], v[56:59]
    v_mfma_f32_16x16x32_bf16 v[64:67], a[168:171], v[168:171], v[64:67]
    v_mfma_f32_16x16x32_bf16 v[72:75], a[172:175], v[168:171], v[72:75]
    v_mfma_f32_16x16x32_bf16 v[52:55], a[0:3], v[172:175], 0
    v_mfma_f32_16x16x32_bf16 v[60:63], a[4:7], v[172:175], 0
    v_mfma_f32_16x16x32_bf16 v[68:71], a[8:11], v[172:175], 0
    v_mfma_f32_16x16x32_bf16 v[76:79], a[12:15], v[172:175], 0
    v_mfma_f32_16x16x32_bf16 v[52:55], a[16:19], v[176:179], v[52:55]
    v_mfma_f32_16x16x32_bf16 v[60:63], a[20:23], v[176:179], v[60:63]
    ds_write_b128 v5, v[48:51] offset:0
    v_mfma_f32_16x16x32_bf16 v[68:71], a[24:27], v[176:179], v[68:71]
    v_mfma_f32_16x16x32_bf16 v[76:79], a[28:31], v[176:179], v[76:79]
    v_mfma_f32_16x16x32_bf16 v[52:55], a[32:35], v[180:183], v[52:55]
    v_mfma_f32_16x16x32_bf16 v[60:63], a[36:39], v[180:183], v[60:63]
    ds_write_b128 v5, v[56:59] offset:2048
    v_mfma_f32_16x16x32_bf16 v[68:71], a[40:43], v[180:183], v[68:71]
    v_mfma_f32_16x16x32_bf16 v[76:79], a[44:47], v[180:183], v[76:79]
    v_mfma_f32_16x16x32_bf16 v[52:55], a[48:51], v[184:187], v[52:55]
    v_mfma_f32_16x16x32_bf16 v[60:63], a[52:55], v[184:187], v[60:63]
    buffer_load_dword v14, v9, s[4:7], s80 offen offset:2048 sc1
    ds_write_b128 v5, v[64:67] offset:4096
    v_mfma_f32_16x16x32_bf16 v[68:71], a[56:59], v[184:187], v[68:71]
    v_mfma_f32_16x16x32_bf16 v[76:79], a[60:63], v[184:187], v[76:79]
    v_mfma_f32_16x16x32_bf16 v[52:55], a[64:67], v[188:191], v[52:55]
    v_mfma_f32_16x16x32_bf16 v[60:63], a[68:71], v[188:191], v[60:63]
    ds_write_b128 v5, v[72:75] offset:6144
    v_mfma_f32_16x16x32_bf16 v[68:71], a[72:75], v[188:191], v[68:71]
    v_mfma_f32_16x16x32_bf16 v[76:79], a[76:79], v[188:191], v[76:79]
    v_mfma_f32_16x16x32_bf16 v[52:55], a[80:83], v[128:131], v[52:55]
    v_mfma_f32_16x16x32_bf16 v[60:63], a[84:87], v[128:131], v[60:63]
    v_mfma_f32_16x16x32_bf16 v[68:71], a[88:91], v[128:131], v[68:71]
    v_mfma_f32_16x16x32_bf16 v[76:79], a[92:95], v[128:131], v[76:79]
    v_mfma_f32_16x16x32_bf16 v[52:55], a[96:99], v[132:135], v[52:55]
    v_mfma_f32_16x16x32_bf16 v[60:63], a[100:103], v[132:135], v[60:63]
    v_mfma_f32_16x16x32_bf16 v[68:71], a[104:107], v[132:135], v[68:71]
    v_mfma_f32_16x16x32_bf16 v[76:79], a[108:111], v[132:135], v[76:79]
    v_mfma_f32_16x16x32_bf16 v[52:55], a[112:115], v[136:139], v[52:55]
    v_mfma_f32_16x16x32_bf16 v[60:63], a[116:119], v[136:139], v[60:63]
    s_waitcnt vmcnt(0)
    v_cmp_gt_u32 vcc, s34, v14
    s_cbranch_vccnz SPIN_142
BACK_143:
    v_mfma_f32_16x16x32_bf16 v[68:71], a[120:123], v[136:139], v[68:71]
    buffer_load_dwordx4 v[152:155], v16, s[4:7], s78 offen offset:0 sc1
    v_mfma_f32_16x16x32_bf16 v[76:79], a[124:127], v[136:139], v[76:79]
    buffer_load_dwordx4 v[156:159], v16, s[4:7], s78 offen offset:2048 sc1
    v_mfma_f32_16x16x32_bf16 v[52:55], a[128:131], v[140:143], v[52:55]
    buffer_load_dwordx4 v[160:163], v17, s[4:7], s78 offen offset:0 sc1
    v_mfma_f32_16x16x32_bf16 v[60:63], a[132:135], v[140:143], v[60:63]
    buffer_load_dwordx4 v[164:167], v17, s[4:7], s78 offen offset:2048 sc1
    v_mfma_f32_16x16x32_bf16 v[68:71], a[136:139], v[140:143], v[68:71]
    buffer_load_dwordx4 v[168:171], v18, s[4:7], s78 offen offset:0 sc1
    v_mfma_f32_16x16x32_bf16 v[76:79], a[140:143], v[140:143], v[76:79]
    buffer_load_dwordx4 v[172:175], v18, s[4:7], s78 offen offset:2048 sc1
    v_mfma_f32_16x16x32_bf16 v[52:55], a[144:147], v[144:147], v[52:55]
    buffer_load_dwordx4 v[176:179], v19, s[4:7], s78 offen offset:0 sc1
    v_mfma_f32_16x16x32_bf16 v[60:63], a[148:151], v[144:147], v[60:63]
    buffer_load_dwordx4 v[180:183], v19, s[4:7], s78 offen offset:2048 sc1
    v_mfma_f32_16x16x32_bf16 v[68:71], a[152:155], v[144:147], v[68:71]
    buffer_load_dwordx4 v[184:187], v20, s[4:7], s78 offen offset:0 sc1
    v_mfma_f32_16x16x32_bf16 v[76:79], a[156:159], v[144:147], v[76:79]
    buffer_load_dwordx4 v[188:191], v20, s[4:7], s78 offen offset:2048 sc1
    v_mfma_f32_16x16x32_bf16 v[52:55], a[160:163], v[148:151], v[52:55]
    v_mfma_f32_16x16x32_bf16 v[60:63], a[164:167], v[148:151], v[60:63]
    v_mfma_f32_16x16x32_bf16 v[68:71], a[168:171], v[148:151], v[68:71]
    v_mfma_f32_16x16x32_bf16 v[76:79], a[172:175], v[148:151], v[76:79]
    s_branch C0_done
ATTG01_0:
    v_mfma_f32_32x32x16_bf16 v[96:111], v[136:139], v[148:151], 0
    s_waitcnt lgkmcnt(0)
    v_exp_f32 v112, v112
    v_exp_f32 v113, v113
    v_exp_f32 v114, v114
    v_exp_f32 v115, v115
    v_mfma_f32_32x32x16_bf16 v[208:223], v[68:71], v[132:135], v[208:223]
    s_mov_b64 exec, s[20:21]
    ds_read_b128 v[64:67], v251 offset:53248
    ds_read_b128 v[68:71], v251 offset:54272
    s_mov_b64 exec, -1
    v_cvt_pk_bf16_f32 v128, v112, v113
    v_exp_f32 v116, v116
    v_exp_f32 v117, v117
    v_cvt_pk_bf16_f32 v129, v114, v115
    v_exp_f32 v118, v118
    v_exp_f32 v119, v119
    v_exp_f32 v120, v120
    v_cvt_pk_bf16_f32 v130, v116, v117
    v_cvt_pk_bf16_f32 v131, v118, v119
    v_exp_f32 v121, v121
    v_exp_f32 v122, v122
    v_mfma_f32_32x32x16_bf16 v[208:223], v[72:75], v[128:131], v[208:223]
    v_exp_f32 v123, v123
    v_cvt_pk_bf16_f32 v132, v120, v121
    v_exp_f32 v124, v124
    v_exp_f32 v125, v125
    v_cvt_pk_bf16_f32 v133, v122, v123
    v_exp_f32 v126, v126
    v_exp_f32 v127, v127
    v_cvt_pk_bf16_f32 v134, v124, v125
    v_cvt_pk_bf16_f32 v135, v126, v127
    v_exp_f32 v96, v96
    v_exp_f32 v97, v97
    v_exp_f32 v98, v98
    v_exp_f32 v99, v99
    v_mfma_f32_32x32x16_bf16 v[208:223], v[76:79], v[132:135], v[208:223]
    v_cvt_pk_bf16_f32 v128, v96, v97
    v_exp_f32 v100, v100
    v_exp_f32 v101, v101
    v_cvt_pk_bf16_f32 v129, v98, v99
    v_exp_f32 v102, v102
    v_exp_f32 v103, v103
    v_exp_f32 v104, v104
    v_cvt_pk_bf16_f32 v130, v100, v101
    v_cvt_pk_bf16_f32 v131, v102, v103
    v_exp_f32 v105, v105
    v_exp_f32 v106, v106
    s_waitcnt lgkmcnt(0)
    v_mfma_f32_32x32x16_bf16 v[208:223], v[64:67], v[128:131], v[208:223]
    v_exp_f32 v107, v107
    v_cvt_pk_bf16_f32 v132, v104, v105
    v_exp_f32 v108, v108
    v_exp_f32 v109, v109
    v_cvt_pk_bf16_f32 v133, v106, v107
    v_exp_f32 v110, v110
    v_exp_f32 v111, v111
    v_cvt_pk_bf16_f32 v134, v108, v109
    v_cvt_pk_bf16_f32 v135, v110, v111
    s_nop 1
    v_mfma_f32_32x32x16_bf16 v[208:223], v[68:71], v[132:135], v[208:223]
    s_nop 11
    v_subrev_u32 v217, 0x2b800000, v216
    v_cmp_lt_u32 s[26:27], s87, v217
    s_nop 0
    s_cmp_lg_u64 s[26:27], 0
    s_cbranch_scc1 SLOW_172
BACK_173:
    v_rcp_f32 v217, v216
    s_nop 0
    v_mul_f32 v208, v208, v217
    v_mul_f32 v209, v209, v217
    v_cvt_pk_bf16_f32 v220, v208, v209
    v_mul_f32 v210, v210, v217
    v_mul_f32 v211, v211, v217
    v_cvt_pk_bf16_f32 v221, v210, v211
    v_mul_f32 v212, v212, v217
    v_mul_f32 v213, v213, v217
    v_cvt_pk_bf16_f32 v222, v212, v213
    v_mul_f32 v214, v214, v217
    v_mul_f32 v215, v215, v217
    v_cvt_pk_bf16_f32 v223, v214, v215
    buffer_store_dwordx4 v[220:223], v0, s[4:7], s54 offen
    s_waitcnt vmcnt(0)
    s_cbranch_vccnz SAFE_174
    buffer_store_dword v11, v10, s[4:7], s56 offen offset:0
BACK_175:
    buffer_load_dword v14, v15, s[4:7], s59 offen offset:0 sc1
    s_branch ATT1_done
ATTG01_1:
    v_mfma_f32_32x32x16_bf16 v[96:111], v[136:139], v[148:151], 0
    s_waitcnt lgkmcnt(0)
    v_exp_f32 v112, v112
    v_exp_f32 v113, v113
    v_exp_f32 v114, v114
    v_exp_f32 v115, v115
    v_mfma_f32_32x32x16_bf16 v[208:223], v[68:71], v[132:135], v[208:223]
    s_mov_b64 exec, s[20:21]
    ds_read_b128 v[64:67], v251 offset:53248
    ds_read_b128 v[68:71], v251 offset:54272
    s_mov_b64 exec, -1
    v_cvt_pk_bf16_f32 v128, v112, v113
    v_exp_f32 v116, v116
    v_exp_f32 v117, v117
    v_cvt_pk_bf16_f32 v129, v114, v115
    v_exp_f32 v118, v118
    v_exp_f32 v119, v119
    v_exp_f32 v120, v120
    v_cvt_pk_bf16_f32 v130, v116, v117
    v_cvt_pk_bf16_f32 v131, v118, v119
    v_exp_f32 v121, v121
    v_exp_f32 v122, v122
    v_mfma_f32_32x32x16_bf16 v[208:223], v[72:75], v[128:131], v[208:223]
    v_exp_f32 v123, v123
    v_cvt_pk_bf16_f32 v132, v120, v121
    v_exp_f32 v124, v124
    v_exp_f32 v125, v125
    v_cvt_pk_bf16_f32 v133, v122, v123
    v_exp_f32 v126, v126
    v_exp_f32 v127, v127
    v_cvt_pk_bf16_f32 v134, v124, v125
    v_cvt_pk_bf16_f32 v135, v126, v127
    v_exp_f32 v96, v96
    v_exp_f32 v97, v97
    v_exp_f32 v98, v98
    v_exp_f32 v99, v99
    v_mfma_f32_32x32x16_bf16 v[208:223], v[76:79], v[132:135], v[208:223]
    v_cvt_pk_bf16_f32 v128, v96, v97
    v_exp_f32 v100, v100
    v_exp_f32 v101, v101
    v_cvt_pk_bf16_f32 v129, v98, v99
    v_exp_f32 v102, v102
    v_exp_f32 v103, v103
    v_exp_f32 v104, v104
    v_cvt_pk_bf16_f32 v130, v100, v101
    v_cvt_pk_bf16_f32 v131, v102, v103
    v_exp_f32 v105, v105
    v_exp_f32 v106, v106
    s_waitcnt lgkmcnt(0)
    v_mfma_f32_32x32x16_bf16 v[208:223], v[64:67], v[128:131], v[208:223]
    v_exp_f32 v107, v107
    v_cvt_pk_bf16_f32 v132, v104, v105
    v_exp_f32 v108, v108
    v_exp_f32 v109, v109
    v_cvt_pk_bf16_f32 v133, v106, v107
    v_exp_f32 v110, v110
    v_exp_f32 v111, v111
    v_cvt_pk_bf16_f32 v134, v108, v109
    v_cvt_pk_bf16_f32 v135, v110, v111
    s_nop 1
    v_mfma_f32_32x32x16_bf16 v[208:223], v[68:71], v[132:135], v[208:223]
    s_nop 11
    v_subrev_u32 v217, 0x2b800000, v216
    v_cmp_lt_u32 s[26:27], s87, v217
    s_nop 0
    s_cmp_lg_u64 s[26:27], 0
    s_cbranch_scc1 SLOW_194
BACK_195:
    v_rcp_f32 v217, v216
    s_nop 0
    v_mul_f32 v208, v208, v217
    v_mul_f32 v209, v209, v217
    v_cvt_pk_bf16_f32 v220, v208, v209
    v_mul_f32 v210, v210, v217
    v_mul_f32 v211, v211, v217
    v_cvt_pk_bf16_f32 v221, v210, v211
    v_mul_f32 v212, v212, v217
    v_mul_f32 v213, v213, v217
    v_cvt_pk_bf16_f32 v222, v212, v213
    v_mul_f32 v214, v214, v217
    v_mul_f32 v215, v215, v217
    v_cvt_pk_bf16_f32 v223, v214, v215
    buffer_store_dwordx4 v[220:223], v0, s[4:7], s54 offen
    s_waitcnt vmcnt(0)
    s_cbranch_vccnz SAFE_196
    buffer_store_dword v11, v10, s[4:7], s56 offen offset:0
BACK_197:
    buffer_load_dword v14, v15, s[4:7], s59 offen offset:0 sc1
    s_branch ATT1_done
ATTG01_2:
    v_mfma_f32_32x32x16_bf16 v[96:111], v[136:139], v[144:147], 0
    s_waitcnt lgkmcnt(0)
    v_exp_f32 v112, v112
    v_exp_f32 v113, v113
    v_exp_f32 v114, v114
    v_exp_f32 v115, v115
    v_mfma_f32_32x32x16_bf16 v[208:223], v[68:71], v[132:135], v[208:223]
    s_mov_b64 exec, s[20:21]
    ds_read_b128 v[64:67], v250 offset:36864
    ds_read_b128 v[68:71], v250 offset:37888
    s_mov_b64 exec, -1
    v_cvt_pk_bf16_f32 v128, v112, v113
    v_exp_f32 v116, v116
    v_exp_f32 v117, v117
    v_cvt_pk_bf16_f32 v129, v114, v115
    v_exp_f32 v118, v118
    v_exp_f32 v119, v119
    v_exp_f32 v120, v120
    v_cvt_pk_bf16_f32 v130, v116, v117
    v_cvt_pk_bf16_f32 v131, v118, v119
    v_exp_f32 v121, v121
    v_exp_f32 v122, v122
    v_mfma_f32_32x32x16_bf16 v[192:207], v[72:75], v[128:131], v[192:207]
    v_exp_f32 v123, v123
    v_cvt_pk_bf16_f32 v132, v120, v121
    v_exp_f32 v124, v124
    v_exp_f32 v125, v125
    v_cvt_pk_bf16_f32 v133, v122, v123
    v_exp_f32 v126, v126
    v_exp_f32 v127, v127
    v_cvt_pk_bf16_f32 v134, v124, v125
    v_cvt_pk_bf16_f32 v135, v126, v127
    v_exp_f32 v96, v96
    v_exp_f32 v97, v97
    v_exp_f32 v98, v98
    v_exp_f32 v99, v99
    v_mfma_f32_32x32x16_bf16 v[192:207], v[76:79], v[132:135], v[192:207]
    v_cvt_pk_bf16_f32 v128, v96, v97
    v_exp_f32 v100, v100
    v_exp_f32 v101, v101
    v_cvt_pk_bf16_f32 v129, v98, v99
    v_exp_f32 v102, v102
    v_exp_f32 v103, v103
    v_exp_f32 v104, v104
    v_cvt_pk_bf16_f32 v130, v100, v101
    v_cvt_pk_bf16_f32 v131, v102, v103
    v_exp_f32 v105, v105
    v_exp_f32 v106, v106
    s_waitcnt lgkmcnt(0)
    v_mfma_f32_32x32x16_bf16 v[192:207], v[64:67], v[128:131], v[192:207]
    v_exp_f32 v107, v107
    v_cvt_pk_bf16_f32 v132, v104, v105
    v_exp_f32 v108, v108
    v_exp_f32 v109, v109
    v_cvt_pk_bf16_f32 v133, v106, v107
    v_exp_f32 v110, v110
    v_exp_f32 v111, v111
    v_cvt_pk_bf16_f32 v134, v108, v109
    v_cvt_pk_bf16_f32 v135, v110, v111
    s_nop 1
    v_mfma_f32_32x32x16_bf16 v[192:207], v[68:71], v[132:135], v[192:207]
    v_subrev_u32 v217, 0x2b800000, v216
    v_cmp_lt_u32 s[26:27], s87, v217
    s_nop 0
    s_cmp_lg_u64 s[26:27], 0
    s_cbranch_scc1 SLOW_216
BACK_217:
    v_rcp_f32 v217, v216
    s_nop 0
    v_mul_f32 v208, v208, v217
    v_mul_f32 v209, v209, v217
    v_cvt_pk_bf16_f32 v220, v208, v209
    v_mul_f32 v210, v210, v217
    v_mul_f32 v211, v211, v217
    v_cvt_pk_bf16_f32 v221, v210, v211
    v_mul_f32 v212, v212, v217
    v_mul_f32 v213, v213, v217
    v_cvt_pk_bf16_f32 v222, v212, v213
    v_mul_f32 v214, v214, v217
    v_mul_f32 v215, v215, v217
    v_cvt_pk_bf16_f32 v223, v214, v215
    buffer_store_dwordx4 v[220:223], v0, s[4:7], s54 offen
    s_waitcnt vmcnt(0)
    s_cbranch_vccnz SAFE_218
    buffer_store_dword v11, v10, s[4:7], s56 offen offset:0
BACK_219:
    buffer_load_dword v14, v15, s[4:7], s59 offen offset:0 sc1
    s_branch ATT1_done
ATTG01_3:
    v_mfma_f32_32x32x16_bf16 v[96:111], v[136:139], v[144:147], 0
    s_waitcnt lgkmcnt(0)
    v_exp_f32 v112, v112
    v_exp_f32 v113, v113
    v_exp_f32 v114, v114
    v_exp_f32 v115, v115
    v_mfma_f32_32x32x16_bf16 v[208:223], v[68:71], v[132:135], v[208:223]
    s_mov_b64 exec, s[20:21]
    ds_read_b128 v[64:67], v250 offset:36864
    ds_read_b128 v[68:71], v250 offset:37888
    s_mov_b64 exec, -1
    v_cvt_pk_bf16_f32 v128, v112, v113
    v_exp_f32 v116, v116
    v_exp_f32 v117, v117
    v_cvt_pk_bf16_f32 v129, v114, v115
    v_exp_f32 v118, v118
    v_exp_f32 v119, v119
    v_exp_f32 v120, v120
    v_cvt_pk_bf16_f32 v130, v116, v117
    v_cvt_pk_bf16_f32 v131, v118, v119
    v_exp_f32 v121, v121
    v_exp_f32 v122, v122
    v_mfma_f32_32x32x16_bf16 v[192:207], v[72:75], v[128:131], v[192:207]
    v_exp_f32 v123, v123
    v_cvt_pk_bf16_f32 v132, v120, v121
    v_exp_f32 v124, v124
    v_exp_f32 v125, v125
    v_cvt_pk_bf16_f32 v133, v122, v123
    v_exp_f32 v126, v126
    v_exp_f32 v127, v127
    v_cvt_pk_bf16_f32 v134, v124, v125
    v_cvt_pk_bf16_f32 v135, v126, v127
    v_exp_f32 v96, v96
    v_exp_f32 v97, v97
    v_exp_f32 v98, v98
    v_exp_f32 v99, v99
    v_mfma_f32_32x32x16_bf16 v[192:207], v[76:79], v[132:135], v[192:207]
    v_cvt_pk_bf16_f32 v128, v96, v97
    v_exp_f32 v100, v100
    v_exp_f32 v101, v101
    v_cvt_pk_bf16_f32 v129, v98, v99
    v_exp_f32 v102, v102
    v_exp_f32 v103, v103
    v_exp_f32 v104, v104
    v_cvt_pk_bf16_f32 v130, v100, v101
    v_cvt_pk_bf16_f32 v131, v102, v103
    v_exp_f32 v105, v105
    v_exp_f32 v106, v106
    s_waitcnt lgkmcnt(0)
    v_mfma_f32_32x32x16_bf16 v[192:207], v[64:67], v[128:131], v[192:207]
    v_exp_f32 v107, v107
    v_cvt_pk_bf16_f32 v132, v104, v105
    v_exp_f32 v108, v108
    v_exp_f32 v109, v109
    v_cvt_pk_bf16_f32 v133, v106, v107
    v_exp_f32 v110, v110
    v_exp_f32 v111, v111
    v_cvt_pk_bf16_f32 v134, v108, v109
    v_cvt_pk_bf16_f32 v135, v110, v111
    s_nop 1
    v_mfma_f32_32x32x16_bf16 v[192:207], v[68:71], v[132:135], v[192:207]
    v_subrev_u32 v217, 0x2b800000, v216
    v_cmp_lt_u32 s[26:27], s87, v217
    s_nop 0
    s_cmp_lg_u64 s[26:27], 0
    s_cbranch_scc1 SLOW_238
BACK_239:
    v_rcp_f32 v217, v216
    s_nop 0
    v_mul_f32 v208, v208, v217
    v_mul_f32 v209, v209, v217
    v_cvt_pk_bf16_f32 v220, v208, v209
    v_mul_f32 v210, v210, v217
    v_mul_f32 v211, v211, v217
    v_cvt_pk_bf16_f32 v221, v210, v211
    v_mul_f32 v212, v212, v217
    v_mul_f32 v213, v213, v217
    v_cvt_pk_bf16_f32 v222, v212, v213
    v_mul_f32 v214, v214, v217
    v_mul_f32 v215, v215, v217
    v_cvt_pk_bf16_f32 v223, v214, v215
    buffer_store_dwordx4 v[220:223], v0, s[4:7], s54 offen
    s_waitcnt vmcnt(0)
    s_cbranch_vccnz SAFE_240
    buffer_store_dword v11, v10, s[4:7], s56 offen offset:0
BACK_241:
    buffer_load_dword v14, v15, s[4:7], s59 offen offset:0 sc1
    s_branch ATT1_done
C1_2:
    s_nop 7
    v_accvgpr_read_b32 v224, a248
    v_accvgpr_read_b32 v225, a249
    v_accvgpr_read_b32 v226, a250
    v_accvgpr_read_b32 v227, a251
    v_accvgpr_read_b32 v228, a252
    v_accvgpr_read_b32 v229, a253
    v_accvgpr_read_b32 v230, a254
    v_accvgpr_read_b32 v231, a255
    ds_write_b128 v5, v[132:135] offset:33792
    ds_write_b128 v5, v[140:143] offset:35840
    ds_write_b128 v5, v[148:151] offset:37888
    ds_write_b128 v5, v[156:159] offset:39936
    s_waitcnt vmcnt(0)
    v_cmp_gt_u32 vcc, s35, v14
    s_cbranch_vccz BACK_278
SPIN_277:
    buffer_load_dword v14, v9, s[4:7], s71 offen offset:1024 sc1
    s_sub_u32 s16, s16, 1
    s_cbranch_scc1 M_end
    s_waitcnt vmcnt(0)
    v_cmp_gt_u32 vcc, 2, v14
    s_cbranch_vccnz SPIN_277
    s_cmp_lg_u32 s15, 0
    s_cbranch_scc1 SPIN2_279
BACK_278:
    buffer_load_dwordx4 v[32:35], v240, s[8:11], s67 offen offset:0 sc1
    buffer_load_dwordx4 v[36:39], v240, s[8:11], s67 offen offset:1024 sc1
    buffer_load_dwordx4 v[40:43], v240, s[8:11], s67 offen offset:2048 sc1
    buffer_load_dwordx4 v[44:47], v240, s[8:11], s67 offen offset:3072 sc1
    ds_read_b128 v[80:83], v248 offset:0
    ds_read_b128 v[84:87], v248 offset:1024
    ds_read_b128 v[88:91], v248 offset:256
    ds_read_b128 v[92:95], v248 offset:1280
    ds_read_b128 v[96:99], v248 offset:6144
    ds_read_b128 v[100:103], v248 offset:7168
    s_waitcnt lgkmcnt(6)
    s_barrier
    s_waitcnt vmcnt(2) lgkmcnt(5)
    v_mfma_f32_16x16x32_bf16 v[144:147], v[80:83], v[32:35], 0
    v_mfma_f32_16x16x32_bf16 v[148:151], v[80:83], v[36:39], 0
    s_waitcnt lgkmcnt(4)
    ds_read_b128 v[80:83], v248 offset:6400
    buffer_load_dwordx4 v[48:51], v241, s[8:11], s67 offen offset:0 sc1
    v_mfma_f32_16x16x32_bf16 v[160:163], v[84:87], v[32:35], 0
    ds_read_b128 v[192:195], v6 offset:32768
    ds_read_b128 v[196:199], v6 offset:33280
    v_mfma_f32_16x16x32_bf16 v[164:167], v[84:87], v[36:39], 0
    s_waitcnt lgkmcnt(6)
    ds_read_b128 v[84:87], v248 offset:7424
    buffer_load_dwordx4 v[52:55], v241, s[8:11], s67 offen offset:1024 sc1
    v_mfma_f32_16x16x32_bf16 v[152:155], v[88:91], v[32:35], 0
    ds_read_b128 v[200:203], v6 offset:40960
    ds_read_b128 v[204:207], v6 offset:41472
    v_mfma_f32_16x16x32_bf16 v[156:159], v[88:91], v[36:39], 0
    s_waitcnt lgkmcnt(8)
    ds_read_b128 v[88:91], v248 offset:12288
    ds_read_b128 v[208:211], v6 offset:49152
    v_mfma_f32_16x16x32_bf16 v[168:171], v[92:95], v[32:35], 0
    ds_read_b128 v[212:215], v6 offset:49664
    v_mfma_f32_16x16x32_bf16 v[172:175], v[92:95], v[36:39], 0
    s_waitcnt vmcnt(2) lgkmcnt(10)
    ds_read_b128 v[92:95], v248 offset:13312
    buffer_load_dwordx4 v[56:59], v241, s[8:11], s67 offen offset:2048 sc1
    v_mfma_f32_16x16x32_bf16 v[144:147], v[96:99], v[40:43], v[144:147]
    ds_read_b128 v[216:219], v6 offset:57344
    ds_read_b128 v[220:223], v6 offset:57856
    v_mfma_f32_16x16x32_bf16 v[148:151], v[96:99], v[44:47], v[148:151]
    s_waitcnt lgkmcnt(12)
    ds_read_b128 v[96:99], v248 offset:12544
    v_mfma_f32_16x16x32_bf16 v[160:163], v[100:103], v[40:43], v[160:163]
    v_mfma_f32_16x16x32_bf16 v[164:167], v[100:103], v[44:47], v[164:167]
    s_waitcnt lgkmcnt(7)
    ds_read_b128 v[100:103], v248 offset:13568
    buffer_load_dwordx4 v[60:63], v241, s[8:11], s67 offen offset:3072 sc1
    v_mfma_f32_16x16x32_bf16 v[152:155], v[80:83], v[40:43], v[152:155]
    v_add_f32 v224, v224, v192
    v_add_f32 v225, v225, v193
    v_mfma_f32_16x16x32_bf16 v[156:159], v[80:83], v[44:47], v[156:159]
    ds_read_b128 v[80:83], v248 offset:18432
    buffer_load_dwordx4 v[64:67], v242, s[8:11], s67 offen offset:0 sc1
    v_mfma_f32_16x16x32_bf16 v[168:171], v[84:87], v[40:43], v[168:171]
    v_add_f32 v226, v226, v194
    v_add_f32 v227, v227, v195
    v_mfma_f32_16x16x32_bf16 v[172:175], v[84:87], v[44:47], v[172:175]
    s_waitcnt vmcnt(3) lgkmcnt(8)
    ds_read_b128 v[84:87], v248 offset:19456
    v_add_f32 v228, v228, v196
    v_mfma_f32_16x16x32_bf16 v[144:147], v[88:91], v[48:51], v[144:147]
    v_add_f32 v229, v229, v197
    v_add_f32 v230, v230, v198
    v_mfma_f32_16x16x32_bf16 v[148:151], v[88:91], v[52:55], v[148:151]
    s_waitcnt lgkmcnt(6)
    ds_read_b128 v[88:91], v248 offset:18688
    buffer_load_dwordx4 v[68:71], v242, s[8:11], s67 offen offset:1024 sc1
    v_mfma_f32_16x16x32_bf16 v[160:163], v[92:95], v[48:51], v[160:163]
    v_add_f32 v231, v231, v199
    v_add_f32 v224, v224, v200
    v_mfma_f32_16x16x32_bf16 v[164:167], v[92:95], v[52:55], v[164:167]
    s_waitcnt lgkmcnt(4)
    ds_read_b128 v[92:95], v248 offset:19712
    v_add_f32 v225, v225, v201
    v_mfma_f32_16x16x32_bf16 v[152:155], v[96:99], v[48:51], v[152:155]
    v_add_f32 v226, v226, v202
    v_add_f32 v227, v227, v203
    v_mfma_f32_16x16x32_bf16 v[156:159], v[96:99], v[52:55], v[156:159]
    s_waitcnt lgkmcnt(4)
    ds_read_b128 v[96:99], v248 offset:24576
    buffer_load_dwordx4 v[72:75], v242, s[8:11], s67 offen offset:2048 sc1
    v_mfma_f32_16x16x32_bf16 v[168:171], v[100:103], v[48:51], v[168:171]
    v_add_f32 v228, v228, v204
    v_add_f32 v229, v229, v205
    v_mfma_f32_16x16x32_bf16 v[172:175], v[100:103], v[52:55], v[172:175]
    s_waitcnt vmcnt(3) lgkmcnt(4)
    ds_read_b128 v[100:103], v248 offset:25600
    buffer_load_dwordx4 v[76:79], v242, s[8:11], s67 offen offset:3072 sc1
    v_mfma_f32_16x16x32_bf16 v[144:147], v[80:83], v[56:59], v[144:147]
    v_add_f32 v230, v230, v206
    v_add_f32 v231, v231, v207
    v_mfma_f32_16x16x32_bf16 v[148:151], v[80:83], v[60:63], v[148:151]
    s_waitcnt lgkmcnt(4)
    ds_read_b128 v[80:83], v248 offset:24832
    v_add_f32 v224, v224, v208
    v_mfma_f32_16x16x32_bf16 v[160:163], v[84:87], v[56:59], v[160:163]
    v_add_f32 v225, v225, v209
    v_add_f32 v226, v226, v210
    v_mfma_f32_16x16x32_bf16 v[164:167], v[84:87], v[60:63], v[164:167]
    s_waitcnt lgkmcnt(4)
    ds_read_b128 v[84:87], v248 offset:25856
    buffer_load_dwordx4 v[32:35], v243, s[8:11], s67 offen offset:0 sc1
    v_mfma_f32_16x16x32_bf16 v[152:155], v[88:91], v[56:59], v[152:155]
    v_add_f32 v227, v227, v211
    v_add_f32 v228, v228, v212
    v_mfma_f32_16x16x32_bf16 v[156:159], v[88:91], v[60:63], v[156:159]
    s_waitcnt lgkmcnt(4)
    ds_read_b128 v[88:91], v248 offset:30720
    v_add_f32 v229, v229, v213
    v_mfma_f32_16x16x32_bf16 v[168:171], v[92:95], v[56:59], v[168:171]
    v_add_f32 v230, v230, v214
    v_add_f32 v231, v231, v215
    v_mfma_f32_16x16x32_bf16 v[172:175], v[92:95], v[60:63], v[172:175]
    s_waitcnt vmcnt(3) lgkmcnt(4)
    ds_read_b128 v[92:95], v248 offset:31744
    buffer_load_dwordx4 v[36:39], v243, s[8:11], s67 offen offset:1024 sc1
    v_mfma_f32_16x16x32_bf16 v[144:147], v[96:99], v[64:67], v[144:147]
    v_add_f32 v224, v224, v216
    v_add_f32 v225, v225, v217
    v_mfma_f32_16x16x32_bf16 v[148:151], v[96:99], v[68:71], v[148:151]
    s_waitcnt lgkmcnt(4)
    ds_read_b128 v[96:99], v248 offset:30976
    buffer_load_dwordx4 v[40:43], v243, s[8:11], s67 offen offset:2048 sc1
    v_mfma_f32_16x16x32_bf16 v[160:163], v[100:103], v[64:67], v[160:163]
    v_add_f32 v226, v226, v218
    v_add_f32 v227, v227, v219
    v_mfma_f32_16x16x32_bf16 v[164:167], v[100:103], v[68:71], v[164:167]
    s_waitcnt lgkmcnt(4)
    ds_read_b128 v[100:103], v248 offset:32000
    v_add_f32 v228, v228, v220
    v_mfma_f32_16x16x32_bf16 v[152:155], v[80:83], v[64:67], v[152:155]
    v_add_f32 v229, v229, v221
    v_add_f32 v230, v230, v222
    v_mfma_f32_16x16x32_bf16 v[156:159], v[80:83], v[68:71], v[156:159]
    s_waitcnt lgkmcnt(4)
    ds_read_b128 v[80:83], v248 offset:36864
    buffer_load_dwordx4 v[44:47], v243, s[8:11], s67 offen offset:3072 sc1
    v_mfma_f32_16x16x32_bf16 v[168:171], v[84:87], v[64:67], v[168:171]
    v_add_f32 v231, v231, v223
    v_cvt_pk_bf16_f32 v192, v224, v225
    v_mfma_f32_16x16x32_bf16 v[172:175], v[84:87], v[68:71], v[172:175]
    s_waitcnt vmcnt(4) lgkmcnt(4)
    ds_read_b128 v[84:87], v248 offset:37888
    v_cvt_pk_bf16_f32 v193, v226, v227
    v_mfma_f32_16x16x32_bf16 v[144:147], v[88:91], v[72:75], v[144:147]
    v_cvt_pk_bf16_f32 v194, v228, v229
    v_cvt_pk_bf16_f32 v195, v230, v231
    v_mfma_f32_16x16x32_bf16 v[148:151], v[88:91], v[76:79], v[148:151]
    s_waitcnt lgkmcnt(4)
    ds_read_b128 v[88:91], v248 offset:37120
    buffer_load_dwordx4 v[48:51], v244, s[8:11], s67 offen offset:0 sc1
    v_mfma_f32_16x16x32_bf16 v[160:163], v[92:95], v[72:75], v[160:163]
    buffer_store_dwordx4 v[192:195], v7, s[8:11], s62 offen
    v_dot2_f32_bf16 v196, v192, s36, 0
    v_dot2_f32_bf16 v197, v192, v192, 0
    v_dot2_f32_bf16 v196, v193, s36, v196
    v_dot2_f32_bf16 v197, v193, v193, v197
    v_dot2_f32_bf16 v196, v194, s36, v196
    v_dot2_f32_bf16 v197, v194, v194, v197
    v_dot2_f32_bf16 v196, v195, s36, v196
    v_dot2_f32_bf16 v197, v195, v195, v197
    v_mfma_f32_16x16x32_bf16 v[164:167], v[92:95], v[76:79], v[164:167]
    s_waitcnt lgkmcnt(4)
    ds_read_b128 v[92:95], v248 offset:38144
    v_accvgpr_write_b32 a248, v224
    v_mfma_f32_16x16x32_bf16 v[152:155], v[96:99], v[72:75], v[152:155]
    v_accvgpr_write_b32 a249, v225
    v_accvgpr_write_b32 a250, v226
    v_mfma_f32_16x16x32_bf16 v[156:159], v[96:99], v[76:79], v[156:159]
    s_waitcnt lgkmcnt(4)
    ds_read_b128 v[96:99], v248 offset:43008
    buffer_load_dwordx4 v[52:55], v244, s[8:11], s67 offen offset:1024 sc1
    v_mfma_f32_16x16x32_bf16 v[168:171], v[100:103], v[72:75], v[168:171]
    v_permlane16_swap_b32 v196, v197
    v_add_f32 v196, v196, v197
    v_mfma_f32_16x16x32_bf16 v[172:175], v[100:103], v[76:79], v[172:175]
    s_waitcnt vmcnt(5) lgkmcnt(4)
    ds_read_b128 v[100:103], v248 offset:44032
    buffer_load_dwordx4 v[56:59], v244, s[8:11], s67 offen offset:2048 sc1
    v_mfma_f32_16x16x32_bf16 v[144:147], v[80:83], v[32:35], v[144:147]
    v_mov_b32 v197, v196
    v_accvgpr_write_b32 a251, v227
    v_mfma_f32_16x16x32_bf16 v[148:151], v[80:83], v[36:39], v[148:151]
    s_waitcnt lgkmcnt(4)
    ds_read_b128 v[80:83], v248 offset:43264
    v_accvgpr_write_b32 a252, v228
    v_mfma_f32_16x16x32_bf16 v[160:163], v[84:87], v[32:35], v[160:163]
    v_permlane32_swap_b32 v196, v197
    v_add_f32 v196, v196, v197
    v_mfma_f32_16x16x32_bf16 v[164:167], v[84:87], v[36:39], v[164:167]
    s_waitcnt lgkmcnt(4)
    ds_read_b128 v[84:87], v248 offset:44288
    buffer_load_dwordx4 v[60:63], v244, s[8:11], s67 offen offset:3072 sc1
    v_mfma_f32_16x16x32_bf16 v[152:155], v[88:91], v[32:35], v[152:155]
    v_accvgpr_write_b32 a253, v229
    v_accvgpr_write_b32 a254, v230
    v_mfma_f32_16x16x32_bf16 v[156:159], v[88:91], v[36:39], v[156:159]
    s_waitcnt lgkmcnt(4)
    ds_read_b128 v[88:91], v248 offset:49152
    v_add_f32_dpp v196, v196, v196 row_ror:8 row_mask:0xf bank_mask:0xf
    v_mfma_f32_16x16x32_bf16 v[168:171], v[92:95], v[32:35], v[168:171]
    s_cbranch_vccnz SAFE_280
    buffer_store_dword v196, v8, s[4:7], s64 offen
BACK_281:
    v_mfma_f32_16x16x32_bf16 v[172:175], v[92:95], v[36:39], v[172:175]
    s_waitcnt vmcnt(6) lgkmcnt(4)
    ds_read_b128 v[92:95], v248 offset:50176
    buffer_load_dwordx4 v[64:67], v245, s[8:11], s67 offen offset:0 sc1
    v_mfma_f32_16x16x32_bf16 v[144:147], v[96:99], v[40:43], v[144:147]
    v_accvgpr_write_b32 a255, v231
    v_mfma_f32_16x16x32_bf16 v[148:151], v[96:99], v[44:47], v[148:151]
    s_waitcnt lgkmcnt(4)
    ds_read_b128 v[96:99], v248 offset:49408
    buffer_load_dwordx4 v[68:71], v245, s[8:11], s67 offen offset:1024 sc1
    v_mfma_f32_16x16x32_bf16 v[160:163], v[100:103], v[40:43], v[160:163]
    v_mfma_f32_16x16x32_bf16 v[164:167], v[100:103], v[44:47], v[164:167]
    s_waitcnt lgkmcnt(4)
    ds_read_b128 v[100:103], v248 offset:50432
    v_mfma_f32_16x16x32_bf16 v[152:155], v[80:83], v[40:43], v[152:155]
    v_mfma_f32_16x16x32_bf16 v[156:159], v[80:83], v[44:47], v[156:159]
    s_waitcnt lgkmcnt(4)
    ds_read_b128 v[80:83], v248 offset:55296
    buffer_load_dwordx4 v[72:75], v245, s[8:11], s67 offen offset:2048 sc1
    v_mfma_f32_16x16x32_bf16 v[168:171], v[84:87], v[40:43], v[168:171]
    v_mfma_f32_16x16x32_bf16 v[172:175], v[84:87], v[44:47], v[172:175]
    s_waitcnt vmcnt(6) lgkmcnt(4)
    ds_read_b128 v[84:87], v248 offset:56320
    v_mfma_f32_16x16x32_bf16 v[144:147], v[88:91], v[48:51], v[144:147]
    v_mfma_f32_16x16x32_bf16 v[148:151], v[88:91], v[52:55], v[148:151]
    s_waitcnt lgkmcnt(4)
    ds_read_b128 v[88:91], v248 offset:55552
    buffer_load_dwordx4 v[76:79], v245, s[8:11], s67 offen offset:3072 sc1
    v_mfma_f32_16x16x32_bf16 v[160:163], v[92:95], v[48:51], v[160:163]
    v_mfma_f32_16x16x32_bf16 v[164:167], v[92:95], v[52:55], v[164:167]
    s_waitcnt lgkmcnt(4)
    ds_read_b128 v[92:95], v248 offset:56576
    buffer_load_dwordx4 v[32:35], v246, s[8:11], s67 offen offset:0 sc1
    v_mfma_f32_16x16x32_bf16 v[152:155], v[96:99], v[48:51], v[152:155]
    v_mfma_f32_16x16x32_bf16 v[156:159], v[96:99], v[52:55], v[156:159]
    s_waitcnt vmcnt(5) lgkmcnt(4)
    ds_read_b128 v[96:99], v249 offset:0
    v_mfma_f32_16x16x32_bf16 v[168:171], v[100:103], v[48:51], v[168:171]
    s_cbranch_vccnz SAFE_285
    buffer_store_dword v11, v10, s[4:7], s66 offen offset:1024
BACK_286:
    v_mfma_f32_16x16x32_bf16 v[172:175], v[100:103], v[52:55], v[172:175]
    s_waitcnt lgkmcnt(4)
    ds_read_b128 v[100:103], v249 offset:1024
    buffer_load_dwordx4 v[36:39], v246, s[8:11], s67 offen offset:1024 sc1
    v_mfma_f32_16x16x32_bf16 v[144:147], v[80:83], v[56:59], v[144:147]
    v_mfma_f32_16x16x32_bf16 v[148:151], v[80:83], v[60:63], v[148:151]
    s_waitcnt lgkmcnt(4)
    ds_read_b128 v[80:83], v249 offset:256
    v_mfma_f32_16x16x32_bf16 v[160:163], v[84:87], v[56:59], v[160:163]
    v_mfma_f32_16x16x32_bf16 v[164:167], v[84:87], v[60:63], v[164:167]
    s_waitcnt lgkmcnt(4)
    ds_read_b128 v[84:87], v249 offset:1280
    buffer_load_dwordx4 v[40:43], v246, s[8:11], s67 offen offset:2048 sc1
    v_mfma_f32_16x16x32_bf16 v[152:155], v[88:91], v[56:59], v[152:155]
    v_mfma_f32_16x16x32_bf16 v[156:159], v[88:91], v[60:63], v[156:159]
    s_waitcnt lgkmcnt(4)
    ds_read_b128 v[88:91], v249 offset:6144
    v_mfma_f32_16x16x32_bf16 v[168:171], v[92:95], v[56:59], v[168:171]
    v_mfma_f32_16x16x32_bf16 v[172:175], v[92:95], v[60:63], v[172:175]
    s_waitcnt vmcnt(6) lgkmcnt(4)
    ds_read_b128 v[92:95], v249 offset:7168
    buffer_load_dwordx4 v[44:47], v246, s[8:11], s67 offen offset:3072 sc1
    v_mfma_f32_16x16x32_bf16 v[144:147], v[96:99], v[64:67], v[144:147]
    v_mfma_f32_16x16x32_bf16 v[148:151], v[96:99], v[68:71], v[148:151]
    s_waitcnt lgkmcnt(4)
    ds_read_b128 v[96:99], v249 offset:6400
    buffer_load_dwordx4 v[48:51], v247, s[8:11], s67 offen offset:0 sc1
    v_mfma_f32_16x16x32_bf16 v[160:163], v[100:103], v[64:67], v[160:163]
    buffer_load_dword v14, v9, s[4:7], s72 offen offset:1024 sc1
    v_mfma_f32_16x16x32_bf16 v[164:167], v[100:103], v[68:71], v[164:167]
    s_waitcnt lgkmcnt(4)
    ds_read_b128 v[100:103], v249 offset:7424
    v_mfma_f32_16x16x32_bf16 v[152:155], v[80:83], v[64:67], v[152:155]
    v_mfma_f32_16x16x32_bf16 v[156:159], v[80:83], v[68:71], v[156:159]
    s_waitcnt lgkmcnt(4)
    ds_read_b128 v[80:83], v249 offset:12288
    buffer_load_dwordx4 v[52:55], v247, s[8:11], s67 offen offset:1024 sc1
    v_mfma_f32_16x16x32_bf16 v[168:171], v[84:87], v[64:67], v[168:171]
    v_mfma_f32_16x16x32_bf16 v[172:175], v[84:87], v[68:71], v[172:175]
    s_waitcnt vmcnt(8) lgkmcnt(4)
    ds_read_b128 v[84:87], v249 offset:13312
    v_mfma_f32_16x16x32_bf16 v[144:147], v[88:91], v[72:75], v[144:147]
    v_mfma_f32_16x16x32_bf16 v[148:151], v[88:91], v[76:79], v[148:151]
    s_waitcnt lgkmcnt(4)
    ds_read_b128 v[88:91], v249 offset:12544
    buffer_load_dwordx4 v[56:59], v247, s[8:11], s67 offen offset:2048 sc1
    v_mfma_f32_16x16x32_bf16 v[160:163], v[92:95], v[72:75], v[160:163]
    v_mfma_f32_16x16x32_bf16 v[164:167], v[92:95], v[76:79], v[164:167]
    s_waitcnt lgkmcnt(4)
    ds_read_b128 v[92:95], v249 offset:13568
    buffer_load_dwordx4 v[60:63], v247, s[8:11], s67 offen offset:3072 sc1
    v_mfma_f32_16x16x32_bf16 v[152:155], v[96:99], v[72:75], v[152:155]
    v_mfma_f32_16x16x32_bf16 v[156:159], v[96:99], v[76:79], v[156:159]
    s_waitcnt vmcnt(3) lgkmcnt(4)
    ds_read_b128 v[96:99], v249 offset:18432
    v_mfma_f32_16x16x32_bf16 v[168:171], v[100:103], v[72:75], v[168:171]
    v_cmp_gt_u32 vcc, s35, v14
    s_cbranch_vccnz SPIN_282
BACK_283:
    v_mfma_f32_16x16x32_bf16 v[172:175], v[100:103], v[76:79], v[172:175]
    s_waitcnt lgkmcnt(4)
    ds_read_b128 v[100:103], v249 offset:19456
    buffer_load_dwordx4 v[104:107], v16, s[4:7], s69 offen offset:0 sc1
    v_mfma_f32_16x16x32_bf16 v[144:147], v[80:83], v[32:35], v[144:147]
    buffer_load_dwordx4 v[108:111], v16, s[4:7], s69 offen offset:1024 sc1
    buffer_load_dwordx4 v[112:115], v16, s[4:7], s70 offen offset:0 sc1
    v_mfma_f32_16x16x32_bf16 v[148:151], v[80:83], v[36:39], v[148:151]
    s_waitcnt lgkmcnt(4)
    ds_read_b128 v[80:83], v249 offset:18688
    buffer_load_dwordx4 v[116:119], v16, s[4:7], s70 offen offset:1024 sc1
    v_mfma_f32_16x16x32_bf16 v[160:163], v[84:87], v[32:35], v[160:163]
    buffer_load_dwordx4 v[64:67], v240, s[8:11], s68 offen offset:0 sc1
    v_mfma_f32_16x16x32_bf16 v[164:167], v[84:87], v[36:39], v[164:167]
    s_waitcnt lgkmcnt(4)
    ds_read_b128 v[84:87], v249 offset:19712
    buffer_load_dwordx4 v[68:71], v240, s[8:11], s68 offen offset:1024 sc1
    v_mfma_f32_16x16x32_bf16 v[152:155], v[88:91], v[32:35], v[152:155]
    v_mfma_f32_16x16x32_bf16 v[156:159], v[88:91], v[36:39], v[156:159]
    s_waitcnt lgkmcnt(4)
    ds_read_b128 v[88:91], v249 offset:24576
    v_mfma_f32_16x16x32_bf16 v[168:171], v[92:95], v[32:35], v[168:171]
    v_mfma_f32_16x16x32_bf16 v[172:175], v[92:95], v[36:39], v[172:175]
    s_waitcnt lgkmcnt(4)
    ds_read_b128 v[92:95], v249 offset:25600
    buffer_load_dwordx4 v[72:75], v240, s[8:11], s68 offen offset:2048 sc1
    v_mfma_f32_16x16x32_bf16 v[144:147], v[96:99], v[40:43], v[144:147]
    v_mfma_f32_16x16x32_bf16 v[148:151], v[96:99], v[44:47], v[148:151]
    s_waitcnt lgkmcnt(4)
    ds_read_b128 v[96:99], v249 offset:24832
    buffer_load_dwordx4 v[76:79], v240, s[8:11], s68 offen offset:3072 sc1
    v_mfma_f32_16x16x32_bf16 v[160:163], v[100:103], v[40:43], v[160:163]
    v_mfma_f32_16x16x32_bf16 v[164:167], v[100:103], v[44:47], v[164:167]
    s_waitcnt lgkmcnt(4)
    ds_read_b128 v[100:103], v249 offset:25856
    v_mfma_f32_16x16x32_bf16 v[152:155], v[80:83], v[40:43], v[152:155]
    v_mfma_f32_16x16x32_bf16 v[156:159], v[80:83], v[44:47], v[156:159]
    s_waitcnt lgkmcnt(4)
    ds_read_b128 v[80:83], v249 offset:30720
    buffer_load_dwordx4 v[32:35], v241, s[8:11], s68 offen offset:0 sc1
    v_mfma_f32_16x16x32_bf16 v[168:171], v[84:87], v[40:43], v[168:171]
    v_mfma_f32_16x16x32_bf16 v[172:175], v[84:87], v[44:47], v[172:175]
    s_waitcnt vmcnt(11) lgkmcnt(4)
    ds_read_b128 v[84:87], v249 offset:31744
    v_mfma_f32_16x16x32_bf16 v[144:147], v[88:91], v[48:51], v[144:147]
    v_mfma_f32_16x16x32_bf16 v[148:151], v[88:91], v[52:55], v[148:151]
    s_waitcnt lgkmcnt(4)
    ds_read_b128 v[88:91], v249 offset:30976
    buffer_load_dwordx4 v[36:39], v241, s[8:11], s68 offen offset:1024 sc1
    v_mfma_f32_16x16x32_bf16 v[160:163], v[92:95], v[48:51], v[160:163]
    v_mfma_f32_16x16x32_bf16 v[164:167], v[92:95], v[52:55], v[164:167]
    s_waitcnt lgkmcnt(4)
    ds_read_b128 v[92:95], v249 offset:32000
    buffer_load_dwordx4 v[40:43], v241, s[8:11], s68 offen offset:2048 sc1
    v_mfma_f32_16x16x32_bf16 v[152:155], v[96:99], v[48:51], v[152:155]
    v_mfma_f32_16x16x32_bf16 v[156:159], v[96:99], v[52:55], v[156:159]
    s_waitcnt lgkmcnt(4)
    ds_read_b128 v[96:99], v248 offset:0
    v_mfma_f32_16x16x32_bf16 v[168:171], v[100:103], v[48:51], v[168:171]
    v_mfma_f32_16x16x32_bf16 v[172:175], v[100:103], v[52:55], v[172:175]
    s_waitcnt vmcnt(9) lgkmcnt(4)
    ds_read_b128 v[100:103], v248 offset:1024
    buffer_load_dwordx4 v[44:47], v241, s[8:11], s68 offen offset:3072 sc1
    v_mfma_f32_16x16x32_bf16 v[144:147], v[80:83], v[56:59], v[144:147]
    v_add_f32 v104, v104, v106
    v_add_f32 v105, v105, v107
    v_mfma_f32_16x16x32_bf16 v[148:151], v[80:83], v[60:63], v[148:151]
    s_waitcnt lgkmcnt(4)
    ds_read_b128 v[80:83], v248 offset:256
    v_add_f32 v108, v108, v110
    v_mfma_f32_16x16x32_bf16 v[160:163], v[84:87], v[56:59], v[160:163]
    v_add_f32 v109, v109, v111
    v_add_f32 v104, v104, v108
    v_mfma_f32_16x16x32_bf16 v[164:167], v[84:87], v[60:63], v[164:167]
    s_waitcnt lgkmcnt(4)
    ds_read_b128 v[84:87], v248 offset:1280
    buffer_load_dwordx4 v[48:51], v242, s[8:11], s68 offen offset:0 sc1
    v_mfma_f32_16x16x32_bf16 v[152:155], v[88:91], v[56:59], v[152:155]
    v_add_f32 v105, v105, v109
    s_nop 1
    v_permlane32_swap_b32 v104, v105
    v_mfma_f32_16x16x32_bf16 v[156:159], v[88:91], v[60:63], v[156:159]
    s_waitcnt lgkmcnt(4)
    ds_read_b128 v[88:91], v248 offset:6144
    buffer_load_dwordx4 v[52:55], v242, s[8:11], s68 offen offset:1024 sc1
    v_mfma_f32_16x16x32_bf16 v[168:171], v[92:95], v[56:59], v[168:171]
    v_add_f32 v104, v104, v105
    v_mul_f32 v104, 0x3b000000, v104
    v_mfma_f32_16x16x32_bf16 v[172:175], v[92:95], v[60:63], v[172:175]
    ds_read_b128 v[92:95], v248 offset:7168
    v_mov_b32 v105, v104
    s_nop 1
    v_permlane32_swap_b32 v104, v105
    v_fma_f32 v105, -v104, v104, v105
    v_max_f32 v105, 0, v105
    v_add_f32 v105, 0x3727c5ac, v105
    v_rsq_f32 v120, v105
    v_cvt_pk_bf16_f32 v106, -v104, -v104
    v_and_b32 v107, 0xffff0000, v106
    v_sub_f32 v107, -v104, v107
    v_cvt_pk_bf16_f32 v107, v107, v107
    v_cndmask_b32 v124, v107, v106, s[24:25]
    v_mul_f32 v120, v120, v120
    v_mov_b32 v105, v124
    v_mov_b32 v107, 0
    v_mov_b32 v121, v120
    v_mov_b32 v109, 0
    v_mov_b32 v111, v124
    v_permlane16_swap_b32 v105, v107
    v_mov_b32 v104, 0
    v_permlane16_swap_b32 v120, v121
    v_permlane16_swap_b32 v109, v111
    v_mov_b32 v106, 0
    v_mov_b32 v108, 0
    v_mov_b32 v110, 0
    v_mfma_f32_16x16x16_bf16 v[144:147], v[24:25], v[104:105], v[144:147]
    v_mfma_f32_16x16x16_bf16 v[148:151], v[24:25], v[106:107], v[148:151]
    buffer_load_dwordx4 v[56:59], v242, s[8:11], s68 offen offset:2048 sc1
    v_mfma_f32_16x16x16_bf16 v[152:155], v[24:25], v[108:109], v[152:155]
    v_mfma_f32_16x16x16_bf16 v[156:159], v[24:25], v[110:111], v[156:159]
    v_mfma_f32_16x16x16_bf16 v[160:163], v[26:27], v[104:105], v[160:163]
    v_mfma_f32_16x16x16_bf16 v[164:167], v[26:27], v[106:107], v[164:167]
    buffer_load_dwordx4 v[60:63], v242, s[8:11], s68 offen offset:3072 sc1
    s_nop 3
    v_mul_f32 v144, v144, v152
    v_mfma_f32_16x16x16_bf16 v[168:171], v[26:27], v[108:109], v[168:171]
    v_mul_f32 v145, v145, v153
    v_mul_f32 v144, v144, v120
    v_mfma_f32_16x16x16_bf16 v[172:175], v[26:27], v[110:111], v[172:175]
    s_waitcnt vmcnt(10) lgkmcnt(5)
    v_mul_f32 v145, v145, v120
    v_cvt_pk_bf16_f32 v152, v144, v145
    v_mfma_f32_16x16x32_bf16 v[192:195], v[96:99], v[64:67], 0
    v_mul_f32 v146, v146, v154
    v_mul_f32 v147, v147, v155
    v_mfma_f32_16x16x32_bf16 v[196:199], v[96:99], v[68:71], 0
    s_waitcnt lgkmcnt(4)
    ds_read_b128 v[96:99], v248 offset:6400
    v_mul_f32 v146, v146, v120
    v_mfma_f32_16x16x32_bf16 v[208:211], v[100:103], v[64:67], 0
    v_mul_f32 v147, v147, v120
    v_cvt_pk_bf16_f32 v153, v146, v147
    v_mfma_f32_16x16x32_bf16 v[212:215], v[100:103], v[68:71], 0
    s_waitcnt lgkmcnt(4)
    ds_read_b128 v[100:103], v248 offset:7424
    v_mul_f32 v148, v148, v156
    v_mfma_f32_16x16x32_bf16 v[200:203], v[80:83], v[64:67], 0
    v_mul_f32 v149, v149, v157
    v_mul_f32 v148, v148, v121
    v_mfma_f32_16x16x32_bf16 v[204:207], v[80:83], v[68:71], 0
    s_waitcnt lgkmcnt(4)
    ds_read_b128 v[80:83], v248 offset:12288
    v_mul_f32 v149, v149, v121
    v_mfma_f32_16x16x32_bf16 v[216:219], v[84:87], v[64:67], 0
    v_cvt_pk_bf16_f32 v154, v148, v149
    v_mul_f32 v150, v150, v158
    v_mfma_f32_16x16x32_bf16 v[220:223], v[84:87], v[68:71], 0
    s_waitcnt vmcnt(8) lgkmcnt(4)
    ds_read_b128 v[84:87], v248 offset:13312
    buffer_load_dwordx4 v[64:67], v243, s[8:11], s68 offen offset:0 sc1
    v_mfma_f32_16x16x32_bf16 v[192:195], v[88:91], v[72:75], v[192:195]
    v_mul_f32 v151, v151, v159
    v_mul_f32 v150, v150, v121
    v_mfma_f32_16x16x32_bf16 v[196:199], v[88:91], v[76:79], v[196:199]
    s_waitcnt lgkmcnt(4)
    ds_read_b128 v[88:91], v248 offset:12544
    buffer_load_dwordx4 v[68:71], v243, s[8:11], s68 offen offset:1024 sc1
    v_mfma_f32_16x16x32_bf16 v[208:211], v[92:95], v[72:75], v[208:211]
    v_mul_f32 v151, v151, v121
    v_cvt_pk_bf16_f32 v155, v150, v151
    v_mfma_f32_16x16x32_bf16 v[212:215], v[92:95], v[76:79], v[212:215]
    s_waitcnt lgkmcnt(4)
    ds_read_b128 v[92:95], v248 offset:13568
    v_permlane32_swap_b32 v152, v154
    v_mfma_f32_16x16x32_bf16 v[200:203], v[96:99], v[72:75], v[200:203]
    v_permlane32_swap_b32 v153, v155
    v_mfma_f32_16x16x32_bf16 v[204:207], v[96:99], v[76:79], v[204:207]
    s_waitcnt lgkmcnt(4)
    ds_read_b128 v[96:99], v248 offset:18432
    buffer_store_dwordx4 v[152:155], v250, s[4:7], s73 offen offset:0
    v_mfma_f32_16x16x32_bf16 v[216:219], v[100:103], v[72:75], v[216:219]
    v_mul_f32 v160, v160, v168
    v_mul_f32 v161, v161, v169
    v_mfma_f32_16x16x32_bf16 v[220:223], v[100:103], v[76:79], v[220:223]
    s_waitcnt vmcnt(9) lgkmcnt(4)
    ds_read_b128 v[100:103], v248 offset:19456
    buffer_load_dwordx4 v[72:75], v243, s[8:11], s68 offen offset:2048 sc1
    v_mfma_f32_16x16x32_bf16 v[192:195], v[80:83], v[32:35], v[192:195]
    v_mul_f32 v160, v160, v120
    v_mul_f32 v161, v161, v120
    v_mfma_f32_16x16x32_bf16 v[196:199], v[80:83], v[36:39], v[196:199]
    s_waitcnt lgkmcnt(4)
    ds_read_b128 v[80:83], v248 offset:18688
    buffer_load_dwordx4 v[76:79], v243, s[8:11], s68 offen offset:3072 sc1
    v_mfma_f32_16x16x32_bf16 v[208:211], v[84:87], v[32:35], v[208:211]
    v_cvt_pk_bf16_f32 v168, v160, v161
    v_mul_f32 v162, v162, v170
    v_mfma_f32_16x16x32_bf16 v[212:215], v[84:87], v[36:39], v[212:215]
    s_waitcnt lgkmcnt(4)
    ds_read_b128 v[84:87], v248 offset:19712
    v_mul_f32 v163, v163, v171
    v_mfma_f32_16x16x32_bf16 v[200:203], v[88:91], v[32:35], v[200:203]
    v_mul_f32 v162, v162, v120
    v_mul_f32 v163, v163, v120
    v_mfma_f32_16x16x32_bf16 v[204:207], v[88:91], v[36:39], v[204:207]
    s_waitcnt lgkmcnt(4)
    ds_read_b128 v[88:91], v248 offset:24576
    v_cvt_pk_bf16_f32 v169, v162, v163
    v_mfma_f32_16x16x32_bf16 v[216:219], v[92:95], v[32:35], v[216:219]
    v_mul_f32 v164, v164, v172
    v_mul_f32 v165, v165, v173
    v_mfma_f32_16x16x32_bf16 v[220:223], v[92:95], v[36:39], v[220:223]
    s_waitcnt vmcnt(9) lgkmcnt(4)
    ds_read_b128 v[92:95], v248 offset:25600
    buffer_load_dwordx4 v[32:35], v244, s[8:11], s68 offen offset:0 sc1
    v_mfma_f32_16x16x32_bf16 v[192:195], v[96:99], v[40:43], v[192:195]
    v_mul_f32 v164, v164, v121
    v_mul_f32 v165, v165, v121
    v_mfma_f32_16x16x32_bf16 v[196:199], v[96:99], v[44:47], v[196:199]
    s_waitcnt lgkmcnt(4)
    ds_read_b128 v[96:99], v248 offset:24832
    buffer_load_dwordx4 v[36:39], v244, s[8:11], s68 offen offset:1024 sc1
    v_mfma_f32_16x16x32_bf16 v[208:211], v[100:103], v[40:43], v[208:211]
    v_cvt_pk_bf16_f32 v170, v164, v165
    v_mul_f32 v166, v166, v174
    v_mfma_f32_16x16x32_bf16 v[212:215], v[100:103], v[44:47], v[212:215]
    s_waitcnt lgkmcnt(4)
    ds_read_b128 v[100:103], v248 offset:25856
    v_mul_f32 v167, v167, v175
    v_mfma_f32_16x16x32_bf16 v[200:203], v[80:83], v[40:43], v[200:203]
    v_mul_f32 v166, v166, v121
    v_mul_f32 v167, v167, v121
    v_mfma_f32_16x16x32_bf16 v[204:207], v[80:83], v[44:47], v[204:207]
    s_waitcnt lgkmcnt(4)
    ds_read_b128 v[80:83], v248 offset:30720
    v_cvt_pk_bf16_f32 v171, v166, v167
    v_mfma_f32_16x16x32_bf16 v[216:219], v[84:87], v[40:43], v[216:219]
    v_permlane32_swap_b32 v168, v170
    v_permlane32_swap_b32 v169, v171
    v_mfma_f32_16x16x32_bf16 v[220:223], v[84:87], v[44:47], v[220:223]
    s_waitcnt vmcnt(9) lgkmcnt(4)
    ds_read_b128 v[84:87], v248 offset:31744
    buffer_load_dwordx4 v[40:43], v244, s[8:11], s68 offen offset:2048 sc1
    v_mfma_f32_16x16x32_bf16 v[192:195], v[88:91], v[48:51], v[192:195]
    buffer_store_dwordx4 v[168:171], v251, s[4:7], s73 offen offset:512
    v_mfma_f32_16x16x32_bf16 v[196:199], v[88:91], v[52:55], v[196:199]
    s_waitcnt lgkmcnt(4)
    ds_read_b128 v[88:91], v248 offset:30976
    buffer_load_dwordx4 v[44:47], v244, s[8:11], s68 offen offset:3072 sc1
    v_mfma_f32_16x16x32_bf16 v[208:211], v[92:95], v[48:51], v[208:211]
    v_add_f32 v112, v112, v114
    v_add_f32 v113, v113, v115
    v_mfma_f32_16x16x32_bf16 v[212:215], v[92:95], v[52:55], v[212:215]
    s_waitcnt lgkmcnt(4)
    ds_read_b128 v[92:95], v248 offset:32000
    v_add_f32 v116, v116, v118
    v_mfma_f32_16x16x32_bf16 v[200:203], v[96:99], v[48:51], v[200:203]
    v_add_f32 v117, v117, v119
    v_add_f32 v112, v112, v116
    v_mfma_f32_16x16x32_bf16 v[204:207], v[96:99], v[52:55], v[204:207]
    s_waitcnt lgkmcnt(4)
    ds_read_b128 v[96:99], v248 offset:36864
    v_add_f32 v113, v113, v117
    v_mfma_f32_16x16x32_bf16 v[216:219], v[100:103], v[48:51], v[216:219]
    s_nop 0
    v_permlane32_swap_b32 v112, v113
    v_add_f32 v112, v112, v113
    v_mfma_f32_16x16x32_bf16 v[220:223], v[100:103], v[52:55], v[220:223]
    s_waitcnt vmcnt(10) lgkmcnt(4)
    ds_read_b128 v[100:103], v248 offset:37888
    buffer_load_dwordx4 v[48:51], v245, s[8:11], s68 offen offset:0 sc1
    v_mfma_f32_16x16x32_bf16 v[192:195], v[80:83], v[56:59], v[192:195]
    v_mul_f32 v112, 0x3b000000, v112
    v_mov_b32 v113, v112
    v_mfma_f32_16x16x32_bf16 v[196:199], v[80:83], v[60:63], v[196:199]
    s_waitcnt lgkmcnt(4)
    ds_read_b128 v[80:83], v248 offset:37120
    buffer_load_dwordx4 v[52:55], v245, s[8:11], s68 offen offset:1024 sc1
    v_mfma_f32_16x16x32_bf16 v[208:211], v[84:87], v[56:59], v[208:211]
    v_permlane32_swap_b32 v112, v113
    v_fma_f32 v113, -v112, v112, v113
    v_mfma_f32_16x16x32_bf16 v[212:215], v[84:87], v[60:63], v[212:215]
    s_waitcnt lgkmcnt(4)
    ds_read_b128 v[84:87], v248 offset:38144
    v_max_f32 v113, 0, v113
    v_mfma_f32_16x16x32_bf16 v[200:203], v[88:91], v[56:59], v[200:203]
    v_add_f32 v113, 0x3727c5ac, v113
    v_mfma_f32_16x16x32_bf16 v[204:207], v[88:91], v[60:63], v[204:207]
    s_waitcnt lgkmcnt(4)
    ds_read_b128 v[88:91], v248 offset:43008
    v_mfma_f32_16x16x32_bf16 v[216:219], v[92:95], v[56:59], v[216:219]
    v_rsq_f32 v122, v113
    v_mfma_f32_16x16x32_bf16 v[220:223], v[92:95], v[60:63], v[220:223]
    s_waitcnt vmcnt(10) lgkmcnt(4)
    ds_read_b128 v[92:95], v248 offset:44032
    buffer_load_dwordx4 v[56:59], v245, s[8:11], s68 offen offset:2048 sc1
    v_mfma_f32_16x16x32_bf16 v[192:195], v[96:99], v[64:67], v[192:195]
    v_cvt_pk_bf16_f32 v114, -v112, -v112
    v_and_b32 v115, 0xffff0000, v114
    v_mfma_f32_16x16x32_bf16 v[196:199], v[96:99], v[68:71], v[196:199]
    s_waitcnt lgkmcnt(4)
    ds_read_b128 v[96:99], v248 offset:43264
    buffer_load_dwordx4 v[60:63], v245, s[8:11], s68 offen offset:3072 sc1
    v_mfma_f32_16x16x32_bf16 v[208:211], v[100:103], v[64:67], v[208:211]
    v_sub_f32 v115, -v112, v115
    v_cvt_pk_bf16_f32 v115, v115, v115
    v_mfma_f32_16x16x32_bf16 v[212:215], v[100:103], v[68:71], v[212:215]
    s_waitcnt lgkmcnt(4)
    ds_read_b128 v[100:103], v248 offset:44288
    v_cndmask_b32 v124, v115, v114, s[24:25]
    v_mfma_f32_16x16x32_bf16 v[200:203], v[80:83], v[64:67], v[200:203]
    v_mul_f32 v122, v122, v122
    v_mov_b32 v113, v124
    v_mfma_f32_16x16x32_bf16 v[204:207], v[80:83], v[68:71], v[204:207]
    s_waitcnt lgkmcnt(4)
    ds_read_b128 v[80:83], v248 offset:49152
    v_mov_b32 v115, 0
    v_mfma_f32_16x16x32_bf16 v[216:219], v[84:87], v[64:67], v[216:219]
    v_mov_b32 v123, v122
    v_mov_b32 v117, 0
    v_mfma_f32_16x16x32_bf16 v[220:223], v[84:87], v[68:71], v[220:223]
    s_waitcnt vmcnt(9) lgkmcnt(4)
    ds_read_b128 v[84:87], v248 offset:50176
    buffer_load_dwordx4 v[64:67], v246, s[8:11], s68 offen offset:0 sc1
    v_mfma_f32_16x16x32_bf16 v[192:195], v[88:91], v[72:75], v[192:195]
    v_mov_b32 v119, v124
    v_permlane16_swap_b32 v113, v115
    v_mfma_f32_16x16x32_bf16 v[196:199], v[88:91], v[76:79], v[196:199]
    s_waitcnt lgkmcnt(4)
    ds_read_b128 v[88:91], v248 offset:49408
    buffer_load_dwordx4 v[68:71], v246, s[8:11], s68 offen offset:1024 sc1
    v_mfma_f32_16x16x32_bf16 v[208:211], v[92:95], v[72:75], v[208:211]
    v_mov_b32 v112, 0
    v_permlane16_swap_b32 v122, v123
    v_mfma_f32_16x16x32_bf16 v[212:215], v[92:95], v[76:79], v[212:215]
    s_waitcnt lgkmcnt(4)
    ds_read_b128 v[92:95], v248 offset:50432
    v_permlane16_swap_b32 v117, v119
    v_mfma_f32_16x16x32_bf16 v[200:203], v[96:99], v[72:75], v[200:203]
    v_mov_b32 v114, 0
    v_mov_b32 v116, 0
    v_mfma_f32_16x16x32_bf16 v[204:207], v[96:99], v[76:79], v[204:207]
    s_waitcnt lgkmcnt(4)
    ds_read_b128 v[96:99], v248 offset:55296
    v_mov_b32 v118, 0
    v_mfma_f32_16x16x32_bf16 v[216:219], v[100:103], v[72:75], v[216:219]
    s_waitcnt vmcnt(7)
    s_cbranch_vccnz SAFE_287
    buffer_store_dword v11, v10, s[4:7], s75 offen offset:2048
BACK_288:
    v_mfma_f32_16x16x32_bf16 v[220:223], v[100:103], v[76:79], v[220:223]
    s_waitcnt lgkmcnt(4)
    ds_read_b128 v[100:103], v248 offset:56320
    buffer_load_dwordx4 v[72:75], v246, s[8:11], s68 offen offset:2048 sc1
    v_mfma_f32_16x16x32_bf16 v[192:195], v[80:83], v[32:35], v[192:195]
    v_mfma_f32_16x16x32_bf16 v[196:199], v[80:83], v[36:39], v[196:199]
    s_waitcnt lgkmcnt(4)
    ds_read_b128 v[80:83], v248 offset:55552
    buffer_load_dwordx4 v[76:79], v246, s[8:11], s68 offen offset:3072 sc1
    v_mfma_f32_16x16x32_bf16 v[208:211], v[84:87], v[32:35], v[208:211]
    buffer_load_dword v14, v9, s[4:7], s79 offen offset:2048 sc1
    v_mfma_f32_16x16x32_bf16 v[212:215], v[84:87], v[36:39], v[212:215]
    s_waitcnt vmcnt(0) lgkmcnt(4)
    ds_read_b128 v[84:87], v248 offset:56576
    v_mfma_f32_16x16x32_bf16 v[200:203], v[88:91], v[32:35], v[200:203]
    v_cmp_gt_u32 vcc, s35, v14
    s_cbranch_vccnz SPIN_289
BACK_290:
    v_mfma_f32_16x16x32_bf16 v[204:207], v[88:91], v[36:39], v[204:207]
    s_waitcnt lgkmcnt(4)
    ds_read_b128 v[88:91], v249 offset:0
    buffer_load_dwordx4 v[128:131], v16, s[4:7], s77 offen offset:0 sc1
    v_mfma_f32_16x16x32_bf16 v[216:219], v[92:95], v[32:35], v[216:219]
    v_mfma_f32_16x16x32_bf16 v[220:223], v[92:95], v[36:39], v[220:223]
    s_waitcnt lgkmcnt(4)
    ds_read_b128 v[92:95], v249 offset:1024
    buffer_load_dwordx4 v[32:35], v247, s[8:11], s68 offen offset:0 sc1
    v_mfma_f32_16x16x32_bf16 v[192:195], v[96:99], v[40:43], v[192:195]
    v_mfma_f32_16x16x32_bf16 v[196:199], v[96:99], v[44:47], v[196:199]
    s_waitcnt lgkmcnt(4)
    ds_read_b128 v[96:99], v249 offset:256
    buffer_load_dwordx4 v[36:39], v247, s[8:11], s68 offen offset:1024 sc1
    v_mfma_f32_16x16x32_bf16 v[208:211], v[100:103], v[40:43], v[208:211]
    buffer_load_dwordx4 v[132:135], v16, s[4:7], s77 offen offset:2048 sc1
    v_mfma_f32_16x16x32_bf16 v[212:215], v[100:103], v[44:47], v[212:215]
    s_waitcnt lgkmcnt(4)
    ds_read_b128 v[100:103], v249 offset:1280
    v_mfma_f32_16x16x32_bf16 v[200:203], v[80:83], v[40:43], v[200:203]
    v_mfma_f32_16x16x32_bf16 v[204:207], v[80:83], v[44:47], v[204:207]
    s_waitcnt lgkmcnt(4)
    ds_read_b128 v[80:83], v249 offset:6144
    buffer_load_dwordx4 v[136:139], v17, s[4:7], s77 offen offset:0 sc1
    v_mfma_f32_16x16x32_bf16 v[216:219], v[84:87], v[40:43], v[216:219]
    v_mfma_f32_16x16x32_bf16 v[220:223], v[84:87], v[44:47], v[220:223]
    s_waitcnt lgkmcnt(4)
    ds_read_b128 v[84:87], v249 offset:7168
    buffer_load_dwordx4 v[40:43], v247, s[8:11], s68 offen offset:2048 sc1
    v_mfma_f32_16x16x32_bf16 v[192:195], v[88:91], v[48:51], v[192:195]
    v_mfma_f32_16x16x32_bf16 v[196:199], v[88:91], v[52:55], v[196:199]
    s_waitcnt lgkmcnt(4)
    ds_read_b128 v[88:91], v249 offset:6400
    buffer_load_dwordx4 v[44:47], v247, s[8:11], s68 offen offset:3072 sc1
    v_mfma_f32_16x16x32_bf16 v[208:211], v[92:95], v[48:51], v[208:211]
    buffer_load_dwordx4 v[140:143], v17, s[4:7], s77 offen offset:2048 sc1
    v_mfma_f32_16x16x32_bf16 v[212:215], v[92:95], v[52:55], v[212:215]
    s_waitcnt lgkmcnt(4)
    ds_read_b128 v[92:95], v249 offset:7424
    v_mfma_f32_16x16x32_bf16 v[200:203], v[96:99], v[48:51], v[200:203]
    v_mfma_f32_16x16x32_bf16 v[204:207], v[96:99], v[52:55], v[204:207]
    s_waitcnt lgkmcnt(4)
    ds_read_b128 v[96:99], v249 offset:12288
    buffer_load_dwordx4 v[144:147], v18, s[4:7], s77 offen offset:0 sc1
    v_mfma_f32_16x16x32_bf16 v[216:219], v[100:103], v[48:51], v[216:219]
    v_mfma_f32_16x16x32_bf16 v[220:223], v[100:103], v[52:55], v[220:223]
    ds_read_b128 v[100:103], v249 offset:12544
    v_mfma_f32_16x16x16_bf16 v[192:195], v[24:25], v[112:113], v[192:195]
    v_mfma_f32_16x16x16_bf16 v[196:199], v[24:25], v[114:115], v[196:199]
    buffer_load_dwordx4 v[148:151], v18, s[4:7], s77 offen offset:2048 sc1
    v_mfma_f32_16x16x16_bf16 v[200:203], v[24:25], v[116:117], v[200:203]
    v_mfma_f32_16x16x16_bf16 v[204:207], v[24:25], v[118:119], v[204:207]
    v_mfma_f32_16x16x16_bf16 v[208:211], v[26:27], v[112:113], v[208:211]
    v_mfma_f32_16x16x16_bf16 v[212:215], v[26:27], v[114:115], v[212:215]
    buffer_load_dwordx4 v[152:155], v19, s[4:7], s77 offen offset:0 sc1
    v_mfma_f32_16x16x16_bf16 v[216:219], v[26:27], v[116:117], v[216:219]
    v_mfma_f32_16x16x16_bf16 v[220:223], v[26:27], v[118:119], v[220:223]
    s_waitcnt lgkmcnt(5)
    v_mfma_f32_16x16x32_bf16 v[192:195], v[80:83], v[56:59], v[192:195]
    v_mfma_f32_16x16x32_bf16 v[196:199], v[80:83], v[60:63], v[196:199]
    s_waitcnt lgkmcnt(4)
    ds_read_b128 v[80:83], v249 offset:18432
    buffer_load_dwordx4 v[156:159], v19, s[4:7], s77 offen offset:2048 sc1
    v_mfma_f32_16x16x32_bf16 v[208:211], v[84:87], v[56:59], v[208:211]
    v_mfma_f32_16x16x32_bf16 v[212:215], v[84:87], v[60:63], v[212:215]
    s_waitcnt lgkmcnt(4)
    ds_read_b128 v[84:87], v249 offset:18688
    v_mfma_f32_16x16x32_bf16 v[200:203], v[88:91], v[56:59], v[200:203]
    v_mfma_f32_16x16x32_bf16 v[204:207], v[88:91], v[60:63], v[204:207]
    s_waitcnt lgkmcnt(4)
    ds_read_b128 v[88:91], v249 offset:24576
    buffer_load_dwordx4 v[160:163], v20, s[4:7], s77 offen offset:0 sc1
    v_mfma_f32_16x16x32_bf16 v[216:219], v[92:95], v[56:59], v[216:219]
    v_mfma_f32_16x16x32_bf16 v[220:223], v[92:95], v[60:63], v[220:223]
    s_waitcnt lgkmcnt(4)
    ds_read_b128 v[92:95], v249 offset:24832
    v_mfma_f32_16x16x32_bf16 v[192:195], v[96:99], v[64:67], v[192:195]
    v_mfma_f32_16x16x32_bf16 v[196:199], v[96:99], v[68:71], v[196:199]
    s_waitcnt lgkmcnt(4)
    ds_read_b128 v[96:99], v249 offset:30720
    buffer_load_dwordx4 v[164:167], v20, s[4:7], s77 offen offset:2048 sc1
    v_mfma_f32_16x16x32_bf16 v[200:203], v[100:103], v[64:67], v[200:203]
    v_mfma_f32_16x16x32_bf16 v[204:207], v[100:103], v[68:71], v[204:207]
    s_waitcnt lgkmcnt(4)
    ds_read_b128 v[100:103], v249 offset:30976
    v_mfma_f32_16x16x32_bf16 v[192:195], v[80:83], v[72:75], v[192:195]
    v_mfma_f32_16x16x32_bf16 v[196:199], v[80:83], v[76:79], v[196:199]
    s_waitcnt lgkmcnt(4)
    ds_read_b128 v[80:83], v249 offset:13312
    buffer_load_dwordx4 v[168:171], v21, s[4:7], s77 offen offset:0 sc1
    v_mfma_f32_16x16x32_bf16 v[200:203], v[84:87], v[72:75], v[200:203]
    v_mfma_f32_16x16x32_bf16 v[204:207], v[84:87], v[76:79], v[204:207]
    s_waitcnt vmcnt(12) lgkmcnt(4)
    ds_read_b128 v[84:87], v249 offset:13568
    v_mfma_f32_16x16x32_bf16 v[192:195], v[88:91], v[32:35], v[192:195]
    v_mfma_f32_16x16x32_bf16 v[196:199], v[88:91], v[36:39], v[196:199]
    s_waitcnt lgkmcnt(4)
    ds_read_b128 v[88:91], v249 offset:19456
    buffer_load_dwordx4 v[172:175], v16, s[4:7], s77 offen offset:1024 sc1
    v_mfma_f32_16x16x32_bf16 v[200:203], v[92:95], v[32:35], v[200:203]
    v_mfma_f32_16x16x32_bf16 v[204:207], v[92:95], v[36:39], v[204:207]
    s_waitcnt vmcnt(9) lgkmcnt(4)
    ds_read_b128 v[92:95], v249 offset:19712
    v_mfma_f32_16x16x32_bf16 v[192:195], v[96:99], v[40:43], v[192:195]
    v_mfma_f32_16x16x32_bf16 v[196:199], v[96:99], v[44:47], v[196:199]
    s_waitcnt lgkmcnt(4)
    ds_read_b128 v[96:99], v249 offset:25600
    buffer_load_dwordx4 v[176:179], v16, s[4:7], s77 offen offset:3072 sc1
    v_mfma_f32_16x16x32_bf16 v[200:203], v[100:103], v[40:43], v[200:203]
    v_mfma_f32_16x16x32_bf16 v[204:207], v[100:103], v[44:47], v[204:207]
    s_waitcnt lgkmcnt(4)
    ds_read_b128 v[100:103], v249 offset:25856
    v_mfma_f32_16x16x32_bf16 v[208:211], v[80:83], v[64:67], v[208:211]
    v_mfma_f32_16x16x32_bf16 v[212:215], v[80:83], v[68:71], v[212:215]
    s_waitcnt lgkmcnt(4)
    ds_read_b128 v[80:83], v249 offset:31744
    buffer_load_dwordx4 v[180:183], v17, s[4:7], s77 offen offset:1024 sc1
    v_mfma_f32_16x16x32_bf16 v[216:219], v[84:87], v[64:67], v[216:219]
    v_mul_f32 v192, v192, v200
    v_mul_f32 v193, v193, v201
    v_mfma_f32_16x16x32_bf16 v[220:223], v[84:87], v[68:71], v[220:223]
    s_waitcnt lgkmcnt(4)
    ds_read_b128 v[84:87], v249 offset:32000
    v_mul_f32 v192, v192, v122
    v_mfma_f32_16x16x32_bf16 v[208:211], v[88:91], v[72:75], v[208:211]
    v_mul_f32 v193, v193, v122
    v_cvt_pk_bf16_f32 v200, v192, v193
    v_mfma_f32_16x16x32_bf16 v[212:215], v[88:91], v[76:79], v[212:215]
    s_waitcnt lgkmcnt(4)
    buffer_load_dwordx4 v[184:187], v17, s[4:7], s77 offen offset:3072 sc1
    v_mul_f32 v194, v194, v202
    v_mfma_f32_16x16x32_bf16 v[216:219], v[92:95], v[72:75], v[216:219]
    v_mul_f32 v195, v195, v203
    v_mul_f32 v194, v194, v122
    v_mfma_f32_16x16x32_bf16 v[220:223], v[92:95], v[76:79], v[220:223]
    s_waitcnt lgkmcnt(3)
    v_mul_f32 v195, v195, v122
    v_cvt_pk_bf16_f32 v201, v194, v195
    v_mfma_f32_16x16x32_bf16 v[208:211], v[96:99], v[32:35], v[208:211]
    v_mul_f32 v196, v196, v204
    v_mul_f32 v197, v197, v205
    v_mfma_f32_16x16x32_bf16 v[212:215], v[96:99], v[36:39], v[212:215]
    s_waitcnt lgkmcnt(2)
    buffer_load_dwordx4 v[188:191], v18, s[4:7], s77 offen offset:1024 sc1
    v_mul_f32 v196, v196, v123
    v_mfma_f32_16x16x32_bf16 v[216:219], v[100:103], v[32:35], v[216:219]
    v_mul_f32 v197, v197, v123
    v_cvt_pk_bf16_f32 v202, v196, v197
    v_mfma_f32_16x16x32_bf16 v[220:223], v[100:103], v[36:39], v[220:223]
    s_waitcnt lgkmcnt(1)
    v_mul_f32 v198, v198, v206
    v_mul_f32 v199, v199, v207
    v_mfma_f32_16x16x32_bf16 v[208:211], v[80:83], v[40:43], v[208:211]
    v_mul_f32 v198, v198, v123
    v_mul_f32 v199, v199, v123
    v_mfma_f32_16x16x32_bf16 v[212:215], v[80:83], v[44:47], v[212:215]
    s_waitcnt lgkmcnt(0)
    v_cvt_pk_bf16_f32 v203, v198, v199
    v_permlane32_swap_b32 v200, v202
    v_mfma_f32_16x16x32_bf16 v[216:219], v[84:87], v[40:43], v[216:219]
    v_permlane32_swap_b32 v201, v203
    v_mfma_f32_16x16x32_bf16 v[220:223], v[84:87], v[44:47], v[220:223]
    buffer_store_dwordx4 v[200:203], v250, s[4:7], s74 offen offset:0
    v_mfma_f32_16x16x32_bf16 v[48:51], a[0:3], v[128:131], 0
    v_mfma_f32_16x16x32_bf16 v[56:59], a[4:7], v[128:131], 0
    s_nop 2
    v_mul_f32 v208, v208, v216
    v_mul_f32 v209, v209, v217
    v_mfma_f32_16x16x32_bf16 v[64:67], a[8:11], v[128:131], 0
    v_mul_f32 v208, v208, v122
    v_mul_f32 v209, v209, v122
    v_mfma_f32_16x16x32_bf16 v[72:75], a[12:15], v[128:131], 0
    buffer_load_dwordx4 v[128:131], v18, s[4:7], s77 offen offset:3072 sc1
    v_cvt_pk_bf16_f32 v216, v208, v209
    v_mfma_f32_16x16x32_bf16 v[48:51], a[16:19], v[132:135], v[48:51]
    v_mul_f32 v210, v210, v218
    v_mul_f32 v211, v211, v219
    v_mfma_f32_16x16x32_bf16 v[56:59], a[20:23], v[132:135], v[56:59]
    v_mul_f32 v210, v210, v122
    v_mul_f32 v211, v211, v122
    v_mfma_f32_16x16x32_bf16 v[64:67], a[24:27], v[132:135], v[64:67]
    v_cvt_pk_bf16_f32 v217, v210, v211
    v_mul_f32 v212, v212, v220
    v_mfma_f32_16x16x32_bf16 v[72:75], a[28:31], v[132:135], v[72:75]
    buffer_load_dwordx4 v[132:135], v19, s[4:7], s77 offen offset:1024 sc1
    v_mul_f32 v213, v213, v221
    v_mfma_f32_16x16x32_bf16 v[48:51], a[32:35], v[136:139], v[48:51]
    v_mul_f32 v212, v212, v123
    v_mul_f32 v213, v213, v123
    v_mfma_f32_16x16x32_bf16 v[56:59], a[36:39], v[136:139], v[56:59]
    v_cvt_pk_bf16_f32 v218, v212, v213
    v_mul_f32 v214, v214, v222
    v_mfma_f32_16x16x32_bf16 v[64:67], a[40:43], v[136:139], v[64:67]
    v_mul_f32 v215, v215, v223
    v_mul_f32 v214, v214, v123
    v_mfma_f32_16x16x32_bf16 v[72:75], a[44:47], v[136:139], v[72:75]
    s_waitcnt vmcnt(15)
    buffer_load_dwordx4 v[136:139], v19, s[4:7], s77 offen offset:3072 sc1
    v_mul_f32 v215, v215, v123
    v_mfma_f32_16x16x32_bf16 v[48:51], a[48:51], v[140:143], v[48:51]
    v_cvt_pk_bf16_f32 v219, v214, v215
    v_permlane32_swap_b32 v216, v218
    v_mfma_f32_16x16x32_bf16 v[56:59], a[52:55], v[140:143], v[56:59]
    v_permlane32_swap_b32 v217, v219
    v_mfma_f32_16x16x32_bf16 v[64:67], a[56:59], v[140:143], v[64:67]
    buffer_store_dwordx4 v[216:219], v251, s[4:7], s74 offen offset:512
    v_mfma_f32_16x16x32_bf16 v[72:75], a[60:63], v[140:143], v[72:75]
    s_waitcnt vmcnt(16)
    buffer_load_dwordx4 v[140:143], v20, s[4:7], s77 offen offset:1024 sc1
    v_mfma_f32_16x16x32_bf16 v[48:51], a[64:67], v[144:147], v[48:51]
    v_mfma_f32_16x16x32_bf16 v[56:59], a[68:71], v[144:147], v[56:59]
    v_mfma_f32_16x16x32_bf16 v[64:67], a[72:75], v[144:147], v[64:67]
    v_mfma_f32_16x16x32_bf16 v[72:75], a[76:79], v[144:147], v[72:75]
    s_waitcnt vmcnt(16)
    buffer_load_dwordx4 v[144:147], v20, s[4:7], s77 offen offset:3072 sc1
    v_mfma_f32_16x16x32_bf16 v[48:51], a[80:83], v[148:151], v[48:51]
    v_mfma_f32_16x16x32_bf16 v[56:59], a[84:87], v[148:151], v[56:59]
    v_mfma_f32_16x16x32_bf16 v[64:67], a[88:91], v[148:151], v[64:67]
    v_mfma_f32_16x16x32_bf16 v[72:75], a[92:95], v[148:151], v[72:75]
    s_waitcnt vmcnt(16)
    buffer_load_dwordx4 v[148:151], v21, s[4:7], s77 offen offset:1024 sc1
    v_mfma_f32_16x16x32_bf16 v[48:51], a[96:99], v[152:155], v[48:51]
    v_mfma_f32_16x16x32_bf16 v[56:59], a[100:103], v[152:155], v[56:59]
    v_mfma_f32_16x16x32_bf16 v[64:67], a[104:107], v[152:155], v[64:67]
    v_mfma_f32_16x16x32_bf16 v[72:75], a[108:111], v[152:155], v[72:75]
    s_waitcnt vmcnt(16)
    v_mfma_f32_16x16x32_bf16 v[48:51], a[112:115], v[156:159], v[48:51]
    v_mfma_f32_16x16x32_bf16 v[56:59], a[116:119], v[156:159], v[56:59]
    v_mfma_f32_16x16x32_bf16 v[64:67], a[120:123], v[156:159], v[64:67]
    v_mfma_f32_16x16x32_bf16 v[72:75], a[124:127], v[156:159], v[72:75]
    s_waitcnt vmcnt(15)
    v_mfma_f32_16x16x32_bf16 v[48:51], a[128:131], v[160:163], v[48:51]
    v_mfma_f32_16x16x32_bf16 v[56:59], a[132:135], v[160:163], v[56:59]
    s_waitcnt vmcnt(3)
    s_cbranch_vccnz SAFE_292
    buffer_store_dword v11, v10, s[4:7], s76 offen offset:2048
BACK_293:
    v_mfma_f32_16x16x32_bf16 v[64:67], a[136:139], v[160:163], v[64:67]
    v_mfma_f32_16x16x32_bf16 v[72:75], a[140:143], v[160:163], v[72:75]
    v_mfma_f32_16x16x32_bf16 v[48:51], a[144:147], v[164:167], v[48:51]
    v_mfma_f32_16x16x32_bf16 v[56:59], a[148:151], v[164:167], v[56:59]
    v_mfma_f32_16x16x32_bf16 v[64:67], a[152:155], v[164:167], v[64:67]
    v_mfma_f32_16x16x32_bf16 v[72:75], a[156:159], v[164:167], v[72:75]
    v_mfma_f32_16x16x32_bf16 v[48:51], a[160:163], v[168:171], v[48:51]
    v_mfma_f32_16x16x32_bf16 v[56:59], a[164:167], v[168:171], v[56:59]
    v_mfma_f32_16x16x32_bf16 v[64:67], a[168:171], v[168:171], v[64:67]
    v_mfma_f32_16x16x32_bf16 v[72:75], a[172:175], v[168:171], v[72:75]
    v_mfma_f32_16x16x32_bf16 v[52:55], a[0:3], v[172:175], 0
    v_mfma_f32_16x16x32_bf16 v[60:63], a[4:7], v[172:175], 0
    v_mfma_f32_16x16x32_bf16 v[68:71], a[8:11], v[172:175], 0
    v_mfma_f32_16x16x32_bf16 v[76:79], a[12:15], v[172:175], 0
    v_mfma_f32_16x16x32_bf16 v[52:55], a[16:19], v[176:179], v[52:55]
    v_mfma_f32_16x16x32_bf16 v[60:63], a[20:23], v[176:179], v[60:63]
    ds_write_b128 v5, v[48:51] offset:0
    v_mfma_f32_16x16x32_bf16 v[68:71], a[24:27], v[176:179], v[68:71]
    v_mfma_f32_16x16x32_bf16 v[76:79], a[28:31], v[176:179], v[76:79]
    v_mfma_f32_16x16x32_bf16 v[52:55], a[32:35], v[180:183], v[52:55]
    v_mfma_f32_16x16x32_bf16 v[60:63], a[36:39], v[180:183], v[60:63]
    ds_write_b128 v5, v[56:59] offset:2048
    v_mfma_f32_16x16x32_bf16 v[68:71], a[40:43], v[180:183], v[68:71]
    v_mfma_f32_16x16x32_bf16 v[76:79], a[44:47], v[180:183], v[76:79]
    v_mfma_f32_16x16x32_bf16 v[52:55], a[48:51], v[184:187], v[52:55]
    v_mfma_f32_16x16x32_bf16 v[60:63], a[52:55], v[184:187], v[60:63]
    buffer_load_dword v14, v9, s[4:7], s80 offen offset:2048 sc1
    ds_write_b128 v5, v[64:67] offset:4096
    v_mfma_f32_16x16x32_bf16 v[68:71], a[56:59], v[184:187], v[68:71]
    v_mfma_f32_16x16x32_bf16 v[76:79], a[60:63], v[184:187], v[76:79]
    v_mfma_f32_16x16x32_bf16 v[52:55], a[64:67], v[188:191], v[52:55]
    v_mfma_f32_16x16x32_bf16 v[60:63], a[68:71], v[188:191], v[60:63]
    ds_write_b128 v5, v[72:75] offset:6144
    v_mfma_f32_16x16x32_bf16 v[68:71], a[72:75], v[188:191], v[68:71]
    v_mfma_f32_16x16x32_bf16 v[76:79], a[76:79], v[188:191], v[76:79]
    v_mfma_f32_16x16x32_bf16 v[52:55], a[80:83], v[128:131], v[52:55]
    v_mfma_f32_16x16x32_bf16 v[60:63], a[84:87], v[128:131], v[60:63]
    v_mfma_f32_16x16x32_bf16 v[68:71], a[88:91], v[128:131], v[68:71]
    v_mfma_f32_16x16x32_bf16 v[76:79], a[92:95], v[128:131], v[76:79]
    v_mfma_f32_16x16x32_bf16 v[52:55], a[96:99], v[132:135], v[52:55]
    v_mfma_f32_16x16x32_bf16 v[60:63], a[100:103], v[132:135], v[60:63]
    v_mfma_f32_16x16x32_bf16 v[68:71], a[104:107], v[132:135], v[68:71]
    v_mfma_f32_16x16x32_bf16 v[76:79], a[108:111], v[132:135], v[76:79]
    v_mfma_f32_16x16x32_bf16 v[52:55], a[112:115], v[136:139], v[52:55]
    v_mfma_f32_16x16x32_bf16 v[60:63], a[116:119], v[136:139], v[60:63]
    s_waitcnt vmcnt(0)
    v_cmp_gt_u32 vcc, s35, v14
    s_cbranch_vccnz SPIN_294
BACK_295:
    v_mfma_f32_16x16x32_bf16 v[68:71], a[120:123], v[136:139], v[68:71]
    buffer_load_dwordx4 v[152:155], v16, s[4:7], s78 offen offset:0 sc1
    v_mfma_f32_16x16x32_bf16 v[76:79], a[124:127], v[136:139], v[76:79]
    buffer_load_dwordx4 v[156:159], v16, s[4:7], s78 offen offset:2048 sc1
    v_mfma_f32_16x16x32_bf16 v[52:55], a[128:131], v[140:143], v[52:55]
    buffer_load_dwordx4 v[160:163], v17, s[4:7], s78 offen offset:0 sc1
    v_mfma_f32_16x16x32_bf16 v[60:63], a[132:135], v[140:143], v[60:63]
    buffer_load_dwordx4 v[164:167], v17, s[4:7], s78 offen offset:2048 sc1
    v_mfma_f32_16x16x32_bf16 v[68:71], a[136:139], v[140:143], v[68:71]
    buffer_load_dwordx4 v[168:171], v18, s[4:7], s78 offen offset:0 sc1
    v_mfma_f32_16x16x32_bf16 v[76:79], a[140:143], v[140:143], v[76:79]
    buffer_load_dwordx4 v[172:175], v18, s[4:7], s78 offen offset:2048 sc1
    v_mfma_f32_16x16x32_bf16 v[52:55], a[144:147], v[144:147], v[52:55]
    buffer_load_dwordx4 v[176:179], v19, s[4:7], s78 offen offset:0 sc1
    v_mfma_f32_16x16x32_bf16 v[60:63], a[148:151], v[144:147], v[60:63]
    buffer_load_dwordx4 v[180:183], v19, s[4:7], s78 offen offset:2048 sc1
    v_mfma_f32_16x16x32_bf16 v[68:71], a[152:155], v[144:147], v[68:71]
    buffer_load_dwordx4 v[184:187], v20, s[4:7], s78 offen offset:0 sc1
    v_mfma_f32_16x16x32_bf16 v[76:79], a[156:159], v[144:147], v[76:79]
    buffer_load_dwordx4 v[188:191], v20, s[4:7], s78 offen offset:2048 sc1
    v_mfma_f32_16x16x32_bf16 v[52:55], a[160:163], v[148:151], v[52:55]
    v_mfma_f32_16x16x32_bf16 v[60:63], a[164:167], v[148:151], v[60:63]
    v_mfma_f32_16x16x32_bf16 v[68:71], a[168:171], v[148:151], v[68:71]
    v_mfma_f32_16x16x32_bf16 v[76:79], a[172:175], v[148:151], v[76:79]
    s_branch C1_done
JM_spin:
    global_load_dword v185, v174, s[90:91] sc1
    s_sub_u32 s16, s16, 1
    s_cbranch_scc1 M_end
    s_waitcnt vmcnt(0)
    s_branch JM_chk
S2_spin:
    buffer_load_dword v14, v251, s[4:7], s33 offen sc1
    s_sub_u32 s16, s16, 1
    s_cbranch_scc1 M_end
    s_waitcnt vmcnt(0)
    s_branch S2_back
SAFE_2:
    s_waitcnt vmcnt(0)
    buffer_wbl2 sc1
    s_waitcnt vmcnt(0)
    buffer_store_dword v11, v10, s[4:7], s46 offen offset:0 sc1
    s_branch BACK_3
SPIN_5:
    buffer_load_dword v14, v1, s[4:7], s48 offen offset:0 sc1
    s_sub_u32 s16, s16, 1
    s_cbranch_scc1 M_end
    s_waitcnt vmcnt(0)
    v_cmp_gt_u32 vcc, 1, v14
    s_cbranch_vccnz SPIN_5
    s_cmp_eq_u32 s15, 0
    s_cbranch_scc1 BACK_6
    buffer_inv sc1
    s_waitcnt vmcnt(0)
    s_mov_b64 vcc, -1
    s_branch BACK_6
SPIN_8:
    buffer_load_dword v2, v4, s[4:7], s51 offen offset:0 sc1
    s_sub_u32 s16, s16, 1
    s_cbranch_scc1 M_end
    s_waitcnt vmcnt(0)
    v_cmp_gt_u32 vcc, 1, v2
    s_cbranch_vccnz SPIN_8
    s_cmp_eq_u32 s15, 0
    s_cbranch_scc1 BACK_9
    buffer_inv sc1
    s_waitcnt vmcnt(0)
    s_mov_b64 vcc, -1
    s_branch BACK_9
SLOW_11:
    v_mov_b32 v156, v148
    v_mov_b32 v157, v149
    v_mov_b32 v158, v150
    v_mov_b32 v159, v151
    v_mov_b32 v240, v249
    v_mov_b32 v241, v251
    s_xor_b32 s31, s17, 7
    s_call_b64 s[28:29], SLOWATTH
    v_mov_b32 v208, v176
    v_mov_b32 v209, v177
    v_mov_b32 v210, v178
    v_mov_b32 v211, v179
    v_mov_b32 v212, v180
    v_mov_b32 v213, v181
    v_mov_b32 v214, v182
    v_mov_b32 v215, v183
    v_mov_b32 v216, v184
    s_branch BACK_12
SAFE_13:
    s_waitcnt vmcnt(0)
    buffer_wbl2 sc1
    s_waitcnt vmcnt(0)
    buffer_store_dword v11, v10, s[4:7], s56 offen offset:0 sc1
    s_branch BACK_14
SLOW_20:
    v_mov_b32 v156, v148
    v_mov_b32 v157, v149
    v_mov_b32 v158, v150
    v_mov_b32 v159, v151
    v_mov_b32 v240, v249
    v_mov_b32 v241, v251
    s_xor_b32 s31, s17, 7
    s_call_b64 s[28:29], SLOWATTH
    v_mov_b32 v208, v176
    v_mov_b32 v209, v177
    v_mov_b32 v210, v178
    v_mov_b32 v211, v179
    v_mov_b32 v212, v180
    v_mov_b32 v213, v181
    v_mov_b32 v214, v182
    v_mov_b32 v215, v183
    v_mov_b32 v216, v184
    s_branch BACK_21
SAFE_22:
    s_waitcnt vmcnt(0)
    buffer_wbl2 sc1
    s_waitcnt vmcnt(0)
    buffer_store_dword v11, v10, s[4:7], s56 offen offset:0 sc1
    s_branch BACK_23
SPIN_27:
    buffer_load_dword v14, v1, s[4:7], s48 offen offset:0 sc1
    s_sub_u32 s16, s16, 1
    s_cbranch_scc1 M_end
    s_waitcnt vmcnt(0)
    v_cmp_gt_u32 vcc, 1, v14
    s_cbranch_vccnz SPIN_27
    s_cmp_eq_u32 s15, 0
    s_cbranch_scc1 BACK_28
    buffer_inv sc1
    s_waitcnt vmcnt(0)
    s_mov_b64 vcc, -1
    s_branch BACK_28
SPIN_30:
    buffer_load_dword v2, v4, s[4:7], s51 offen offset:0 sc1
    s_sub_u32 s16, s16, 1
    s_cbranch_scc1 M_end
    s_waitcnt vmcnt(0)
    v_cmp_gt_u32 vcc, 1, v2
    s_cbranch_vccnz SPIN_30
    s_cmp_eq_u32 s15, 0
    s_cbranch_scc1 BACK_31
    buffer_inv sc1
    s_waitcnt vmcnt(0)
    s_mov_b64 vcc, -1
    s_branch BACK_31
SLOW_33:
    v_mov_b32 v156, v148
    v_mov_b32 v157, v149
    v_mov_b32 v158, v150
    v_mov_b32 v159, v151
    v_mov_b32 v240, v249
    v_mov_b32 v241, v251
    s_xor_b32 s31, s17, 7
    s_call_b64 s[28:29], SLOWATTH
    v_mov_b32 v208, v176
    v_mov_b32 v209, v177
    v_mov_b32 v210, v178
    v_mov_b32 v211, v179
    v_mov_b32 v212, v180
    v_mov_b32 v213, v181
    v_mov_b32 v214, v182
    v_mov_b32 v215, v183
    v_mov_b32 v216, v184
    s_branch BACK_34
SAFE_35:
    s_waitcnt vmcnt(0)
    buffer_wbl2 sc1
    s_waitcnt vmcnt(0)
    buffer_store_dword v11, v10, s[4:7], s56 offen offset:0 sc1
    s_branch BACK_36
SLOW_42:
    v_mov_b32 v156, v148
    v_mov_b32 v157, v149
    v_mov_b32 v158, v150
    v_mov_b32 v159, v151
    v_mov_b32 v240, v249
    v_mov_b32 v241, v251
    s_xor_b32 s31, s17, 7
    s_call_b64 s[28:29], SLOWATTH
    v_mov_b32 v208, v176
    v_mov_b32 v209, v177
    v_mov_b32 v210, v178
    v_mov_b32 v211, v179
    v_mov_b32 v212, v180
    v_mov_b32 v213, v181
    v_mov_b32 v214, v182
    v_mov_b32 v215, v183
    v_mov_b32 v216, v184
    s_branch BACK_43
SAFE_44:
    s_waitcnt vmcnt(0)
    buffer_wbl2 sc1
    s_waitcnt vmcnt(0)
    buffer_store_dword v11, v10, s[4:7], s56 offen offset:0 sc1
    s_branch BACK_45
SPIN_49:
    buffer_load_dword v14, v1, s[4:7], s48 offen offset:0 sc1
    s_sub_u32 s16, s16, 1
    s_cbranch_scc1 M_end
    s_waitcnt vmcnt(0)
    v_cmp_gt_u32 vcc, 1, v14
    s_cbranch_vccnz SPIN_49
    s_cmp_eq_u32 s15, 0
    s_cbranch_scc1 BACK_50
    buffer_inv sc1
    s_waitcnt vmcnt(0)
    s_mov_b64 vcc, -1
    s_branch BACK_50
SPIN_52:
    buffer_load_dword v2, v4, s[4:7], s51 offen offset:0 sc1
    s_sub_u32 s16, s16, 1
    s_cbranch_scc1 M_end
    s_waitcnt vmcnt(0)
    v_cmp_gt_u32 vcc, 1, v2
    s_cbranch_vccnz SPIN_52
    s_cmp_eq_u32 s15, 0
    s_cbranch_scc1 BACK_53
    buffer_inv sc1
    s_waitcnt vmcnt(0)
    s_mov_b64 vcc, -1
    s_branch BACK_53
SLOW_55:
    v_mov_b32 v156, v148
    v_mov_b32 v157, v149
    v_mov_b32 v158, v150
    v_mov_b32 v159, v151
    v_mov_b32 v240, v249
    v_mov_b32 v241, v251
    s_xor_b32 s31, s17, 7
    s_call_b64 s[28:29], SLOWATTH
    v_mov_b32 v208, v176
    v_mov_b32 v209, v177
    v_mov_b32 v210, v178
    v_mov_b32 v211, v179
    v_mov_b32 v212, v180
    v_mov_b32 v213, v181
    v_mov_b32 v214, v182
    v_mov_b32 v215, v183
    v_mov_b32 v216, v184
    s_branch BACK_56
SAFE_57:
    s_waitcnt vmcnt(0)
    buffer_wbl2 sc1
    s_waitcnt vmcnt(0)
    buffer_store_dword v11, v10, s[4:7], s56 offen offset:0 sc1
    s_branch BACK_58
SLOW_64:
    v_mov_b32 v156, v148
    v_mov_b32 v157, v149
    v_mov_b32 v158, v150
    v_mov_b32 v159, v151
    v_mov_b32 v240, v249
    v_mov_b32 v241, v251
    s_xor_b32 s31, s17, 7
    s_call_b64 s[28:29], SLOWATTH
    v_mov_b32 v208, v176
    v_mov_b32 v209, v177
    v_mov_b32 v210, v178
    v_mov_b32 v211, v179
    v_mov_b32 v212, v180
    v_mov_b32 v213, v181
    v_mov_b32 v214, v182
    v_mov_b32 v215, v183
    v_mov_b32 v216, v184
    s_branch BACK_65
SAFE_66:
    s_waitcnt vmcnt(0)
    buffer_wbl2 sc1
    s_waitcnt vmcnt(0)
    buffer_store_dword v11, v10, s[4:7], s56 offen offset:0 sc1
    s_branch BACK_67
SPIN_71:
    buffer_load_dword v14, v1, s[4:7], s48 offen offset:0 sc1
    s_sub_u32 s16, s16, 1
    s_cbranch_scc1 M_end
    s_waitcnt vmcnt(0)
    v_cmp_gt_u32 vcc, 1, v14
    s_cbranch_vccnz SPIN_71
    s_cmp_eq_u32 s15, 0
    s_cbranch_scc1 BACK_72
    buffer_inv sc1
    s_waitcnt vmcnt(0)
    s_mov_b64 vcc, -1
    s_branch BACK_72
SPIN_74:
    buffer_load_dword v2, v4, s[4:7], s51 offen offset:0 sc1
    s_sub_u32 s16, s16, 1
    s_cbranch_scc1 M_end
    s_waitcnt vmcnt(0)
    v_cmp_gt_u32 vcc, 1, v2
    s_cbranch_vccnz SPIN_74
    s_cmp_eq_u32 s15, 0
    s_cbranch_scc1 BACK_75
    buffer_inv sc1
    s_waitcnt vmcnt(0)
    s_mov_b64 vcc, -1
    s_branch BACK_75
SLOW_77:
    v_mov_b32 v156, v148
    v_mov_b32 v157, v149
    v_mov_b32 v158, v150
    v_mov_b32 v159, v151
    v_mov_b32 v240, v249
    v_mov_b32 v241, v251
    s_xor_b32 s31, s17, 7
    s_call_b64 s[28:29], SLOWATTH
    v_mov_b32 v208, v176
    v_mov_b32 v209, v177
    v_mov_b32 v210, v178
    v_mov_b32 v211, v179
    v_mov_b32 v212, v180
    v_mov_b32 v213, v181
    v_mov_b32 v214, v182
    v_mov_b32 v215, v183
    v_mov_b32 v216, v184
    s_branch BACK_78
SAFE_79:
    s_waitcnt vmcnt(0)
    buffer_wbl2 sc1
    s_waitcnt vmcnt(0)
    buffer_store_dword v11, v10, s[4:7], s56 offen offset:0 sc1
    s_branch BACK_80
SPIN2_84:
    buffer_inv sc1
    s_waitcnt vmcnt(0)
    s_mov_b64 vcc, -1
    s_branch BACK_83
SLOW_86:
    v_mov_b32 v156, v148
    v_mov_b32 v157, v149
    v_mov_b32 v158, v150
    v_mov_b32 v159, v151
    v_mov_b32 v240, v249
    v_mov_b32 v241, v251
    s_xor_b32 s31, s17, 7
    s_call_b64 s[28:29], SLOWATTH
    v_mov_b32 v208, v176
    v_mov_b32 v209, v177
    v_mov_b32 v210, v178
    v_mov_b32 v211, v179
    v_mov_b32 v212, v180
    v_mov_b32 v213, v181
    v_mov_b32 v214, v182
    v_mov_b32 v215, v183
    v_mov_b32 v216, v184
    s_branch BACK_87
SAFE_88:
    s_waitcnt vmcnt(0)
    buffer_wbl2 sc1
    s_waitcnt vmcnt(0)
    buffer_store_dword v11, v10, s[4:7], s56 offen offset:0 sc1
    s_branch BACK_89
SLOW_93:
    v_mov_b32 v156, v144
    v_mov_b32 v157, v145
    v_mov_b32 v158, v146
    v_mov_b32 v159, v147
    v_mov_b32 v240, v248
    v_mov_b32 v241, v250
    s_xor_b32 s31, s17, 0
    s_call_b64 s[28:29], SLOWATTL
    v_mov_b32 v192, v96
    v_mov_b32 v193, v97
    v_mov_b32 v194, v98
    v_mov_b32 v195, v99
    v_mov_b32 v196, v100
    v_mov_b32 v197, v101
    v_mov_b32 v198, v102
    v_mov_b32 v199, v103
    v_mov_b32 v200, v104
    s_branch BACK_94
SAFE_95:
    buffer_store_dword v196, v8, s[4:7], s63 offen sc1
    s_branch BACK_96
SPIN2_99:
    buffer_inv sc1
    s_waitcnt vmcnt(0)
    s_mov_b64 vcc, -1
    s_branch BACK_98
SAFE_100:
    s_waitcnt vmcnt(0)
    buffer_wbl2 sc1
    s_waitcnt vmcnt(0)
    buffer_store_dword v11, v10, s[4:7], s55 offen offset:0 sc1
    s_branch BACK_101
SAFE_102:
    s_waitcnt vmcnt(0)
    buffer_wbl2 sc1
    s_waitcnt vmcnt(0)
    buffer_store_dword v11, v10, s[4:7], s65 offen offset:1024 sc1
    s_branch BACK_103
SPIN2_106:
    buffer_inv sc1
    s_waitcnt vmcnt(0)
    s_mov_b64 vcc, -1
    s_branch BACK_105
SAFE_107:
    buffer_store_dword v196, v8, s[4:7], s64 offen sc1
    s_branch BACK_108
SPIN_109:
    buffer_load_dword v14, v9, s[4:7], s72 offen offset:1024 sc1
    s_sub_u32 s16, s16, 1
    s_cbranch_scc1 M_end
    s_waitcnt vmcnt(0)
    v_cmp_gt_u32 vcc, 1, v14
    s_cbranch_vccnz SPIN_109
    s_cmp_eq_u32 s15, 0
    s_cbranch_scc1 BACK_110
    buffer_inv sc1
    s_waitcnt vmcnt(0)
    s_mov_b64 vcc, -1
    s_branch BACK_110
SAFE_112:
    s_waitcnt vmcnt(0)
    buffer_wbl2 sc1
    s_waitcnt vmcnt(0)
    buffer_store_dword v11, v10, s[4:7], s66 offen offset:1024 sc1
    s_branch BACK_113
SAFE_114:
    s_waitcnt vmcnt(0)
    buffer_wbl2 sc1
    s_waitcnt vmcnt(0)
    buffer_store_dword v11, v10, s[4:7], s75 offen offset:2048 sc1
    s_branch BACK_115
SPIN_116:
    buffer_load_dword v14, v9, s[4:7], s79 offen offset:2048 sc1
    s_sub_u32 s16, s16, 1
    s_cbranch_scc1 M_end
    s_waitcnt vmcnt(0)
    v_cmp_gt_u32 vcc, 1, v14
    s_cbranch_vccnz SPIN_116
    s_cmp_eq_u32 s15, 0
    s_cbranch_scc1 BACK_117
    buffer_inv sc1
    s_waitcnt vmcnt(0)
    s_mov_b64 vcc, -1
    s_branch BACK_117
SAFE_119:
    s_waitcnt vmcnt(0)
    buffer_wbl2 sc1
    s_waitcnt vmcnt(0)
    buffer_store_dword v11, v10, s[4:7], s76 offen offset:2048 sc1
    s_branch BACK_120
SPIN_121:
    buffer_load_dword v14, v9, s[4:7], s80 offen offset:2048 sc1
    s_sub_u32 s16, s16, 1
    s_cbranch_scc1 M_end
    s_waitcnt vmcnt(0)
    v_cmp_gt_u32 vcc, 1, v14
    s_cbranch_vccnz SPIN_121
    s_cmp_eq_u32 s15, 0
    s_cbranch_scc1 BACK_122
    buffer_inv sc1
    s_waitcnt vmcnt(0)
    s_mov_b64 vcc, -1
    s_branch BACK_122
SPIN2_127:
    buffer_inv sc1
    s_waitcnt vmcnt(0)
    s_mov_b64 vcc, -1
    s_branch BACK_126
SAFE_128:
    buffer_store_dword v196, v8, s[4:7], s64 offen sc1
    s_branch BACK_129
SPIN_130:
    buffer_load_dword v14, v9, s[4:7], s72 offen offset:1024 sc1
    s_sub_u32 s16, s16, 1
    s_cbranch_scc1 M_end
    s_waitcnt vmcnt(0)
    v_cmp_gt_u32 vcc, 1, v14
    s_cbranch_vccnz SPIN_130
    s_cmp_eq_u32 s15, 0
    s_cbranch_scc1 BACK_131
    buffer_inv sc1
    s_waitcnt vmcnt(0)
    s_mov_b64 vcc, -1
    s_branch BACK_131
SAFE_133:
    s_waitcnt vmcnt(0)
    buffer_wbl2 sc1
    s_waitcnt vmcnt(0)
    buffer_store_dword v11, v10, s[4:7], s66 offen offset:1024 sc1
    s_branch BACK_134
SAFE_135:
    s_waitcnt vmcnt(0)
    buffer_wbl2 sc1
    s_waitcnt vmcnt(0)
    buffer_store_dword v11, v10, s[4:7], s75 offen offset:2048 sc1
    s_branch BACK_136
SPIN_137:
    buffer_load_dword v14, v9, s[4:7], s79 offen offset:2048 sc1
    s_sub_u32 s16, s16, 1
    s_cbranch_scc1 M_end
    s_waitcnt vmcnt(0)
    v_cmp_gt_u32 vcc, 1, v14
    s_cbranch_vccnz SPIN_137
    s_cmp_eq_u32 s15, 0
    s_cbranch_scc1 BACK_138
    buffer_inv sc1
    s_waitcnt vmcnt(0)
    s_mov_b64 vcc, -1
    s_branch BACK_138
SAFE_140:
    s_waitcnt vmcnt(0)
    buffer_wbl2 sc1
    s_waitcnt vmcnt(0)
    buffer_store_dword v11, v10, s[4:7], s76 offen offset:2048 sc1
    s_branch BACK_141
SPIN_142:
    buffer_load_dword v14, v9, s[4:7], s80 offen offset:2048 sc1
    s_sub_u32 s16, s16, 1
    s_cbranch_scc1 M_end
    s_waitcnt vmcnt(0)
    v_cmp_gt_u32 vcc, 1, v14
    s_cbranch_vccnz SPIN_142
    s_cmp_eq_u32 s15, 0
    s_cbranch_scc1 BACK_143
    buffer_inv sc1
    s_waitcnt vmcnt(0)
    s_mov_b64 vcc, -1
    s_branch BACK_143
SAFE_145:
    buffer_store_dword v196, v8, s[4:7], s63 offen sc1
    s_branch BACK_146
SAFE_147:
    buffer_store_dword v196, v8, s[4:7], s64 offen sc1
    s_branch BACK_148
SAFE_149:
    s_waitcnt vmcnt(0)
    buffer_wbl2 sc1
    s_waitcnt vmcnt(0)
    buffer_store_dword v11, v10, s[4:7], s65 offen offset:3072 sc1
    s_branch BACK_150
SAFE_151:
    s_waitcnt vmcnt(0)
    buffer_wbl2 sc1
    s_waitcnt vmcnt(0)
    buffer_store_dword v11, v10, s[4:7], s66 offen offset:3072 sc1
    s_branch BACK_152
SPIN_153:
    buffer_load_dword v14, v31, s[4:7], s39 offen offset:0 sc1
    s_sub_u32 s16, s16, 1
    s_cbranch_scc1 M_end
    s_waitcnt vmcnt(0)
    v_cmp_gt_u32 vcc, 1, v14
    s_cbranch_vccnz SPIN_153
    s_cmp_eq_u32 s15, 0
    s_cbranch_scc1 BACK_154
    buffer_inv sc1
    s_waitcnt vmcnt(0)
    s_mov_b64 vcc, -1
    s_branch BACK_154
SPIN_157:
    buffer_load_dword v14, v1, s[4:7], s48 offen offset:0 sc1
    s_sub_u32 s16, s16, 1
    s_cbranch_scc1 M_end
    s_waitcnt vmcnt(0)
    v_cmp_gt_u32 vcc, 2, v14
    s_cbranch_vccnz SPIN_157
    s_cmp_eq_u32 s15, 0
    s_cbranch_scc1 BACK_158
    buffer_inv sc1
    s_waitcnt vmcnt(0)
    s_mov_b64 vcc, -1
    s_branch BACK_158
SPIN_160:
    buffer_load_dword v2, v4, s[4:7], s51 offen offset:0 sc1
    s_sub_u32 s16, s16, 1
    s_cbranch_scc1 M_end
    s_waitcnt vmcnt(0)
    v_cmp_gt_u32 vcc, 2, v2
    s_cbranch_vccnz SPIN_160
    s_cmp_eq_u32 s15, 0
    s_cbranch_scc1 BACK_161
    buffer_inv sc1
    s_waitcnt vmcnt(0)
    s_mov_b64 vcc, -1
    s_branch BACK_161
SAFE_163:
    s_waitcnt vmcnt(0)
    buffer_wbl2 sc1
    s_waitcnt vmcnt(0)
    buffer_store_dword v11, v10, s[4:7], s46 offen offset:0 sc1
    s_branch BACK_164
SLOW_165:
    v_mov_b32 v156, v148
    v_mov_b32 v157, v149
    v_mov_b32 v158, v150
    v_mov_b32 v159, v151
    v_mov_b32 v240, v249
    v_mov_b32 v241, v251
    s_xor_b32 s31, s17, 7
    s_call_b64 s[28:29], SLOWATTH
    v_mov_b32 v208, v176
    v_mov_b32 v209, v177
    v_mov_b32 v210, v178
    v_mov_b32 v211, v179
    v_mov_b32 v212, v180
    v_mov_b32 v213, v181
    v_mov_b32 v214, v182
    v_mov_b32 v215, v183
    v_mov_b32 v216, v184
    s_branch BACK_166
SAFE_167:
    s_waitcnt vmcnt(0)
    buffer_wbl2 sc1
    s_waitcnt vmcnt(0)
    buffer_store_dword v11, v10, s[4:7], s56 offen offset:0 sc1
    s_branch BACK_168
SLOW_172:
    v_mov_b32 v156, v148
    v_mov_b32 v157, v149
    v_mov_b32 v158, v150
    v_mov_b32 v159, v151
    v_mov_b32 v240, v249
    v_mov_b32 v241, v251
    s_xor_b32 s31, s17, 7
    s_call_b64 s[28:29], SLOWATTH
    v_mov_b32 v208, v176
    v_mov_b32 v209, v177
    v_mov_b32 v210, v178
    v_mov_b32 v211, v179
    v_mov_b32 v212, v180
    v_mov_b32 v213, v181
    v_mov_b32 v214, v182
    v_mov_b32 v215, v183
    v_mov_b32 v216, v184
    s_branch BACK_173
SAFE_174:
    s_waitcnt vmcnt(0)
    buffer_wbl2 sc1
    s_waitcnt vmcnt(0)
    buffer_store_dword v11, v10, s[4:7], s56 offen offset:0 sc1
    s_branch BACK_175
SPIN_179:
    buffer_load_dword v14, v1, s[4:7], s48 offen offset:0 sc1
    s_sub_u32 s16, s16, 1
    s_cbranch_scc1 M_end
    s_waitcnt vmcnt(0)
    v_cmp_gt_u32 vcc, 2, v14
    s_cbranch_vccnz SPIN_179
    s_cmp_eq_u32 s15, 0
    s_cbranch_scc1 BACK_180
    buffer_inv sc1
    s_waitcnt vmcnt(0)
    s_mov_b64 vcc, -1
    s_branch BACK_180
SPIN_182:
    buffer_load_dword v2, v4, s[4:7], s51 offen offset:0 sc1
    s_sub_u32 s16, s16, 1
    s_cbranch_scc1 M_end
    s_waitcnt vmcnt(0)
    v_cmp_gt_u32 vcc, 2, v2
    s_cbranch_vccnz SPIN_182
    s_cmp_eq_u32 s15, 0
    s_cbranch_scc1 BACK_183
    buffer_inv sc1
    s_waitcnt vmcnt(0)
    s_mov_b64 vcc, -1
    s_branch BACK_183
SAFE_185:
    s_waitcnt vmcnt(0)
    buffer_wbl2 sc1
    s_waitcnt vmcnt(0)
    buffer_store_dword v11, v10, s[4:7], s46 offen offset:0 sc1
    s_branch BACK_186
SLOW_187:
    v_mov_b32 v156, v148
    v_mov_b32 v157, v149
    v_mov_b32 v158, v150
    v_mov_b32 v159, v151
    v_mov_b32 v240, v249
    v_mov_b32 v241, v251
    s_xor_b32 s31, s17, 7
    s_call_b64 s[28:29], SLOWATTH
    v_mov_b32 v208, v176
    v_mov_b32 v209, v177
    v_mov_b32 v210, v178
    v_mov_b32 v211, v179
    v_mov_b32 v212, v180
    v_mov_b32 v213, v181
    v_mov_b32 v214, v182
    v_mov_b32 v215, v183
    v_mov_b32 v216, v184
    s_branch BACK_188
SAFE_189:
    s_waitcnt vmcnt(0)
    buffer_wbl2 sc1
    s_waitcnt vmcnt(0)
    buffer_store_dword v11, v10, s[4:7], s56 offen offset:0 sc1
    s_branch BACK_190
SLOW_194:
    v_mov_b32 v156, v148
    v_mov_b32 v157, v149
    v_mov_b32 v158, v150
    v_mov_b32 v159, v151
    v_mov_b32 v240, v249
    v_mov_b32 v241, v251
    s_xor_b32 s31, s17, 7
    s_call_b64 s[28:29], SLOWATTH
    v_mov_b32 v208, v176
    v_mov_b32 v209, v177
    v_mov_b32 v210, v178
    v_mov_b32 v211, v179
    v_mov_b32 v212, v180
    v_mov_b32 v213, v181
    v_mov_b32 v214, v182
    v_mov_b32 v215, v183
    v_mov_b32 v216, v184
    s_branch BACK_195
SAFE_196:
    s_waitcnt vmcnt(0)
    buffer_wbl2 sc1
    s_waitcnt vmcnt(0)
    buffer_store_dword v11, v10, s[4:7], s56 offen offset:0 sc1
    s_branch BACK_197
SPIN_201:
    buffer_load_dword v14, v1, s[4:7], s48 offen offset:0 sc1
    s_sub_u32 s16, s16, 1
    s_cbranch_scc1 M_end
    s_waitcnt vmcnt(0)
    v_cmp_gt_u32 vcc, 2, v14
    s_cbranch_vccnz SPIN_201
    s_cmp_eq_u32 s15, 0
    s_cbranch_scc1 BACK_202
    buffer_inv sc1
    s_waitcnt vmcnt(0)
    s_mov_b64 vcc, -1
    s_branch BACK_202
SPIN_204:
    buffer_load_dword v2, v4, s[4:7], s51 offen offset:0 sc1
    s_sub_u32 s16, s16, 1
    s_cbranch_scc1 M_end
    s_waitcnt vmcnt(0)
    v_cmp_gt_u32 vcc, 2, v2
    s_cbranch_vccnz SPIN_204
    s_cmp_eq_u32 s15, 0
    s_cbranch_scc1 BACK_205
    buffer_inv sc1
    s_waitcnt vmcnt(0)
    s_mov_b64 vcc, -1
    s_branch BACK_205
SAFE_207:
    s_waitcnt vmcnt(0)
    buffer_wbl2 sc1
    s_waitcnt vmcnt(0)
    buffer_store_dword v11, v10, s[4:7], s46 offen offset:0 sc1
    s_branch BACK_208
SLOW_209:
    v_mov_b32 v156, v148
    v_mov_b32 v157, v149
    v_mov_b32 v158, v150
    v_mov_b32 v159, v151
    v_mov_b32 v240, v249
    v_mov_b32 v241, v251
    s_xor_b32 s31, s17, 7
    s_call_b64 s[28:29], SLOWATTH
    v_mov_b32 v208, v176
    v_mov_b32 v209, v177
    v_mov_b32 v210, v178
    v_mov_b32 v211, v179
    v_mov_b32 v212, v180
    v_mov_b32 v213, v181
    v_mov_b32 v214, v182
    v_mov_b32 v215, v183
    v_mov_b32 v216, v184
    s_branch BACK_210
SAFE_211:
    s_waitcnt vmcnt(0)
    buffer_wbl2 sc1
    s_waitcnt vmcnt(0)
    buffer_store_dword v11, v10, s[4:7], s56 offen offset:0 sc1
    s_branch BACK_212
SLOW_216:
    v_mov_b32 v156, v148
    v_mov_b32 v157, v149
    v_mov_b32 v158, v150
    v_mov_b32 v159, v151
    v_mov_b32 v240, v249
    v_mov_b32 v241, v251
    s_xor_b32 s31, s17, 7
    s_call_b64 s[28:29], SLOWATTH
    v_mov_b32 v208, v176
    v_mov_b32 v209, v177
    v_mov_b32 v210, v178
    v_mov_b32 v211, v179
    v_mov_b32 v212, v180
    v_mov_b32 v213, v181
    v_mov_b32 v214, v182
    v_mov_b32 v215, v183
    v_mov_b32 v216, v184
    s_branch BACK_217
SAFE_218:
    s_waitcnt vmcnt(0)
    buffer_wbl2 sc1
    s_waitcnt vmcnt(0)
    buffer_store_dword v11, v10, s[4:7], s56 offen offset:0 sc1
    s_branch BACK_219
SPIN_223:
    buffer_load_dword v14, v1, s[4:7], s48 offen offset:0 sc1
    s_sub_u32 s16, s16, 1
    s_cbranch_scc1 M_end
    s_waitcnt vmcnt(0)
    v_cmp_gt_u32 vcc, 2, v14
    s_cbranch_vccnz SPIN_223
    s_cmp_eq_u32 s15, 0
    s_cbranch_scc1 BACK_224
    buffer_inv sc1
    s_waitcnt vmcnt(0)
    s_mov_b64 vcc, -1
    s_branch BACK_224
SPIN_226:
    buffer_load_dword v2, v4, s[4:7], s51 offen offset:0 sc1
    s_sub_u32 s16, s16, 1
    s_cbranch_scc1 M_end
    s_waitcnt vmcnt(0)
    v_cmp_gt_u32 vcc, 2, v2
    s_cbranch_vccnz SPIN_226
    s_cmp_eq_u32 s15, 0
    s_cbranch_scc1 BACK_227
    buffer_inv sc1
    s_waitcnt vmcnt(0)
    s_mov_b64 vcc, -1
    s_branch BACK_227
SAFE_229:
    s_waitcnt vmcnt(0)
    buffer_wbl2 sc1
    s_waitcnt vmcnt(0)
    buffer_store_dword v11, v10, s[4:7], s46 offen offset:0 sc1
    s_branch BACK_230
SLOW_231:
    v_mov_b32 v156, v148
    v_mov_b32 v157, v149
    v_mov_b32 v158, v150
    v_mov_b32 v159, v151
    v_mov_b32 v240, v249
    v_mov_b32 v241, v251
    s_xor_b32 s31, s17, 7
    s_call_b64 s[28:29], SLOWATTH
    v_mov_b32 v208, v176
    v_mov_b32 v209, v177
    v_mov_b32 v210, v178
    v_mov_b32 v211, v179
    v_mov_b32 v212, v180
    v_mov_b32 v213, v181
    v_mov_b32 v214, v182
    v_mov_b32 v215, v183
    v_mov_b32 v216, v184
    s_branch BACK_232
SAFE_233:
    s_waitcnt vmcnt(0)
    buffer_wbl2 sc1
    s_waitcnt vmcnt(0)
    buffer_store_dword v11, v10, s[4:7], s56 offen offset:0 sc1
    s_branch BACK_234
SPIN2_237:
    buffer_inv sc1
    s_waitcnt vmcnt(0)
    s_mov_b64 vcc, -1
    s_branch BACK_236
SLOW_238:
    v_mov_b32 v156, v148
    v_mov_b32 v157, v149
    v_mov_b32 v158, v150
    v_mov_b32 v159, v151
    v_mov_b32 v240, v249
    v_mov_b32 v241, v251
    s_xor_b32 s31, s17, 7
    s_call_b64 s[28:29], SLOWATTH
    v_mov_b32 v208, v176
    v_mov_b32 v209, v177
    v_mov_b32 v210, v178
    v_mov_b32 v211, v179
    v_mov_b32 v212, v180
    v_mov_b32 v213, v181
    v_mov_b32 v214, v182
    v_mov_b32 v215, v183
    v_mov_b32 v216, v184
    s_branch BACK_239
SAFE_240:
    s_waitcnt vmcnt(0)
    buffer_wbl2 sc1
    s_waitcnt vmcnt(0)
    buffer_store_dword v11, v10, s[4:7], s56 offen offset:0 sc1
    s_branch BACK_241
SLOW_245:
    v_mov_b32 v156, v144
    v_mov_b32 v157, v145
    v_mov_b32 v158, v146
    v_mov_b32 v159, v147
    v_mov_b32 v240, v248
    v_mov_b32 v241, v250
    s_xor_b32 s31, s17, 0
    s_call_b64 s[28:29], SLOWATTL
    v_mov_b32 v192, v96
    v_mov_b32 v193, v97
    v_mov_b32 v194, v98
    v_mov_b32 v195, v99
    v_mov_b32 v196, v100
    v_mov_b32 v197, v101
    v_mov_b32 v198, v102
    v_mov_b32 v199, v103
    v_mov_b32 v200, v104
    s_branch BACK_246
SAFE_247:
    buffer_store_dword v196, v8, s[4:7], s63 offen sc1
    s_branch BACK_248
SPIN2_251:
    buffer_inv sc1
    s_waitcnt vmcnt(0)
    s_mov_b64 vcc, -1
    s_branch BACK_250
SAFE_252:
    s_waitcnt vmcnt(0)
    buffer_wbl2 sc1
    s_waitcnt vmcnt(0)
    buffer_store_dword v11, v10, s[4:7], s55 offen offset:0 sc1
    s_branch BACK_253
SAFE_254:
    s_waitcnt vmcnt(0)
    buffer_wbl2 sc1
    s_waitcnt vmcnt(0)
    buffer_store_dword v11, v10, s[4:7], s65 offen offset:1024 sc1
    s_branch BACK_255
SPIN2_258:
    buffer_inv sc1
    s_waitcnt vmcnt(0)
    s_mov_b64 vcc, -1
    s_branch BACK_257
SAFE_259:
    buffer_store_dword v196, v8, s[4:7], s64 offen sc1
    s_branch BACK_260
SPIN_261:
    buffer_load_dword v14, v9, s[4:7], s72 offen offset:1024 sc1
    s_sub_u32 s16, s16, 1
    s_cbranch_scc1 M_end
    s_waitcnt vmcnt(0)
    v_cmp_gt_u32 vcc, 2, v14
    s_cbranch_vccnz SPIN_261
    s_cmp_eq_u32 s15, 0
    s_cbranch_scc1 BACK_262
    buffer_inv sc1
    s_waitcnt vmcnt(0)
    s_mov_b64 vcc, -1
    s_branch BACK_262
SAFE_264:
    s_waitcnt vmcnt(0)
    buffer_wbl2 sc1
    s_waitcnt vmcnt(0)
    buffer_store_dword v11, v10, s[4:7], s66 offen offset:1024 sc1
    s_branch BACK_265
SAFE_266:
    s_waitcnt vmcnt(0)
    buffer_wbl2 sc1
    s_waitcnt vmcnt(0)
    buffer_store_dword v11, v10, s[4:7], s75 offen offset:2048 sc1
    s_branch BACK_267
SPIN_268:
    buffer_load_dword v14, v9, s[4:7], s79 offen offset:2048 sc1
    s_sub_u32 s16, s16, 1
    s_cbranch_scc1 M_end
    s_waitcnt vmcnt(0)
    v_cmp_gt_u32 vcc, 2, v14
    s_cbranch_vccnz SPIN_268
    s_cmp_eq_u32 s15, 0
    s_cbranch_scc1 BACK_269
    buffer_inv sc1
    s_waitcnt vmcnt(0)
    s_mov_b64 vcc, -1
    s_branch BACK_269
SAFE_271:
    s_waitcnt vmcnt(0)
    buffer_wbl2 sc1
    s_waitcnt vmcnt(0)
    buffer_store_dword v11, v10, s[4:7], s76 offen offset:2048 sc1
    s_branch BACK_272
SPIN_273:
    buffer_load_dword v14, v9, s[4:7], s80 offen offset:2048 sc1
    s_sub_u32 s16, s16, 1
    s_cbranch_scc1 M_end
    s_waitcnt vmcnt(0)
    v_cmp_gt_u32 vcc, 2, v14
    s_cbranch_vccnz SPIN_273
    s_cmp_eq_u32 s15, 0
    s_cbranch_scc1 BACK_274
    buffer_inv sc1
    s_waitcnt vmcnt(0)
    s_mov_b64 vcc, -1
    s_branch BACK_274
SPIN2_279:
    buffer_inv sc1
    s_waitcnt vmcnt(0)
    s_mov_b64 vcc, -1
    s_branch BACK_278
SAFE_280:
    buffer_store_dword v196, v8, s[4:7], s64 offen sc1
    s_branch BACK_281
SPIN_282:
    buffer_load_dword v14, v9, s[4:7], s72 offen offset:1024 sc1
    s_sub_u32 s16, s16, 1
    s_cbranch_scc1 M_end
    s_waitcnt vmcnt(0)
    v_cmp_gt_u32 vcc, 2, v14
    s_cbranch_vccnz SPIN_282
    s_cmp_eq_u32 s15, 0
    s_cbranch_scc1 BACK_283
    buffer_inv sc1
    s_waitcnt vmcnt(0)
    s_mov_b64 vcc, -1
    s_branch BACK_283
SAFE_285:
    s_waitcnt vmcnt(0)
    buffer_wbl2 sc1
    s_waitcnt vmcnt(0)
    buffer_store_dword v11, v10, s[4:7], s66 offen offset:1024 sc1
    s_branch BACK_286
SAFE_287:
    s_waitcnt vmcnt(0)
    buffer_wbl2 sc1
    s_waitcnt vmcnt(0)
    buffer_store_dword v11, v10, s[4:7], s75 offen offset:2048 sc1
    s_branch BACK_288
SPIN_289:
    buffer_load_dword v14, v9, s[4:7], s79 offen offset:2048 sc1
    s_sub_u32 s16, s16, 1
    s_cbranch_scc1 M_end
    s_waitcnt vmcnt(0)
    v_cmp_gt_u32 vcc, 2, v14
    s_cbranch_vccnz SPIN_289
    s_cmp_eq_u32 s15, 0
    s_cbranch_scc1 BACK_290
    buffer_inv sc1
    s_waitcnt vmcnt(0)
    s_mov_b64 vcc, -1
    s_branch BACK_290
SAFE_292:
    s_waitcnt vmcnt(0)
    buffer_wbl2 sc1
    s_waitcnt vmcnt(0)
    buffer_store_dword v11, v10, s[4:7], s76 offen offset:2048 sc1
    s_branch BACK_293
SPIN_294:
    buffer_load_dword v14, v9, s[4:7], s80 offen offset:2048 sc1
    s_sub_u32 s16, s16, 1
    s_cbranch_scc1 M_end
    s_waitcnt vmcnt(0)
    v_cmp_gt_u32 vcc, 2, v14
    s_cbranch_vccnz SPIN_294
    s_cmp_eq_u32 s15, 0
    s_cbranch_scc1 BACK_295
    buffer_inv sc1
    s_waitcnt vmcnt(0)
    s_mov_b64 vcc, -1
    s_branch BACK_295
SLOWATTL:
    s_nop 15
    s_cmp_eq_u32 s12, 0
    s_cselect_b32 s32, 8, s31
    v_mov_b32 v244, 0xff800000
SL1L_top:
    s_lshl_b32 s33, s32, 12
    v_add_u32 v242, s33, v240
    v_add_u32 v243, s33, v241
    ds_read_b128 v[152:155], v242
    s_add_u32 s33, s31, 8
    s_waitcnt lgkmcnt(0)
    s_cmp_eq_u32 s32, s31
    s_cbranch_scc1 SL1L_a
    s_cmp_eq_u32 s32, s33
    s_cbranch_scc1 SL1L_d
    v_mfma_f32_32x32x16_bf16 v[80:95], v[152:155], v[156:159], 0
    s_branch SL1L_j
SL1L_a:
    v_mfma_f32_32x32x16_bf16 v[80:95], v[152:155], v[156:159], v[48:63]
    s_branch SL1L_j
SL1L_d:
    v_mfma_f32_32x32x16_bf16 v[80:95], v[152:155], v[156:159], v[32:47]
SL1L_j:
    s_nop 15
    v_max3_f32 v244, v80, v81, v244
    v_max3_f32 v244, v82, v83, v244
    v_max3_f32 v244, v84, v85, v244
    v_max3_f32 v244, v86, v87, v244
    v_max3_f32 v244, v88, v89, v244
    v_max3_f32 v244, v90, v91, v244
    v_max3_f32 v244, v92, v93, v244
    v_max3_f32 v244, v94, v95, v244
    s_add_u32 s32, s32, 1
    s_cmp_le_u32 s32, s33
    s_cbranch_scc1 SL1L_top
    v_mov_b32 v245, v244
    s_nop 1
    v_permlane32_swap_b32 v244, v245
    v_max_f32 v244, v244, v245
    s_cmp_eq_u32 s12, 0
    s_cselect_b32 s32, 8, s31
    v_mov_b32 v96, 0
    v_mov_b32 v97, 0
    v_mov_b32 v98, 0
    v_mov_b32 v99, 0
    v_mov_b32 v100, 0
    v_mov_b32 v101, 0
    v_mov_b32 v102, 0
    v_mov_b32 v103, 0
    v_mov_b32 v104, 0
    v_mov_b32 v105, 0
    v_mov_b32 v106, 0
    v_mov_b32 v107, 0
    v_mov_b32 v108, 0
    v_mov_b32 v109, 0
    v_mov_b32 v110, 0
    v_mov_b32 v111, 0
    v_mov_b32 v224, 0x3f803f80
    v_mov_b32 v225, 0x3f803f80
    v_mov_b32 v226, 0x3f803f80
    v_mov_b32 v227, 0x3f803f80
    v_mov_b32 v228, 0x3f803f80
    v_mov_b32 v229, 0x3f803f80
    v_mov_b32 v230, 0x3f803f80
    v_mov_b32 v231, 0x3f803f80
SL2L_top:
    s_lshl_b32 s33, s32, 12
    v_add_u32 v242, s33, v240
    v_add_u32 v243, s33, v241
    ds_read_b128 v[152:155], v242
    s_add_u32 s33, s31, 8
    s_waitcnt lgkmcnt(0)
    s_cmp_eq_u32 s32, s31
    s_cbranch_scc1 SL2L_a
    s_cmp_eq_u32 s32, s33
    s_cbranch_scc1 SL2L_d
    v_mfma_f32_32x32x16_bf16 v[80:95], v[152:155], v[156:159], 0
    s_branch SL2L_j
SL2L_a:
    v_mfma_f32_32x32x16_bf16 v[80:95], v[152:155], v[156:159], v[48:63]
    s_branch SL2L_j
SL2L_d:
    v_mfma_f32_32x32x16_bf16 v[80:95], v[152:155], v[156:159], v[32:47]
SL2L_j:
    s_nop 15
    s_mov_b64 exec, s[20:21]
    ds_read_b128 v[224:227], v243
    ds_read_b128 v[228:231], v243 offset:1024
    s_mov_b64 exec, -1
    v_sub_f32 v80, v80, v244
    v_sub_f32 v81, v81, v244
    v_sub_f32 v82, v82, v244
    v_sub_f32 v83, v83, v244
    v_sub_f32 v84, v84, v244
    v_sub_f32 v85, v85, v244
    v_sub_f32 v86, v86, v244
    v_sub_f32 v87, v87, v244
    v_sub_f32 v88, v88, v244
    v_sub_f32 v89, v89, v244
    v_sub_f32 v90, v90, v244
    v_sub_f32 v91, v91, v244
    v_sub_f32 v92, v92, v244
    v_sub_f32 v93, v93, v244
    v_sub_f32 v94, v94, v244
    v_sub_f32 v95, v95, v244
    v_exp_f32 v80, v80
    v_exp_f32 v81, v81
    v_exp_f32 v82, v82
    v_exp_f32 v83, v83
    v_exp_f32 v84, v84
    v_exp_f32 v85, v85
    v_exp_f32 v86, v86
    v_exp_f32 v87, v87
    v_exp_f32 v88, v88
    v_exp_f32 v89, v89
    v_exp_f32 v90, v90
    v_exp_f32 v91, v91
    v_exp_f32 v92, v92
    v_exp_f32 v93, v93
    v_exp_f32 v94, v94
    v_exp_f32 v95, v95
    v_cvt_pk_bf16_f32 v80, v80, v81
    v_cvt_pk_bf16_f32 v81, v82, v83
    v_cvt_pk_bf16_f32 v82, v84, v85
    v_cvt_pk_bf16_f32 v83, v86, v87
    v_cvt_pk_bf16_f32 v84, v88, v89
    v_cvt_pk_bf16_f32 v85, v90, v91
    v_cvt_pk_bf16_f32 v86, v92, v93
    v_cvt_pk_bf16_f32 v87, v94, v95
    s_waitcnt lgkmcnt(0)
    s_nop 1
    v_mfma_f32_32x32x16_bf16 v[96:111], v[224:227], v[80:83], v[96:111]
    v_mfma_f32_32x32x16_bf16 v[96:111], v[228:231], v[84:87], v[96:111]
    s_nop 15
    s_add_u32 s32, s32, 1
    s_cmp_le_u32 s32, s33
    s_cbranch_scc1 SL2L_top
    s_setpc_b64 s[28:29]
SLOWATTH:
    s_nop 15
    s_cmp_eq_u32 s12, 0
    s_cselect_b32 s32, 8, s31
    v_mov_b32 v244, 0xff800000
SL1H_top:
    s_lshl_b32 s33, s32, 12
    v_add_u32 v242, s33, v240
    v_add_u32 v243, s33, v241
    ds_read_b128 v[152:155], v242
    s_add_u32 s33, s31, 8
    s_waitcnt lgkmcnt(0)
    s_cmp_eq_u32 s32, s31
    s_cbranch_scc1 SL1H_a
    s_cmp_eq_u32 s32, s33
    s_cbranch_scc1 SL1H_d
    v_mfma_f32_32x32x16_bf16 v[80:95], v[152:155], v[156:159], 0
    s_branch SL1H_j
SL1H_a:
    v_mfma_f32_32x32x16_bf16 v[80:95], v[152:155], v[156:159], v[48:63]
    s_branch SL1H_j
SL1H_d:
    v_mfma_f32_32x32x16_bf16 v[80:95], v[152:155], v[156:159], v[32:47]
SL1H_j:
    s_nop 15
    v_max3_f32 v244, v80, v81, v244
    v_max3_f32 v244, v82, v83, v244
    v_max3_f32 v244, v84, v85, v244
    v_max3_f32 v244, v86, v87, v244
    v_max3_f32 v244, v88, v89, v244
    v_max3_f32 v244, v90, v91, v244
    v_max3_f32 v244, v92, v93, v244
    v_max3_f32 v244, v94, v95, v244
    s_add_u32 s32, s32, 1
    s_cmp_le_u32 s32, s33
    s_cbranch_scc1 SL1H_top
    v_mov_b32 v245, v244
    s_nop 1
    v_permlane32_swap_b32 v244, v245
    v_max_f32 v244, v244, v245
    s_cmp_eq_u32 s12, 0
    s_cselect_b32 s32, 8, s31
    v_mov_b32 v176, 0
    v_mov_b32 v177, 0
    v_mov_b32 v178, 0
    v_mov_b32 v179, 0
    v_mov_b32 v180, 0
    v_mov_b32 v181, 0
    v_mov_b32 v182, 0
    v_mov_b32 v183, 0
    v_mov_b32 v184, 0
    v_mov_b32 v185, 0
    v_mov_b32 v186, 0
    v_mov_b32 v187, 0
    v_mov_b32 v188, 0
    v_mov_b32 v189, 0
    v_mov_b32 v190, 0
    v_mov_b32 v191, 0
    v_mov_b32 v224, 0x3f803f80
    v_mov_b32 v225, 0x3f803f80
    v_mov_b32 v226, 0x3f803f80
    v_mov_b32 v227, 0x3f803f80
    v_mov_b32 v228, 0x3f803f80
    v_mov_b32 v229, 0x3f803f80
    v_mov_b32 v230, 0x3f803f80
    v_mov_b32 v231, 0x3f803f80
SL2H_top:
    s_lshl_b32 s33, s32, 12
    v_add_u32 v242, s33, v240
    v_add_u32 v243, s33, v241
    ds_read_b128 v[152:155], v242
    s_add_u32 s33, s31, 8
    s_waitcnt lgkmcnt(0)
    s_cmp_eq_u32 s32, s31
    s_cbranch_scc1 SL2H_a
    s_cmp_eq_u32 s32, s33
    s_cbranch_scc1 SL2H_d
    v_mfma_f32_32x32x16_bf16 v[80:95], v[152:155], v[156:159], 0
    s_branch SL2H_j
SL2H_a:
    v_mfma_f32_32x32x16_bf16 v[80:95], v[152:155], v[156:159], v[48:63]
    s_branch SL2H_j
SL2H_d:
    v_mfma_f32_32x32x16_bf16 v[80:95], v[152:155], v[156:159], v[32:47]
SL2H_j:
    s_nop 15
    s_mov_b64 exec, s[20:21]
    ds_read_b128 v[224:227], v243
    ds_read_b128 v[228:231], v243 offset:1024
    s_mov_b64 exec, -1
    v_sub_f32 v80, v80, v244
    v_sub_f32 v81, v81, v244
    v_sub_f32 v82, v82, v244
    v_sub_f32 v83, v83, v244
    v_sub_f32 v84, v84, v244
    v_sub_f32 v85, v85, v244
    v_sub_f32 v86, v86, v244
    v_sub_f32 v87, v87, v244
    v_sub_f32 v88, v88, v244
    v_sub_f32 v89, v89, v244
    v_sub_f32 v90, v90, v244
    v_sub_f32 v91, v91, v244
    v_sub_f32 v92, v92, v244
    v_sub_f32 v93, v93, v244
    v_sub_f32 v94, v94, v244
    v_sub_f32 v95, v95, v244
    v_exp_f32 v80, v80
    v_exp_f32 v81, v81
    v_exp_f32 v82, v82
    v_exp_f32 v83, v83
    v_exp_f32 v84, v84
    v_exp_f32 v85, v85
    v_exp_f32 v86, v86
    v_exp_f32 v87, v87
    v_exp_f32 v88, v88
    v_exp_f32 v89, v89
    v_exp_f32 v90, v90
    v_exp_f32 v91, v91
    v_exp_f32 v92, v92
    v_exp_f32 v93, v93
    v_exp_f32 v94, v94
    v_exp_f32 v95, v95
    v_cvt_pk_bf16_f32 v80, v80, v81
    v_cvt_pk_bf16_f32 v81, v82, v83
    v_cvt_pk_bf16_f32 v82, v84, v85
    v_cvt_pk_bf16_f32 v83, v86, v87
    v_cvt_pk_bf16_f32 v84, v88, v89
    v_cvt_pk_bf16_f32 v85, v90, v91
    v_cvt_pk_bf16_f32 v86, v92, v93
    v_cvt_pk_bf16_f32 v87, v94, v95
    s_waitcnt lgkmcnt(0)
    s_nop 1
    v_mfma_f32_32x32x16_bf16 v[176:191], v[224:227], v[80:83], v[176:191]
    v_mfma_f32_32x32x16_bf16 v[176:191], v[228:231], v[84:87], v[176:191]
    s_nop 15
    s_add_u32 s32, s32, 1
    s_cmp_le_u32 s32, s33
    s_cbranch_scc1 SL2H_top
    s_setpc_b64 s[28:29]
M_last:
.section .rodata,"a"
.p2align 6
.amdhsa_kernel interleave_layers__sliding_block__glu_gated_bilinear__prompt_kernel
  .amdhsa_next_free_vgpr 512
  .amdhsa_next_free_sgpr 102
  .amdhsa_accum_offset 256
  .amdhsa_group_segment_fixed_size 0
  .amdhsa_kernarg_size 80
  .amdhsa_user_sgpr_count 2
  .amdhsa_user_sgpr_kernarg_segment_ptr 1
  .amdhsa_system_sgpr_workgroup_id_x 1
.end_amdhsa_kernel
```
